```python
import torch

def _softmax(x, axis=-1):
    return torch.softmax(x, dim=axis)
def _gelu(x):
    return torch.nn.functional.gelu(x, approximate="tanh")
def _silu(x):
    return torch.nn.functional.silu(x)
def _sigmoid(x):
    return torch.sigmoid(x)
def _layernorm(x, axis=-1, eps=1e-5):
    m = x.mean(dim=axis, keepdim=True)
    v = x.var(dim=axis, keepdim=True, unbiased=False)
    return (x - m) / torch.sqrt(v + eps)
def _scatter_add(tgt, idx, src, axis=0):
    return tgt.clone().index_add_(axis, idx, src)
def _segment_sum(src, seg, n):
    out = torch.zeros((n,) + src.shape[1:], dtype=src.dtype)
    return out.index_add_(0, seg, src)
def _pad(x, pw):
    flat = tuple(v for pair in reversed(pw) for v in pair)
    return torch.nn.functional.pad(x, flat)

kernel_name = 'standalone__cross_network_dcn__recsys'

def setup_inputs():

    _w = (lambda a: (lambda t: t.to(torch.bfloat16) if t.is_floating_point() else t)(torch.as_tensor(a)))
    B, F, D, L = 16384, 100, 16, 6
    Din = min(F * D, 1024)
    return {
        "x0": _w((lambda *s: torch.randn(*s, dtype=torch.bfloat16) * 0.05)(B, Din)),
        "ws": _w((lambda *s: torch.randn(*s, dtype=torch.bfloat16) * 0.8)(L, Din, Din) * (Din ** -0.5)),
        "bs": _w((lambda *s: torch.randn(*s, dtype=torch.bfloat16) * 3.2)(L, Din) * 0.01),
    }

def reference(x0, ws, bs):
    x = x0
    L = ws.shape[0]
    for l in range(L):
        proj = torch.einsum('bd,de->be', x, ws[l]) + bs[l]
        x = x0 * proj + x
    return x
```

```asm
; @launch grid=(256,1,1) block=(256,1,1) lds=163840
.amdgcn_target "amdgcn-amd-amdhsa--gfx950"
.text
.globl standalone__cross_network_dcn__recsys_kernel
.p2align 8
.type standalone__cross_network_dcn__recsys_kernel,@function
standalone__cross_network_dcn__recsys_kernel:
s_cmp_ge_u32 s2, 256
s_cbranch_scc1 L_done
s_load_dwordx4 s[4:7], s[0:1], 0
s_load_dwordx4 s[56:59], s[0:1], 16
s_load_dwordx4 s[60:63], s[0:1], 32
s_getpc_b64 s[8:9]
s_mov_b32 s10, L_codeend - .
s_mov_b32 s11, 0x00020000
s_lshr_b32 s12, s2, 3
s_lshl_b32 s12, s12, 7
v_and_b32 v9, 31, v0
v_lshlrev_b32 v9, 12, v9
buffer_load_dword v250, v9, s[8:11], s12 offen
v_lshrrev_b32 v1, 6, v0
v_and_b32 v2, 63, v0
v_readfirstlane_b32 s48, v1
v_lshrrev_b32 v5, 2, v2
v_and_b32 v7, 3, v2
v_lshlrev_b32 v6, 11, v5
v_lshl_add_u32 v254, v7, 4, v6
v_and_b32 v5, 7, v5
v_lshrrev_b32 v6, 1, v5
v_xor_b32 v6, v6, v7
v_lshlrev_b32 v5, 11, v5
v_lshl_add_u32 v5, v6, 4, v5
v_lshrrev_b32 v6, 5, v2
v_lshl_add_u32 v255, v6, 6, v5
s_and_b32 s3, s2, 1
s_lshr_b32 s37, s2, 1
s_lshl_b32 s37, s37, 18
s_lshl_b32 s42, s3, 2
s_add_u32 s42, s42, s48
s_xor_b32 s3, s3, 1
s_lshl_b32 s43, s3, 10
s_add_u32 s32, s37, s43
s_lshl_b32 s43, s48, 16
s_add_u32 s32, s32, s43
s_lshl_b32 s43, s42, 8
s_add_u32 s37, s37, s43
s_lshl_b32 s38, s3, 20
s_add_u32 s38, s38, s43
s_mov_b32 s21, s43
s_lshl_b32 s34, s48, 12
s_lshl_b32 s39, s48, 13
s_add_u32 s39, s39, 98304
s_waitcnt lgkmcnt(0)
s_mov_b32 s12, s4
s_mov_b32 s13, s5
s_mov_b32 s14, 0x2000000
s_mov_b32 s15, 0x00020000
s_mov_b32 s52, s6
s_mov_b32 s53, s7
s_mov_b32 s54, 0xc00000
s_mov_b32 s55, 0x00020000
s_lshl_b32 s4, s2, 2
s_add_u32 s4, s4, s48
s_lshr_b32 s5, s4, 7
s_lshr_b32 s6, s4, 2
s_and_b32 s6, s6, 31
s_and_b32 s7, s4, 3
s_lshl_b32 s40, s6, 16
s_lshl_b32 s43, s5, 8
s_add_u32 s40, s40, s43
s_lshl_b32 s43, s7, 6
s_add_u32 s40, s40, s43
s_add_u32 m0, s39, 4294934528
s_nop 0
buffer_load_dwordx4 v254, s[52:55], s40 offen  lds
s_add_u32 s40, s40, 32768
s_add_u32 m0, s39, 4294935552
s_nop 0
buffer_load_dwordx4 v254, s[52:55], s40 offen  lds
s_add_u32 s40, s40, 2064384
s_lshr_b32 s43, s2, 3
s_mul_i32 s43, s43, 8192
s_and_b32 s20, s38, 0x100400
s_add_u32 s43, s43, s20
v_lshrrev_b32 v9, 3, v2
v_min_u32 v9, 3, v9
v_lshlrev_b32 v9, 11, v9
v_and_b32 v10, 7, v2
v_lshl_add_u32 v9, v10, 7, v9
buffer_load_dword v251, v9, s[52:55], s43 offen
s_add_u32 m0, s34, 0
s_nop 0
buffer_load_dwordx4 v255, s[12:15], s32 offen  lds
s_add_u32 s32, s32, 16384
s_add_u32 m0, s34, 1024
s_nop 0
buffer_load_dwordx4 v255, s[12:15], s32 offen  lds
s_add_u32 s32, s32, 16384
s_add_u32 m0, s34, 2048
s_nop 0
buffer_load_dwordx4 v255, s[12:15], s32 offen  lds
s_add_u32 s32, s32, 16384
s_add_u32 m0, s34, 3072
s_nop 0
buffer_load_dwordx4 v255, s[12:15], s32 offen  lds
s_add_u32 s32, s32, 4294918272
s_add_u32 m0, s34, 16384
s_nop 0
buffer_load_dwordx4 v255, s[12:15], s32 offen  lds
s_add_u32 s32, s32, 16384
s_add_u32 m0, s34, 17408
s_nop 0
buffer_load_dwordx4 v255, s[12:15], s32 offen  lds
s_add_u32 s32, s32, 16384
s_add_u32 m0, s34, 18432
s_nop 0
buffer_load_dwordx4 v255, s[12:15], s32 offen  lds
s_add_u32 s32, s32, 16384
s_add_u32 m0, s34, 19456
s_nop 0
buffer_load_dwordx4 v255, s[12:15], s32 offen  lds
s_add_u32 s32, s32, 4294918272
s_mov_b32 s46, s58
s_mov_b32 s47, s59
s_mov_b32 s44, s62
s_mov_b32 s45, s63
s_mov_b32 s58, 0x3000
s_mov_b32 s59, 0x00020000
s_mov_b32 s62, 256
s_mov_b32 s63, 0x00020000
s_mov_b32 s8, s44
s_mov_b32 s9, s45
s_mov_b32 s10, 0x10000000
s_mov_b32 s11, 0x00020000
s_mov_b32 s16, s44
s_mov_b32 s17, s45
s_mov_b32 s18, 33685504
s_mov_b32 s19, 0x00020000
s_lshl_b32 s23, s2, 8
s_add_u32 s23, s23, 17825792
s_xor_b32 s24, s23, 256
s_lshl_b32 s43, s48, 2
s_add_u32 s50, s23, s43
s_add_u32 s50, s50, 65536
s_lshl_b32 s43, s48, 4
s_add_u32 s23, s23, s43
s_lshl_b32 s51, s42, 13
s_add_u32 s51, s51, 17891328
v_mov_b32 v8, 0
buffer_store_dword v8, off, s[8:11], s23 sc1
buffer_store_dword v8, off, s[8:11], s50 sc1
s_lshr_b32 s41, s6, 2
s_sub_u32 s41, s41, s5
s_and_b32 s41, s41, 3
s_lshl_b32 s41, s41, 2
s_and_b32 s43, s6, 3
s_add_u32 s41, s41, s43
s_lshl_b32 s43, s43, 2
s_lshr_b32 s29, s6, 2
s_and_b32 s29, s29, 3
s_add_u32 s43, s43, s29
s_add_u32 s43, s43, 16
s_lshr_b32 s29, s5, 2
s_lshl_b32 s64, s29, 4
s_xor_b32 s64, s64, s6
s_xor_b32 s64, s64, 16
s_sub_u32 s65, s64, 4
s_cmp_lt_u32 s65, 4
s_cselect_b32 s65, 1, 0
s_cmp_eq_u32 s48, 0
s_cselect_b32 s65, s65, 2
s_lshr_b32 s6, s6, 4
s_cmp_eq_u32 s29, s6
s_cselect_b32 s41, s41, s43
s_and_b32 s43, s64, 1
s_lshl_b32 s43, s43, 10
s_lshr_b32 s64, s64, 1
s_lshl_b32 s64, s64, 14
s_add_u32 s64, s64, s43
s_and_b32 s43, s41, 1
s_lshl_b32 s43, s43, 10
s_lshr_b32 s41, s41, 1
s_lshl_b32 s41, s41, 14
s_add_u32 s41, s41, s43
s_lshl_b32 s43, s7, 12
s_add_u32 s41, s41, s43
s_add_u32 s64, s64, s43
s_lshl_b32 s43, s5, 21
s_add_u32 s41, s41, s43
s_add_u32 s64, s64, s43
s_add_u32 s41, s41, 262144
s_mov_b32 s29, 0
s_lshl_b32 s20, s42, 21
s_add_u32 s20, s20, 32768
s_mov_b32 s22, 0
s_mov_b32 s49, 0
s_mov_b32 s36, 0
s_mov_b32 s35, 0
s_and_b32 s6, s48, 1
s_lshl_b32 s6, s6, 15
s_mov_b32 s100, 0
s_mov_b32 s101, 0x8000
s_and_b32 s67, s2, 0xe0
s_lshr_b32 s67, s67, 1
s_lshl_b32 s3, s42, 4
s_add_u32 s25, s48, 0
s_and_b32 s25, s25, 3
s_lshl_b32 s25, s25, 15
s_add_u32 s26, s48, 1
s_and_b32 s26, s26, 3
s_lshl_b32 s26, s26, 15
s_add_u32 s27, s48, 2
s_and_b32 s27, s27, 3
s_lshl_b32 s27, s27, 15
s_add_u32 s28, s48, 3
s_and_b32 s28, s28, 3
s_lshl_b32 s28, s28, 15
s_xor_b32 s33, s2, 1
s_add_u32 s33, s33, 1
s_mul_i32 s33, s33, 131072
s_add_u32 s33, s33, s34
s_add_u32 s31, s2, 1
s_mul_i32 s31, s31, 131072
s_sub_u32 s31, s31, s25
s_lshr_b32 s43, s48, 1
s_lshl_b32 s43, s43, 14
s_add_u32 s31, s31, s43
s_and_b32 s43, s48, 1
s_lshl_b32 s43, s43, 9
s_add_u32 s31, s31, s43
v_lshrrev_b32 v4, 4, v2
v_and_b32 v3, 7, v2
v_lshrrev_b32 v6, 1, v3
v_xor_b32 v6, v6, v4
v_lshlrev_b32 v6, 4, v6
v_lshl_add_u32 v6, v3, 6, v6
v_and_b32 v3, 8, v2
v_lshl_add_u32 v252, v3, 7, v6
v_and_b32 v5, 15, v2
v_lshlrev_b32 v5, 4, v5
v_lshl_add_u32 v5, v4, 9, v5
v_add_u32 v253, s39, v5
v_subrev_u32 v248, 0x8000, v253
v_lshlrev_b32 v249, 4, v2
v_mov_b32 v5, 0x3f80
v_mov_b32 v6, 0x3f800000
v_cmp_eq_u32 vcc, 0, v7
s_nop 1
v_cndmask_b32 v9, 0, v5, vcc
v_cmp_eq_u32 vcc, 1, v7
s_nop 1
v_cndmask_b32 v9, v9, v6, vcc
v_cmp_eq_u32 vcc, 2, v7
s_nop 1
v_cndmask_b32 v10, 0, v5, vcc
v_cmp_eq_u32 vcc, 3, v7
s_nop 1
v_cndmask_b32 v10, v10, v6, vcc
v_accvgpr_write_b32 a252, v9
v_accvgpr_write_b32 a253, v10
v_cmp_eq_u32 vcc, 0, v4
s_nop 1
v_cndmask_b32 v9, 0, v5, vcc
v_cmp_eq_u32 vcc, 3, v4
s_nop 1
v_cndmask_b32 v9, v9, v5, vcc
v_accvgpr_write_b32 a254, v9
s_waitcnt vmcnt(11)
ds_read_b64_tr_b16 v[240:241], v248 offset:0
ds_read_b64_tr_b16 v[242:243], v248 offset:256
ds_read_b64_tr_b16 v[244:245], v248 offset:8
ds_read_b64_tr_b16 v[246:247], v248 offset:264
s_waitcnt lgkmcnt(2)
buffer_store_dwordx4 v[240:243], v249, s[8:11], s64 offen offset:0 sc1
s_waitcnt lgkmcnt(0)
buffer_store_dwordx4 v[244:247], v249, s[8:11], s64 offen offset:2048 sc1
s_add_u32 m0, s39, 0
s_nop 0
buffer_load_dwordx4 v254, s[52:55], s38 offen lds
s_add_u32 s38, s38, 32768
s_add_u32 m0, s39, 1024
s_nop 0
buffer_load_dwordx4 v254, s[52:55], s38 offen lds
s_add_u32 s38, s38, 32768
s_add_u32 m0, s39, 2048
s_nop 0
buffer_load_dwordx4 v254, s[52:55], s38 offen lds
s_add_u32 s38, s38, 32768
s_add_u32 m0, s39, 3072
s_nop 0
buffer_load_dwordx4 v254, s[52:55], s38 offen lds
s_add_u32 s38, s38, 4294869056
s_add_u32 m0, s39, 4096
s_nop 0
buffer_load_dwordx4 v254, s[52:55], s38 offen lds
s_add_u32 s38, s38, 32768
s_add_u32 m0, s39, 5120
s_nop 0
buffer_load_dwordx4 v254, s[52:55], s38 offen lds
s_add_u32 s38, s38, 32768
s_add_u32 m0, s39, 6144
s_nop 0
buffer_load_dwordx4 v254, s[52:55], s38 offen lds
s_add_u32 s38, s38, 32768
s_add_u32 m0, s39, 7168
s_nop 0
buffer_load_dwordx4 v254, s[52:55], s38 offen lds
s_add_u32 s38, s38, 4294869056
s_add_u32 m0, s39, 32768
s_nop 0
buffer_load_dwordx4 v254, s[52:55], s38 offen lds
s_add_u32 s38, s38, 32768
s_add_u32 m0, s39, 33792
s_nop 0
buffer_load_dwordx4 v254, s[52:55], s38 offen lds
s_add_u32 s38, s38, 32768
s_add_u32 m0, s39, 34816
s_nop 0
buffer_load_dwordx4 v254, s[52:55], s38 offen lds
s_add_u32 s38, s38, 32768
s_add_u32 m0, s39, 35840
s_nop 0
buffer_load_dwordx4 v254, s[52:55], s38 offen lds
s_add_u32 s38, s38, 4294869056
s_add_u32 m0, s39, 36864
s_nop 0
buffer_load_dwordx4 v254, s[52:55], s38 offen lds
s_add_u32 s38, s38, 32768
s_add_u32 m0, s39, 37888
s_nop 0
buffer_load_dwordx4 v254, s[52:55], s38 offen lds
s_add_u32 s38, s38, 32768
s_add_u32 m0, s39, 38912
s_nop 0
buffer_load_dwordx4 v254, s[52:55], s38 offen lds
s_add_u32 s38, s38, 32768
s_add_u32 m0, s39, 39936
s_nop 0
buffer_load_dwordx4 v254, s[52:55], s38 offen lds
s_add_u32 s38, s38, 32576
s_and_b32 s38, s38, 0x1fffff
s_waitcnt vmcnt(24)
s_barrier
ds_read_b128 a[144:147], v252 offset:0
ds_read_b128 a[148:151], v252 offset:512
ds_read_b128 a[152:155], v252 offset:2048
ds_read_b128 a[156:159], v252 offset:2560
ds_read_b128 a[160:163], v252 offset:4096
ds_read_b128 a[164:167], v252 offset:4608
ds_read_b128 a[168:171], v252 offset:6144
ds_read_b128 a[172:175], v252 offset:6656
ds_read_b128 a[176:179], v252 offset:8192
ds_read_b128 a[180:183], v252 offset:8704
ds_read_b128 a[184:187], v252 offset:10240
ds_read_b128 a[188:191], v252 offset:10752
ds_read_b128 a[192:195], v252 offset:12288
ds_read_b128 a[196:199], v252 offset:12800
ds_read_b128 a[200:203], v252 offset:14336
ds_read_b128 a[204:207], v252 offset:14848
s_waitcnt vmcnt(12)
ds_read_b64_tr_b16 a[208:209], v253 offset:0
ds_read_b64_tr_b16 a[210:211], v253 offset:256
ds_read_b64_tr_b16 a[212:213], v253 offset:2048
ds_read_b64_tr_b16 a[214:215], v253 offset:2304
ds_read_b64_tr_b16 a[216:217], v253 offset:8
ds_read_b64_tr_b16 a[218:219], v253 offset:264
ds_read_b64_tr_b16 a[220:221], v253 offset:2056
ds_read_b64_tr_b16 a[222:223], v253 offset:2312
s_waitcnt lgkmcnt(4)
v_mfma_f32_16x16x32_bf16 v[0:3], a[208:211], a[144:147], 1.0
s_waitcnt vmcnt(8)
ds_read_b64_tr_b16 a[224:225], v253 offset:4096
ds_read_b64_tr_b16 a[232:233], v253 offset:4104
v_mfma_f32_16x16x32_bf16 v[0:3], a[212:215], a[148:151], v[0:3]
ds_read_b64_tr_b16 a[226:227], v253 offset:4352
ds_read_b64_tr_b16 a[234:235], v253 offset:4360
v_mfma_f32_16x16x32_bf16 v[4:7], a[208:211], a[152:155], 1.0
ds_read_b64_tr_b16 a[228:229], v253 offset:6144
ds_read_b64_tr_b16 a[236:237], v253 offset:6152
v_mfma_f32_16x16x32_bf16 v[4:7], a[212:215], a[156:159], v[4:7]
s_add_u32 m0, s39, 0
ds_read_b64_tr_b16 a[230:231], v253 offset:6400
ds_read_b64_tr_b16 a[238:239], v253 offset:6408
v_mfma_f32_16x16x32_bf16 v[8:11], a[208:211], a[160:163], 1.0
s_waitcnt lgkmcnt(8)
buffer_load_dwordx4 v254, s[52:55], s38 offen lds
v_mfma_f32_16x16x32_bf16 v[8:11], a[212:215], a[164:167], v[8:11]
s_add_u32 s38, s38, 32768
v_mfma_f32_16x16x32_bf16 v[12:15], a[208:211], a[168:171], 1.0
s_add_u32 m0, s39, 1024
v_mfma_f32_16x16x32_bf16 v[12:15], a[212:215], a[172:175], v[12:15]
buffer_load_dwordx4 v254, s[52:55], s38 offen lds
v_mfma_f32_16x16x32_bf16 v[16:19], a[208:211], a[176:179], 1.0
s_add_u32 s38, s38, 32768
v_mfma_f32_16x16x32_bf16 v[16:19], a[212:215], a[180:183], v[16:19]
s_add_u32 m0, s39, 2048
v_mfma_f32_16x16x32_bf16 v[20:23], a[208:211], a[184:187], 1.0
buffer_load_dwordx4 v254, s[52:55], s38 offen lds
v_mfma_f32_16x16x32_bf16 v[20:23], a[212:215], a[188:191], v[20:23]
s_add_u32 s38, s38, 32768
v_mfma_f32_16x16x32_bf16 v[24:27], a[208:211], a[192:195], 1.0
s_add_u32 m0, s39, 3072
v_mfma_f32_16x16x32_bf16 v[24:27], a[212:215], a[196:199], v[24:27]
buffer_load_dwordx4 v254, s[52:55], s38 offen lds
v_mfma_f32_16x16x32_bf16 v[28:31], a[208:211], a[200:203], 1.0
s_add_u32 s38, s38, 4294869056
v_mfma_f32_16x16x32_bf16 v[28:31], a[212:215], a[204:207], v[28:31]
v_mov_b32 v248, 1
v_mfma_f32_16x16x32_bf16 v[60:63], a[216:219], a[200:203], 1.0
s_waitcnt vmcnt(8)
ds_read_b64_tr_b16 a[240:241], v253 offset:32768
v_mfma_f32_16x16x32_bf16 v[60:63], a[220:223], a[204:207], v[60:63]
s_barrier
ds_read_b64_tr_b16 a[242:243], v253 offset:33024
v_mfma_f32_16x16x32_bf16 v[56:59], a[216:219], a[192:195], 1.0
ds_read_b64_tr_b16 a[244:245], v253 offset:34816
s_cmp_lg_u32 s65, 1
s_cbranch_scc1 L_nosig
s_mov_b64 exec, 1
buffer_atomic_add v248, off, s[60:63], s67 offset:0 sc1
s_mov_b64 exec, -1
L_nosig:
v_mfma_f32_16x16x32_bf16 v[56:59], a[220:223], a[196:199], v[56:59]
s_add_u32 m0, s39, 4096
ds_read_b64_tr_b16 a[246:247], v253 offset:35072
s_cmp_lg_u32 s65, 0
s_cbranch_scc1 L_nosig2
s_mov_b64 exec, 1
buffer_atomic_add v248, off, s[60:63], s67 offset:128 sc1
s_mov_b64 exec, -1
L_nosig2:
v_mfma_f32_16x16x32_bf16 v[52:55], a[216:219], a[184:187], 1.0
s_waitcnt lgkmcnt(4)
buffer_load_dwordx4 v254, s[52:55], s38 offen lds
v_mfma_f32_16x16x32_bf16 v[52:55], a[220:223], a[188:191], v[52:55]
s_add_u32 s38, s38, 32768
v_mfma_f32_16x16x32_bf16 v[48:51], a[216:219], a[176:179], 1.0
s_add_u32 m0, s39, 5120
v_mfma_f32_16x16x32_bf16 v[48:51], a[220:223], a[180:183], v[48:51]
buffer_load_dwordx4 v254, s[52:55], s38 offen lds
v_mfma_f32_16x16x32_bf16 v[44:47], a[216:219], a[168:171], 1.0
s_add_u32 s38, s38, 32768
v_mfma_f32_16x16x32_bf16 v[44:47], a[220:223], a[172:175], v[44:47]
s_add_u32 m0, s39, 6144
v_mfma_f32_16x16x32_bf16 v[40:43], a[216:219], a[160:163], 1.0
buffer_load_dwordx4 v254, s[52:55], s38 offen lds
v_mfma_f32_16x16x32_bf16 v[40:43], a[220:223], a[164:167], v[40:43]
s_add_u32 s38, s38, 32768
v_mfma_f32_16x16x32_bf16 v[36:39], a[216:219], a[152:155], 1.0
s_add_u32 m0, s39, 7168
v_mfma_f32_16x16x32_bf16 v[36:39], a[220:223], a[156:159], v[36:39]
buffer_load_dwordx4 v254, s[52:55], s38 offen lds
v_mfma_f32_16x16x32_bf16 v[32:35], a[216:219], a[144:147], 1.0
s_add_u32 s38, s38, 4294869056
v_mfma_f32_16x16x32_bf16 v[32:35], a[220:223], a[148:151], v[32:35]
v_mfma_f32_16x16x32_bf16 v[64:67], a[224:227], a[144:147], 1.0
ds_read_b64_tr_b16 a[248:249], v253 offset:32776
v_mfma_f32_16x16x32_bf16 v[64:67], a[228:231], a[148:151], v[64:67]
ds_read_b64_tr_b16 a[250:251], v253 offset:33032
v_mfma_f32_16x16x32_bf16 v[68:71], a[224:227], a[152:155], 1.0
ds_read_b64_tr_b16 a[208:209], v253 offset:34824
v_mfma_f32_16x16x32_bf16 v[68:71], a[228:231], a[156:159], v[68:71]
ds_read_b64_tr_b16 a[210:211], v253 offset:35080
v_mfma_f32_16x16x32_bf16 v[72:75], a[224:227], a[160:163], 1.0
v_mfma_f32_16x16x32_bf16 v[72:75], a[228:231], a[164:167], v[72:75]
v_mfma_f32_16x16x32_bf16 v[76:79], a[224:227], a[168:171], 1.0
s_add_u32 m0, s39, 32768
v_mfma_f32_16x16x32_bf16 v[76:79], a[228:231], a[172:175], v[76:79]
s_waitcnt lgkmcnt(0)
buffer_load_dwordx4 v254, s[52:55], s38 offen lds
v_mfma_f32_16x16x32_bf16 v[80:83], a[224:227], a[176:179], 1.0
s_add_u32 s38, s38, 32768
v_mfma_f32_16x16x32_bf16 v[80:83], a[228:231], a[180:183], v[80:83]
s_add_u32 m0, s39, 33792
v_mfma_f32_16x16x32_bf16 v[84:87], a[224:227], a[184:187], 1.0
buffer_load_dwordx4 v254, s[52:55], s38 offen lds
v_mfma_f32_16x16x32_bf16 v[84:87], a[228:231], a[188:191], v[84:87]
s_add_u32 s38, s38, 32768
v_mfma_f32_16x16x32_bf16 v[88:91], a[224:227], a[192:195], 1.0
s_add_u32 m0, s39, 34816
v_mfma_f32_16x16x32_bf16 v[88:91], a[228:231], a[196:199], v[88:91]
buffer_load_dwordx4 v254, s[52:55], s38 offen lds
v_mfma_f32_16x16x32_bf16 v[92:95], a[224:227], a[200:203], 1.0
s_add_u32 s38, s38, 32768
v_mfma_f32_16x16x32_bf16 v[92:95], a[228:231], a[204:207], v[92:95]
v_mfma_f32_16x16x32_bf16 v[124:127], a[232:235], a[200:203], 1.0
s_waitcnt vmcnt(11)
ds_read_b64_tr_b16 a[212:213], v253 offset:36864
v_mfma_f32_16x16x32_bf16 v[124:127], a[236:239], a[204:207], v[124:127]
ds_read_b64_tr_b16 a[214:215], v253 offset:37120
v_mfma_f32_16x16x32_bf16 v[120:123], a[232:235], a[192:195], 1.0
ds_read_b64_tr_b16 a[216:217], v253 offset:38912
v_mfma_f32_16x16x32_bf16 v[120:123], a[236:239], a[196:199], v[120:123]
s_add_u32 m0, s39, 35840
ds_read_b64_tr_b16 a[218:219], v253 offset:39168
v_mfma_f32_16x16x32_bf16 v[116:119], a[232:235], a[184:187], 1.0
buffer_load_dwordx4 v254, s[52:55], s38 offen lds
v_mfma_f32_16x16x32_bf16 v[116:119], a[236:239], a[188:191], v[116:119]
s_add_u32 s38, s38, 4294869056
v_mfma_f32_16x16x32_bf16 v[112:115], a[232:235], a[176:179], 1.0
v_mfma_f32_16x16x32_bf16 v[112:115], a[236:239], a[180:183], v[112:115]
v_mfma_f32_16x16x32_bf16 v[108:111], a[232:235], a[168:171], 1.0
v_mfma_f32_16x16x32_bf16 v[108:111], a[236:239], a[172:175], v[108:111]
v_mfma_f32_16x16x32_bf16 v[104:107], a[232:235], a[160:163], 1.0
v_mfma_f32_16x16x32_bf16 v[104:107], a[236:239], a[164:167], v[104:107]
s_add_u32 m0, s34, 32768
v_mfma_f32_16x16x32_bf16 v[100:103], a[232:235], a[152:155], 1.0
buffer_load_dwordx4 v255, s[12:15], s32 offen  lds
v_mfma_f32_16x16x32_bf16 v[100:103], a[236:239], a[156:159], v[100:103]
s_add_u32 s32, s32, 16384
v_mfma_f32_16x16x32_bf16 v[96:99], a[232:235], a[144:147], 1.0
v_mfma_f32_16x16x32_bf16 v[96:99], a[236:239], a[148:151], v[96:99]
v_mfma_f32_16x16x32_bf16 v[128:131], a[240:243], a[144:147], 1.0
ds_read_b64_tr_b16 a[220:221], v253 offset:36872
v_mfma_f32_16x16x32_bf16 v[128:131], a[244:247], a[148:151], v[128:131]
ds_read_b64_tr_b16 a[222:223], v253 offset:37128
v_mfma_f32_16x16x32_bf16 v[132:135], a[240:243], a[152:155], 1.0
ds_read_b64_tr_b16 a[224:225], v253 offset:38920
v_mfma_f32_16x16x32_bf16 v[132:135], a[244:247], a[156:159], v[132:135]
ds_read_b64_tr_b16 a[226:227], v253 offset:39176
v_mfma_f32_16x16x32_bf16 v[136:139], a[240:243], a[160:163], 1.0
v_mfma_f32_16x16x32_bf16 v[136:139], a[244:247], a[164:167], v[136:139]
v_mfma_f32_16x16x32_bf16 v[140:143], a[240:243], a[168:171], 1.0
s_add_u32 m0, s39, 36864
v_mfma_f32_16x16x32_bf16 v[140:143], a[244:247], a[172:175], v[140:143]
s_waitcnt lgkmcnt(0)
buffer_load_dwordx4 v254, s[52:55], s38 offen lds
v_mfma_f32_16x16x32_bf16 v[144:147], a[240:243], a[176:179], 1.0
s_add_u32 s38, s38, 32768
v_mfma_f32_16x16x32_bf16 v[144:147], a[244:247], a[180:183], v[144:147]
s_add_u32 m0, s39, 37888
v_mfma_f32_16x16x32_bf16 v[148:151], a[240:243], a[184:187], 1.0
buffer_load_dwordx4 v254, s[52:55], s38 offen lds
v_mfma_f32_16x16x32_bf16 v[148:151], a[244:247], a[188:191], v[148:151]
s_add_u32 s38, s38, 32768
v_mfma_f32_16x16x32_bf16 v[152:155], a[240:243], a[192:195], 1.0
s_add_u32 m0, s39, 38912
v_mfma_f32_16x16x32_bf16 v[152:155], a[244:247], a[196:199], v[152:155]
buffer_load_dwordx4 v254, s[52:55], s38 offen lds
v_mfma_f32_16x16x32_bf16 v[156:159], a[240:243], a[200:203], 1.0
s_add_u32 s38, s38, 32768
v_mfma_f32_16x16x32_bf16 v[156:159], a[244:247], a[204:207], v[156:159]
v_mfma_f32_16x16x32_bf16 v[188:191], a[248:251], a[200:203], 1.0
s_waitcnt vmcnt(12)
ds_read_b64_tr_b16 a[228:229], v253 offset:0
v_mfma_f32_16x16x32_bf16 v[188:191], a[208:211], a[204:207], v[188:191]
ds_read_b64_tr_b16 a[230:231], v253 offset:256
v_mfma_f32_16x16x32_bf16 v[184:187], a[248:251], a[192:195], 1.0
ds_read_b64_tr_b16 a[232:233], v253 offset:2048
v_mfma_f32_16x16x32_bf16 v[184:187], a[208:211], a[196:199], v[184:187]
s_add_u32 m0, s34, 33792
ds_read_b64_tr_b16 a[234:235], v253 offset:2304
v_mfma_f32_16x16x32_bf16 v[180:183], a[248:251], a[184:187], 1.0
buffer_load_dwordx4 v255, s[12:15], s32 offen  lds
v_mfma_f32_16x16x32_bf16 v[180:183], a[208:211], a[188:191], v[180:183]
s_add_u32 s32, s32, 16384
s_add_u32 m0, s39, 39936
v_mfma_f32_16x16x32_bf16 v[176:179], a[248:251], a[176:179], 1.0
buffer_load_dwordx4 v254, s[52:55], s38 offen lds
v_mfma_f32_16x16x32_bf16 v[176:179], a[208:211], a[180:183], v[176:179]
s_add_u32 s38, s38, 32576
s_and_b32 s38, s38, 0x1fffff
v_mov_b32 v250, v254
v_mov_b32 v251, v253
v_mfma_f32_16x16x32_bf16 v[172:175], a[248:251], a[168:171], 1.0
v_mbcnt_lo_u32_b32 v254, -1, 0
v_mfma_f32_16x16x32_bf16 v[172:175], a[208:211], a[172:175], v[172:175]
s_barrier
v_mbcnt_hi_u32_b32 v254, -1, v254
v_mfma_f32_16x16x32_bf16 v[168:171], a[248:251], a[160:163], 1.0
v_lshlrev_b32 v254, 4, v254
v_mfma_f32_16x16x32_bf16 v[168:171], a[208:211], a[164:167], v[168:171]
v_mfma_f32_16x16x32_bf16 v[164:167], a[248:251], a[152:155], 1.0
v_mfma_f32_16x16x32_bf16 v[164:167], a[208:211], a[156:159], v[164:167]
v_mfma_f32_16x16x32_bf16 v[160:163], a[248:251], a[144:147], 1.0
v_mfma_f32_16x16x32_bf16 v[160:163], a[208:211], a[148:151], v[160:163]
buffer_load_dword v244, off, s[60:63], s3 offset:0 sc1
v_mfma_f32_16x16x32_bf16 v[192:195], a[212:215], a[144:147], 1.0
ds_read_b64_tr_b16 a[236:237], v253 offset:8
v_mfma_f32_16x16x32_bf16 v[192:195], a[216:219], a[148:151], v[192:195]
ds_read_b64_tr_b16 a[238:239], v253 offset:264
v_mfma_f32_16x16x32_bf16 v[196:199], a[212:215], a[152:155], 1.0
ds_read_b64_tr_b16 a[240:241], v253 offset:2056
v_mfma_f32_16x16x32_bf16 v[196:199], a[216:219], a[156:159], v[196:199]
ds_read_b64_tr_b16 a[242:243], v253 offset:2312
v_mfma_f32_16x16x32_bf16 v[200:203], a[212:215], a[160:163], 1.0
v_mfma_f32_16x16x32_bf16 v[200:203], a[216:219], a[164:167], v[200:203]
v_mfma_f32_16x16x32_bf16 v[204:207], a[212:215], a[168:171], 1.0
v_mfma_f32_16x16x32_bf16 v[204:207], a[216:219], a[172:175], v[204:207]
v_mfma_f32_16x16x32_bf16 v[208:211], a[212:215], a[176:179], 1.0
v_mfma_f32_16x16x32_bf16 v[208:211], a[216:219], a[180:183], v[208:211]
v_mfma_f32_16x16x32_bf16 v[212:215], a[212:215], a[184:187], 1.0
v_mfma_f32_16x16x32_bf16 v[212:215], a[216:219], a[188:191], v[212:215]
s_add_u32 m0, s34, 34816
v_mfma_f32_16x16x32_bf16 v[216:219], a[212:215], a[192:195], 1.0
buffer_load_dwordx4 v255, s[12:15], s32 offen  lds
v_mfma_f32_16x16x32_bf16 v[216:219], a[216:219], a[196:199], v[216:219]
s_add_u32 s32, s32, 16384
v_mfma_f32_16x16x32_bf16 v[220:223], a[212:215], a[200:203], 1.0
v_mfma_f32_16x16x32_bf16 v[220:223], a[216:219], a[204:207], v[220:223]
v_mfma_f32_16x16x32_bf16 a[12:15], a[220:223], a[200:203], 1.0
s_waitcnt vmcnt(12)
ds_read_b128 a[200:203], v252 offset:30720
ds_read_b64_tr_b16 a[244:245], v253 offset:4096
v_mfma_f32_16x16x32_bf16 a[12:15], a[224:227], a[204:207], a[12:15]
ds_read_b128 a[204:207], v252 offset:31232
ds_read_b64_tr_b16 a[246:247], v253 offset:4352
v_mfma_f32_16x16x32_bf16 a[8:11], a[220:223], a[192:195], 1.0
ds_read_b128 a[192:195], v252 offset:28672
ds_read_b64_tr_b16 a[248:249], v253 offset:6144
v_mfma_f32_16x16x32_bf16 a[8:11], a[224:227], a[196:199], a[8:11]
ds_read_b128 a[196:199], v252 offset:29184
ds_read_b64_tr_b16 a[250:251], v253 offset:6400
v_mfma_f32_16x16x32_bf16 a[4:7], a[220:223], a[184:187], 1.0
ds_read_b128 a[184:187], v252 offset:26624
v_mfma_f32_16x16x32_bf16 a[4:7], a[224:227], a[188:191], a[4:7]
ds_read_b128 a[188:191], v252 offset:27136
v_mfma_f32_16x16x32_bf16 a[0:3], a[220:223], a[176:179], 1.0
ds_read_b128 a[176:179], v252 offset:24576
v_mfma_f32_16x16x32_bf16 a[0:3], a[224:227], a[180:183], a[0:3]
ds_read_b128 a[180:183], v252 offset:25088
v_mfma_f32_16x16x32_bf16 v[236:239], a[220:223], a[168:171], 1.0
ds_read_b128 a[168:171], v252 offset:22528
v_mfma_f32_16x16x32_bf16 v[236:239], a[224:227], a[172:175], v[236:239]
ds_read_b128 a[172:175], v252 offset:23040
v_mfma_f32_16x16x32_bf16 v[232:235], a[220:223], a[160:163], 1.0
ds_read_b128 a[160:163], v252 offset:20480
v_mfma_f32_16x16x32_bf16 v[232:235], a[224:227], a[164:167], v[232:235]
ds_read_b128 a[164:167], v252 offset:20992
v_mfma_f32_16x16x32_bf16 v[228:231], a[220:223], a[152:155], 1.0
ds_read_b128 a[152:155], v252 offset:18432
v_mfma_f32_16x16x32_bf16 v[228:231], a[224:227], a[156:159], v[228:231]
ds_read_b128 a[156:159], v252 offset:18944
v_mfma_f32_16x16x32_bf16 v[224:227], a[220:223], a[144:147], 1.0
ds_read_b128 a[144:147], v252 offset:16384
v_mfma_f32_16x16x32_bf16 v[224:227], a[224:227], a[148:151], v[224:227]
s_waitcnt lgkmcnt(12)
ds_read_b128 a[148:151], v252 offset:16896
v_mfma_f32_16x16x32_bf16 v[28:31], a[228:231], a[200:203], v[28:31]
ds_read_b64_tr_b16 a[208:209], v253 offset:4104
v_mfma_f32_16x16x32_bf16 v[28:31], a[232:235], a[204:207], v[28:31]
ds_read_b64_tr_b16 a[210:211], v253 offset:4360
v_mfma_f32_16x16x32_bf16 v[24:27], a[228:231], a[192:195], v[24:27]
ds_read_b64_tr_b16 a[212:213], v253 offset:6152
v_mfma_f32_16x16x32_bf16 v[24:27], a[232:235], a[196:199], v[24:27]
s_waitcnt lgkmcnt(11)
s_add_u32 m0, s34, 35840
ds_read_b64_tr_b16 a[214:215], v253 offset:6408
v_mfma_f32_16x16x32_bf16 v[20:23], a[228:231], a[184:187], v[20:23]
buffer_load_dwordx4 v255, s[12:15], s32 offen  lds
v_mfma_f32_16x16x32_bf16 v[20:23], a[232:235], a[188:191], v[20:23]
s_add_u32 s32, s32, 4294918272
v_mfma_f32_16x16x32_bf16 v[16:19], a[228:231], a[176:179], v[16:19]
v_mfma_f32_16x16x32_bf16 v[16:19], a[232:235], a[180:183], v[16:19]
s_waitcnt lgkmcnt(8)
v_mfma_f32_16x16x32_bf16 v[12:15], a[228:231], a[168:171], v[12:15]
v_mfma_f32_16x16x32_bf16 v[12:15], a[232:235], a[172:175], v[12:15]
v_mfma_f32_16x16x32_bf16 v[8:11], a[228:231], a[160:163], v[8:11]
v_mfma_f32_16x16x32_bf16 v[8:11], a[232:235], a[164:167], v[8:11]
s_waitcnt lgkmcnt(4)
v_mfma_f32_16x16x32_bf16 v[4:7], a[228:231], a[152:155], v[4:7]
v_mfma_f32_16x16x32_bf16 v[4:7], a[232:235], a[156:159], v[4:7]
v_mfma_f32_16x16x32_bf16 v[0:3], a[228:231], a[144:147], v[0:3]
v_mfma_f32_16x16x32_bf16 v[0:3], a[232:235], a[148:151], v[0:3]
v_mfma_f32_16x16x32_bf16 v[32:35], a[236:239], a[144:147], v[32:35]
s_waitcnt vmcnt(9)
ds_read_b64_tr_b16 a[220:221], v253 offset:32768
v_mfma_f32_16x16x32_bf16 v[32:35], a[240:243], a[148:151], v[32:35]
ds_read_b64_tr_b16 a[222:223], v253 offset:33024
v_mfma_f32_16x16x32_bf16 v[36:39], a[236:239], a[152:155], v[36:39]
ds_read_b64_tr_b16 a[224:225], v253 offset:34816
v_mfma_f32_16x16x32_bf16 v[36:39], a[240:243], a[156:159], v[36:39]
ds_read_b64_tr_b16 a[226:227], v253 offset:35072
v_mfma_f32_16x16x32_bf16 v[40:43], a[236:239], a[160:163], v[40:43]
v_mfma_f32_16x16x32_bf16 v[40:43], a[240:243], a[164:167], v[40:43]
v_mfma_f32_16x16x32_bf16 v[44:47], a[236:239], a[168:171], v[44:47]
v_mfma_f32_16x16x32_bf16 v[44:47], a[240:243], a[172:175], v[44:47]
v_mfma_f32_16x16x32_bf16 v[48:51], a[236:239], a[176:179], v[48:51]
v_mfma_f32_16x16x32_bf16 v[48:51], a[240:243], a[180:183], v[48:51]
v_mfma_f32_16x16x32_bf16 v[52:55], a[236:239], a[184:187], v[52:55]
v_mfma_f32_16x16x32_bf16 v[52:55], a[240:243], a[188:191], v[52:55]
s_add_u32 m0, s34, 49152
v_mfma_f32_16x16x32_bf16 v[56:59], a[236:239], a[192:195], v[56:59]
buffer_load_dwordx4 v255, s[12:15], s32 offen  lds
v_mfma_f32_16x16x32_bf16 v[56:59], a[240:243], a[196:199], v[56:59]
s_add_u32 s32, s32, 16384
v_mfma_f32_16x16x32_bf16 v[60:63], a[236:239], a[200:203], v[60:63]
v_mfma_f32_16x16x32_bf16 v[60:63], a[240:243], a[204:207], v[60:63]
v_mfma_f32_16x16x32_bf16 v[92:95], a[244:247], a[200:203], v[92:95]
ds_read_b64_tr_b16 a[228:229], v253 offset:32776
v_mfma_f32_16x16x32_bf16 v[92:95], a[248:251], a[204:207], v[92:95]
ds_read_b64_tr_b16 a[230:231], v253 offset:33032
v_mfma_f32_16x16x32_bf16 v[88:91], a[244:247], a[192:195], v[88:91]
ds_read_b64_tr_b16 a[232:233], v253 offset:34824
v_mfma_f32_16x16x32_bf16 v[88:91], a[248:251], a[196:199], v[88:91]
ds_read_b64_tr_b16 a[234:235], v253 offset:35080
v_mfma_f32_16x16x32_bf16 v[84:87], a[244:247], a[184:187], v[84:87]
v_mfma_f32_16x16x32_bf16 v[84:87], a[248:251], a[188:191], v[84:87]
v_mfma_f32_16x16x32_bf16 v[80:83], a[244:247], a[176:179], v[80:83]
v_mfma_f32_16x16x32_bf16 v[80:83], a[248:251], a[180:183], v[80:83]
v_mfma_f32_16x16x32_bf16 v[76:79], a[244:247], a[168:171], v[76:79]
v_mfma_f32_16x16x32_bf16 v[76:79], a[248:251], a[172:175], v[76:79]
v_mfma_f32_16x16x32_bf16 v[72:75], a[244:247], a[160:163], v[72:75]
v_mfma_f32_16x16x32_bf16 v[72:75], a[248:251], a[164:167], v[72:75]
v_mfma_f32_16x16x32_bf16 v[68:71], a[244:247], a[152:155], v[68:71]
v_mfma_f32_16x16x32_bf16 v[68:71], a[248:251], a[156:159], v[68:71]
v_mfma_f32_16x16x32_bf16 v[64:67], a[244:247], a[144:147], v[64:67]
v_mfma_f32_16x16x32_bf16 v[64:67], a[248:251], a[148:151], v[64:67]
s_waitcnt lgkmcnt(8)
v_mfma_f32_16x16x32_bf16 v[96:99], a[208:211], a[144:147], v[96:99]
s_waitcnt vmcnt(4)
ds_read_b64_tr_b16 a[236:237], v253 offset:36864
v_mfma_f32_16x16x32_bf16 v[96:99], a[212:215], a[148:151], v[96:99]
ds_read_b64_tr_b16 a[238:239], v253 offset:37120
v_mfma_f32_16x16x32_bf16 v[100:103], a[208:211], a[152:155], v[100:103]
ds_read_b64_tr_b16 a[240:241], v253 offset:38912
v_mfma_f32_16x16x32_bf16 v[100:103], a[212:215], a[156:159], v[100:103]
s_add_u32 m0, s34, 50176
ds_read_b64_tr_b16 a[242:243], v253 offset:39168
v_mfma_f32_16x16x32_bf16 v[104:107], a[208:211], a[160:163], v[104:107]
buffer_load_dwordx4 v255, s[12:15], s32 offen  lds
v_mfma_f32_16x16x32_bf16 v[104:107], a[212:215], a[164:167], v[104:107]
s_waitcnt vmcnt(4)
s_add_u32 s32, s32, 16384
v_cmp_le_u32 vcc, 4, v244
v_mfma_f32_16x16x32_bf16 v[108:111], a[208:211], a[168:171], v[108:111]
v_mfma_f32_16x16x32_bf16 v[108:111], a[212:215], a[172:175], v[108:111]
s_cmp_eq_u64 vcc, -1
s_cbranch_scc0 L_spinAdbg
L_retAdbg:
v_mfma_f32_16x16x32_bf16 v[112:115], a[208:211], a[176:179], v[112:115]
v_mfma_f32_16x16x32_bf16 v[112:115], a[212:215], a[180:183], v[112:115]
v_mfma_f32_16x16x32_bf16 v[116:119], a[208:211], a[184:187], v[116:119]
v_mfma_f32_16x16x32_bf16 v[116:119], a[212:215], a[188:191], v[116:119]
v_mfma_f32_16x16x32_bf16 v[120:123], a[208:211], a[192:195], v[120:123]
v_mfma_f32_16x16x32_bf16 v[120:123], a[212:215], a[196:199], v[120:123]
v_mfma_f32_16x16x32_bf16 v[124:127], a[208:211], a[200:203], v[124:127]
v_mfma_f32_16x16x32_bf16 v[124:127], a[212:215], a[204:207], v[124:127]
s_waitcnt lgkmcnt(8)
buffer_load_dwordx4 a[208:211], v254, s[8:11], s20 offen offset:0
v_mfma_f32_16x16x32_bf16 v[156:159], a[220:223], a[200:203], v[156:159]
ds_read_b64_tr_b16 a[244:245], v253 offset:36872
v_mfma_f32_16x16x32_bf16 v[156:159], a[224:227], a[204:207], v[156:159]
ds_read_b64_tr_b16 a[246:247], v253 offset:37128
v_mfma_f32_16x16x32_bf16 v[152:155], a[220:223], a[192:195], v[152:155]
ds_read_b64_tr_b16 a[248:249], v253 offset:38920
v_mfma_f32_16x16x32_bf16 v[152:155], a[224:227], a[196:199], v[152:155]
ds_read_b64_tr_b16 a[250:251], v253 offset:39176
v_mfma_f32_16x16x32_bf16 v[148:151], a[220:223], a[184:187], v[148:151]
buffer_load_dwordx4 a[212:215], v254, s[8:11], s20 offen offset:1024
v_and_b32 v253, 0x7ff, v252
v_mfma_f32_16x16x32_bf16 v[148:151], a[224:227], a[188:191], v[148:151]
v_mfma_f32_16x16x32_bf16 v[144:147], a[220:223], a[176:179], v[144:147]
buffer_load_dwordx4 a[216:219], v254, s[8:11], s20 offen offset:2048
v_mfma_f32_16x16x32_bf16 v[144:147], a[224:227], a[180:183], v[144:147]
v_mfma_f32_16x16x32_bf16 v[140:143], a[220:223], a[168:171], v[140:143]
v_mfma_f32_16x16x32_bf16 v[140:143], a[224:227], a[172:175], v[140:143]
v_mfma_f32_16x16x32_bf16 v[136:139], a[220:223], a[160:163], v[136:139]
v_mfma_f32_16x16x32_bf16 v[136:139], a[224:227], a[164:167], v[136:139]
s_add_u32 m0, s34, 51200
v_mfma_f32_16x16x32_bf16 v[132:135], a[220:223], a[152:155], v[132:135]
buffer_load_dwordx4 v255, s[12:15], s32 offen  lds
v_mfma_f32_16x16x32_bf16 v[132:135], a[224:227], a[156:159], v[132:135]
s_add_u32 s32, s32, 16384
v_mfma_f32_16x16x32_bf16 v[128:131], a[220:223], a[144:147], v[128:131]
v_mfma_f32_16x16x32_bf16 v[128:131], a[224:227], a[148:151], v[128:131]
s_waitcnt lgkmcnt(8)
buffer_load_dwordx4 a[220:223], v254, s[8:11], s20 offen offset:3072
v_mfma_f32_16x16x32_bf16 v[160:163], a[228:231], a[144:147], v[160:163]
s_add_u32 s20, s20, 4096
v_mfma_f32_16x16x32_bf16 v[160:163], a[232:235], a[148:151], v[160:163]
buffer_load_dwordx4 a[224:227], v254, s[8:11], s20 offen offset:0
v_mfma_f32_16x16x32_bf16 v[164:167], a[228:231], a[152:155], v[164:167]
v_mfma_f32_16x16x32_bf16 v[164:167], a[232:235], a[156:159], v[164:167]
v_mfma_f32_16x16x32_bf16 v[168:171], a[228:231], a[160:163], v[168:171]
v_mfma_f32_16x16x32_bf16 v[168:171], a[232:235], a[164:167], v[168:171]
v_mfma_f32_16x16x32_bf16 v[172:175], a[228:231], a[168:171], v[172:175]
v_mfma_f32_16x16x32_bf16 v[172:175], a[232:235], a[172:175], v[172:175]
v_mfma_f32_16x16x32_bf16 v[176:179], a[228:231], a[176:179], v[176:179]
v_mfma_f32_16x16x32_bf16 v[176:179], a[232:235], a[180:183], v[176:179]
s_waitcnt vmcnt(8)
s_barrier
v_mfma_f32_16x16x32_bf16 v[180:183], a[228:231], a[184:187], v[180:183]
v_mfma_f32_16x16x32_bf16 v[180:183], a[232:235], a[188:191], v[180:183]
v_mfma_f32_16x16x32_bf16 v[184:187], a[228:231], a[192:195], v[184:187]
v_mfma_f32_16x16x32_bf16 v[184:187], a[232:235], a[196:199], v[184:187]
v_mfma_f32_16x16x32_bf16 v[188:191], a[228:231], a[200:203], v[188:191]
v_mfma_f32_16x16x32_bf16 v[188:191], a[232:235], a[204:207], v[188:191]
s_waitcnt lgkmcnt(4)
buffer_load_dwordx4 a[228:231], v254, s[8:11], s20 offen offset:1024
v_mfma_f32_16x16x32_bf16 v[220:223], a[236:239], a[200:203], v[220:223]
v_mfma_f32_16x16x32_bf16 v[220:223], a[240:243], a[204:207], v[220:223]
buffer_load_dwordx4 a[232:235], v254, s[8:11], s20 offen offset:2048
v_mfma_f32_16x16x32_bf16 v[216:219], a[236:239], a[192:195], v[216:219]
v_mfma_f32_16x16x32_bf16 v[216:219], a[240:243], a[196:199], v[216:219]
s_add_u32 m0, s34, 52224
v_mfma_f32_16x16x32_bf16 v[212:215], a[236:239], a[184:187], v[212:215]
buffer_load_dwordx4 v255, s[12:15], s32 offen  lds
v_mfma_f32_16x16x32_bf16 v[212:215], a[240:243], a[188:191], v[212:215]
s_add_u32 s32, s32, 4294918272
v_mfma_f32_16x16x32_bf16 v[208:211], a[236:239], a[176:179], v[208:211]
v_mfma_f32_16x16x32_bf16 v[208:211], a[240:243], a[180:183], v[208:211]
v_mfma_f32_16x16x32_bf16 v[204:207], a[236:239], a[168:171], v[204:207]
v_mfma_f32_16x16x32_bf16 v[204:207], a[240:243], a[172:175], v[204:207]
v_mfma_f32_16x16x32_bf16 v[200:203], a[236:239], a[160:163], v[200:203]
v_mfma_f32_16x16x32_bf16 v[200:203], a[240:243], a[164:167], v[200:203]
v_mfma_f32_16x16x32_bf16 v[196:199], a[236:239], a[152:155], v[196:199]
v_mfma_f32_16x16x32_bf16 v[196:199], a[240:243], a[156:159], v[196:199]
v_mfma_f32_16x16x32_bf16 v[192:195], a[236:239], a[144:147], v[192:195]
v_mfma_f32_16x16x32_bf16 v[192:195], a[240:243], a[148:151], v[192:195]
s_waitcnt lgkmcnt(0)
buffer_load_dwordx4 a[236:239], v254, s[8:11], s20 offen offset:3072
v_mfma_f32_16x16x32_bf16 v[224:227], a[244:247], a[144:147], v[224:227]
s_add_u32 s20, s20, 4096
ds_read_b128 a[144:147], v252 offset:32768
v_mfma_f32_16x16x32_bf16 v[224:227], a[248:251], a[148:151], v[224:227]
ds_read_b128 a[148:151], v252 offset:33280
buffer_load_dwordx4 a[240:243], v254, s[8:11], s20 offen offset:0
v_mfma_f32_16x16x32_bf16 v[228:231], a[244:247], a[152:155], v[228:231]
ds_read_b128 a[152:155], v252 offset:34816
v_mfma_f32_16x16x32_bf16 v[228:231], a[248:251], a[156:159], v[228:231]
ds_read_b128 a[156:159], v252 offset:35328
v_mfma_f32_16x16x32_bf16 v[232:235], a[244:247], a[160:163], v[232:235]
ds_read_b128 a[160:163], v252 offset:36864
v_mfma_f32_16x16x32_bf16 v[232:235], a[248:251], a[164:167], v[232:235]
ds_read_b128 a[164:167], v252 offset:37376
v_mfma_f32_16x16x32_bf16 v[236:239], a[244:247], a[168:171], v[236:239]
ds_read_b128 a[168:171], v252 offset:38912
v_mfma_f32_16x16x32_bf16 v[236:239], a[248:251], a[172:175], v[236:239]
ds_read_b128 a[172:175], v252 offset:39424
v_mfma_f32_16x16x32_bf16 a[0:3], a[244:247], a[176:179], a[0:3]
ds_read_b128 a[176:179], v252 offset:40960
v_mfma_f32_16x16x32_bf16 a[0:3], a[248:251], a[180:183], a[0:3]
ds_read_b128 a[180:183], v252 offset:41472
v_mfma_f32_16x16x32_bf16 a[4:7], a[244:247], a[184:187], a[4:7]
ds_read_b128 a[184:187], v252 offset:43008
v_mfma_f32_16x16x32_bf16 a[4:7], a[248:251], a[188:191], a[4:7]
ds_read_b128 a[188:191], v252 offset:43520
v_mfma_f32_16x16x32_bf16 a[8:11], a[244:247], a[192:195], a[8:11]
ds_read_b128 a[192:195], v252 offset:45056
v_mfma_f32_16x16x32_bf16 a[8:11], a[248:251], a[196:199], a[8:11]
ds_read_b128 a[196:199], v252 offset:45568
v_mfma_f32_16x16x32_bf16 a[12:15], a[244:247], a[200:203], a[12:15]
ds_read_b128 a[200:203], v252 offset:47104
v_mfma_f32_16x16x32_bf16 a[12:15], a[248:251], a[204:207], a[12:15]
s_waitcnt vmcnt(9) lgkmcnt(11)
ds_read_b128 a[204:207], v252 offset:47616
v_mfma_f32_16x16x32_bf16 v[0:3], a[208:211], a[144:147], v[0:3]
s_add_u32 m0, s34, 65536
buffer_load_dwordx4 a[244:247], v254, s[8:11], s20 offen offset:1024
v_mfma_f32_16x16x32_bf16 v[0:3], a[212:215], a[148:151], v[0:3]
buffer_load_dwordx4 v255, s[12:15], s32 offen  lds
v_mfma_f32_16x16x32_bf16 v[4:7], a[208:211], a[152:155], v[4:7]
s_add_u32 s32, s32, 16384
buffer_load_dwordx4 a[248:251], v254, s[8:11], s20 offen offset:2048
v_mfma_f32_16x16x32_bf16 v[4:7], a[212:215], a[156:159], v[4:7]
s_waitcnt lgkmcnt(8)
v_mfma_f32_16x16x32_bf16 v[8:11], a[208:211], a[160:163], v[8:11]
v_mfma_f32_16x16x32_bf16 v[8:11], a[212:215], a[164:167], v[8:11]
v_mfma_f32_16x16x32_bf16 v[12:15], a[208:211], a[168:171], v[12:15]
v_mfma_f32_16x16x32_bf16 v[12:15], a[212:215], a[172:175], v[12:15]
s_waitcnt lgkmcnt(4)
v_mfma_f32_16x16x32_bf16 v[16:19], a[208:211], a[176:179], v[16:19]
v_mfma_f32_16x16x32_bf16 v[16:19], a[212:215], a[180:183], v[16:19]
v_mfma_f32_16x16x32_bf16 v[20:23], a[208:211], a[184:187], v[20:23]
v_mfma_f32_16x16x32_bf16 v[20:23], a[212:215], a[188:191], v[20:23]
s_waitcnt lgkmcnt(0)
v_mfma_f32_16x16x32_bf16 v[24:27], a[208:211], a[192:195], v[24:27]
v_mfma_f32_16x16x32_bf16 v[24:27], a[212:215], a[196:199], v[24:27]
v_mfma_f32_16x16x32_bf16 v[28:31], a[208:211], a[200:203], v[28:31]
buffer_load_dwordx4 a[208:211], v254, s[8:11], s20 offen offset:3072
v_mfma_f32_16x16x32_bf16 v[28:31], a[212:215], a[204:207], v[28:31]
s_waitcnt vmcnt(10)
s_add_u32 s20, s20, 4096
v_mfma_f32_16x16x32_bf16 v[60:63], a[216:219], a[200:203], v[60:63]
buffer_load_dwordx4 a[212:215], v254, s[8:11], s20 offen offset:0
v_mfma_f32_16x16x32_bf16 v[60:63], a[220:223], a[204:207], v[60:63]
v_mfma_f32_16x16x32_bf16 v[56:59], a[216:219], a[192:195], v[56:59]
v_mfma_f32_16x16x32_bf16 v[56:59], a[220:223], a[196:199], v[56:59]
v_mfma_f32_16x16x32_bf16 v[52:55], a[216:219], a[184:187], v[52:55]
v_mfma_f32_16x16x32_bf16 v[52:55], a[220:223], a[188:191], v[52:55]
v_mfma_f32_16x16x32_bf16 v[48:51], a[216:219], a[176:179], v[48:51]
v_mfma_f32_16x16x32_bf16 v[48:51], a[220:223], a[180:183], v[48:51]
v_mfma_f32_16x16x32_bf16 v[44:47], a[216:219], a[168:171], v[44:47]
s_add_u32 m0, s34, 66560
v_mfma_f32_16x16x32_bf16 v[44:47], a[220:223], a[172:175], v[44:47]
s_waitcnt vmcnt(7)
s_barrier
buffer_load_dwordx4 v255, s[12:15], s32 offen  lds
v_mfma_f32_16x16x32_bf16 v[40:43], a[216:219], a[160:163], v[40:43]
s_add_u32 s32, s32, 16384
v_mfma_f32_16x16x32_bf16 v[40:43], a[220:223], a[164:167], v[40:43]
v_mfma_f32_16x16x32_bf16 v[36:39], a[216:219], a[152:155], v[36:39]
v_mfma_f32_16x16x32_bf16 v[36:39], a[220:223], a[156:159], v[36:39]
v_mfma_f32_16x16x32_bf16 v[32:35], a[216:219], a[144:147], v[32:35]
buffer_load_dwordx4 a[216:219], v254, s[8:11], s20 offen offset:1024
v_mfma_f32_16x16x32_bf16 v[32:35], a[220:223], a[148:151], v[32:35]
v_mfma_f32_16x16x32_bf16 v[64:67], a[224:227], a[144:147], v[64:67]
buffer_load_dwordx4 a[220:223], v254, s[8:11], s20 offen offset:2048
v_mfma_f32_16x16x32_bf16 v[64:67], a[228:231], a[148:151], v[64:67]
v_mfma_f32_16x16x32_bf16 v[68:71], a[224:227], a[152:155], v[68:71]
v_mfma_f32_16x16x32_bf16 v[68:71], a[228:231], a[156:159], v[68:71]
v_mfma_f32_16x16x32_bf16 v[72:75], a[224:227], a[160:163], v[72:75]
v_mfma_f32_16x16x32_bf16 v[72:75], a[228:231], a[164:167], v[72:75]
v_mfma_f32_16x16x32_bf16 v[76:79], a[224:227], a[168:171], v[76:79]
v_mfma_f32_16x16x32_bf16 v[76:79], a[228:231], a[172:175], v[76:79]
v_mfma_f32_16x16x32_bf16 v[80:83], a[224:227], a[176:179], v[80:83]
v_mfma_f32_16x16x32_bf16 v[80:83], a[228:231], a[180:183], v[80:83]
v_mfma_f32_16x16x32_bf16 v[84:87], a[224:227], a[184:187], v[84:87]
v_mfma_f32_16x16x32_bf16 v[84:87], a[228:231], a[188:191], v[84:87]
v_mfma_f32_16x16x32_bf16 v[88:91], a[224:227], a[192:195], v[88:91]
v_mfma_f32_16x16x32_bf16 v[88:91], a[228:231], a[196:199], v[88:91]
v_mfma_f32_16x16x32_bf16 v[92:95], a[224:227], a[200:203], v[92:95]
buffer_load_dwordx4 a[224:227], v254, s[8:11], s20 offen offset:3072
v_mfma_f32_16x16x32_bf16 v[92:95], a[228:231], a[204:207], v[92:95]
s_waitcnt vmcnt(10)
s_add_u32 s20, s20, 4096
v_mfma_f32_16x16x32_bf16 v[124:127], a[232:235], a[200:203], v[124:127]
s_add_u32 m0, s34, 67584
buffer_load_dwordx4 a[228:231], v254, s[8:11], s20 offen offset:0
v_mfma_f32_16x16x32_bf16 v[124:127], a[236:239], a[204:207], v[124:127]
buffer_load_dwordx4 v255, s[12:15], s32 offen  lds
v_mfma_f32_16x16x32_bf16 v[120:123], a[232:235], a[192:195], v[120:123]
s_add_u32 s32, s32, 16384
v_mfma_f32_16x16x32_bf16 v[120:123], a[236:239], a[196:199], v[120:123]
v_mfma_f32_16x16x32_bf16 v[116:119], a[232:235], a[184:187], v[116:119]
v_mfma_f32_16x16x32_bf16 v[116:119], a[236:239], a[188:191], v[116:119]
v_mfma_f32_16x16x32_bf16 v[112:115], a[232:235], a[176:179], v[112:115]
v_mfma_f32_16x16x32_bf16 v[112:115], a[236:239], a[180:183], v[112:115]
v_mfma_f32_16x16x32_bf16 v[108:111], a[232:235], a[168:171], v[108:111]
v_mfma_f32_16x16x32_bf16 v[108:111], a[236:239], a[172:175], v[108:111]
v_mfma_f32_16x16x32_bf16 v[104:107], a[232:235], a[160:163], v[104:107]
v_mfma_f32_16x16x32_bf16 v[104:107], a[236:239], a[164:167], v[104:107]
v_mfma_f32_16x16x32_bf16 v[100:103], a[232:235], a[152:155], v[100:103]
v_mfma_f32_16x16x32_bf16 v[100:103], a[236:239], a[156:159], v[100:103]
v_mfma_f32_16x16x32_bf16 v[96:99], a[232:235], a[144:147], v[96:99]
buffer_load_dwordx4 a[232:235], v254, s[8:11], s20 offen offset:1024
v_mfma_f32_16x16x32_bf16 v[96:99], a[236:239], a[148:151], v[96:99]
s_waitcnt vmcnt(11)
v_mfma_f32_16x16x32_bf16 v[128:131], a[240:243], a[144:147], v[128:131]
buffer_load_dwordx4 a[236:239], v254, s[8:11], s20 offen offset:2048
v_mfma_f32_16x16x32_bf16 v[128:131], a[244:247], a[148:151], v[128:131]
v_mfma_f32_16x16x32_bf16 v[132:135], a[240:243], a[152:155], v[132:135]
v_mfma_f32_16x16x32_bf16 v[132:135], a[244:247], a[156:159], v[132:135]
v_mfma_f32_16x16x32_bf16 v[136:139], a[240:243], a[160:163], v[136:139]
v_mfma_f32_16x16x32_bf16 v[136:139], a[244:247], a[164:167], v[136:139]
v_mfma_f32_16x16x32_bf16 v[140:143], a[240:243], a[168:171], v[140:143]
v_mfma_f32_16x16x32_bf16 v[140:143], a[244:247], a[172:175], v[140:143]
v_mfma_f32_16x16x32_bf16 v[144:147], a[240:243], a[176:179], v[144:147]
s_add_u32 m0, s34, 68608
v_mfma_f32_16x16x32_bf16 v[144:147], a[244:247], a[180:183], v[144:147]
buffer_load_dwordx4 v255, s[12:15], s32 offen  lds
v_mfma_f32_16x16x32_bf16 v[148:151], a[240:243], a[184:187], v[148:151]
s_add_u32 s32, s32, 4294918272
v_mfma_f32_16x16x32_bf16 v[148:151], a[244:247], a[188:191], v[148:151]
v_mfma_f32_16x16x32_bf16 v[152:155], a[240:243], a[192:195], v[152:155]
v_mfma_f32_16x16x32_bf16 v[152:155], a[244:247], a[196:199], v[152:155]
v_mfma_f32_16x16x32_bf16 v[156:159], a[240:243], a[200:203], v[156:159]
buffer_load_dwordx4 a[240:243], v254, s[8:11], s20 offen offset:3072
v_mfma_f32_16x16x32_bf16 v[156:159], a[244:247], a[204:207], v[156:159]
s_waitcnt vmcnt(11)
s_add_u32 s20, s20, 4096
v_mfma_f32_16x16x32_bf16 v[188:191], a[248:251], a[200:203], v[188:191]
buffer_load_dwordx4 a[244:247], v254, s[8:11], s20 offen offset:0
v_mfma_f32_16x16x32_bf16 v[188:191], a[208:211], a[204:207], v[188:191]
buffer_load_dword v244, off, s[60:63], s3 offset:128 sc1
v_mfma_f32_16x16x32_bf16 v[184:187], a[248:251], a[192:195], v[184:187]
v_mfma_f32_16x16x32_bf16 v[184:187], a[208:211], a[196:199], v[184:187]
v_mfma_f32_16x16x32_bf16 v[180:183], a[248:251], a[184:187], v[180:183]
v_mfma_f32_16x16x32_bf16 v[180:183], a[208:211], a[188:191], v[180:183]
v_mfma_f32_16x16x32_bf16 v[176:179], a[248:251], a[176:179], v[176:179]
v_mfma_f32_16x16x32_bf16 v[176:179], a[208:211], a[180:183], v[176:179]
v_mfma_f32_16x16x32_bf16 v[172:175], a[248:251], a[168:171], v[172:175]
v_mfma_f32_16x16x32_bf16 v[172:175], a[208:211], a[172:175], v[172:175]
v_mfma_f32_16x16x32_bf16 v[168:171], a[248:251], a[160:163], v[168:171]
v_mfma_f32_16x16x32_bf16 v[168:171], a[208:211], a[164:167], v[168:171]
v_mfma_f32_16x16x32_bf16 v[164:167], a[248:251], a[152:155], v[164:167]
v_mfma_f32_16x16x32_bf16 v[164:167], a[208:211], a[156:159], v[164:167]
v_mfma_f32_16x16x32_bf16 v[160:163], a[248:251], a[144:147], v[160:163]
buffer_load_dwordx4 a[248:251], v254, s[8:11], s20 offen offset:1024
v_mfma_f32_16x16x32_bf16 v[160:163], a[208:211], a[148:151], v[160:163]
s_waitcnt vmcnt(11)
v_mfma_f32_16x16x32_bf16 v[192:195], a[212:215], a[144:147], v[192:195]
s_add_u32 m0, s34, 81920
buffer_load_dwordx4 a[208:211], v254, s[8:11], s20 offen offset:2048
v_mfma_f32_16x16x32_bf16 v[192:195], a[216:219], a[148:151], v[192:195]
buffer_load_dwordx4 v255, s[12:15], s32 offen  lds
v_mfma_f32_16x16x32_bf16 v[196:199], a[212:215], a[152:155], v[196:199]
s_add_u32 s32, s32, 16384
v_mfma_f32_16x16x32_bf16 v[196:199], a[216:219], a[156:159], v[196:199]
v_mfma_f32_16x16x32_bf16 v[200:203], a[212:215], a[160:163], v[200:203]
v_mfma_f32_16x16x32_bf16 v[200:203], a[216:219], a[164:167], v[200:203]
v_mfma_f32_16x16x32_bf16 v[204:207], a[212:215], a[168:171], v[204:207]
v_mfma_f32_16x16x32_bf16 v[204:207], a[216:219], a[172:175], v[204:207]
v_mfma_f32_16x16x32_bf16 v[208:211], a[212:215], a[176:179], v[208:211]
v_mfma_f32_16x16x32_bf16 v[208:211], a[216:219], a[180:183], v[208:211]
v_mfma_f32_16x16x32_bf16 v[212:215], a[212:215], a[184:187], v[212:215]
v_mfma_f32_16x16x32_bf16 v[212:215], a[216:219], a[188:191], v[212:215]
v_mfma_f32_16x16x32_bf16 v[216:219], a[212:215], a[192:195], v[216:219]
v_mfma_f32_16x16x32_bf16 v[216:219], a[216:219], a[196:199], v[216:219]
v_mfma_f32_16x16x32_bf16 v[220:223], a[212:215], a[200:203], v[220:223]
buffer_load_dwordx4 a[212:215], v254, s[8:11], s20 offen offset:3072
v_mfma_f32_16x16x32_bf16 v[220:223], a[216:219], a[204:207], v[220:223]
s_waitcnt vmcnt(12)
s_add_u32 s20, s20, 4096
v_mfma_f32_16x16x32_bf16 a[12:15], a[220:223], a[200:203], a[12:15]
ds_read_b128 a[200:203], v252 offset:63488
v_mfma_f32_16x16x32_bf16 a[12:15], a[224:227], a[204:207], a[12:15]
ds_read_b128 a[204:207], v252 offset:64000
v_mfma_f32_16x16x32_bf16 a[8:11], a[220:223], a[192:195], a[8:11]
ds_read_b128 a[192:195], v252 offset:61440
v_mfma_f32_16x16x32_bf16 a[8:11], a[224:227], a[196:199], a[8:11]
ds_read_b128 a[196:199], v252 offset:61952
v_mfma_f32_16x16x32_bf16 a[4:7], a[220:223], a[184:187], a[4:7]
ds_read_b128 a[184:187], v252 offset:59392
v_mfma_f32_16x16x32_bf16 a[4:7], a[224:227], a[188:191], a[4:7]
ds_read_b128 a[188:191], v252 offset:59904
v_mfma_f32_16x16x32_bf16 a[0:3], a[220:223], a[176:179], a[0:3]
ds_read_b128 a[176:179], v252 offset:57344
v_mfma_f32_16x16x32_bf16 a[0:3], a[224:227], a[180:183], a[0:3]
ds_read_b128 a[180:183], v252 offset:57856
v_mfma_f32_16x16x32_bf16 v[236:239], a[220:223], a[168:171], v[236:239]
ds_read_b128 a[168:171], v252 offset:55296
v_mfma_f32_16x16x32_bf16 v[236:239], a[224:227], a[172:175], v[236:239]
ds_read_b128 a[172:175], v252 offset:55808
v_mfma_f32_16x16x32_bf16 v[232:235], a[220:223], a[160:163], v[232:235]
ds_read_b128 a[160:163], v252 offset:53248
v_mfma_f32_16x16x32_bf16 v[232:235], a[224:227], a[164:167], v[232:235]
ds_read_b128 a[164:167], v252 offset:53760
v_mfma_f32_16x16x32_bf16 v[228:231], a[220:223], a[152:155], v[228:231]
ds_read_b128 a[152:155], v252 offset:51200
v_mfma_f32_16x16x32_bf16 v[228:231], a[224:227], a[156:159], v[228:231]
ds_read_b128 a[156:159], v252 offset:51712
v_mfma_f32_16x16x32_bf16 v[224:227], a[220:223], a[144:147], v[224:227]
ds_read_b128 a[144:147], v252 offset:49152
v_mfma_f32_16x16x32_bf16 v[224:227], a[224:227], a[148:151], v[224:227]
s_waitcnt vmcnt(9) lgkmcnt(11)
ds_read_b128 a[148:151], v252 offset:49664
v_mfma_f32_16x16x32_bf16 v[28:31], a[228:231], a[200:203], v[28:31]
s_add_u32 m0, s34, 82944
buffer_load_dwordx4 a[220:223], v254, s[8:11], s20 offen offset:0
v_mfma_f32_16x16x32_bf16 v[28:31], a[232:235], a[204:207], v[28:31]
buffer_load_dwordx4 v255, s[12:15], s32 offen  lds
v_mfma_f32_16x16x32_bf16 v[24:27], a[228:231], a[192:195], v[24:27]
s_add_u32 s32, s32, 16384
buffer_load_dwordx4 a[224:227], v254, s[8:11], s20 offen offset:1024
v_mfma_f32_16x16x32_bf16 v[24:27], a[232:235], a[196:199], v[24:27]
s_waitcnt lgkmcnt(8)
v_mfma_f32_16x16x32_bf16 v[20:23], a[228:231], a[184:187], v[20:23]
v_mfma_f32_16x16x32_bf16 v[20:23], a[232:235], a[188:191], v[20:23]
v_mfma_f32_16x16x32_bf16 v[16:19], a[228:231], a[176:179], v[16:19]
v_mfma_f32_16x16x32_bf16 v[16:19], a[232:235], a[180:183], v[16:19]
s_waitcnt lgkmcnt(4)
v_mfma_f32_16x16x32_bf16 v[12:15], a[228:231], a[168:171], v[12:15]
v_mfma_f32_16x16x32_bf16 v[12:15], a[232:235], a[172:175], v[12:15]
v_mfma_f32_16x16x32_bf16 v[8:11], a[228:231], a[160:163], v[8:11]
v_mfma_f32_16x16x32_bf16 v[8:11], a[232:235], a[164:167], v[8:11]
s_waitcnt lgkmcnt(0)
v_mfma_f32_16x16x32_bf16 v[4:7], a[228:231], a[152:155], v[4:7]
v_mfma_f32_16x16x32_bf16 v[4:7], a[232:235], a[156:159], v[4:7]
v_mfma_f32_16x16x32_bf16 v[0:3], a[228:231], a[144:147], v[0:3]
buffer_load_dwordx4 a[228:231], v254, s[8:11], s20 offen offset:2048
v_mfma_f32_16x16x32_bf16 v[0:3], a[232:235], a[148:151], v[0:3]
s_waitcnt vmcnt(10)
v_mfma_f32_16x16x32_bf16 v[32:35], a[236:239], a[144:147], v[32:35]
buffer_load_dwordx4 a[232:235], v254, s[8:11], s20 offen offset:3072
v_mfma_f32_16x16x32_bf16 v[32:35], a[240:243], a[148:151], v[32:35]
s_add_u32 s20, s20, 4096
v_mfma_f32_16x16x32_bf16 v[36:39], a[236:239], a[152:155], v[36:39]
v_mfma_f32_16x16x32_bf16 v[36:39], a[240:243], a[156:159], v[36:39]
v_mfma_f32_16x16x32_bf16 v[40:43], a[236:239], a[160:163], v[40:43]
v_mfma_f32_16x16x32_bf16 v[40:43], a[240:243], a[164:167], v[40:43]
v_mfma_f32_16x16x32_bf16 v[44:47], a[236:239], a[168:171], v[44:47]
v_mfma_f32_16x16x32_bf16 v[44:47], a[240:243], a[172:175], v[44:47]
v_mfma_f32_16x16x32_bf16 v[48:51], a[236:239], a[176:179], v[48:51]
s_add_u32 m0, s34, 83968
v_mfma_f32_16x16x32_bf16 v[48:51], a[240:243], a[180:183], v[48:51]
buffer_load_dwordx4 v255, s[12:15], s32 offen  lds
v_mfma_f32_16x16x32_bf16 v[52:55], a[236:239], a[184:187], v[52:55]
s_add_u32 s32, s32, 16384
v_mfma_f32_16x16x32_bf16 v[52:55], a[240:243], a[188:191], v[52:55]
v_mfma_f32_16x16x32_bf16 v[56:59], a[236:239], a[192:195], v[56:59]
v_mfma_f32_16x16x32_bf16 v[56:59], a[240:243], a[196:199], v[56:59]
v_mfma_f32_16x16x32_bf16 v[60:63], a[236:239], a[200:203], v[60:63]
buffer_load_dwordx4 a[236:239], v254, s[8:11], s20 offen offset:0
v_mfma_f32_16x16x32_bf16 v[60:63], a[240:243], a[204:207], v[60:63]
s_waitcnt vmcnt(10)
v_mfma_f32_16x16x32_bf16 v[92:95], a[244:247], a[200:203], v[92:95]
buffer_load_dwordx4 a[240:243], v254, s[8:11], s20 offen offset:1024
v_mfma_f32_16x16x32_bf16 v[92:95], a[248:251], a[204:207], v[92:95]
v_mfma_f32_16x16x32_bf16 v[88:91], a[244:247], a[192:195], v[88:91]
v_mfma_f32_16x16x32_bf16 v[88:91], a[248:251], a[196:199], v[88:91]
v_mfma_f32_16x16x32_bf16 v[84:87], a[244:247], a[184:187], v[84:87]
v_mfma_f32_16x16x32_bf16 v[84:87], a[248:251], a[188:191], v[84:87]
v_mfma_f32_16x16x32_bf16 v[80:83], a[244:247], a[176:179], v[80:83]
v_mfma_f32_16x16x32_bf16 v[80:83], a[248:251], a[180:183], v[80:83]
v_mfma_f32_16x16x32_bf16 v[76:79], a[244:247], a[168:171], v[76:79]
v_mfma_f32_16x16x32_bf16 v[76:79], a[248:251], a[172:175], v[76:79]
v_mfma_f32_16x16x32_bf16 v[72:75], a[244:247], a[160:163], v[72:75]
v_mfma_f32_16x16x32_bf16 v[72:75], a[248:251], a[164:167], v[72:75]
v_mfma_f32_16x16x32_bf16 v[68:71], a[244:247], a[152:155], v[68:71]
v_mfma_f32_16x16x32_bf16 v[68:71], a[248:251], a[156:159], v[68:71]
v_mfma_f32_16x16x32_bf16 v[64:67], a[244:247], a[144:147], v[64:67]
buffer_load_dwordx4 a[244:247], v254, s[8:11], s20 offen offset:2048
v_mfma_f32_16x16x32_bf16 v[64:67], a[248:251], a[148:151], v[64:67]
s_waitcnt vmcnt(9)
v_mfma_f32_16x16x32_bf16 v[96:99], a[208:211], a[144:147], v[96:99]
s_add_u32 m0, s34, 84992
buffer_load_dwordx4 a[248:251], v254, s[8:11], s20 offen offset:3072
v_mfma_f32_16x16x32_bf16 v[96:99], a[212:215], a[148:151], v[96:99]
s_add_u32 s20, s20, 4096
buffer_load_dwordx4 v255, s[12:15], s32 offen  lds
v_mfma_f32_16x16x32_bf16 v[100:103], a[208:211], a[152:155], v[100:103]
s_add_u32 s32, s32, 4294918272
v_mfma_f32_16x16x32_bf16 v[100:103], a[212:215], a[156:159], v[100:103]
v_mfma_f32_16x16x32_bf16 v[104:107], a[208:211], a[160:163], v[104:107]
v_mfma_f32_16x16x32_bf16 v[104:107], a[212:215], a[164:167], v[104:107]
v_mfma_f32_16x16x32_bf16 v[108:111], a[208:211], a[168:171], v[108:111]
v_mfma_f32_16x16x32_bf16 v[108:111], a[212:215], a[172:175], v[108:111]
v_mfma_f32_16x16x32_bf16 v[112:115], a[208:211], a[176:179], v[112:115]
v_mfma_f32_16x16x32_bf16 v[112:115], a[212:215], a[180:183], v[112:115]
v_mfma_f32_16x16x32_bf16 v[116:119], a[208:211], a[184:187], v[116:119]
v_cmp_le_u32 vcc, 28, v244
v_mfma_f32_16x16x32_bf16 v[116:119], a[212:215], a[188:191], v[116:119]
v_mfma_f32_16x16x32_bf16 v[120:123], a[208:211], a[192:195], v[120:123]
s_cmp_eq_u64 vcc, -1
s_cbranch_scc0 L_spinAdbgB
L_retAdbgB:
v_mfma_f32_16x16x32_bf16 v[120:123], a[212:215], a[196:199], v[120:123]
v_mfma_f32_16x16x32_bf16 v[124:127], a[208:211], a[200:203], v[124:127]
buffer_load_dwordx4 a[208:211], v254, s[8:11], s20 offen offset:0
v_mfma_f32_16x16x32_bf16 v[124:127], a[212:215], a[204:207], v[124:127]
s_waitcnt vmcnt(9)
v_mfma_f32_16x16x32_bf16 v[156:159], a[220:223], a[200:203], v[156:159]
buffer_load_dwordx4 a[212:215], v254, s[8:11], s20 offen offset:1024
v_mfma_f32_16x16x32_bf16 v[156:159], a[224:227], a[204:207], v[156:159]
v_mfma_f32_16x16x32_bf16 v[152:155], a[220:223], a[192:195], v[152:155]
buffer_load_dwordx4 a[216:219], v254, s[8:11], s20 offen offset:2048
v_mfma_f32_16x16x32_bf16 v[152:155], a[224:227], a[196:199], v[152:155]
v_mfma_f32_16x16x32_bf16 v[148:151], a[220:223], a[184:187], v[148:151]
v_mfma_f32_16x16x32_bf16 v[148:151], a[224:227], a[188:191], v[148:151]
v_mfma_f32_16x16x32_bf16 v[144:147], a[220:223], a[176:179], v[144:147]
v_mfma_f32_16x16x32_bf16 v[144:147], a[224:227], a[180:183], v[144:147]
v_mfma_f32_16x16x32_bf16 v[140:143], a[220:223], a[168:171], v[140:143]
s_add_u32 m0, s34, 98304
v_mfma_f32_16x16x32_bf16 v[140:143], a[224:227], a[172:175], v[140:143]
buffer_load_dwordx4 v255, s[12:15], s32 offen  lds
v_mfma_f32_16x16x32_bf16 v[136:139], a[220:223], a[160:163], v[136:139]
s_add_u32 s32, s32, 16384
v_mfma_f32_16x16x32_bf16 v[136:139], a[224:227], a[164:167], v[136:139]
v_mfma_f32_16x16x32_bf16 v[132:135], a[220:223], a[152:155], v[132:135]
v_mfma_f32_16x16x32_bf16 v[132:135], a[224:227], a[156:159], v[132:135]
v_mfma_f32_16x16x32_bf16 v[128:131], a[220:223], a[144:147], v[128:131]
buffer_load_dwordx4 a[220:223], v254, s[8:11], s20 offen offset:3072
v_mfma_f32_16x16x32_bf16 v[128:131], a[224:227], a[148:151], v[128:131]
s_waitcnt vmcnt(11)
s_add_u32 s20, s20, 4096
v_mfma_f32_16x16x32_bf16 v[160:163], a[228:231], a[144:147], v[160:163]
buffer_load_dwordx4 a[224:227], v254, s[8:11], s20 offen offset:0
v_mfma_f32_16x16x32_bf16 v[160:163], a[232:235], a[148:151], v[160:163]
v_mfma_f32_16x16x32_bf16 v[164:167], a[228:231], a[152:155], v[164:167]
v_mfma_f32_16x16x32_bf16 v[164:167], a[232:235], a[156:159], v[164:167]
v_mfma_f32_16x16x32_bf16 v[168:171], a[228:231], a[160:163], v[168:171]
v_mfma_f32_16x16x32_bf16 v[168:171], a[232:235], a[164:167], v[168:171]
v_mfma_f32_16x16x32_bf16 v[172:175], a[228:231], a[168:171], v[172:175]
v_mfma_f32_16x16x32_bf16 v[172:175], a[232:235], a[172:175], v[172:175]
v_mfma_f32_16x16x32_bf16 v[176:179], a[228:231], a[176:179], v[176:179]
v_mfma_f32_16x16x32_bf16 v[176:179], a[232:235], a[180:183], v[176:179]
s_barrier
v_mfma_f32_16x16x32_bf16 v[180:183], a[228:231], a[184:187], v[180:183]
v_mfma_f32_16x16x32_bf16 v[180:183], a[232:235], a[188:191], v[180:183]
v_mfma_f32_16x16x32_bf16 v[184:187], a[228:231], a[192:195], v[184:187]
v_mfma_f32_16x16x32_bf16 v[184:187], a[232:235], a[196:199], v[184:187]
v_mfma_f32_16x16x32_bf16 v[188:191], a[228:231], a[200:203], v[188:191]
buffer_load_dwordx4 a[228:231], v254, s[8:11], s20 offen offset:1024
v_mfma_f32_16x16x32_bf16 v[188:191], a[232:235], a[204:207], v[188:191]
s_waitcnt vmcnt(10)
v_mfma_f32_16x16x32_bf16 v[220:223], a[236:239], a[200:203], v[220:223]
s_add_u32 m0, s34, 99328
buffer_load_dwordx4 a[232:235], v254, s[8:11], s20 offen offset:2048
v_mfma_f32_16x16x32_bf16 v[220:223], a[240:243], a[204:207], v[220:223]
buffer_load_dwordx4 v255, s[12:15], s32 offen  lds
v_mfma_f32_16x16x32_bf16 v[216:219], a[236:239], a[192:195], v[216:219]
s_add_u32 s32, s32, 16384
v_mfma_f32_16x16x32_bf16 v[216:219], a[240:243], a[196:199], v[216:219]
v_mfma_f32_16x16x32_bf16 v[212:215], a[236:239], a[184:187], v[212:215]
v_mfma_f32_16x16x32_bf16 v[212:215], a[240:243], a[188:191], v[212:215]
v_xor_b32 v252, 0x10000, v252
v_mfma_f32_16x16x32_bf16 v[208:211], a[236:239], a[176:179], v[208:211]
v_mfma_f32_16x16x32_bf16 v[208:211], a[240:243], a[180:183], v[208:211]
v_mfma_f32_16x16x32_bf16 v[204:207], a[236:239], a[168:171], v[204:207]
v_mfma_f32_16x16x32_bf16 v[204:207], a[240:243], a[172:175], v[204:207]
v_mfma_f32_16x16x32_bf16 v[200:203], a[236:239], a[160:163], v[200:203]
v_mfma_f32_16x16x32_bf16 v[200:203], a[240:243], a[164:167], v[200:203]
v_mfma_f32_16x16x32_bf16 v[196:199], a[236:239], a[152:155], v[196:199]
v_mfma_f32_16x16x32_bf16 v[196:199], a[240:243], a[156:159], v[196:199]
v_mfma_f32_16x16x32_bf16 v[192:195], a[236:239], a[144:147], v[192:195]
buffer_load_dwordx4 a[236:239], v254, s[8:11], s20 offen offset:3072
v_mfma_f32_16x16x32_bf16 v[192:195], a[240:243], a[148:151], v[192:195]
s_waitcnt vmcnt(11)
s_add_u32 s20, s20, 4096
v_mfma_f32_16x16x32_bf16 v[224:227], a[244:247], a[144:147], v[224:227]
ds_read_b128 a[144:147], v252 offset:0
buffer_load_dwordx4 a[240:243], v254, s[8:11], s20 offen offset:0
v_mfma_f32_16x16x32_bf16 v[224:227], a[248:251], a[148:151], v[224:227]
ds_read_b128 a[148:151], v252 offset:512
v_mfma_f32_16x16x32_bf16 v[228:231], a[244:247], a[152:155], v[228:231]
ds_read_b128 a[152:155], v252 offset:2048
v_mfma_f32_16x16x32_bf16 v[228:231], a[248:251], a[156:159], v[228:231]
ds_read_b128 a[156:159], v252 offset:2560
v_mfma_f32_16x16x32_bf16 v[232:235], a[244:247], a[160:163], v[232:235]
ds_read_b128 a[160:163], v252 offset:4096
v_mfma_f32_16x16x32_bf16 v[232:235], a[248:251], a[164:167], v[232:235]
ds_read_b128 a[164:167], v252 offset:4608
v_mfma_f32_16x16x32_bf16 v[236:239], a[244:247], a[168:171], v[236:239]
ds_read_b128 a[168:171], v252 offset:6144
v_mfma_f32_16x16x32_bf16 v[236:239], a[248:251], a[172:175], v[236:239]
ds_read_b128 a[172:175], v252 offset:6656
v_mfma_f32_16x16x32_bf16 a[0:3], a[244:247], a[176:179], a[0:3]
ds_read_b128 a[176:179], v252 offset:8192
v_mfma_f32_16x16x32_bf16 a[0:3], a[248:251], a[180:183], a[0:3]
ds_read_b128 a[180:183], v252 offset:8704
v_mfma_f32_16x16x32_bf16 a[4:7], a[244:247], a[184:187], a[4:7]
ds_read_b128 a[184:187], v252 offset:10240
v_mfma_f32_16x16x32_bf16 a[4:7], a[248:251], a[188:191], a[4:7]
ds_read_b128 a[188:191], v252 offset:10752
v_mfma_f32_16x16x32_bf16 a[8:11], a[244:247], a[192:195], a[8:11]
ds_read_b128 a[192:195], v252 offset:12288
v_mfma_f32_16x16x32_bf16 a[8:11], a[248:251], a[196:199], a[8:11]
ds_read_b128 a[196:199], v252 offset:12800
v_mfma_f32_16x16x32_bf16 a[12:15], a[244:247], a[200:203], a[12:15]
ds_read_b128 a[200:203], v252 offset:14336
v_mfma_f32_16x16x32_bf16 a[12:15], a[248:251], a[204:207], a[12:15]
s_waitcnt vmcnt(9) lgkmcnt(11)
ds_read_b128 a[204:207], v252 offset:14848
v_mfma_f32_16x16x32_bf16 v[0:3], a[208:211], a[144:147], v[0:3]
s_add_u32 m0, s34, 100352
buffer_load_dwordx4 a[244:247], v254, s[8:11], s20 offen offset:1024
v_mfma_f32_16x16x32_bf16 v[0:3], a[212:215], a[148:151], v[0:3]
buffer_load_dwordx4 v255, s[12:15], s32 offen  lds
v_mfma_f32_16x16x32_bf16 v[4:7], a[208:211], a[152:155], v[4:7]
s_add_u32 s32, s32, 16384
buffer_load_dwordx4 a[248:251], v254, s[8:11], s20 offen offset:2048
v_mfma_f32_16x16x32_bf16 v[4:7], a[212:215], a[156:159], v[4:7]
s_waitcnt lgkmcnt(8)
v_mfma_f32_16x16x32_bf16 v[8:11], a[208:211], a[160:163], v[8:11]
v_mfma_f32_16x16x32_bf16 v[8:11], a[212:215], a[164:167], v[8:11]
v_mfma_f32_16x16x32_bf16 v[12:15], a[208:211], a[168:171], v[12:15]
v_mfma_f32_16x16x32_bf16 v[12:15], a[212:215], a[172:175], v[12:15]
s_waitcnt lgkmcnt(4)
v_mfma_f32_16x16x32_bf16 v[16:19], a[208:211], a[176:179], v[16:19]
v_mfma_f32_16x16x32_bf16 v[16:19], a[212:215], a[180:183], v[16:19]
v_mfma_f32_16x16x32_bf16 v[20:23], a[208:211], a[184:187], v[20:23]
v_mfma_f32_16x16x32_bf16 v[20:23], a[212:215], a[188:191], v[20:23]
s_waitcnt lgkmcnt(0)
v_mfma_f32_16x16x32_bf16 v[24:27], a[208:211], a[192:195], v[24:27]
v_mfma_f32_16x16x32_bf16 v[24:27], a[212:215], a[196:199], v[24:27]
v_mfma_f32_16x16x32_bf16 v[28:31], a[208:211], a[200:203], v[28:31]
buffer_load_dwordx4 a[208:211], v254, s[8:11], s20 offen offset:3072
v_mfma_f32_16x16x32_bf16 v[28:31], a[212:215], a[204:207], v[28:31]
s_waitcnt vmcnt(10)
s_add_u32 s20, s20, 4096
v_mfma_f32_16x16x32_bf16 v[60:63], a[216:219], a[200:203], v[60:63]
buffer_load_dwordx4 a[212:215], v254, s[8:11], s20 offen offset:0
v_mfma_f32_16x16x32_bf16 v[60:63], a[220:223], a[204:207], v[60:63]
v_mfma_f32_16x16x32_bf16 v[56:59], a[216:219], a[192:195], v[56:59]
v_mfma_f32_16x16x32_bf16 v[56:59], a[220:223], a[196:199], v[56:59]
v_mfma_f32_16x16x32_bf16 v[52:55], a[216:219], a[184:187], v[52:55]
v_mfma_f32_16x16x32_bf16 v[52:55], a[220:223], a[188:191], v[52:55]
v_mfma_f32_16x16x32_bf16 v[48:51], a[216:219], a[176:179], v[48:51]
v_mfma_f32_16x16x32_bf16 v[48:51], a[220:223], a[180:183], v[48:51]
v_mfma_f32_16x16x32_bf16 v[44:47], a[216:219], a[168:171], v[44:47]
s_add_u32 m0, s34, 101376
v_mfma_f32_16x16x32_bf16 v[44:47], a[220:223], a[172:175], v[44:47]
buffer_load_dwordx4 v255, s[12:15], s32 offen  lds
v_mfma_f32_16x16x32_bf16 v[40:43], a[216:219], a[160:163], v[40:43]
s_add_u32 s32, s32, 4294918272
v_mfma_f32_16x16x32_bf16 v[40:43], a[220:223], a[164:167], v[40:43]
v_mfma_f32_16x16x32_bf16 v[36:39], a[216:219], a[152:155], v[36:39]
v_mfma_f32_16x16x32_bf16 v[36:39], a[220:223], a[156:159], v[36:39]
v_mfma_f32_16x16x32_bf16 v[32:35], a[216:219], a[144:147], v[32:35]
buffer_load_dwordx4 a[216:219], v254, s[8:11], s20 offen offset:1024
v_mfma_f32_16x16x32_bf16 v[32:35], a[220:223], a[148:151], v[32:35]
s_waitcnt vmcnt(11)
v_mfma_f32_16x16x32_bf16 v[64:67], a[224:227], a[144:147], v[64:67]
buffer_load_dwordx4 a[220:223], v254, s[8:11], s20 offen offset:2048
v_mfma_f32_16x16x32_bf16 v[64:67], a[228:231], a[148:151], v[64:67]
v_mfma_f32_16x16x32_bf16 v[68:71], a[224:227], a[152:155], v[68:71]
v_mfma_f32_16x16x32_bf16 v[68:71], a[228:231], a[156:159], v[68:71]
v_mfma_f32_16x16x32_bf16 v[72:75], a[224:227], a[160:163], v[72:75]
v_mfma_f32_16x16x32_bf16 v[72:75], a[228:231], a[164:167], v[72:75]
v_mfma_f32_16x16x32_bf16 v[76:79], a[224:227], a[168:171], v[76:79]
v_mfma_f32_16x16x32_bf16 v[76:79], a[228:231], a[172:175], v[76:79]
v_mfma_f32_16x16x32_bf16 v[80:83], a[224:227], a[176:179], v[80:83]
v_mfma_f32_16x16x32_bf16 v[80:83], a[228:231], a[180:183], v[80:83]
v_mfma_f32_16x16x32_bf16 v[84:87], a[224:227], a[184:187], v[84:87]
v_mfma_f32_16x16x32_bf16 v[84:87], a[228:231], a[188:191], v[84:87]
v_mfma_f32_16x16x32_bf16 v[88:91], a[224:227], a[192:195], v[88:91]
v_mfma_f32_16x16x32_bf16 v[88:91], a[228:231], a[196:199], v[88:91]
v_mfma_f32_16x16x32_bf16 v[92:95], a[224:227], a[200:203], v[92:95]
buffer_load_dwordx4 a[224:227], v254, s[8:11], s20 offen offset:3072
v_mfma_f32_16x16x32_bf16 v[92:95], a[228:231], a[204:207], v[92:95]
s_waitcnt vmcnt(10)
s_add_u32 s20, s20, 4096
v_mfma_f32_16x16x32_bf16 v[124:127], a[232:235], a[200:203], v[124:127]
s_add_u32 m0, s34, 114688
buffer_load_dwordx4 a[228:231], v254, s[8:11], s20 offen offset:0
v_mfma_f32_16x16x32_bf16 v[124:127], a[236:239], a[204:207], v[124:127]
buffer_load_dwordx4 v255, s[12:15], s32 offen  lds
v_mfma_f32_16x16x32_bf16 v[120:123], a[232:235], a[192:195], v[120:123]
s_add_u32 s32, s32, 16384
v_mfma_f32_16x16x32_bf16 v[120:123], a[236:239], a[196:199], v[120:123]
v_mfma_f32_16x16x32_bf16 v[116:119], a[232:235], a[184:187], v[116:119]
v_mfma_f32_16x16x32_bf16 v[116:119], a[236:239], a[188:191], v[116:119]
v_mfma_f32_16x16x32_bf16 v[112:115], a[232:235], a[176:179], v[112:115]
v_mfma_f32_16x16x32_bf16 v[112:115], a[236:239], a[180:183], v[112:115]
v_mfma_f32_16x16x32_bf16 v[108:111], a[232:235], a[168:171], v[108:111]
v_mfma_f32_16x16x32_bf16 v[108:111], a[236:239], a[172:175], v[108:111]
v_mfma_f32_16x16x32_bf16 v[104:107], a[232:235], a[160:163], v[104:107]
v_mfma_f32_16x16x32_bf16 v[104:107], a[236:239], a[164:167], v[104:107]
v_mfma_f32_16x16x32_bf16 v[100:103], a[232:235], a[152:155], v[100:103]
v_mfma_f32_16x16x32_bf16 v[100:103], a[236:239], a[156:159], v[100:103]
v_mfma_f32_16x16x32_bf16 v[96:99], a[232:235], a[144:147], v[96:99]
buffer_load_dwordx4 a[232:235], v254, s[8:11], s20 offen offset:1024
v_mfma_f32_16x16x32_bf16 v[96:99], a[236:239], a[148:151], v[96:99]
s_waitcnt vmcnt(11)
v_mfma_f32_16x16x32_bf16 v[128:131], a[240:243], a[144:147], v[128:131]
buffer_load_dwordx4 a[236:239], v254, s[8:11], s20 offen offset:2048
v_mfma_f32_16x16x32_bf16 v[128:131], a[244:247], a[148:151], v[128:131]
v_mfma_f32_16x16x32_bf16 v[132:135], a[240:243], a[152:155], v[132:135]
v_mfma_f32_16x16x32_bf16 v[132:135], a[244:247], a[156:159], v[132:135]
v_mfma_f32_16x16x32_bf16 v[136:139], a[240:243], a[160:163], v[136:139]
v_mfma_f32_16x16x32_bf16 v[136:139], a[244:247], a[164:167], v[136:139]
v_mfma_f32_16x16x32_bf16 v[140:143], a[240:243], a[168:171], v[140:143]
v_mfma_f32_16x16x32_bf16 v[140:143], a[244:247], a[172:175], v[140:143]
v_mfma_f32_16x16x32_bf16 v[144:147], a[240:243], a[176:179], v[144:147]
s_add_u32 m0, s34, 115712
v_mfma_f32_16x16x32_bf16 v[144:147], a[244:247], a[180:183], v[144:147]
buffer_load_dwordx4 v255, s[12:15], s32 offen  lds
v_mfma_f32_16x16x32_bf16 v[148:151], a[240:243], a[184:187], v[148:151]
s_add_u32 s32, s32, 16384
v_mfma_f32_16x16x32_bf16 v[148:151], a[244:247], a[188:191], v[148:151]
v_mfma_f32_16x16x32_bf16 v[152:155], a[240:243], a[192:195], v[152:155]
v_mfma_f32_16x16x32_bf16 v[152:155], a[244:247], a[196:199], v[152:155]
v_mfma_f32_16x16x32_bf16 v[156:159], a[240:243], a[200:203], v[156:159]
buffer_load_dwordx4 a[240:243], v254, s[8:11], s20 offen offset:3072
v_mfma_f32_16x16x32_bf16 v[156:159], a[244:247], a[204:207], v[156:159]
s_waitcnt vmcnt(11)
s_add_u32 s20, s20, 4096
v_mfma_f32_16x16x32_bf16 v[188:191], a[248:251], a[200:203], v[188:191]
buffer_load_dwordx4 a[244:247], v254, s[8:11], s20 offen offset:0
v_mfma_f32_16x16x32_bf16 v[188:191], a[208:211], a[204:207], v[188:191]
v_mfma_f32_16x16x32_bf16 v[184:187], a[248:251], a[192:195], v[184:187]
v_mfma_f32_16x16x32_bf16 v[184:187], a[208:211], a[196:199], v[184:187]
v_mfma_f32_16x16x32_bf16 v[180:183], a[248:251], a[184:187], v[180:183]
v_mfma_f32_16x16x32_bf16 v[180:183], a[208:211], a[188:191], v[180:183]
v_mfma_f32_16x16x32_bf16 v[176:179], a[248:251], a[176:179], v[176:179]
v_mfma_f32_16x16x32_bf16 v[176:179], a[208:211], a[180:183], v[176:179]
v_mfma_f32_16x16x32_bf16 v[172:175], a[248:251], a[168:171], v[172:175]
v_mfma_f32_16x16x32_bf16 v[172:175], a[208:211], a[172:175], v[172:175]
s_barrier
v_mfma_f32_16x16x32_bf16 v[168:171], a[248:251], a[160:163], v[168:171]
v_mfma_f32_16x16x32_bf16 v[168:171], a[208:211], a[164:167], v[168:171]
v_mfma_f32_16x16x32_bf16 v[164:167], a[248:251], a[152:155], v[164:167]
v_mfma_f32_16x16x32_bf16 v[164:167], a[208:211], a[156:159], v[164:167]
v_mfma_f32_16x16x32_bf16 v[160:163], a[248:251], a[144:147], v[160:163]
buffer_load_dwordx4 a[248:251], v254, s[8:11], s20 offen offset:1024
v_mfma_f32_16x16x32_bf16 v[160:163], a[208:211], a[148:151], v[160:163]
s_waitcnt vmcnt(10)
v_mfma_f32_16x16x32_bf16 v[192:195], a[212:215], a[144:147], v[192:195]
s_add_u32 m0, s34, 116736
buffer_load_dwordx4 a[208:211], v254, s[8:11], s20 offen offset:2048
v_mfma_f32_16x16x32_bf16 v[192:195], a[216:219], a[148:151], v[192:195]
buffer_load_dwordx4 v255, s[12:15], s32 offen  lds
v_mfma_f32_16x16x32_bf16 v[196:199], a[212:215], a[152:155], v[196:199]
s_add_u32 s32, s32, 16384
v_mfma_f32_16x16x32_bf16 v[196:199], a[216:219], a[156:159], v[196:199]
v_mfma_f32_16x16x32_bf16 v[200:203], a[212:215], a[160:163], v[200:203]
v_mfma_f32_16x16x32_bf16 v[200:203], a[216:219], a[164:167], v[200:203]
v_mfma_f32_16x16x32_bf16 v[204:207], a[212:215], a[168:171], v[204:207]
v_mfma_f32_16x16x32_bf16 v[204:207], a[216:219], a[172:175], v[204:207]
v_mfma_f32_16x16x32_bf16 v[208:211], a[212:215], a[176:179], v[208:211]
v_mfma_f32_16x16x32_bf16 v[208:211], a[216:219], a[180:183], v[208:211]
v_mfma_f32_16x16x32_bf16 v[212:215], a[212:215], a[184:187], v[212:215]
v_mfma_f32_16x16x32_bf16 v[212:215], a[216:219], a[188:191], v[212:215]
v_mfma_f32_16x16x32_bf16 v[216:219], a[212:215], a[192:195], v[216:219]
v_mfma_f32_16x16x32_bf16 v[216:219], a[216:219], a[196:199], v[216:219]
v_mfma_f32_16x16x32_bf16 v[220:223], a[212:215], a[200:203], v[220:223]
buffer_load_dwordx4 a[212:215], v254, s[8:11], s20 offen offset:3072
v_mfma_f32_16x16x32_bf16 v[220:223], a[216:219], a[204:207], v[220:223]
s_waitcnt vmcnt(11)
s_add_u32 s20, s20, 4096
v_mfma_f32_16x16x32_bf16 a[12:15], a[220:223], a[200:203], a[12:15]
ds_read_b128 a[200:203], v252 offset:30720
v_mfma_f32_16x16x32_bf16 a[12:15], a[224:227], a[204:207], a[12:15]
ds_read_b128 a[204:207], v252 offset:31232
v_mfma_f32_16x16x32_bf16 a[8:11], a[220:223], a[192:195], a[8:11]
ds_read_b128 a[192:195], v252 offset:28672
v_mfma_f32_16x16x32_bf16 a[8:11], a[224:227], a[196:199], a[8:11]
ds_read_b128 a[196:199], v252 offset:29184
v_mfma_f32_16x16x32_bf16 a[4:7], a[220:223], a[184:187], a[4:7]
ds_read_b128 a[184:187], v252 offset:26624
v_mfma_f32_16x16x32_bf16 a[4:7], a[224:227], a[188:191], a[4:7]
ds_read_b128 a[188:191], v252 offset:27136
v_mfma_f32_16x16x32_bf16 a[0:3], a[220:223], a[176:179], a[0:3]
ds_read_b128 a[176:179], v252 offset:24576
v_mfma_f32_16x16x32_bf16 a[0:3], a[224:227], a[180:183], a[0:3]
ds_read_b128 a[180:183], v252 offset:25088
v_mfma_f32_16x16x32_bf16 v[236:239], a[220:223], a[168:171], v[236:239]
ds_read_b128 a[168:171], v252 offset:22528
v_mfma_f32_16x16x32_bf16 v[236:239], a[224:227], a[172:175], v[236:239]
ds_read_b128 a[172:175], v252 offset:23040
v_mfma_f32_16x16x32_bf16 v[232:235], a[220:223], a[160:163], v[232:235]
ds_read_b128 a[160:163], v252 offset:20480
v_mfma_f32_16x16x32_bf16 v[232:235], a[224:227], a[164:167], v[232:235]
ds_read_b128 a[164:167], v252 offset:20992
v_mfma_f32_16x16x32_bf16 v[228:231], a[220:223], a[152:155], v[228:231]
ds_read_b128 a[152:155], v252 offset:18432
v_mfma_f32_16x16x32_bf16 v[228:231], a[224:227], a[156:159], v[228:231]
ds_read_b128 a[156:159], v252 offset:18944
v_mfma_f32_16x16x32_bf16 v[224:227], a[220:223], a[144:147], v[224:227]
ds_read_b128 a[144:147], v252 offset:16384
v_mfma_f32_16x16x32_bf16 v[224:227], a[224:227], a[148:151], v[224:227]
s_waitcnt vmcnt(8) lgkmcnt(11)
ds_read_b128 a[148:151], v252 offset:16896
v_mfma_f32_16x16x32_bf16 v[28:31], a[228:231], a[200:203], v[28:31]
s_add_u32 m0, s34, 117760
buffer_load_dwordx4 a[220:223], v254, s[8:11], s20 offen offset:0
v_mfma_f32_16x16x32_bf16 v[28:31], a[232:235], a[204:207], v[28:31]
buffer_load_dwordx4 v255, s[12:15], s32 offen  lds
v_mfma_f32_16x16x32_bf16 v[24:27], a[228:231], a[192:195], v[24:27]
s_add_u32 s32, s32, 4294917248
s_xor_b32 s32, s32, 1024
buffer_load_dwordx4 a[224:227], v254, s[8:11], s20 offen offset:1024
v_mfma_f32_16x16x32_bf16 v[24:27], a[232:235], a[196:199], v[24:27]
s_waitcnt lgkmcnt(8)
v_mfma_f32_16x16x32_bf16 v[20:23], a[228:231], a[184:187], v[20:23]
v_mfma_f32_16x16x32_bf16 v[20:23], a[232:235], a[188:191], v[20:23]
v_mfma_f32_16x16x32_bf16 v[16:19], a[228:231], a[176:179], v[16:19]
v_mfma_f32_16x16x32_bf16 v[16:19], a[232:235], a[180:183], v[16:19]
s_waitcnt lgkmcnt(4)
v_mfma_f32_16x16x32_bf16 v[12:15], a[228:231], a[168:171], v[12:15]
v_mfma_f32_16x16x32_bf16 v[12:15], a[232:235], a[172:175], v[12:15]
v_mfma_f32_16x16x32_bf16 v[8:11], a[228:231], a[160:163], v[8:11]
v_mfma_f32_16x16x32_bf16 v[8:11], a[232:235], a[164:167], v[8:11]
s_waitcnt lgkmcnt(0)
v_mfma_f32_16x16x32_bf16 v[4:7], a[228:231], a[152:155], v[4:7]
v_mfma_f32_16x16x32_bf16 v[4:7], a[232:235], a[156:159], v[4:7]
v_mfma_f32_16x16x32_bf16 v[0:3], a[228:231], a[144:147], v[0:3]
buffer_load_dwordx4 a[228:231], v254, s[8:11], s20 offen offset:2048
v_mfma_f32_16x16x32_bf16 v[0:3], a[232:235], a[148:151], v[0:3]
s_waitcnt vmcnt(9)
v_mfma_f32_16x16x32_bf16 v[32:35], a[236:239], a[144:147], v[32:35]
buffer_load_dwordx4 a[232:235], v254, s[8:11], s20 offen offset:3072
v_mfma_f32_16x16x32_bf16 v[32:35], a[240:243], a[148:151], v[32:35]
s_add_u32 s20, s20, 4096
v_mfma_f32_16x16x32_bf16 v[36:39], a[236:239], a[152:155], v[36:39]
v_mfma_f32_16x16x32_bf16 v[36:39], a[240:243], a[156:159], v[36:39]
v_mfma_f32_16x16x32_bf16 v[40:43], a[236:239], a[160:163], v[40:43]
v_mfma_f32_16x16x32_bf16 v[40:43], a[240:243], a[164:167], v[40:43]
v_mfma_f32_16x16x32_bf16 v[44:47], a[236:239], a[168:171], v[44:47]
v_mfma_f32_16x16x32_bf16 v[44:47], a[240:243], a[172:175], v[44:47]
v_mfma_f32_16x16x32_bf16 v[48:51], a[236:239], a[176:179], v[48:51]
s_add_u32 m0, s34, 0
v_mfma_f32_16x16x32_bf16 v[48:51], a[240:243], a[180:183], v[48:51]
buffer_load_dwordx4 v255, s[12:15], s32 offen  lds
v_mfma_f32_16x16x32_bf16 v[52:55], a[236:239], a[184:187], v[52:55]
s_add_u32 s32, s32, 16384
v_mfma_f32_16x16x32_bf16 v[52:55], a[240:243], a[188:191], v[52:55]
v_mfma_f32_16x16x32_bf16 v[56:59], a[236:239], a[192:195], v[56:59]
v_mfma_f32_16x16x32_bf16 v[56:59], a[240:243], a[196:199], v[56:59]
v_mfma_f32_16x16x32_bf16 v[60:63], a[236:239], a[200:203], v[60:63]
buffer_load_dwordx4 a[236:239], v254, s[8:11], s20 offen offset:0
v_mfma_f32_16x16x32_bf16 v[60:63], a[240:243], a[204:207], v[60:63]
s_waitcnt vmcnt(10)
v_mfma_f32_16x16x32_bf16 v[92:95], a[244:247], a[200:203], v[92:95]
buffer_load_dwordx4 a[240:243], v254, s[8:11], s20 offen offset:1024
v_mfma_f32_16x16x32_bf16 v[92:95], a[248:251], a[204:207], v[92:95]
v_mfma_f32_16x16x32_bf16 v[88:91], a[244:247], a[192:195], v[88:91]
v_mfma_f32_16x16x32_bf16 v[88:91], a[248:251], a[196:199], v[88:91]
v_mfma_f32_16x16x32_bf16 v[84:87], a[244:247], a[184:187], v[84:87]
v_mfma_f32_16x16x32_bf16 v[84:87], a[248:251], a[188:191], v[84:87]
v_mfma_f32_16x16x32_bf16 v[80:83], a[244:247], a[176:179], v[80:83]
v_mfma_f32_16x16x32_bf16 v[80:83], a[248:251], a[180:183], v[80:83]
v_mfma_f32_16x16x32_bf16 v[76:79], a[244:247], a[168:171], v[76:79]
v_mfma_f32_16x16x32_bf16 v[76:79], a[248:251], a[172:175], v[76:79]
v_mfma_f32_16x16x32_bf16 v[72:75], a[244:247], a[160:163], v[72:75]
v_mfma_f32_16x16x32_bf16 v[72:75], a[248:251], a[164:167], v[72:75]
v_mfma_f32_16x16x32_bf16 v[68:71], a[244:247], a[152:155], v[68:71]
v_mfma_f32_16x16x32_bf16 v[68:71], a[248:251], a[156:159], v[68:71]
v_mfma_f32_16x16x32_bf16 v[64:67], a[244:247], a[144:147], v[64:67]
buffer_load_dwordx4 a[244:247], v254, s[8:11], s20 offen offset:2048
v_mfma_f32_16x16x32_bf16 v[64:67], a[248:251], a[148:151], v[64:67]
s_waitcnt vmcnt(9)
v_mfma_f32_16x16x32_bf16 v[96:99], a[208:211], a[144:147], v[96:99]
s_add_u32 m0, s34, 1024
buffer_load_dwordx4 a[248:251], v254, s[8:11], s20 offen offset:3072
v_mfma_f32_16x16x32_bf16 v[96:99], a[212:215], a[148:151], v[96:99]
s_add_u32 s20, s20, 4096
buffer_load_dwordx4 v255, s[12:15], s32 offen  lds
v_mfma_f32_16x16x32_bf16 v[100:103], a[208:211], a[152:155], v[100:103]
s_add_u32 s32, s32, 16384
v_mfma_f32_16x16x32_bf16 v[100:103], a[212:215], a[156:159], v[100:103]
v_mfma_f32_16x16x32_bf16 v[104:107], a[208:211], a[160:163], v[104:107]
v_mfma_f32_16x16x32_bf16 v[104:107], a[212:215], a[164:167], v[104:107]
v_mfma_f32_16x16x32_bf16 v[108:111], a[208:211], a[168:171], v[108:111]
v_mfma_f32_16x16x32_bf16 v[108:111], a[212:215], a[172:175], v[108:111]
v_mfma_f32_16x16x32_bf16 v[112:115], a[208:211], a[176:179], v[112:115]
v_mfma_f32_16x16x32_bf16 v[112:115], a[212:215], a[180:183], v[112:115]
v_mfma_f32_16x16x32_bf16 v[116:119], a[208:211], a[184:187], v[116:119]
v_mfma_f32_16x16x32_bf16 v[116:119], a[212:215], a[188:191], v[116:119]
v_mfma_f32_16x16x32_bf16 v[120:123], a[208:211], a[192:195], v[120:123]
v_mfma_f32_16x16x32_bf16 v[120:123], a[212:215], a[196:199], v[120:123]
v_mfma_f32_16x16x32_bf16 v[124:127], a[208:211], a[200:203], v[124:127]
buffer_load_dwordx4 a[208:211], v254, s[8:11], s20 offen offset:0
v_mfma_f32_16x16x32_bf16 v[124:127], a[212:215], a[204:207], v[124:127]
s_waitcnt vmcnt(9)
v_mfma_f32_16x16x32_bf16 v[156:159], a[220:223], a[200:203], v[156:159]
buffer_load_dwordx4 a[212:215], v254, s[8:11], s20 offen offset:1024
v_mfma_f32_16x16x32_bf16 v[156:159], a[224:227], a[204:207], v[156:159]
v_mfma_f32_16x16x32_bf16 v[152:155], a[220:223], a[192:195], v[152:155]
buffer_load_dwordx4 a[216:219], v254, s[8:11], s20 offen offset:2048
v_mfma_f32_16x16x32_bf16 v[152:155], a[224:227], a[196:199], v[152:155]
v_mfma_f32_16x16x32_bf16 v[148:151], a[220:223], a[184:187], v[148:151]
v_mfma_f32_16x16x32_bf16 v[148:151], a[224:227], a[188:191], v[148:151]
v_mfma_f32_16x16x32_bf16 v[144:147], a[220:223], a[176:179], v[144:147]
v_mfma_f32_16x16x32_bf16 v[144:147], a[224:227], a[180:183], v[144:147]
v_mfma_f32_16x16x32_bf16 v[140:143], a[220:223], a[168:171], v[140:143]
s_add_u32 m0, s34, 2048
v_mfma_f32_16x16x32_bf16 v[140:143], a[224:227], a[172:175], v[140:143]
buffer_load_dwordx4 v255, s[12:15], s32 offen  lds
v_mfma_f32_16x16x32_bf16 v[136:139], a[220:223], a[160:163], v[136:139]
s_add_u32 s32, s32, 16384
v_mfma_f32_16x16x32_bf16 v[136:139], a[224:227], a[164:167], v[136:139]
v_mfma_f32_16x16x32_bf16 v[132:135], a[220:223], a[152:155], v[132:135]
v_mfma_f32_16x16x32_bf16 v[132:135], a[224:227], a[156:159], v[132:135]
v_mfma_f32_16x16x32_bf16 v[128:131], a[220:223], a[144:147], v[128:131]
buffer_load_dwordx4 a[220:223], v254, s[8:11], s20 offen offset:3072
v_mfma_f32_16x16x32_bf16 v[128:131], a[224:227], a[148:151], v[128:131]
s_waitcnt vmcnt(11)
s_add_u32 s20, s20, 4096
v_mfma_f32_16x16x32_bf16 v[160:163], a[228:231], a[144:147], v[160:163]
buffer_load_dwordx4 a[224:227], v254, s[8:11], s20 offen offset:0
v_mfma_f32_16x16x32_bf16 v[160:163], a[232:235], a[148:151], v[160:163]
v_mfma_f32_16x16x32_bf16 v[164:167], a[228:231], a[152:155], v[164:167]
v_mfma_f32_16x16x32_bf16 v[164:167], a[232:235], a[156:159], v[164:167]
v_mfma_f32_16x16x32_bf16 v[168:171], a[228:231], a[160:163], v[168:171]
v_mfma_f32_16x16x32_bf16 v[168:171], a[232:235], a[164:167], v[168:171]
v_mfma_f32_16x16x32_bf16 v[172:175], a[228:231], a[168:171], v[172:175]
v_mfma_f32_16x16x32_bf16 v[172:175], a[232:235], a[172:175], v[172:175]
v_mfma_f32_16x16x32_bf16 v[176:179], a[228:231], a[176:179], v[176:179]
v_mfma_f32_16x16x32_bf16 v[176:179], a[232:235], a[180:183], v[176:179]
s_barrier
v_mfma_f32_16x16x32_bf16 v[180:183], a[228:231], a[184:187], v[180:183]
v_mfma_f32_16x16x32_bf16 v[180:183], a[232:235], a[188:191], v[180:183]
v_mfma_f32_16x16x32_bf16 v[184:187], a[228:231], a[192:195], v[184:187]
v_mfma_f32_16x16x32_bf16 v[184:187], a[232:235], a[196:199], v[184:187]
v_mfma_f32_16x16x32_bf16 v[188:191], a[228:231], a[200:203], v[188:191]
buffer_load_dwordx4 a[228:231], v254, s[8:11], s20 offen offset:1024
v_mfma_f32_16x16x32_bf16 v[188:191], a[232:235], a[204:207], v[188:191]
s_waitcnt vmcnt(10)
v_mfma_f32_16x16x32_bf16 v[220:223], a[236:239], a[200:203], v[220:223]
s_add_u32 m0, s34, 3072
buffer_load_dwordx4 a[232:235], v254, s[8:11], s20 offen offset:2048
v_mfma_f32_16x16x32_bf16 v[220:223], a[240:243], a[204:207], v[220:223]
buffer_load_dwordx4 v255, s[12:15], s32 offen  lds
v_mfma_f32_16x16x32_bf16 v[216:219], a[236:239], a[192:195], v[216:219]
s_add_u32 s32, s32, 4294918272
v_mfma_f32_16x16x32_bf16 v[216:219], a[240:243], a[196:199], v[216:219]
v_mfma_f32_16x16x32_bf16 v[212:215], a[236:239], a[184:187], v[212:215]
v_mfma_f32_16x16x32_bf16 v[212:215], a[240:243], a[188:191], v[212:215]
v_mfma_f32_16x16x32_bf16 v[208:211], a[236:239], a[176:179], v[208:211]
v_mfma_f32_16x16x32_bf16 v[208:211], a[240:243], a[180:183], v[208:211]
v_mfma_f32_16x16x32_bf16 v[204:207], a[236:239], a[168:171], v[204:207]
v_mfma_f32_16x16x32_bf16 v[204:207], a[240:243], a[172:175], v[204:207]
v_mfma_f32_16x16x32_bf16 v[200:203], a[236:239], a[160:163], v[200:203]
v_mfma_f32_16x16x32_bf16 v[200:203], a[240:243], a[164:167], v[200:203]
v_mfma_f32_16x16x32_bf16 v[196:199], a[236:239], a[152:155], v[196:199]
v_mfma_f32_16x16x32_bf16 v[196:199], a[240:243], a[156:159], v[196:199]
v_mfma_f32_16x16x32_bf16 v[192:195], a[236:239], a[144:147], v[192:195]
buffer_load_dwordx4 a[236:239], v254, s[8:11], s20 offen offset:3072
v_mfma_f32_16x16x32_bf16 v[192:195], a[240:243], a[148:151], v[192:195]
s_waitcnt vmcnt(11)
s_add_u32 s20, s20, 4096
v_mfma_f32_16x16x32_bf16 v[224:227], a[244:247], a[144:147], v[224:227]
ds_read_b128 a[144:147], v252 offset:32768
buffer_load_dwordx4 a[240:243], v254, s[8:11], s20 offen offset:0
v_mfma_f32_16x16x32_bf16 v[224:227], a[248:251], a[148:151], v[224:227]
ds_read_b128 a[148:151], v252 offset:33280
v_mfma_f32_16x16x32_bf16 v[228:231], a[244:247], a[152:155], v[228:231]
ds_read_b128 a[152:155], v252 offset:34816
v_mfma_f32_16x16x32_bf16 v[228:231], a[248:251], a[156:159], v[228:231]
ds_read_b128 a[156:159], v252 offset:35328
v_mfma_f32_16x16x32_bf16 v[232:235], a[244:247], a[160:163], v[232:235]
ds_read_b128 a[160:163], v252 offset:36864
v_mfma_f32_16x16x32_bf16 v[232:235], a[248:251], a[164:167], v[232:235]
ds_read_b128 a[164:167], v252 offset:37376
v_mfma_f32_16x16x32_bf16 v[236:239], a[244:247], a[168:171], v[236:239]
ds_read_b128 a[168:171], v252 offset:38912
v_mfma_f32_16x16x32_bf16 v[236:239], a[248:251], a[172:175], v[236:239]
s_add_u32 m0, s39, 32768
ds_read_b128 a[172:175], v252 offset:39424
v_mfma_f32_16x16x32_bf16 a[0:3], a[244:247], a[176:179], a[0:3]
ds_read_b128 a[176:179], v252 offset:40960
buffer_load_dwordx4 v250, s[52:55], s40 offen  lds
v_mfma_f32_16x16x32_bf16 a[0:3], a[248:251], a[180:183], a[0:3]
s_add_u32 s40, s40, 32768
ds_read_b128 a[180:183], v252 offset:41472
v_mfma_f32_16x16x32_bf16 a[4:7], a[244:247], a[184:187], a[4:7]
ds_read_b128 a[184:187], v252 offset:43008
v_mfma_f32_16x16x32_bf16 a[4:7], a[248:251], a[188:191], a[4:7]
ds_read_b128 a[188:191], v252 offset:43520
v_mfma_f32_16x16x32_bf16 a[8:11], a[244:247], a[192:195], a[8:11]
ds_read_b128 a[192:195], v252 offset:45056
v_mfma_f32_16x16x32_bf16 a[8:11], a[248:251], a[196:199], a[8:11]
ds_read_b128 a[196:199], v252 offset:45568
v_mfma_f32_16x16x32_bf16 a[12:15], a[244:247], a[200:203], a[12:15]
ds_read_b128 a[200:203], v252 offset:47104
v_mfma_f32_16x16x32_bf16 a[12:15], a[248:251], a[204:207], a[12:15]
s_waitcnt vmcnt(10) lgkmcnt(11)
ds_read_b128 a[204:207], v252 offset:47616
v_mfma_f32_16x16x32_bf16 v[0:3], a[208:211], a[144:147], v[0:3]
s_add_u32 m0, s34, 16384
buffer_load_dwordx4 a[244:247], v254, s[8:11], s20 offen offset:1024
v_mfma_f32_16x16x32_bf16 v[0:3], a[212:215], a[148:151], v[0:3]
buffer_load_dwordx4 v255, s[12:15], s32 offen  lds
v_mfma_f32_16x16x32_bf16 v[4:7], a[208:211], a[152:155], v[4:7]
s_add_u32 s32, s32, 16384
s_add_u32 m0, s39, 33792
buffer_load_dwordx4 a[248:251], v254, s[8:11], s20 offen offset:2048
v_mfma_f32_16x16x32_bf16 v[4:7], a[212:215], a[156:159], v[4:7]
s_waitcnt lgkmcnt(8)
buffer_load_dwordx4 v250, s[52:55], s40 offen  lds
v_mfma_f32_16x16x32_bf16 v[8:11], a[208:211], a[160:163], v[8:11]
s_add_u32 s40, s40, 2064384
v_mfma_f32_16x16x32_bf16 v[8:11], a[212:215], a[164:167], v[8:11]
v_mfma_f32_16x16x32_bf16 v[12:15], a[208:211], a[168:171], v[12:15]
v_mfma_f32_16x16x32_bf16 v[12:15], a[212:215], a[172:175], v[12:15]
s_waitcnt lgkmcnt(4)
v_mfma_f32_16x16x32_bf16 v[16:19], a[208:211], a[176:179], v[16:19]
v_mfma_f32_16x16x32_bf16 v[16:19], a[212:215], a[180:183], v[16:19]
v_mfma_f32_16x16x32_bf16 v[20:23], a[208:211], a[184:187], v[20:23]
v_mfma_f32_16x16x32_bf16 v[20:23], a[212:215], a[188:191], v[20:23]
s_waitcnt lgkmcnt(0)
v_mfma_f32_16x16x32_bf16 v[24:27], a[208:211], a[192:195], v[24:27]
v_mfma_f32_16x16x32_bf16 v[24:27], a[212:215], a[196:199], v[24:27]
v_mfma_f32_16x16x32_bf16 v[28:31], a[208:211], a[200:203], v[28:31]
buffer_load_dwordx4 a[208:211], v254, s[8:11], s20 offen offset:3072
v_mfma_f32_16x16x32_bf16 v[28:31], a[212:215], a[204:207], v[28:31]
s_waitcnt vmcnt(12)
s_add_u32 s20, s20, 4096
v_mfma_f32_16x16x32_bf16 v[60:63], a[216:219], a[200:203], v[60:63]
buffer_load_dwordx4 a[212:215], v254, s[8:11], s20 offen offset:0
v_mfma_f32_16x16x32_bf16 v[60:63], a[220:223], a[204:207], v[60:63]
v_mfma_f32_16x16x32_bf16 v[56:59], a[216:219], a[192:195], v[56:59]
v_mfma_f32_16x16x32_bf16 v[56:59], a[220:223], a[196:199], v[56:59]
v_mfma_f32_16x16x32_bf16 v[52:55], a[216:219], a[184:187], v[52:55]
v_mfma_f32_16x16x32_bf16 v[52:55], a[220:223], a[188:191], v[52:55]
v_mfma_f32_16x16x32_bf16 v[48:51], a[216:219], a[176:179], v[48:51]
v_mfma_f32_16x16x32_bf16 v[48:51], a[220:223], a[180:183], v[48:51]
v_mfma_f32_16x16x32_bf16 v[44:47], a[216:219], a[168:171], v[44:47]
s_add_u32 m0, s34, 17408
v_mfma_f32_16x16x32_bf16 v[44:47], a[220:223], a[172:175], v[44:47]
buffer_load_dwordx4 v255, s[12:15], s32 offen  lds
v_mfma_f32_16x16x32_bf16 v[40:43], a[216:219], a[160:163], v[40:43]
s_add_u32 s32, s32, 16384
v_mfma_f32_16x16x32_bf16 v[40:43], a[220:223], a[164:167], v[40:43]
v_mfma_f32_16x16x32_bf16 v[36:39], a[216:219], a[152:155], v[36:39]
v_mfma_f32_16x16x32_bf16 v[36:39], a[220:223], a[156:159], v[36:39]
v_mfma_f32_16x16x32_bf16 v[32:35], a[216:219], a[144:147], v[32:35]
buffer_load_dwordx4 a[216:219], v254, s[8:11], s20 offen offset:1024
v_mfma_f32_16x16x32_bf16 v[32:35], a[220:223], a[148:151], v[32:35]
s_waitcnt vmcnt(13)
v_mfma_f32_16x16x32_bf16 v[64:67], a[224:227], a[144:147], v[64:67]
buffer_load_dwordx4 a[220:223], v254, s[8:11], s20 offen offset:2048
v_mfma_f32_16x16x32_bf16 v[64:67], a[228:231], a[148:151], v[64:67]
v_mfma_f32_16x16x32_bf16 v[68:71], a[224:227], a[152:155], v[68:71]
v_mfma_f32_16x16x32_bf16 v[68:71], a[228:231], a[156:159], v[68:71]
v_mfma_f32_16x16x32_bf16 v[72:75], a[224:227], a[160:163], v[72:75]
v_mfma_f32_16x16x32_bf16 v[72:75], a[228:231], a[164:167], v[72:75]
v_mfma_f32_16x16x32_bf16 v[76:79], a[224:227], a[168:171], v[76:79]
v_mfma_f32_16x16x32_bf16 v[76:79], a[228:231], a[172:175], v[76:79]
v_mfma_f32_16x16x32_bf16 v[80:83], a[224:227], a[176:179], v[80:83]
v_mfma_f32_16x16x32_bf16 v[80:83], a[228:231], a[180:183], v[80:83]
v_mfma_f32_16x16x32_bf16 v[84:87], a[224:227], a[184:187], v[84:87]
v_mfma_f32_16x16x32_bf16 v[84:87], a[228:231], a[188:191], v[84:87]
v_mfma_f32_16x16x32_bf16 v[88:91], a[224:227], a[192:195], v[88:91]
v_mfma_f32_16x16x32_bf16 v[88:91], a[228:231], a[196:199], v[88:91]
v_mfma_f32_16x16x32_bf16 v[92:95], a[224:227], a[200:203], v[92:95]
buffer_load_dwordx4 a[224:227], v254, s[8:11], s20 offen offset:3072
v_mfma_f32_16x16x32_bf16 v[92:95], a[228:231], a[204:207], v[92:95]
s_waitcnt vmcnt(12)
s_add_u32 s20, s20, 4096
v_mfma_f32_16x16x32_bf16 v[124:127], a[232:235], a[200:203], v[124:127]
s_add_u32 m0, s34, 18432
buffer_load_dwordx4 a[228:231], v254, s[8:11], s20 offen offset:0
v_mfma_f32_16x16x32_bf16 v[124:127], a[236:239], a[204:207], v[124:127]
buffer_load_dwordx4 v255, s[12:15], s32 offen  lds
v_mfma_f32_16x16x32_bf16 v[120:123], a[232:235], a[192:195], v[120:123]
s_add_u32 s32, s32, 16384
v_mfma_f32_16x16x32_bf16 v[120:123], a[236:239], a[196:199], v[120:123]
v_mfma_f32_16x16x32_bf16 v[116:119], a[232:235], a[184:187], v[116:119]
v_mfma_f32_16x16x32_bf16 v[116:119], a[236:239], a[188:191], v[116:119]
v_mfma_f32_16x16x32_bf16 v[112:115], a[232:235], a[176:179], v[112:115]
v_mfma_f32_16x16x32_bf16 v[112:115], a[236:239], a[180:183], v[112:115]
v_mfma_f32_16x16x32_bf16 v[108:111], a[232:235], a[168:171], v[108:111]
v_mfma_f32_16x16x32_bf16 v[108:111], a[236:239], a[172:175], v[108:111]
v_mfma_f32_16x16x32_bf16 v[104:107], a[232:235], a[160:163], v[104:107]
v_mfma_f32_16x16x32_bf16 v[104:107], a[236:239], a[164:167], v[104:107]
v_mfma_f32_16x16x32_bf16 v[100:103], a[232:235], a[152:155], v[100:103]
v_mfma_f32_16x16x32_bf16 v[100:103], a[236:239], a[156:159], v[100:103]
v_mfma_f32_16x16x32_bf16 v[96:99], a[232:235], a[144:147], v[96:99]
buffer_load_dwordx4 a[232:235], v254, s[8:11], s20 offen offset:1024
v_mfma_f32_16x16x32_bf16 v[96:99], a[236:239], a[148:151], v[96:99]
s_waitcnt vmcnt(12)
v_mfma_f32_16x16x32_bf16 v[128:131], a[240:243], a[144:147], v[128:131]
buffer_load_dwordx4 a[236:239], v254, s[8:11], s20 offen offset:2048
v_mfma_f32_16x16x32_bf16 v[128:131], a[244:247], a[148:151], v[128:131]
v_mfma_f32_16x16x32_bf16 v[132:135], a[240:243], a[152:155], v[132:135]
v_mfma_f32_16x16x32_bf16 v[132:135], a[244:247], a[156:159], v[132:135]
v_mfma_f32_16x16x32_bf16 v[136:139], a[240:243], a[160:163], v[136:139]
v_mfma_f32_16x16x32_bf16 v[136:139], a[244:247], a[164:167], v[136:139]
v_mfma_f32_16x16x32_bf16 v[140:143], a[240:243], a[168:171], v[140:143]
v_mfma_f32_16x16x32_bf16 v[140:143], a[244:247], a[172:175], v[140:143]
v_mfma_f32_16x16x32_bf16 v[144:147], a[240:243], a[176:179], v[144:147]
s_add_u32 m0, s34, 19456
v_mfma_f32_16x16x32_bf16 v[144:147], a[244:247], a[180:183], v[144:147]
buffer_load_dwordx4 v255, s[12:15], s32 offen  lds
v_mfma_f32_16x16x32_bf16 v[148:151], a[240:243], a[184:187], v[148:151]
s_add_u32 s32, s32, 4294918272
v_mfma_f32_16x16x32_bf16 v[148:151], a[244:247], a[188:191], v[148:151]
v_mfma_f32_16x16x32_bf16 v[152:155], a[240:243], a[192:195], v[152:155]
v_mfma_f32_16x16x32_bf16 v[152:155], a[244:247], a[196:199], v[152:155]
v_mfma_f32_16x16x32_bf16 v[156:159], a[240:243], a[200:203], v[156:159]
buffer_load_dwordx4 a[240:243], v254, s[8:11], s20 offen offset:3072
v_mfma_f32_16x16x32_bf16 v[156:159], a[244:247], a[204:207], v[156:159]
s_waitcnt vmcnt(11)
s_add_u32 s20, s20, 4096
v_mfma_f32_16x16x32_bf16 v[188:191], a[248:251], a[200:203], v[188:191]
buffer_load_dwordx4 a[244:247], v254, s[8:11], s20 offen offset:0
v_mfma_f32_16x16x32_bf16 v[188:191], a[208:211], a[204:207], v[188:191]
v_mfma_f32_16x16x32_bf16 v[184:187], a[248:251], a[192:195], v[184:187]
v_mfma_f32_16x16x32_bf16 v[184:187], a[208:211], a[196:199], v[184:187]
v_mfma_f32_16x16x32_bf16 v[180:183], a[248:251], a[184:187], v[180:183]
v_mfma_f32_16x16x32_bf16 v[180:183], a[208:211], a[188:191], v[180:183]
v_mfma_f32_16x16x32_bf16 v[176:179], a[248:251], a[176:179], v[176:179]
v_mfma_f32_16x16x32_bf16 v[176:179], a[208:211], a[180:183], v[176:179]
v_mfma_f32_16x16x32_bf16 v[172:175], a[248:251], a[168:171], v[172:175]
v_mfma_f32_16x16x32_bf16 v[172:175], a[208:211], a[172:175], v[172:175]
s_barrier
v_mfma_f32_16x16x32_bf16 v[168:171], a[248:251], a[160:163], v[168:171]
v_mfma_f32_16x16x32_bf16 v[168:171], a[208:211], a[164:167], v[168:171]
v_mfma_f32_16x16x32_bf16 v[164:167], a[248:251], a[152:155], v[164:167]
v_mfma_f32_16x16x32_bf16 v[164:167], a[208:211], a[156:159], v[164:167]
v_mfma_f32_16x16x32_bf16 v[160:163], a[248:251], a[144:147], v[160:163]
buffer_load_dwordx4 a[248:251], v254, s[8:11], s20 offen offset:1024
v_mfma_f32_16x16x32_bf16 v[160:163], a[208:211], a[148:151], v[160:163]
s_waitcnt vmcnt(10)
v_mfma_f32_16x16x32_bf16 v[192:195], a[212:215], a[144:147], v[192:195]
buffer_load_dwordx4 a[208:211], v254, s[8:11], s20 offen offset:2048
v_mfma_f32_16x16x32_bf16 v[192:195], a[216:219], a[148:151], v[192:195]
v_mfma_f32_16x16x32_bf16 v[196:199], a[212:215], a[152:155], v[196:199]
v_mfma_f32_16x16x32_bf16 v[196:199], a[216:219], a[156:159], v[196:199]
v_mfma_f32_16x16x32_bf16 v[200:203], a[212:215], a[160:163], v[200:203]
v_mfma_f32_16x16x32_bf16 v[200:203], a[216:219], a[164:167], v[200:203]
v_mfma_f32_16x16x32_bf16 v[204:207], a[212:215], a[168:171], v[204:207]
v_mfma_f32_16x16x32_bf16 v[204:207], a[216:219], a[172:175], v[204:207]
v_mfma_f32_16x16x32_bf16 v[208:211], a[212:215], a[176:179], v[208:211]
v_mfma_f32_16x16x32_bf16 v[208:211], a[216:219], a[180:183], v[208:211]
v_mfma_f32_16x16x32_bf16 v[212:215], a[212:215], a[184:187], v[212:215]
ds_read_b64_tr_b16 v[240:241], v251 offset:32768
v_mfma_f32_16x16x32_bf16 v[212:215], a[216:219], a[188:191], v[212:215]
ds_read_b64_tr_b16 v[242:243], v251 offset:33024
v_mfma_f32_16x16x32_bf16 v[216:219], a[212:215], a[192:195], v[216:219]
ds_read_b64_tr_b16 v[244:245], v251 offset:32776
v_mfma_f32_16x16x32_bf16 v[216:219], a[216:219], a[196:199], v[216:219]
ds_read_b64_tr_b16 v[246:247], v251 offset:33032
v_mfma_f32_16x16x32_bf16 v[220:223], a[212:215], a[200:203], v[220:223]
buffer_load_dwordx4 a[212:215], v254, s[8:11], s20 offen offset:3072
v_mfma_f32_16x16x32_bf16 v[220:223], a[216:219], a[204:207], v[220:223]
s_waitcnt vmcnt(10)
s_add_u32 s20, s20, 4096
v_mfma_f32_16x16x32_bf16 a[12:15], a[220:223], a[200:203], a[12:15]
ds_read_b128 a[200:203], v252 offset:63488
v_mfma_f32_16x16x32_bf16 a[12:15], a[224:227], a[204:207], a[12:15]
ds_read_b128 a[204:207], v252 offset:64000
v_mfma_f32_16x16x32_bf16 a[8:11], a[220:223], a[192:195], a[8:11]
ds_read_b128 a[192:195], v252 offset:61440
v_mfma_f32_16x16x32_bf16 a[8:11], a[224:227], a[196:199], a[8:11]
ds_read_b128 a[196:199], v252 offset:61952
v_mfma_f32_16x16x32_bf16 a[4:7], a[220:223], a[184:187], a[4:7]
s_waitcnt lgkmcnt(6)
ds_read_b128 a[184:187], v252 offset:59392
buffer_store_dwordx4 v[240:243], v254, s[8:11], s41 offen offset:0 sc1
v_mfma_f32_16x16x32_bf16 a[4:7], a[224:227], a[188:191], a[4:7]
ds_read_b128 a[188:191], v252 offset:59904
v_mfma_f32_16x16x32_bf16 a[0:3], a[220:223], a[176:179], a[0:3]
ds_read_b128 a[176:179], v252 offset:57344
v_mfma_f32_16x16x32_bf16 a[0:3], a[224:227], a[180:183], a[0:3]
ds_read_b128 a[180:183], v252 offset:57856
v_mfma_f32_16x16x32_bf16 v[236:239], a[220:223], a[168:171], v[236:239]
ds_read_b128 a[168:171], v252 offset:55296
v_mfma_f32_16x16x32_bf16 v[236:239], a[224:227], a[172:175], v[236:239]
ds_read_b128 a[172:175], v252 offset:55808
v_mfma_f32_16x16x32_bf16 v[232:235], a[220:223], a[160:163], v[232:235]
ds_read_b128 a[160:163], v252 offset:53248
v_mfma_f32_16x16x32_bf16 v[232:235], a[224:227], a[164:167], v[232:235]
ds_read_b128 a[164:167], v252 offset:53760
v_mfma_f32_16x16x32_bf16 v[228:231], a[220:223], a[152:155], v[228:231]
ds_read_b128 a[152:155], v252 offset:51200
v_mfma_f32_16x16x32_bf16 v[228:231], a[224:227], a[156:159], v[228:231]
ds_read_b128 a[156:159], v252 offset:51712
v_mfma_f32_16x16x32_bf16 v[224:227], a[220:223], a[144:147], v[224:227]
ds_read_b128 a[144:147], v252 offset:49152
v_mfma_f32_16x16x32_bf16 v[224:227], a[224:227], a[148:151], v[224:227]
s_waitcnt vmcnt(8) lgkmcnt(11)
ds_read_b128 a[148:151], v252 offset:49664
v_mfma_f32_16x16x32_bf16 v[28:31], a[228:231], a[200:203], v[28:31]
s_add_u32 m0, s34, 32768
buffer_load_dwordx4 a[220:223], v254, s[8:11], s20 offen offset:0
v_mfma_f32_16x16x32_bf16 v[28:31], a[232:235], a[204:207], v[28:31]
buffer_load_dwordx4 v255, s[12:15], s32 offen  lds
v_mfma_f32_16x16x32_bf16 v[24:27], a[228:231], a[192:195], v[24:27]
s_add_u32 s32, s32, 16384
buffer_load_dwordx4 a[224:227], v254, s[8:11], s20 offen offset:1024
v_mfma_f32_16x16x32_bf16 v[24:27], a[232:235], a[196:199], v[24:27]
s_waitcnt lgkmcnt(8)
v_mfma_f32_16x16x32_bf16 v[20:23], a[228:231], a[184:187], v[20:23]
v_mfma_f32_16x16x32_bf16 v[20:23], a[232:235], a[188:191], v[20:23]
v_mfma_f32_16x16x32_bf16 v[16:19], a[228:231], a[176:179], v[16:19]
v_mfma_f32_16x16x32_bf16 v[16:19], a[232:235], a[180:183], v[16:19]
s_waitcnt lgkmcnt(4)
v_mfma_f32_16x16x32_bf16 v[12:15], a[228:231], a[168:171], v[12:15]
v_mfma_f32_16x16x32_bf16 v[12:15], a[232:235], a[172:175], v[12:15]
v_mfma_f32_16x16x32_bf16 v[8:11], a[228:231], a[160:163], v[8:11]
v_mfma_f32_16x16x32_bf16 v[8:11], a[232:235], a[164:167], v[8:11]
s_waitcnt lgkmcnt(0)
v_mfma_f32_16x16x32_bf16 v[4:7], a[228:231], a[152:155], v[4:7]
v_mfma_f32_16x16x32_bf16 v[4:7], a[232:235], a[156:159], v[4:7]
v_mfma_f32_16x16x32_bf16 v[0:3], a[228:231], a[144:147], v[0:3]
buffer_load_dwordx4 a[228:231], v254, s[8:11], s20 offen offset:2048
v_mfma_f32_16x16x32_bf16 v[0:3], a[232:235], a[148:151], v[0:3]
s_waitcnt vmcnt(9)
v_mfma_f32_16x16x32_bf16 v[32:35], a[236:239], a[144:147], v[32:35]
buffer_load_dwordx4 a[232:235], v254, s[8:11], s20 offen offset:3072
v_mfma_f32_16x16x32_bf16 v[32:35], a[240:243], a[148:151], v[32:35]
s_add_u32 s20, s20, 4096
v_mfma_f32_16x16x32_bf16 v[36:39], a[236:239], a[152:155], v[36:39]
buffer_store_dwordx4 v[244:247], v254, s[8:11], s41 offen offset:2048 sc1
v_mfma_f32_16x16x32_bf16 v[36:39], a[240:243], a[156:159], v[36:39]
s_add_u32 s41, s41, 262144
v_mfma_f32_16x16x32_bf16 v[40:43], a[236:239], a[160:163], v[40:43]
v_mfma_f32_16x16x32_bf16 v[40:43], a[240:243], a[164:167], v[40:43]
v_mfma_f32_16x16x32_bf16 v[44:47], a[236:239], a[168:171], v[44:47]
v_mbcnt_lo_u32_b32 v240, -1, 0
v_mfma_f32_16x16x32_bf16 v[44:47], a[240:243], a[172:175], v[44:47]
v_mbcnt_hi_u32_b32 v240, -1, v240
v_mfma_f32_16x16x32_bf16 v[48:51], a[236:239], a[176:179], v[48:51]
s_add_u32 m0, s34, 33792
v_and_b32 v249, 3, v240
v_mfma_f32_16x16x32_bf16 v[48:51], a[240:243], a[180:183], v[48:51]
buffer_load_dwordx4 v255, s[12:15], s32 offen  lds
v_lshlrev_b32 v249, 1, v249
v_mfma_f32_16x16x32_bf16 v[52:55], a[236:239], a[184:187], v[52:55]
s_add_u32 s32, s32, 16384
v_and_b32 v242, 4, v240
v_mfma_f32_16x16x32_bf16 v[52:55], a[240:243], a[188:191], v[52:55]
v_lshl_add_u32 v249, v242, 3, v249
v_mfma_f32_16x16x32_bf16 v[56:59], a[236:239], a[192:195], v[56:59]
v_lshrrev_b32 v242, 5, v240
v_mfma_f32_16x16x32_bf16 v[56:59], a[240:243], a[196:199], v[56:59]
v_lshl_add_u32 v249, v242, 4, v249
v_mfma_f32_16x16x32_bf16 v[60:63], a[236:239], a[200:203], v[60:63]
buffer_load_dwordx4 a[236:239], v254, s[8:11], s20 offen offset:0
v_mfma_f32_16x16x32_bf16 v[60:63], a[240:243], a[204:207], v[60:63]
s_waitcnt vmcnt(11)
buffer_load_ushort v244, v249, s[56:59], s21 offen offset:0
v_mfma_f32_16x16x32_bf16 v[92:95], a[244:247], a[200:203], v[92:95]
buffer_load_dwordx4 a[240:243], v254, s[8:11], s20 offen offset:1024
v_mfma_f32_16x16x32_bf16 v[92:95], a[248:251], a[204:207], v[92:95]
v_mfma_f32_16x16x32_bf16 v[88:91], a[244:247], a[192:195], v[88:91]
v_mfma_f32_16x16x32_bf16 v[88:91], a[248:251], a[196:199], v[88:91]
buffer_load_ushort v240, v249, s[56:59], s21 offen offset:8
v_mfma_f32_16x16x32_bf16 v[84:87], a[244:247], a[184:187], v[84:87]
v_mfma_f32_16x16x32_bf16 v[84:87], a[248:251], a[188:191], v[84:87]
v_mfma_f32_16x16x32_bf16 v[80:83], a[244:247], a[176:179], v[80:83]
v_mfma_f32_16x16x32_bf16 v[80:83], a[248:251], a[180:183], v[80:83]
buffer_load_ushort v245, v249, s[56:59], s21 offen offset:64
v_mfma_f32_16x16x32_bf16 v[76:79], a[244:247], a[168:171], v[76:79]
v_mfma_f32_16x16x32_bf16 v[76:79], a[248:251], a[172:175], v[76:79]
v_mfma_f32_16x16x32_bf16 v[72:75], a[244:247], a[160:163], v[72:75]
v_mfma_f32_16x16x32_bf16 v[72:75], a[248:251], a[164:167], v[72:75]
buffer_load_ushort v241, v249, s[56:59], s21 offen offset:72
v_mfma_f32_16x16x32_bf16 v[68:71], a[244:247], a[152:155], v[68:71]
v_mfma_f32_16x16x32_bf16 v[68:71], a[248:251], a[156:159], v[68:71]
v_mfma_f32_16x16x32_bf16 v[64:67], a[244:247], a[144:147], v[64:67]
buffer_load_dwordx4 a[244:247], v254, s[8:11], s20 offen offset:2048
v_mfma_f32_16x16x32_bf16 v[64:67], a[248:251], a[148:151], v[64:67]
s_waitcnt vmcnt(15)
buffer_load_ushort v246, v249, s[56:59], s21 offen offset:128
v_mfma_f32_16x16x32_bf16 v[96:99], a[208:211], a[144:147], v[96:99]
s_add_u32 m0, s34, 34816
buffer_load_dwordx4 a[248:251], v254, s[8:11], s20 offen offset:3072
v_mfma_f32_16x16x32_bf16 v[96:99], a[212:215], a[148:151], v[96:99]
s_add_u32 s20, s20, 4096
buffer_load_dwordx4 v255, s[12:15], s32 offen  lds
v_mfma_f32_16x16x32_bf16 v[100:103], a[208:211], a[152:155], v[100:103]
s_add_u32 s32, s32, 16384
v_mfma_f32_16x16x32_bf16 v[100:103], a[212:215], a[156:159], v[100:103]
buffer_load_ushort v242, v249, s[56:59], s21 offen offset:136
v_mfma_f32_16x16x32_bf16 v[104:107], a[208:211], a[160:163], v[104:107]
v_mfma_f32_16x16x32_bf16 v[104:107], a[212:215], a[164:167], v[104:107]
v_mfma_f32_16x16x32_bf16 v[108:111], a[208:211], a[168:171], v[108:111]
v_mfma_f32_16x16x32_bf16 v[108:111], a[212:215], a[172:175], v[108:111]
buffer_load_ushort v247, v249, s[56:59], s21 offen offset:192
v_mfma_f32_16x16x32_bf16 v[112:115], a[208:211], a[176:179], v[112:115]
v_mfma_f32_16x16x32_bf16 v[112:115], a[212:215], a[180:183], v[112:115]
v_mfma_f32_16x16x32_bf16 v[116:119], a[208:211], a[184:187], v[116:119]
v_mfma_f32_16x16x32_bf16 v[116:119], a[212:215], a[188:191], v[116:119]
buffer_load_ushort v243, v249, s[56:59], s21 offen offset:200
v_mfma_f32_16x16x32_bf16 v[120:123], a[208:211], a[192:195], v[120:123]
v_mfma_f32_16x16x32_bf16 v[120:123], a[212:215], a[196:199], v[120:123]
v_mfma_f32_16x16x32_bf16 v[124:127], a[208:211], a[200:203], v[124:127]
buffer_load_dwordx4 a[208:211], v254, s[8:11], s20 offen offset:0
v_mfma_f32_16x16x32_bf16 v[124:127], a[212:215], a[204:207], v[124:127]
s_waitcnt vmcnt(18)
s_add_u32 s21, s21, 2048
v_mfma_f32_16x16x32_bf16 v[156:159], a[220:223], a[200:203], v[156:159]
buffer_load_dwordx4 a[212:215], v254, s[8:11], s20 offen offset:1024
v_mfma_f32_16x16x32_bf16 v[156:159], a[224:227], a[204:207], v[156:159]
v_mfma_f32_16x16x32_bf16 v[152:155], a[220:223], a[192:195], v[152:155]
buffer_load_dwordx4 a[216:219], v254, s[8:11], s20 offen offset:2048
v_mfma_f32_16x16x32_bf16 v[152:155], a[224:227], a[196:199], v[152:155]
v_mfma_f32_16x16x32_bf16 v[148:151], a[220:223], a[184:187], v[148:151]
v_mfma_f32_16x16x32_bf16 v[148:151], a[224:227], a[188:191], v[148:151]
v_mfma_f32_16x16x32_bf16 v[144:147], a[220:223], a[176:179], v[144:147]
v_mfma_f32_16x16x32_bf16 v[144:147], a[224:227], a[180:183], v[144:147]
v_mfma_f32_16x16x32_bf16 v[140:143], a[220:223], a[168:171], v[140:143]
s_add_u32 m0, s34, 35840
v_mfma_f32_16x16x32_bf16 v[140:143], a[224:227], a[172:175], v[140:143]
buffer_load_dwordx4 v255, s[12:15], s32 offen  lds
v_mfma_f32_16x16x32_bf16 v[136:139], a[220:223], a[160:163], v[136:139]
s_add_u32 s32, s32, 4294918272
v_mfma_f32_16x16x32_bf16 v[136:139], a[224:227], a[164:167], v[136:139]
v_mfma_f32_16x16x32_bf16 v[132:135], a[220:223], a[152:155], v[132:135]
v_mfma_f32_16x16x32_bf16 v[132:135], a[224:227], a[156:159], v[132:135]
v_mfma_f32_16x16x32_bf16 v[128:131], a[220:223], a[144:147], v[128:131]
buffer_load_dwordx4 a[220:223], v254, s[8:11], s20 offen offset:3072
v_mfma_f32_16x16x32_bf16 v[128:131], a[224:227], a[148:151], v[128:131]
s_waitcnt vmcnt(20)
s_add_u32 s20, s20, 4096
v_mfma_f32_16x16x32_bf16 v[160:163], a[228:231], a[144:147], v[160:163]
buffer_load_dwordx4 a[224:227], v254, s[8:11], s20 offen offset:0
v_mfma_f32_16x16x32_bf16 v[160:163], a[232:235], a[148:151], v[160:163]
v_mfma_f32_16x16x32_bf16 v[164:167], a[228:231], a[152:155], v[164:167]
v_mfma_f32_16x16x32_bf16 v[164:167], a[232:235], a[156:159], v[164:167]
v_mfma_f32_16x16x32_bf16 v[168:171], a[228:231], a[160:163], v[168:171]
v_mfma_f32_16x16x32_bf16 v[168:171], a[232:235], a[164:167], v[168:171]
v_mfma_f32_16x16x32_bf16 v[172:175], a[228:231], a[168:171], v[172:175]
v_mfma_f32_16x16x32_bf16 v[172:175], a[232:235], a[172:175], v[172:175]
v_mfma_f32_16x16x32_bf16 v[176:179], a[228:231], a[176:179], v[176:179]
v_mfma_f32_16x16x32_bf16 v[176:179], a[232:235], a[180:183], v[176:179]
s_barrier
v_mfma_f32_16x16x32_bf16 v[180:183], a[228:231], a[184:187], v[180:183]
v_mfma_f32_16x16x32_bf16 v[180:183], a[232:235], a[188:191], v[180:183]
v_mfma_f32_16x16x32_bf16 v[184:187], a[228:231], a[192:195], v[184:187]
v_mfma_f32_16x16x32_bf16 v[184:187], a[232:235], a[196:199], v[184:187]
v_mfma_f32_16x16x32_bf16 v[188:191], a[228:231], a[200:203], v[188:191]
buffer_load_dwordx4 a[228:231], v254, s[8:11], s20 offen offset:1024
v_mfma_f32_16x16x32_bf16 v[188:191], a[232:235], a[204:207], v[188:191]
s_waitcnt vmcnt(17)
v_mfma_f32_16x16x32_bf16 v[220:223], a[236:239], a[200:203], v[220:223]
buffer_load_dwordx4 a[232:235], v254, s[8:11], s20 offen offset:2048
v_mfma_f32_16x16x32_bf16 v[220:223], a[240:243], a[204:207], v[220:223]
v_mfma_f32_16x16x32_bf16 v[216:219], a[236:239], a[192:195], v[216:219]
v_mfma_f32_16x16x32_bf16 v[216:219], a[240:243], a[196:199], v[216:219]
v_mfma_f32_16x16x32_bf16 v[212:215], a[236:239], a[184:187], v[212:215]
v_mfma_f32_16x16x32_bf16 v[212:215], a[240:243], a[188:191], v[212:215]
v_xor_b32 v252, 0x10000, v252
v_mfma_f32_16x16x32_bf16 v[208:211], a[236:239], a[176:179], v[208:211]
v_mfma_f32_16x16x32_bf16 v[208:211], a[240:243], a[180:183], v[208:211]
v_mfma_f32_16x16x32_bf16 v[204:207], a[236:239], a[168:171], v[204:207]
v_mfma_f32_16x16x32_bf16 v[204:207], a[240:243], a[172:175], v[204:207]
v_mfma_f32_16x16x32_bf16 v[200:203], a[236:239], a[160:163], v[200:203]
v_mfma_f32_16x16x32_bf16 v[200:203], a[240:243], a[164:167], v[200:203]
v_mfma_f32_16x16x32_bf16 v[196:199], a[236:239], a[152:155], v[196:199]
v_mfma_f32_16x16x32_bf16 v[196:199], a[240:243], a[156:159], v[196:199]
v_mfma_f32_16x16x32_bf16 v[192:195], a[236:239], a[144:147], v[192:195]
buffer_load_dwordx4 a[236:239], v254, s[8:11], s20 offen offset:3072
v_mov_b32 v248, 1
v_mfma_f32_16x16x32_bf16 v[192:195], a[240:243], a[148:151], v[192:195]
s_waitcnt vmcnt(13)
s_add_u32 s20, s20, 4096
buffer_store_dword v248, off, s[8:11], s50 sc1
v_mfma_f32_16x16x32_bf16 v[224:227], a[244:247], a[144:147], v[224:227]
ds_read_b128 a[144:147], v252 offset:0
buffer_load_dwordx4 a[240:243], v254, s[8:11], s20 offen offset:0
v_mfma_f32_16x16x32_bf16 v[224:227], a[248:251], a[148:151], v[224:227]
ds_read_b128 a[148:151], v252 offset:512
v_mfma_f32_16x16x32_bf16 v[228:231], a[244:247], a[152:155], v[228:231]
ds_read_b128 a[152:155], v252 offset:2048
v_mfma_f32_16x16x32_bf16 v[228:231], a[248:251], a[156:159], v[228:231]
ds_read_b128 a[156:159], v252 offset:2560
v_mfma_f32_16x16x32_bf16 v[232:235], a[244:247], a[160:163], v[232:235]
ds_read_b128 a[160:163], v252 offset:4096
v_mfma_f32_16x16x32_bf16 v[232:235], a[248:251], a[164:167], v[232:235]
ds_read_b128 a[164:167], v252 offset:4608
v_mfma_f32_16x16x32_bf16 v[236:239], a[244:247], a[168:171], v[236:239]
ds_read_b128 a[168:171], v252 offset:6144
v_mfma_f32_16x16x32_bf16 v[236:239], a[248:251], a[172:175], v[236:239]
ds_read_b128 a[172:175], v252 offset:6656
v_mfma_f32_16x16x32_bf16 a[0:3], a[244:247], a[176:179], a[0:3]
ds_read_b128 a[176:179], v252 offset:8192
v_mfma_f32_16x16x32_bf16 a[0:3], a[248:251], a[180:183], a[0:3]
ds_read_b128 a[180:183], v252 offset:8704
v_mfma_f32_16x16x32_bf16 a[4:7], a[244:247], a[184:187], a[4:7]
ds_read_b128 a[184:187], v252 offset:10240
v_mfma_f32_16x16x32_bf16 a[4:7], a[248:251], a[188:191], a[4:7]
ds_read_b128 a[188:191], v252 offset:10752
v_mfma_f32_16x16x32_bf16 a[8:11], a[244:247], a[192:195], a[8:11]
ds_read_b128 a[192:195], v252 offset:12288
v_mfma_f32_16x16x32_bf16 a[8:11], a[248:251], a[196:199], a[8:11]
ds_read_b128 a[196:199], v252 offset:12800
v_mfma_f32_16x16x32_bf16 a[12:15], a[244:247], a[200:203], a[12:15]
ds_read_b128 a[200:203], v252 offset:14336
v_mfma_f32_16x16x32_bf16 a[12:15], a[248:251], a[204:207], a[12:15]
s_waitcnt vmcnt(9) lgkmcnt(11)
ds_read_b128 a[204:207], v252 offset:14848
v_mfma_f32_16x16x32_bf16 v[0:3], a[208:211], a[144:147], v[0:3]
s_add_u32 m0, s34, 49152
buffer_load_dwordx4 a[244:247], v254, s[8:11], s20 offen offset:1024
v_mfma_f32_16x16x32_bf16 v[0:3], a[212:215], a[148:151], v[0:3]
buffer_load_dwordx4 v255, s[12:15], s32 offen  lds
v_mfma_f32_16x16x32_bf16 v[4:7], a[208:211], a[152:155], v[4:7]
s_add_u32 s32, s32, 16384
buffer_load_dwordx4 a[248:251], v254, s[8:11], s20 offen offset:2048
v_mfma_f32_16x16x32_bf16 v[4:7], a[212:215], a[156:159], v[4:7]
s_waitcnt lgkmcnt(8)
v_mfma_f32_16x16x32_bf16 v[8:11], a[208:211], a[160:163], v[8:11]
v_mfma_f32_16x16x32_bf16 v[8:11], a[212:215], a[164:167], v[8:11]
v_mfma_f32_16x16x32_bf16 v[12:15], a[208:211], a[168:171], v[12:15]
v_lshl_or_b32 v244, v240, 16, v244
v_mfma_f32_16x16x32_bf16 v[12:15], a[212:215], a[172:175], v[12:15]
s_waitcnt lgkmcnt(4)
v_lshl_or_b32 v245, v241, 16, v245
v_mfma_f32_16x16x32_bf16 v[16:19], a[208:211], a[176:179], v[16:19]
v_lshl_or_b32 v246, v242, 16, v246
v_mfma_f32_16x16x32_bf16 v[16:19], a[212:215], a[180:183], v[16:19]
v_lshl_or_b32 v247, v243, 16, v247
v_mfma_f32_16x16x32_bf16 v[20:23], a[208:211], a[184:187], v[20:23]
v_mov_b32 v241, 0
v_mfma_f32_16x16x32_bf16 v[20:23], a[212:215], a[188:191], v[20:23]
s_waitcnt lgkmcnt(0)
v_mov_b32 v242, 0
v_mfma_f32_16x16x32_bf16 v[24:27], a[208:211], a[192:195], v[24:27]
v_mov_b32 v243, 0
v_mfma_f32_16x16x32_bf16 v[24:27], a[212:215], a[196:199], v[24:27]
v_mfma_f32_16x16x32_bf16 v[28:31], a[208:211], a[200:203], v[28:31]
buffer_load_dwordx4 a[208:211], v254, s[8:11], s20 offen offset:3072
v_mfma_f32_16x16x32_bf16 v[28:31], a[212:215], a[204:207], v[28:31]
s_waitcnt vmcnt(10)
s_add_u32 s20, s20, 4096
v_mfma_f32_16x16x32_bf16 v[60:63], a[216:219], a[200:203], v[60:63]
buffer_load_dwordx4 a[212:215], v254, s[8:11], s20 offen offset:0
v_mfma_f32_16x16x32_bf16 v[60:63], a[220:223], a[204:207], v[60:63]
v_mfma_f32_16x16x32_bf16 v[56:59], a[216:219], a[192:195], v[56:59]
v_mfma_f32_16x16x32_bf16 v[56:59], a[220:223], a[196:199], v[56:59]
v_mfma_f32_16x16x32_bf16 v[52:55], a[216:219], a[184:187], v[52:55]
v_mfma_f32_16x16x32_bf16 v[52:55], a[220:223], a[188:191], v[52:55]
v_mfma_f32_16x16x32_bf16 v[48:51], a[216:219], a[176:179], v[48:51]
v_mfma_f32_16x16x32_bf16 v[48:51], a[220:223], a[180:183], v[48:51]
v_mfma_f32_16x16x32_bf16 v[44:47], a[216:219], a[168:171], v[44:47]
s_add_u32 m0, s34, 50176
v_mfma_f32_16x16x32_bf16 v[44:47], a[220:223], a[172:175], v[44:47]
buffer_load_dwordx4 v255, s[12:15], s32 offen  lds
v_mfma_f32_16x16x32_bf16 v[40:43], a[216:219], a[160:163], v[40:43]
s_add_u32 s32, s32, 16384
v_mfma_f32_16x16x32_bf16 v[40:43], a[220:223], a[164:167], v[40:43]
v_mfma_f32_16x16x32_bf16 v[36:39], a[216:219], a[152:155], v[36:39]
v_mfma_f32_16x16x32_bf16 v[36:39], a[220:223], a[156:159], v[36:39]
v_mfma_f32_16x16x32_bf16 v[32:35], a[216:219], a[144:147], v[32:35]
buffer_load_dwordx4 a[216:219], v254, s[8:11], s20 offen offset:1024
v_mfma_f32_16x16x32_bf16 v[32:35], a[220:223], a[148:151], v[32:35]
s_waitcnt vmcnt(11)
v_mfma_f32_16x16x32_bf16 v[64:67], a[224:227], a[144:147], v[64:67]
buffer_load_dwordx4 a[220:223], v254, s[8:11], s20 offen offset:2048
v_mfma_f32_16x16x32_bf16 v[64:67], a[228:231], a[148:151], v[64:67]
v_mfma_f32_16x16x32_bf16 v[68:71], a[224:227], a[152:155], v[68:71]
v_mfma_f32_16x16x32_bf16 v[68:71], a[228:231], a[156:159], v[68:71]
v_mfma_f32_16x16x32_bf16 v[72:75], a[224:227], a[160:163], v[72:75]
v_mfma_f32_16x16x32_bf16 v[72:75], a[228:231], a[164:167], v[72:75]
v_accvgpr_read_b32 v240, a254
v_mfma_f32_16x16x32_bf16 v[76:79], a[224:227], a[168:171], v[76:79]
v_mfma_f32_16x16x32_bf16 v[76:79], a[228:231], a[172:175], v[76:79]
v_mfma_f32_16x16x32_bf16 v[80:83], a[224:227], a[176:179], v[80:83]
v_mfma_f32_16x16x32_bf16 v[80:83], a[228:231], a[180:183], v[80:83]
v_mfma_f32_16x16x32_bf16 v[84:87], a[224:227], a[184:187], v[84:87]
v_mfma_f32_16x16x32_bf16 v[84:87], a[228:231], a[188:191], v[84:87]
v_mfma_f32_16x16x32_bf16 v[88:91], a[224:227], a[192:195], v[88:91]
v_mfma_f32_16x16x32_bf16 v[88:91], a[228:231], a[196:199], v[88:91]
v_mfma_f32_16x16x32_bf16 v[92:95], a[224:227], a[200:203], v[92:95]
buffer_load_dwordx4 a[224:227], v254, s[8:11], s20 offen offset:3072
v_mfma_f32_16x16x32_bf16 v[92:95], a[228:231], a[204:207], v[92:95]
s_waitcnt vmcnt(11)
s_add_u32 s20, s20, 4096
v_mfma_f32_32x32x16_bf16 v[0:15], v[244:247], v[240:243], v[0:15]
v_mfma_f32_16x16x32_bf16 v[124:127], a[232:235], a[200:203], v[124:127]
s_add_u32 m0, s34, 51200
buffer_load_dwordx4 a[228:231], v254, s[8:11], s20 offen offset:0
v_mfma_f32_16x16x32_bf16 v[124:127], a[236:239], a[204:207], v[124:127]
buffer_load_dwordx4 v255, s[12:15], s32 offen  lds
v_mfma_f32_16x16x32_bf16 v[120:123], a[232:235], a[192:195], v[120:123]
s_add_u32 s32, s32, 16384
v_mfma_f32_16x16x32_bf16 v[120:123], a[236:239], a[196:199], v[120:123]
v_mfma_f32_32x32x16_bf16 v[16:31], v[244:247], v[240:243], v[16:31]
v_mfma_f32_16x16x32_bf16 v[116:119], a[232:235], a[184:187], v[116:119]
v_mfma_f32_16x16x32_bf16 v[116:119], a[236:239], a[188:191], v[116:119]
v_lshlrev_b32 v240, 16, v240
v_mfma_f32_16x16x32_bf16 v[112:115], a[232:235], a[176:179], v[112:115]
v_mfma_f32_16x16x32_bf16 v[112:115], a[236:239], a[180:183], v[112:115]
v_mfma_f32_16x16x32_bf16 v[108:111], a[232:235], a[168:171], v[108:111]
v_mfma_f32_16x16x32_bf16 v[108:111], a[236:239], a[172:175], v[108:111]
v_mfma_f32_16x16x32_bf16 v[104:107], a[232:235], a[160:163], v[104:107]
v_mfma_f32_16x16x32_bf16 v[104:107], a[236:239], a[164:167], v[104:107]
v_mfma_f32_16x16x32_bf16 v[100:103], a[232:235], a[152:155], v[100:103]
v_mfma_f32_16x16x32_bf16 v[100:103], a[236:239], a[156:159], v[100:103]
v_mfma_f32_16x16x32_bf16 v[96:99], a[232:235], a[144:147], v[96:99]
buffer_load_dwordx4 a[232:235], v254, s[8:11], s20 offen offset:1024
v_mfma_f32_16x16x32_bf16 v[96:99], a[236:239], a[148:151], v[96:99]
s_waitcnt vmcnt(11)
v_mfma_f32_32x32x16_bf16 v[32:47], v[244:247], v[240:243], v[32:47]
v_mfma_f32_16x16x32_bf16 v[128:131], a[240:243], a[144:147], v[128:131]
buffer_load_dwordx4 a[236:239], v254, s[8:11], s20 offen offset:2048
v_mfma_f32_16x16x32_bf16 v[128:131], a[244:247], a[148:151], v[128:131]
v_mfma_f32_16x16x32_bf16 v[132:135], a[240:243], a[152:155], v[132:135]
v_mfma_f32_16x16x32_bf16 v[132:135], a[244:247], a[156:159], v[132:135]
v_mfma_f32_32x32x16_bf16 v[48:63], v[244:247], v[240:243], v[48:63]
v_mfma_f32_16x16x32_bf16 v[136:139], a[240:243], a[160:163], v[136:139]
v_mfma_f32_16x16x32_bf16 v[136:139], a[244:247], a[164:167], v[136:139]
v_accvgpr_read_b32 v241, a254
v_mfma_f32_16x16x32_bf16 v[140:143], a[240:243], a[168:171], v[140:143]
v_mov_b32 v240, 0
v_mfma_f32_16x16x32_bf16 v[140:143], a[244:247], a[172:175], v[140:143]
v_mfma_f32_16x16x32_bf16 v[144:147], a[240:243], a[176:179], v[144:147]
s_add_u32 m0, s34, 52224
v_mfma_f32_16x16x32_bf16 v[144:147], a[244:247], a[180:183], v[144:147]
buffer_load_dwordx4 v255, s[12:15], s32 offen  lds
v_mfma_f32_16x16x32_bf16 v[148:151], a[240:243], a[184:187], v[148:151]
s_add_u32 s32, s32, 4294918272
v_mfma_f32_16x16x32_bf16 v[148:151], a[244:247], a[188:191], v[148:151]
v_mfma_f32_16x16x32_bf16 v[152:155], a[240:243], a[192:195], v[152:155]
v_mfma_f32_16x16x32_bf16 v[152:155], a[244:247], a[196:199], v[152:155]
v_mfma_f32_16x16x32_bf16 v[156:159], a[240:243], a[200:203], v[156:159]
buffer_load_dwordx4 a[240:243], v254, s[8:11], s20 offen offset:3072
v_mfma_f32_16x16x32_bf16 v[156:159], a[244:247], a[204:207], v[156:159]
s_waitcnt vmcnt(11)
s_add_u32 s20, s20, 4096
v_mfma_f32_32x32x16_bf16 v[64:79], v[244:247], v[240:243], v[64:79]
v_mfma_f32_16x16x32_bf16 v[188:191], a[248:251], a[200:203], v[188:191]
buffer_load_dwordx4 a[244:247], v254, s[8:11], s20 offen offset:0
v_mfma_f32_16x16x32_bf16 v[188:191], a[208:211], a[204:207], v[188:191]
v_mfma_f32_16x16x32_bf16 v[184:187], a[248:251], a[192:195], v[184:187]
v_mfma_f32_16x16x32_bf16 v[184:187], a[208:211], a[196:199], v[184:187]
v_mfma_f32_32x32x16_bf16 v[80:95], v[244:247], v[240:243], v[80:95]
v_mfma_f32_16x16x32_bf16 v[180:183], a[248:251], a[184:187], v[180:183]
v_mfma_f32_16x16x32_bf16 v[180:183], a[208:211], a[188:191], v[180:183]
v_lshlrev_b32 v241, 16, v241
v_mfma_f32_16x16x32_bf16 v[176:179], a[248:251], a[176:179], v[176:179]
v_mfma_f32_16x16x32_bf16 v[176:179], a[208:211], a[180:183], v[176:179]
v_mfma_f32_16x16x32_bf16 v[172:175], a[248:251], a[168:171], v[172:175]
v_mfma_f32_16x16x32_bf16 v[172:175], a[208:211], a[172:175], v[172:175]
s_barrier
v_mfma_f32_16x16x32_bf16 v[168:171], a[248:251], a[160:163], v[168:171]
v_mfma_f32_16x16x32_bf16 v[168:171], a[208:211], a[164:167], v[168:171]
v_mfma_f32_16x16x32_bf16 v[164:167], a[248:251], a[152:155], v[164:167]
v_mfma_f32_16x16x32_bf16 v[164:167], a[208:211], a[156:159], v[164:167]
v_mfma_f32_16x16x32_bf16 v[160:163], a[248:251], a[144:147], v[160:163]
buffer_load_dwordx4 a[248:251], v254, s[8:11], s20 offen offset:1024
v_mfma_f32_16x16x32_bf16 v[160:163], a[208:211], a[148:151], v[160:163]
s_waitcnt vmcnt(10)
v_mfma_f32_32x32x16_bf16 v[96:111], v[244:247], v[240:243], v[96:111]
v_mfma_f32_16x16x32_bf16 v[192:195], a[212:215], a[144:147], v[192:195]
buffer_load_dwordx4 a[208:211], v254, s[8:11], s20 offen offset:2048
v_mfma_f32_16x16x32_bf16 v[192:195], a[216:219], a[148:151], v[192:195]
v_mfma_f32_16x16x32_bf16 v[196:199], a[212:215], a[152:155], v[196:199]
v_mfma_f32_16x16x32_bf16 v[196:199], a[216:219], a[156:159], v[196:199]
v_mfma_f32_32x32x16_bf16 v[112:127], v[244:247], v[240:243], v[112:127]
v_mfma_f32_16x16x32_bf16 v[200:203], a[212:215], a[160:163], v[200:203]
v_mfma_f32_16x16x32_bf16 v[200:203], a[216:219], a[164:167], v[200:203]
v_accvgpr_read_b32 v242, a254
v_mfma_f32_16x16x32_bf16 v[204:207], a[212:215], a[168:171], v[204:207]
v_mov_b32 v241, 0
v_mfma_f32_16x16x32_bf16 v[204:207], a[216:219], a[172:175], v[204:207]
v_mfma_f32_16x16x32_bf16 v[208:211], a[212:215], a[176:179], v[208:211]
v_mfma_f32_16x16x32_bf16 v[208:211], a[216:219], a[180:183], v[208:211]
v_mfma_f32_16x16x32_bf16 v[212:215], a[212:215], a[184:187], v[212:215]
v_mfma_f32_16x16x32_bf16 v[212:215], a[216:219], a[188:191], v[212:215]
v_mfma_f32_16x16x32_bf16 v[216:219], a[212:215], a[192:195], v[216:219]
v_mfma_f32_16x16x32_bf16 v[216:219], a[216:219], a[196:199], v[216:219]
v_mfma_f32_16x16x32_bf16 v[220:223], a[212:215], a[200:203], v[220:223]
buffer_load_dwordx4 a[212:215], v254, s[8:11], s20 offen offset:3072
v_mfma_f32_16x16x32_bf16 v[220:223], a[216:219], a[204:207], v[220:223]
s_waitcnt vmcnt(10)
s_add_u32 s20, s20, 4096
v_mfma_f32_32x32x16_bf16 v[128:143], v[244:247], v[240:243], v[128:143]
v_mfma_f32_16x16x32_bf16 a[12:15], a[220:223], a[200:203], a[12:15]
ds_read_b128 a[200:203], v252 offset:30720
v_mfma_f32_16x16x32_bf16 a[12:15], a[224:227], a[204:207], a[12:15]
ds_read_b128 a[204:207], v252 offset:31232
v_mfma_f32_16x16x32_bf16 a[8:11], a[220:223], a[192:195], a[8:11]
ds_read_b128 a[192:195], v252 offset:28672
v_mfma_f32_16x16x32_bf16 a[8:11], a[224:227], a[196:199], a[8:11]
v_mfma_f32_32x32x16_bf16 v[144:159], v[244:247], v[240:243], v[144:159]
ds_read_b128 a[196:199], v252 offset:29184
v_mfma_f32_16x16x32_bf16 a[4:7], a[220:223], a[184:187], a[4:7]
ds_read_b128 a[184:187], v252 offset:26624
v_mfma_f32_16x16x32_bf16 a[4:7], a[224:227], a[188:191], a[4:7]
ds_read_b128 a[188:191], v252 offset:27136
v_lshlrev_b32 v242, 16, v242
v_mfma_f32_16x16x32_bf16 a[0:3], a[220:223], a[176:179], a[0:3]
ds_read_b128 a[176:179], v252 offset:24576
v_mfma_f32_16x16x32_bf16 a[0:3], a[224:227], a[180:183], a[0:3]
ds_read_b128 a[180:183], v252 offset:25088
v_mfma_f32_16x16x32_bf16 v[236:239], a[220:223], a[168:171], v[236:239]
ds_read_b128 a[168:171], v252 offset:22528
v_mfma_f32_16x16x32_bf16 v[236:239], a[224:227], a[172:175], v[236:239]
ds_read_b128 a[172:175], v252 offset:23040
v_mfma_f32_16x16x32_bf16 v[232:235], a[220:223], a[160:163], v[232:235]
ds_read_b128 a[160:163], v252 offset:20480
v_mfma_f32_16x16x32_bf16 v[232:235], a[224:227], a[164:167], v[232:235]
ds_read_b128 a[164:167], v252 offset:20992
v_mfma_f32_16x16x32_bf16 v[228:231], a[220:223], a[152:155], v[228:231]
ds_read_b128 a[152:155], v252 offset:18432
v_mfma_f32_16x16x32_bf16 v[228:231], a[224:227], a[156:159], v[228:231]
ds_read_b128 a[156:159], v252 offset:18944
v_mfma_f32_16x16x32_bf16 v[224:227], a[220:223], a[144:147], v[224:227]
ds_read_b128 a[144:147], v252 offset:16384
v_mfma_f32_16x16x32_bf16 v[224:227], a[224:227], a[148:151], v[224:227]
s_waitcnt vmcnt(7) lgkmcnt(11)
v_mfma_f32_32x32x16_bf16 v[160:175], v[244:247], v[240:243], v[160:175]
ds_read_b128 a[148:151], v252 offset:16896
v_mfma_f32_16x16x32_bf16 v[28:31], a[228:231], a[200:203], v[28:31]
s_add_u32 m0, s34, 65536
buffer_load_dwordx4 a[220:223], v254, s[8:11], s20 offen offset:0
v_mfma_f32_16x16x32_bf16 v[28:31], a[232:235], a[204:207], v[28:31]
buffer_load_dwordx4 v255, s[12:15], s32 offen  lds
v_mfma_f32_16x16x32_bf16 v[24:27], a[228:231], a[192:195], v[24:27]
s_add_u32 s32, s32, 16384
buffer_load_dwordx4 a[224:227], v254, s[8:11], s20 offen offset:1024
v_mfma_f32_16x16x32_bf16 v[24:27], a[232:235], a[196:199], v[24:27]
s_waitcnt lgkmcnt(8)
v_mfma_f32_32x32x16_bf16 v[176:191], v[244:247], v[240:243], v[176:191]
v_mfma_f32_16x16x32_bf16 v[20:23], a[228:231], a[184:187], v[20:23]
v_mfma_f32_16x16x32_bf16 v[20:23], a[232:235], a[188:191], v[20:23]
v_accvgpr_read_b32 v243, a254
v_mfma_f32_16x16x32_bf16 v[16:19], a[228:231], a[176:179], v[16:19]
v_mov_b32 v242, 0
v_mfma_f32_16x16x32_bf16 v[16:19], a[232:235], a[180:183], v[16:19]
s_waitcnt lgkmcnt(4)
v_mfma_f32_16x16x32_bf16 v[12:15], a[228:231], a[168:171], v[12:15]
v_mfma_f32_16x16x32_bf16 v[12:15], a[232:235], a[172:175], v[12:15]
v_mfma_f32_16x16x32_bf16 v[8:11], a[228:231], a[160:163], v[8:11]
v_mfma_f32_16x16x32_bf16 v[8:11], a[232:235], a[164:167], v[8:11]
s_waitcnt lgkmcnt(0)
v_mfma_f32_16x16x32_bf16 v[4:7], a[228:231], a[152:155], v[4:7]
v_mfma_f32_16x16x32_bf16 v[4:7], a[232:235], a[156:159], v[4:7]
v_mfma_f32_16x16x32_bf16 v[0:3], a[228:231], a[144:147], v[0:3]
buffer_load_dwordx4 a[228:231], v254, s[8:11], s20 offen offset:2048
v_mfma_f32_16x16x32_bf16 v[0:3], a[232:235], a[148:151], v[0:3]
s_waitcnt vmcnt(8)
v_mfma_f32_32x32x16_bf16 v[192:207], v[244:247], v[240:243], v[192:207]
v_mfma_f32_16x16x32_bf16 v[32:35], a[236:239], a[144:147], v[32:35]
buffer_load_dwordx4 a[232:235], v254, s[8:11], s20 offen offset:3072
v_mfma_f32_16x16x32_bf16 v[32:35], a[240:243], a[148:151], v[32:35]
s_add_u32 s20, s20, 4096
v_mfma_f32_16x16x32_bf16 v[36:39], a[236:239], a[152:155], v[36:39]
v_mfma_f32_16x16x32_bf16 v[36:39], a[240:243], a[156:159], v[36:39]
v_mfma_f32_32x32x16_bf16 v[208:223], v[244:247], v[240:243], v[208:223]
v_mfma_f32_16x16x32_bf16 v[40:43], a[236:239], a[160:163], v[40:43]
v_mfma_f32_16x16x32_bf16 v[40:43], a[240:243], a[164:167], v[40:43]
v_lshlrev_b32 v243, 16, v243
v_mfma_f32_16x16x32_bf16 v[44:47], a[236:239], a[168:171], v[44:47]
v_mfma_f32_16x16x32_bf16 v[44:47], a[240:243], a[172:175], v[44:47]
v_mfma_f32_16x16x32_bf16 v[48:51], a[236:239], a[176:179], v[48:51]
s_add_u32 m0, s34, 66560
v_mfma_f32_16x16x32_bf16 v[48:51], a[240:243], a[180:183], v[48:51]
buffer_load_dwordx4 v255, s[12:15], s32 offen  lds
v_mfma_f32_16x16x32_bf16 v[52:55], a[236:239], a[184:187], v[52:55]
s_add_u32 s32, s32, 16384
v_mfma_f32_16x16x32_bf16 v[52:55], a[240:243], a[188:191], v[52:55]
v_mfma_f32_16x16x32_bf16 v[56:59], a[236:239], a[192:195], v[56:59]
v_mfma_f32_16x16x32_bf16 v[56:59], a[240:243], a[196:199], v[56:59]
v_mfma_f32_16x16x32_bf16 v[60:63], a[236:239], a[200:203], v[60:63]
buffer_load_dwordx4 a[236:239], v254, s[8:11], s20 offen offset:0
v_mfma_f32_16x16x32_bf16 v[60:63], a[240:243], a[204:207], v[60:63]
s_waitcnt vmcnt(9)
v_mfma_f32_32x32x16_bf16 v[224:239], v[244:247], v[240:243], v[224:239]
v_mfma_f32_16x16x32_bf16 v[92:95], a[244:247], a[200:203], v[92:95]
buffer_load_dwordx4 a[240:243], v254, s[8:11], s20 offen offset:1024
v_mfma_f32_16x16x32_bf16 v[92:95], a[248:251], a[204:207], v[92:95]
v_mfma_f32_16x16x32_bf16 v[88:91], a[244:247], a[192:195], v[88:91]
v_mfma_f32_16x16x32_bf16 v[88:91], a[248:251], a[196:199], v[88:91]
v_mfma_f32_32x32x16_bf16 a[0:15], v[244:247], v[240:243], a[0:15]
v_mfma_f32_16x16x32_bf16 v[84:87], a[244:247], a[184:187], v[84:87]
v_mfma_f32_16x16x32_bf16 v[84:87], a[248:251], a[188:191], v[84:87]
v_mfma_f32_16x16x32_bf16 v[80:83], a[244:247], a[176:179], v[80:83]
v_mfma_f32_16x16x32_bf16 v[80:83], a[248:251], a[180:183], v[80:83]
v_mfma_f32_16x16x32_bf16 v[76:79], a[244:247], a[168:171], v[76:79]
v_mfma_f32_16x16x32_bf16 v[76:79], a[248:251], a[172:175], v[76:79]
v_mfma_f32_16x16x32_bf16 v[72:75], a[244:247], a[160:163], v[72:75]
v_mfma_f32_16x16x32_bf16 v[72:75], a[248:251], a[164:167], v[72:75]
v_mfma_f32_16x16x32_bf16 v[68:71], a[244:247], a[152:155], v[68:71]
v_mfma_f32_16x16x32_bf16 v[68:71], a[248:251], a[156:159], v[68:71]
v_mfma_f32_16x16x32_bf16 v[64:67], a[244:247], a[144:147], v[64:67]
buffer_load_dwordx4 a[244:247], v254, s[8:11], s20 offen offset:2048
v_mfma_f32_16x16x32_bf16 v[64:67], a[248:251], a[148:151], v[64:67]
s_waitcnt vmcnt(9)
buffer_load_dword v244, off, s[60:63], s67 offset:128 sc1
v_mfma_f32_16x16x32_bf16 v[96:99], a[208:211], a[144:147], v[96:99]
s_add_u32 m0, s34, 67584
buffer_load_dwordx4 a[248:251], v254, s[8:11], s20 offen offset:3072
v_mfma_f32_16x16x32_bf16 v[96:99], a[212:215], a[148:151], v[96:99]
s_add_u32 s20, s20, 4096
buffer_load_dwordx4 v255, s[12:15], s32 offen  lds
v_mfma_f32_16x16x32_bf16 v[100:103], a[208:211], a[152:155], v[100:103]
s_add_u32 s32, s32, 16384
v_mfma_f32_16x16x32_bf16 v[100:103], a[212:215], a[156:159], v[100:103]
v_mfma_f32_16x16x32_bf16 v[104:107], a[208:211], a[160:163], v[104:107]
v_mfma_f32_16x16x32_bf16 v[104:107], a[212:215], a[164:167], v[104:107]
v_mfma_f32_16x16x32_bf16 v[108:111], a[208:211], a[168:171], v[108:111]
v_mfma_f32_16x16x32_bf16 v[108:111], a[212:215], a[172:175], v[108:111]
v_mfma_f32_16x16x32_bf16 v[112:115], a[208:211], a[176:179], v[112:115]
v_mfma_f32_16x16x32_bf16 v[112:115], a[212:215], a[180:183], v[112:115]
v_mfma_f32_16x16x32_bf16 v[116:119], a[208:211], a[184:187], v[116:119]
v_mfma_f32_16x16x32_bf16 v[116:119], a[212:215], a[188:191], v[116:119]
v_mfma_f32_16x16x32_bf16 v[120:123], a[208:211], a[192:195], v[120:123]
v_mfma_f32_16x16x32_bf16 v[120:123], a[212:215], a[196:199], v[120:123]
v_mfma_f32_16x16x32_bf16 v[124:127], a[208:211], a[200:203], v[124:127]
buffer_load_dwordx4 a[208:211], v254, s[8:11], s20 offen offset:0
v_mfma_f32_16x16x32_bf16 v[124:127], a[212:215], a[204:207], v[124:127]
s_waitcnt vmcnt(10)
v_mfma_f32_16x16x32_bf16 v[156:159], a[220:223], a[200:203], v[156:159]
buffer_load_dwordx4 a[212:215], v254, s[8:11], s20 offen offset:1024
v_mfma_f32_16x16x32_bf16 v[156:159], a[224:227], a[204:207], v[156:159]
v_mfma_f32_16x16x32_bf16 v[152:155], a[220:223], a[192:195], v[152:155]
buffer_load_dwordx4 a[216:219], v254, s[8:11], s20 offen offset:2048
v_mfma_f32_16x16x32_bf16 v[152:155], a[224:227], a[196:199], v[152:155]
v_mfma_f32_16x16x32_bf16 v[148:151], a[220:223], a[184:187], v[148:151]
v_mfma_f32_16x16x32_bf16 v[148:151], a[224:227], a[188:191], v[148:151]
v_mfma_f32_16x16x32_bf16 v[144:147], a[220:223], a[176:179], v[144:147]
v_mfma_f32_16x16x32_bf16 v[144:147], a[224:227], a[180:183], v[144:147]
v_mfma_f32_16x16x32_bf16 v[140:143], a[220:223], a[168:171], v[140:143]
s_add_u32 m0, s34, 68608
v_mfma_f32_16x16x32_bf16 v[140:143], a[224:227], a[172:175], v[140:143]
buffer_load_dwordx4 v255, s[12:15], s32 offen  lds
v_mfma_f32_16x16x32_bf16 v[136:139], a[220:223], a[160:163], v[136:139]
s_add_u32 s32, s32, 4294918272
v_mfma_f32_16x16x32_bf16 v[136:139], a[224:227], a[164:167], v[136:139]
v_mfma_f32_16x16x32_bf16 v[132:135], a[220:223], a[152:155], v[132:135]
v_mfma_f32_16x16x32_bf16 v[132:135], a[224:227], a[156:159], v[132:135]
v_mfma_f32_16x16x32_bf16 v[128:131], a[220:223], a[144:147], v[128:131]
buffer_load_dwordx4 a[220:223], v254, s[8:11], s20 offen offset:3072
v_mfma_f32_16x16x32_bf16 v[128:131], a[224:227], a[148:151], v[128:131]
s_waitcnt vmcnt(12)
s_add_u32 s20, s20, 4096
v_mfma_f32_16x16x32_bf16 v[160:163], a[228:231], a[144:147], v[160:163]
buffer_load_dwordx4 a[224:227], v254, s[8:11], s20 offen offset:0
v_mfma_f32_16x16x32_bf16 v[160:163], a[232:235], a[148:151], v[160:163]
v_mfma_f32_16x16x32_bf16 v[164:167], a[228:231], a[152:155], v[164:167]
v_mfma_f32_16x16x32_bf16 v[164:167], a[232:235], a[156:159], v[164:167]
v_mfma_f32_16x16x32_bf16 v[168:171], a[228:231], a[160:163], v[168:171]
v_mfma_f32_16x16x32_bf16 v[168:171], a[232:235], a[164:167], v[168:171]
v_mfma_f32_16x16x32_bf16 v[172:175], a[228:231], a[168:171], v[172:175]
v_mfma_f32_16x16x32_bf16 v[172:175], a[232:235], a[172:175], v[172:175]
v_mfma_f32_16x16x32_bf16 v[176:179], a[228:231], a[176:179], v[176:179]
v_mfma_f32_16x16x32_bf16 v[176:179], a[232:235], a[180:183], v[176:179]
s_barrier
v_mfma_f32_16x16x32_bf16 v[180:183], a[228:231], a[184:187], v[180:183]
v_mfma_f32_16x16x32_bf16 v[180:183], a[232:235], a[188:191], v[180:183]
v_mfma_f32_16x16x32_bf16 v[184:187], a[228:231], a[192:195], v[184:187]
v_mfma_f32_16x16x32_bf16 v[184:187], a[232:235], a[196:199], v[184:187]
v_mfma_f32_16x16x32_bf16 v[188:191], a[228:231], a[200:203], v[188:191]
buffer_load_dwordx4 a[228:231], v254, s[8:11], s20 offen offset:1024
v_mfma_f32_16x16x32_bf16 v[188:191], a[232:235], a[204:207], v[188:191]
s_waitcnt vmcnt(11)
v_mfma_f32_16x16x32_bf16 v[220:223], a[236:239], a[200:203], v[220:223]
buffer_load_dwordx4 a[232:235], v254, s[8:11], s20 offen offset:2048
v_mfma_f32_16x16x32_bf16 v[220:223], a[240:243], a[204:207], v[220:223]
v_mfma_f32_16x16x32_bf16 v[216:219], a[236:239], a[192:195], v[216:219]
v_mfma_f32_16x16x32_bf16 v[216:219], a[240:243], a[196:199], v[216:219]
v_mfma_f32_16x16x32_bf16 v[212:215], a[236:239], a[184:187], v[212:215]
v_mfma_f32_16x16x32_bf16 v[212:215], a[240:243], a[188:191], v[212:215]
v_mfma_f32_16x16x32_bf16 v[208:211], a[236:239], a[176:179], v[208:211]
v_mfma_f32_16x16x32_bf16 v[208:211], a[240:243], a[180:183], v[208:211]
v_mfma_f32_16x16x32_bf16 v[204:207], a[236:239], a[168:171], v[204:207]
v_mfma_f32_16x16x32_bf16 v[204:207], a[240:243], a[172:175], v[204:207]
v_mfma_f32_16x16x32_bf16 v[200:203], a[236:239], a[160:163], v[200:203]
v_mfma_f32_16x16x32_bf16 v[200:203], a[240:243], a[164:167], v[200:203]
v_mfma_f32_16x16x32_bf16 v[196:199], a[236:239], a[152:155], v[196:199]
v_mfma_f32_16x16x32_bf16 v[196:199], a[240:243], a[156:159], v[196:199]
v_mfma_f32_16x16x32_bf16 v[192:195], a[236:239], a[144:147], v[192:195]
buffer_load_dwordx4 a[236:239], v254, s[8:11], s20 offen offset:3072
v_mfma_f32_16x16x32_bf16 v[192:195], a[240:243], a[148:151], v[192:195]
s_waitcnt vmcnt(10)
s_add_u32 s20, s20, 4096
v_mfma_f32_16x16x32_bf16 v[224:227], a[244:247], a[144:147], v[224:227]
ds_read_b128 a[144:147], v252 offset:32768
buffer_load_dwordx4 a[240:243], v254, s[8:11], s20 offen offset:0
v_mfma_f32_16x16x32_bf16 v[224:227], a[248:251], a[148:151], v[224:227]
ds_read_b128 a[148:151], v252 offset:33280
v_mfma_f32_16x16x32_bf16 v[228:231], a[244:247], a[152:155], v[228:231]
ds_read_b128 a[152:155], v252 offset:34816
v_mfma_f32_16x16x32_bf16 v[228:231], a[248:251], a[156:159], v[228:231]
ds_read_b128 a[156:159], v252 offset:35328
v_mfma_f32_16x16x32_bf16 v[232:235], a[244:247], a[160:163], v[232:235]
ds_read_b128 a[160:163], v252 offset:36864
v_mfma_f32_16x16x32_bf16 v[232:235], a[248:251], a[164:167], v[232:235]
ds_read_b128 a[164:167], v252 offset:37376
v_cmp_le_u32 vcc, 28, v244
v_mfma_f32_16x16x32_bf16 v[236:239], a[244:247], a[168:171], v[236:239]
ds_read_b128 a[168:171], v252 offset:38912
v_mfma_f32_16x16x32_bf16 v[236:239], a[248:251], a[172:175], v[236:239]
ds_read_b128 a[172:175], v252 offset:39424
s_cmp_eq_u64 vcc, -1
s_cbranch_scc0 L_spinAdbg2
L_retAdbg2:
v_mfma_f32_16x16x32_bf16 a[0:3], a[244:247], a[176:179], a[0:3]
ds_read_b128 a[176:179], v252 offset:40960
v_mfma_f32_16x16x32_bf16 a[0:3], a[248:251], a[180:183], a[0:3]
ds_read_b128 a[180:183], v252 offset:41472
v_mfma_f32_16x16x32_bf16 a[4:7], a[244:247], a[184:187], a[4:7]
ds_read_b128 a[184:187], v252 offset:43008
v_mfma_f32_16x16x32_bf16 a[4:7], a[248:251], a[188:191], a[4:7]
ds_read_b128 a[188:191], v252 offset:43520
v_mfma_f32_16x16x32_bf16 a[8:11], a[244:247], a[192:195], a[8:11]
ds_read_b128 a[192:195], v252 offset:45056
v_mfma_f32_16x16x32_bf16 a[8:11], a[248:251], a[196:199], a[8:11]
ds_read_b128 a[196:199], v252 offset:45568
v_mfma_f32_16x16x32_bf16 a[12:15], a[244:247], a[200:203], a[12:15]
ds_read_b128 a[200:203], v252 offset:47104
v_mfma_f32_16x16x32_bf16 a[12:15], a[248:251], a[204:207], a[12:15]
s_waitcnt vmcnt(8) lgkmcnt(11)
ds_read_b128 a[204:207], v252 offset:47616
v_mfma_f32_16x16x32_bf16 v[0:3], a[208:211], a[144:147], v[0:3]
s_add_u32 m0, s34, 81920
buffer_load_dwordx4 a[244:247], v254, s[8:11], s20 offen offset:1024
v_mfma_f32_16x16x32_bf16 v[0:3], a[212:215], a[148:151], v[0:3]
buffer_load_dwordx4 v255, s[12:15], s32 offen  lds
v_mfma_f32_16x16x32_bf16 v[4:7], a[208:211], a[152:155], v[4:7]
s_add_u32 s32, s32, 16384
buffer_load_dwordx4 a[248:251], v254, s[8:11], s20 offen offset:2048
v_mfma_f32_16x16x32_bf16 v[4:7], a[212:215], a[156:159], v[4:7]
s_waitcnt lgkmcnt(8)
buffer_load_dword v244, off, s[60:63], s67 offset:0 sc1
v_mfma_f32_16x16x32_bf16 v[8:11], a[208:211], a[160:163], v[8:11]
v_mfma_f32_16x16x32_bf16 v[8:11], a[212:215], a[164:167], v[8:11]
v_mfma_f32_16x16x32_bf16 v[12:15], a[208:211], a[168:171], v[12:15]
v_mfma_f32_16x16x32_bf16 v[12:15], a[212:215], a[172:175], v[12:15]
s_waitcnt lgkmcnt(4)
v_mfma_f32_16x16x32_bf16 v[16:19], a[208:211], a[176:179], v[16:19]
v_mfma_f32_16x16x32_bf16 v[16:19], a[212:215], a[180:183], v[16:19]
v_mfma_f32_16x16x32_bf16 v[20:23], a[208:211], a[184:187], v[20:23]
v_mfma_f32_16x16x32_bf16 v[20:23], a[212:215], a[188:191], v[20:23]
s_waitcnt lgkmcnt(0)
v_mfma_f32_16x16x32_bf16 v[24:27], a[208:211], a[192:195], v[24:27]
v_mfma_f32_16x16x32_bf16 v[24:27], a[212:215], a[196:199], v[24:27]
v_mfma_f32_16x16x32_bf16 v[28:31], a[208:211], a[200:203], v[28:31]
buffer_load_dwordx4 a[208:211], v254, s[8:11], s20 offen offset:3072
v_mfma_f32_16x16x32_bf16 v[28:31], a[212:215], a[204:207], v[28:31]
s_waitcnt vmcnt(10)
s_add_u32 s20, s20, 4096
v_mfma_f32_16x16x32_bf16 v[60:63], a[216:219], a[200:203], v[60:63]
buffer_load_dwordx4 a[212:215], v254, s[8:11], s20 offen offset:0
v_mfma_f32_16x16x32_bf16 v[60:63], a[220:223], a[204:207], v[60:63]
v_mfma_f32_16x16x32_bf16 v[56:59], a[216:219], a[192:195], v[56:59]
v_mfma_f32_16x16x32_bf16 v[56:59], a[220:223], a[196:199], v[56:59]
v_mfma_f32_16x16x32_bf16 v[52:55], a[216:219], a[184:187], v[52:55]
v_mfma_f32_16x16x32_bf16 v[52:55], a[220:223], a[188:191], v[52:55]
v_mfma_f32_16x16x32_bf16 v[48:51], a[216:219], a[176:179], v[48:51]
v_mfma_f32_16x16x32_bf16 v[48:51], a[220:223], a[180:183], v[48:51]
v_mfma_f32_16x16x32_bf16 v[44:47], a[216:219], a[168:171], v[44:47]
s_add_u32 m0, s34, 82944
v_mfma_f32_16x16x32_bf16 v[44:47], a[220:223], a[172:175], v[44:47]
buffer_load_dwordx4 v255, s[12:15], s32 offen  lds
v_mfma_f32_16x16x32_bf16 v[40:43], a[216:219], a[160:163], v[40:43]
s_add_u32 s32, s32, 16384
v_mfma_f32_16x16x32_bf16 v[40:43], a[220:223], a[164:167], v[40:43]
v_mfma_f32_16x16x32_bf16 v[36:39], a[216:219], a[152:155], v[36:39]
v_mfma_f32_16x16x32_bf16 v[36:39], a[220:223], a[156:159], v[36:39]
v_mfma_f32_16x16x32_bf16 v[32:35], a[216:219], a[144:147], v[32:35]
buffer_load_dwordx4 a[216:219], v254, s[8:11], s20 offen offset:1024
v_mfma_f32_16x16x32_bf16 v[32:35], a[220:223], a[148:151], v[32:35]
s_waitcnt vmcnt(11)
v_mfma_f32_16x16x32_bf16 v[64:67], a[224:227], a[144:147], v[64:67]
buffer_load_dwordx4 a[220:223], v254, s[8:11], s20 offen offset:2048
v_mfma_f32_16x16x32_bf16 v[64:67], a[228:231], a[148:151], v[64:67]
v_mfma_f32_16x16x32_bf16 v[68:71], a[224:227], a[152:155], v[68:71]
v_mfma_f32_16x16x32_bf16 v[68:71], a[228:231], a[156:159], v[68:71]
v_mfma_f32_16x16x32_bf16 v[72:75], a[224:227], a[160:163], v[72:75]
v_mfma_f32_16x16x32_bf16 v[72:75], a[228:231], a[164:167], v[72:75]
v_mfma_f32_16x16x32_bf16 v[76:79], a[224:227], a[168:171], v[76:79]
v_mfma_f32_16x16x32_bf16 v[76:79], a[228:231], a[172:175], v[76:79]
v_mfma_f32_16x16x32_bf16 v[80:83], a[224:227], a[176:179], v[80:83]
v_mfma_f32_16x16x32_bf16 v[80:83], a[228:231], a[180:183], v[80:83]
v_mfma_f32_16x16x32_bf16 v[84:87], a[224:227], a[184:187], v[84:87]
v_mfma_f32_16x16x32_bf16 v[84:87], a[228:231], a[188:191], v[84:87]
v_mfma_f32_16x16x32_bf16 v[88:91], a[224:227], a[192:195], v[88:91]
v_mfma_f32_16x16x32_bf16 v[88:91], a[228:231], a[196:199], v[88:91]
v_mfma_f32_16x16x32_bf16 v[92:95], a[224:227], a[200:203], v[92:95]
buffer_load_dwordx4 a[224:227], v254, s[8:11], s20 offen offset:3072
v_mfma_f32_16x16x32_bf16 v[92:95], a[228:231], a[204:207], v[92:95]
s_waitcnt vmcnt(11)
s_add_u32 s20, s20, 4096
v_mfma_f32_16x16x32_bf16 v[124:127], a[232:235], a[200:203], v[124:127]
s_add_u32 m0, s34, 83968
buffer_load_dwordx4 a[228:231], v254, s[8:11], s20 offen offset:0
v_mfma_f32_16x16x32_bf16 v[124:127], a[236:239], a[204:207], v[124:127]
buffer_load_dwordx4 v255, s[12:15], s32 offen  lds
v_mfma_f32_16x16x32_bf16 v[120:123], a[232:235], a[192:195], v[120:123]
s_add_u32 s32, s32, 16384
v_mfma_f32_16x16x32_bf16 v[120:123], a[236:239], a[196:199], v[120:123]
v_mfma_f32_16x16x32_bf16 v[116:119], a[232:235], a[184:187], v[116:119]
v_mfma_f32_16x16x32_bf16 v[116:119], a[236:239], a[188:191], v[116:119]
v_mfma_f32_16x16x32_bf16 v[112:115], a[232:235], a[176:179], v[112:115]
v_mfma_f32_16x16x32_bf16 v[112:115], a[236:239], a[180:183], v[112:115]
v_mfma_f32_16x16x32_bf16 v[108:111], a[232:235], a[168:171], v[108:111]
v_mfma_f32_16x16x32_bf16 v[108:111], a[236:239], a[172:175], v[108:111]
v_mfma_f32_16x16x32_bf16 v[104:107], a[232:235], a[160:163], v[104:107]
v_mfma_f32_16x16x32_bf16 v[104:107], a[236:239], a[164:167], v[104:107]
v_mfma_f32_16x16x32_bf16 v[100:103], a[232:235], a[152:155], v[100:103]
v_mfma_f32_16x16x32_bf16 v[100:103], a[236:239], a[156:159], v[100:103]
v_mfma_f32_16x16x32_bf16 v[96:99], a[232:235], a[144:147], v[96:99]
s_waitcnt vmcnt(8)
buffer_load_dwordx4 a[232:235], v254, s[8:11], s20 offen offset:1024
v_cmp_le_u32 vcc, 4, v244
v_mfma_f32_16x16x32_bf16 v[96:99], a[236:239], a[148:151], v[96:99]
v_mfma_f32_16x16x32_bf16 v[128:131], a[240:243], a[144:147], v[128:131]
buffer_load_dwordx4 a[236:239], v254, s[8:11], s20 offen offset:2048
s_cmp_eq_u64 vcc, -1
s_cbranch_scc0 L_spinAdbg3
L_retAdbg3:
v_mfma_f32_16x16x32_bf16 v[128:131], a[244:247], a[148:151], v[128:131]
v_mfma_f32_16x16x32_bf16 v[132:135], a[240:243], a[152:155], v[132:135]
v_mfma_f32_16x16x32_bf16 v[132:135], a[244:247], a[156:159], v[132:135]
v_mfma_f32_16x16x32_bf16 v[136:139], a[240:243], a[160:163], v[136:139]
v_mfma_f32_16x16x32_bf16 v[136:139], a[244:247], a[164:167], v[136:139]
v_mfma_f32_16x16x32_bf16 v[140:143], a[240:243], a[168:171], v[140:143]
v_mfma_f32_16x16x32_bf16 v[140:143], a[244:247], a[172:175], v[140:143]
v_mfma_f32_16x16x32_bf16 v[144:147], a[240:243], a[176:179], v[144:147]
s_add_u32 m0, s34, 84992
v_mfma_f32_16x16x32_bf16 v[144:147], a[244:247], a[180:183], v[144:147]
buffer_load_dwordx4 v255, s[12:15], s32 offen  lds
v_mfma_f32_16x16x32_bf16 v[148:151], a[240:243], a[184:187], v[148:151]
s_add_u32 s32, s32, 4294918272
v_mfma_f32_16x16x32_bf16 v[148:151], a[244:247], a[188:191], v[148:151]
v_mfma_f32_16x16x32_bf16 v[152:155], a[240:243], a[192:195], v[152:155]
v_mfma_f32_16x16x32_bf16 v[152:155], a[244:247], a[196:199], v[152:155]
v_mfma_f32_16x16x32_bf16 v[156:159], a[240:243], a[200:203], v[156:159]
buffer_load_dwordx4 a[240:243], v254, s[8:11], s20 offen offset:3072
v_mfma_f32_16x16x32_bf16 v[156:159], a[244:247], a[204:207], v[156:159]
s_waitcnt vmcnt(11)
s_add_u32 s20, s20, 4096
v_mfma_f32_16x16x32_bf16 v[188:191], a[248:251], a[200:203], v[188:191]
buffer_load_dwordx4 a[244:247], v254, s[8:11], s20 offen offset:0
v_mfma_f32_16x16x32_bf16 v[188:191], a[208:211], a[204:207], v[188:191]
v_mfma_f32_16x16x32_bf16 v[184:187], a[248:251], a[192:195], v[184:187]
v_mfma_f32_16x16x32_bf16 v[184:187], a[208:211], a[196:199], v[184:187]
v_mfma_f32_16x16x32_bf16 v[180:183], a[248:251], a[184:187], v[180:183]
v_mfma_f32_16x16x32_bf16 v[180:183], a[208:211], a[188:191], v[180:183]
v_mfma_f32_16x16x32_bf16 v[176:179], a[248:251], a[176:179], v[176:179]
v_mfma_f32_16x16x32_bf16 v[176:179], a[208:211], a[180:183], v[176:179]
v_mfma_f32_16x16x32_bf16 v[172:175], a[248:251], a[168:171], v[172:175]
v_mfma_f32_16x16x32_bf16 v[172:175], a[208:211], a[172:175], v[172:175]
s_barrier
v_mfma_f32_16x16x32_bf16 v[168:171], a[248:251], a[160:163], v[168:171]
v_mfma_f32_16x16x32_bf16 v[168:171], a[208:211], a[164:167], v[168:171]
v_mfma_f32_16x16x32_bf16 v[164:167], a[248:251], a[152:155], v[164:167]
v_mfma_f32_16x16x32_bf16 v[164:167], a[208:211], a[156:159], v[164:167]
v_mfma_f32_16x16x32_bf16 v[160:163], a[248:251], a[144:147], v[160:163]
buffer_load_dwordx4 a[248:251], v254, s[8:11], s20 offen offset:1024
v_mfma_f32_16x16x32_bf16 v[160:163], a[208:211], a[148:151], v[160:163]
s_waitcnt vmcnt(10)
v_mfma_f32_16x16x32_bf16 v[192:195], a[212:215], a[144:147], v[192:195]
buffer_load_dwordx4 a[208:211], v254, s[8:11], s20 offen offset:2048
v_mfma_f32_16x16x32_bf16 v[192:195], a[216:219], a[148:151], v[192:195]
v_mfma_f32_16x16x32_bf16 v[196:199], a[212:215], a[152:155], v[196:199]
v_mfma_f32_16x16x32_bf16 v[196:199], a[216:219], a[156:159], v[196:199]
v_mfma_f32_16x16x32_bf16 v[200:203], a[212:215], a[160:163], v[200:203]
v_mfma_f32_16x16x32_bf16 v[200:203], a[216:219], a[164:167], v[200:203]
v_mfma_f32_16x16x32_bf16 v[204:207], a[212:215], a[168:171], v[204:207]
v_mfma_f32_16x16x32_bf16 v[204:207], a[216:219], a[172:175], v[204:207]
v_mfma_f32_16x16x32_bf16 v[208:211], a[212:215], a[176:179], v[208:211]
v_mfma_f32_16x16x32_bf16 v[208:211], a[216:219], a[180:183], v[208:211]
v_mfma_f32_16x16x32_bf16 v[212:215], a[212:215], a[184:187], v[212:215]
v_mfma_f32_16x16x32_bf16 v[212:215], a[216:219], a[188:191], v[212:215]
v_mfma_f32_16x16x32_bf16 v[216:219], a[212:215], a[192:195], v[216:219]
v_mfma_f32_16x16x32_bf16 v[216:219], a[216:219], a[196:199], v[216:219]
v_mfma_f32_16x16x32_bf16 v[220:223], a[212:215], a[200:203], v[220:223]
buffer_load_dwordx4 a[212:215], v254, s[8:11], s20 offen offset:3072
v_mfma_f32_16x16x32_bf16 v[220:223], a[216:219], a[204:207], v[220:223]
s_waitcnt vmcnt(10)
s_add_u32 s20, s20, 4096
v_mfma_f32_16x16x32_bf16 a[12:15], a[220:223], a[200:203], a[12:15]
ds_read_b128 a[200:203], v252 offset:63488
v_mfma_f32_16x16x32_bf16 a[12:15], a[224:227], a[204:207], a[12:15]
ds_read_b128 a[204:207], v252 offset:64000
v_mfma_f32_16x16x32_bf16 a[8:11], a[220:223], a[192:195], a[8:11]
ds_read_b128 a[192:195], v252 offset:61440
v_mfma_f32_16x16x32_bf16 a[8:11], a[224:227], a[196:199], a[8:11]
ds_read_b128 a[196:199], v252 offset:61952
v_mfma_f32_16x16x32_bf16 a[4:7], a[220:223], a[184:187], a[4:7]
ds_read_b128 a[184:187], v252 offset:59392
v_mfma_f32_16x16x32_bf16 a[4:7], a[224:227], a[188:191], a[4:7]
ds_read_b128 a[188:191], v252 offset:59904
v_mfma_f32_16x16x32_bf16 a[0:3], a[220:223], a[176:179], a[0:3]
ds_read_b128 a[176:179], v252 offset:57344
v_mfma_f32_16x16x32_bf16 a[0:3], a[224:227], a[180:183], a[0:3]
ds_read_b128 a[180:183], v252 offset:57856
v_mfma_f32_16x16x32_bf16 v[236:239], a[220:223], a[168:171], v[236:239]
ds_read_b128 a[168:171], v252 offset:55296
v_mfma_f32_16x16x32_bf16 v[236:239], a[224:227], a[172:175], v[236:239]
ds_read_b128 a[172:175], v252 offset:55808
v_mfma_f32_16x16x32_bf16 v[232:235], a[220:223], a[160:163], v[232:235]
ds_read_b128 a[160:163], v252 offset:53248
v_mfma_f32_16x16x32_bf16 v[232:235], a[224:227], a[164:167], v[232:235]
ds_read_b128 a[164:167], v252 offset:53760
v_mfma_f32_16x16x32_bf16 v[228:231], a[220:223], a[152:155], v[228:231]
ds_read_b128 a[152:155], v252 offset:51200
v_mfma_f32_16x16x32_bf16 v[228:231], a[224:227], a[156:159], v[228:231]
ds_read_b128 a[156:159], v252 offset:51712
v_mfma_f32_16x16x32_bf16 v[224:227], a[220:223], a[144:147], v[224:227]
ds_read_b128 a[144:147], v252 offset:49152
v_mfma_f32_16x16x32_bf16 v[224:227], a[224:227], a[148:151], v[224:227]
s_waitcnt vmcnt(7) lgkmcnt(11)
ds_read_b128 a[148:151], v252 offset:49664
v_mfma_f32_16x16x32_bf16 v[28:31], a[228:231], a[200:203], v[28:31]
s_add_u32 m0, s34, 98304
buffer_load_dwordx4 a[220:223], v254, s[8:11], s20 offen offset:0
v_mfma_f32_16x16x32_bf16 v[28:31], a[232:235], a[204:207], v[28:31]
buffer_load_dwordx4 v255, s[12:15], s32 offen  lds
v_mfma_f32_16x16x32_bf16 v[24:27], a[228:231], a[192:195], v[24:27]
s_add_u32 s32, s32, 16384
buffer_load_dwordx4 a[224:227], v254, s[8:11], s20 offen offset:1024
v_mfma_f32_16x16x32_bf16 v[24:27], a[232:235], a[196:199], v[24:27]
s_waitcnt lgkmcnt(8)
v_mfma_f32_16x16x32_bf16 v[20:23], a[228:231], a[184:187], v[20:23]
v_mfma_f32_16x16x32_bf16 v[20:23], a[232:235], a[188:191], v[20:23]
v_mfma_f32_16x16x32_bf16 v[16:19], a[228:231], a[176:179], v[16:19]
v_mfma_f32_16x16x32_bf16 v[16:19], a[232:235], a[180:183], v[16:19]
s_waitcnt lgkmcnt(4)
v_mfma_f32_16x16x32_bf16 v[12:15], a[228:231], a[168:171], v[12:15]
v_mfma_f32_16x16x32_bf16 v[12:15], a[232:235], a[172:175], v[12:15]
v_mfma_f32_16x16x32_bf16 v[8:11], a[228:231], a[160:163], v[8:11]
v_mfma_f32_16x16x32_bf16 v[8:11], a[232:235], a[164:167], v[8:11]
s_waitcnt lgkmcnt(0)
v_mfma_f32_16x16x32_bf16 v[4:7], a[228:231], a[152:155], v[4:7]
v_mfma_f32_16x16x32_bf16 v[4:7], a[232:235], a[156:159], v[4:7]
v_mfma_f32_16x16x32_bf16 v[0:3], a[228:231], a[144:147], v[0:3]
buffer_load_dwordx4 a[228:231], v254, s[8:11], s20 offen offset:2048
v_mfma_f32_16x16x32_bf16 v[0:3], a[232:235], a[148:151], v[0:3]
s_waitcnt vmcnt(8)
v_mfma_f32_16x16x32_bf16 v[32:35], a[236:239], a[144:147], v[32:35]
buffer_load_dwordx4 a[232:235], v254, s[8:11], s20 offen offset:3072
v_mfma_f32_16x16x32_bf16 v[32:35], a[240:243], a[148:151], v[32:35]
s_add_u32 s20, s20, 4096
v_mfma_f32_16x16x32_bf16 v[36:39], a[236:239], a[152:155], v[36:39]
v_mfma_f32_16x16x32_bf16 v[36:39], a[240:243], a[156:159], v[36:39]
v_mfma_f32_16x16x32_bf16 v[40:43], a[236:239], a[160:163], v[40:43]
v_mfma_f32_16x16x32_bf16 v[40:43], a[240:243], a[164:167], v[40:43]
v_mfma_f32_16x16x32_bf16 v[44:47], a[236:239], a[168:171], v[44:47]
v_mfma_f32_16x16x32_bf16 v[44:47], a[240:243], a[172:175], v[44:47]
v_mfma_f32_16x16x32_bf16 v[48:51], a[236:239], a[176:179], v[48:51]
s_add_u32 m0, s34, 99328
v_mfma_f32_16x16x32_bf16 v[48:51], a[240:243], a[180:183], v[48:51]
buffer_load_dwordx4 v255, s[12:15], s32 offen  lds
v_mfma_f32_16x16x32_bf16 v[52:55], a[236:239], a[184:187], v[52:55]
s_add_u32 s32, s32, 16384
v_mfma_f32_16x16x32_bf16 v[52:55], a[240:243], a[188:191], v[52:55]
v_mfma_f32_16x16x32_bf16 v[56:59], a[236:239], a[192:195], v[56:59]
v_mfma_f32_16x16x32_bf16 v[56:59], a[240:243], a[196:199], v[56:59]
v_mfma_f32_16x16x32_bf16 v[60:63], a[236:239], a[200:203], v[60:63]
buffer_load_dwordx4 a[236:239], v254, s[8:11], s20 offen offset:0
v_mfma_f32_16x16x32_bf16 v[60:63], a[240:243], a[204:207], v[60:63]
s_waitcnt vmcnt(9)
v_mbcnt_lo_u32_b32 v248, -1, 0
v_mfma_f32_16x16x32_bf16 v[92:95], a[244:247], a[200:203], v[92:95]
buffer_load_dwordx4 a[240:243], v254, s[8:11], s20 offen offset:1024
v_mbcnt_hi_u32_b32 v248, -1, v248
v_mfma_f32_16x16x32_bf16 v[92:95], a[248:251], a[204:207], v[92:95]
v_and_b32 v248, 31, v248
v_mfma_f32_16x16x32_bf16 v[88:91], a[244:247], a[192:195], v[88:91]
v_lshlrev_b32 v248, 8, v248
v_mfma_f32_16x16x32_bf16 v[88:91], a[248:251], a[196:199], v[88:91]
buffer_load_dwordx4 v[244:247], v248, s[8:11], s51 offen sc1
v_mfma_f32_16x16x32_bf16 v[84:87], a[244:247], a[184:187], v[84:87]
v_mfma_f32_16x16x32_bf16 v[84:87], a[248:251], a[188:191], v[84:87]
v_mfma_f32_16x16x32_bf16 v[80:83], a[244:247], a[176:179], v[80:83]
v_mfma_f32_16x16x32_bf16 v[80:83], a[248:251], a[180:183], v[80:83]
v_mfma_f32_16x16x32_bf16 v[76:79], a[244:247], a[168:171], v[76:79]
v_mfma_f32_16x16x32_bf16 v[76:79], a[248:251], a[172:175], v[76:79]
v_mfma_f32_16x16x32_bf16 v[72:75], a[244:247], a[160:163], v[72:75]
v_mfma_f32_16x16x32_bf16 v[72:75], a[248:251], a[164:167], v[72:75]
v_mfma_f32_16x16x32_bf16 v[68:71], a[244:247], a[152:155], v[68:71]
v_mfma_f32_16x16x32_bf16 v[68:71], a[248:251], a[156:159], v[68:71]
v_mfma_f32_16x16x32_bf16 v[64:67], a[244:247], a[144:147], v[64:67]
buffer_load_dwordx4 a[244:247], v254, s[8:11], s20 offen offset:2048
v_mfma_f32_16x16x32_bf16 v[64:67], a[248:251], a[148:151], v[64:67]
s_waitcnt vmcnt(10)
v_mfma_f32_16x16x32_bf16 v[96:99], a[208:211], a[144:147], v[96:99]
s_add_u32 m0, s34, 100352
buffer_load_dwordx4 a[248:251], v254, s[8:11], s20 offen offset:3072
v_mfma_f32_16x16x32_bf16 v[96:99], a[212:215], a[148:151], v[96:99]
s_add_u32 s20, s20, 4096
buffer_load_dwordx4 v255, s[12:15], s32 offen  lds
v_mfma_f32_16x16x32_bf16 v[100:103], a[208:211], a[152:155], v[100:103]
s_add_u32 s32, s32, 16384
v_mfma_f32_16x16x32_bf16 v[100:103], a[212:215], a[156:159], v[100:103]
v_mfma_f32_16x16x32_bf16 v[104:107], a[208:211], a[160:163], v[104:107]
v_mfma_f32_16x16x32_bf16 v[104:107], a[212:215], a[164:167], v[104:107]
v_mfma_f32_16x16x32_bf16 v[108:111], a[208:211], a[168:171], v[108:111]
v_mfma_f32_16x16x32_bf16 v[108:111], a[212:215], a[172:175], v[108:111]
v_mfma_f32_16x16x32_bf16 v[112:115], a[208:211], a[176:179], v[112:115]
v_mfma_f32_16x16x32_bf16 v[112:115], a[212:215], a[180:183], v[112:115]
v_mfma_f32_16x16x32_bf16 v[116:119], a[208:211], a[184:187], v[116:119]
v_mfma_f32_16x16x32_bf16 v[116:119], a[212:215], a[188:191], v[116:119]
v_mfma_f32_16x16x32_bf16 v[120:123], a[208:211], a[192:195], v[120:123]
v_mfma_f32_16x16x32_bf16 v[120:123], a[212:215], a[196:199], v[120:123]
v_mfma_f32_16x16x32_bf16 v[124:127], a[208:211], a[200:203], v[124:127]
buffer_load_dwordx4 a[208:211], v254, s[8:11], s20 offen offset:0
v_mfma_f32_16x16x32_bf16 v[124:127], a[212:215], a[204:207], v[124:127]
s_waitcnt vmcnt(10)
v_mfma_f32_16x16x32_bf16 v[156:159], a[220:223], a[200:203], v[156:159]
buffer_load_dwordx4 a[212:215], v254, s[8:11], s20 offen offset:1024
v_mfma_f32_16x16x32_bf16 v[156:159], a[224:227], a[204:207], v[156:159]
v_mfma_f32_16x16x32_bf16 v[152:155], a[220:223], a[192:195], v[152:155]
buffer_load_dwordx4 a[216:219], v254, s[8:11], s20 offen offset:2048
v_mfma_f32_16x16x32_bf16 v[152:155], a[224:227], a[196:199], v[152:155]
v_mfma_f32_16x16x32_bf16 v[148:151], a[220:223], a[184:187], v[148:151]
v_mfma_f32_16x16x32_bf16 v[148:151], a[224:227], a[188:191], v[148:151]
v_mfma_f32_16x16x32_bf16 v[144:147], a[220:223], a[176:179], v[144:147]
v_mfma_f32_16x16x32_bf16 v[144:147], a[224:227], a[180:183], v[144:147]
v_mfma_f32_16x16x32_bf16 v[140:143], a[220:223], a[168:171], v[140:143]
s_add_u32 m0, s34, 101376
v_mfma_f32_16x16x32_bf16 v[140:143], a[224:227], a[172:175], v[140:143]
buffer_load_dwordx4 v255, s[12:15], s32 offen  lds
v_mfma_f32_16x16x32_bf16 v[136:139], a[220:223], a[160:163], v[136:139]
s_add_u32 s32, s32, 4294918272
v_mfma_f32_16x16x32_bf16 v[136:139], a[224:227], a[164:167], v[136:139]
v_mfma_f32_16x16x32_bf16 v[132:135], a[220:223], a[152:155], v[132:135]
v_mfma_f32_16x16x32_bf16 v[132:135], a[224:227], a[156:159], v[132:135]
v_mfma_f32_16x16x32_bf16 v[128:131], a[220:223], a[144:147], v[128:131]
buffer_load_dwordx4 a[220:223], v254, s[8:11], s20 offen offset:3072
v_mfma_f32_16x16x32_bf16 v[128:131], a[224:227], a[148:151], v[128:131]
s_waitcnt vmcnt(12)
s_add_u32 s20, s20, 4096
v_mfma_f32_16x16x32_bf16 v[160:163], a[228:231], a[144:147], v[160:163]
buffer_load_dwordx4 a[224:227], v254, s[8:11], s20 offen offset:0
v_mfma_f32_16x16x32_bf16 v[160:163], a[232:235], a[148:151], v[160:163]
v_mfma_f32_16x16x32_bf16 v[164:167], a[228:231], a[152:155], v[164:167]
v_mfma_f32_16x16x32_bf16 v[164:167], a[232:235], a[156:159], v[164:167]
v_mfma_f32_16x16x32_bf16 v[168:171], a[228:231], a[160:163], v[168:171]
v_mfma_f32_16x16x32_bf16 v[168:171], a[232:235], a[164:167], v[168:171]
v_mfma_f32_16x16x32_bf16 v[172:175], a[228:231], a[168:171], v[172:175]
v_mfma_f32_16x16x32_bf16 v[172:175], a[232:235], a[172:175], v[172:175]
v_mfma_f32_16x16x32_bf16 v[176:179], a[228:231], a[176:179], v[176:179]
v_mfma_f32_16x16x32_bf16 v[176:179], a[232:235], a[180:183], v[176:179]
s_barrier
v_mfma_f32_16x16x32_bf16 v[180:183], a[228:231], a[184:187], v[180:183]
v_mfma_f32_16x16x32_bf16 v[180:183], a[232:235], a[188:191], v[180:183]
v_mfma_f32_16x16x32_bf16 v[184:187], a[228:231], a[192:195], v[184:187]
v_mfma_f32_16x16x32_bf16 v[184:187], a[232:235], a[196:199], v[184:187]
v_mfma_f32_16x16x32_bf16 v[188:191], a[228:231], a[200:203], v[188:191]
buffer_load_dwordx4 a[228:231], v254, s[8:11], s20 offen offset:1024
v_mfma_f32_16x16x32_bf16 v[188:191], a[232:235], a[204:207], v[188:191]
s_waitcnt vmcnt(11)
v_mfma_f32_16x16x32_bf16 v[220:223], a[236:239], a[200:203], v[220:223]
buffer_load_dwordx4 a[232:235], v254, s[8:11], s20 offen offset:2048
v_mfma_f32_16x16x32_bf16 v[220:223], a[240:243], a[204:207], v[220:223]
v_mfma_f32_16x16x32_bf16 v[216:219], a[236:239], a[192:195], v[216:219]
v_mfma_f32_16x16x32_bf16 v[216:219], a[240:243], a[196:199], v[216:219]
v_mfma_f32_16x16x32_bf16 v[212:215], a[236:239], a[184:187], v[212:215]
v_mfma_f32_16x16x32_bf16 v[212:215], a[240:243], a[188:191], v[212:215]
v_xor_b32 v252, 0x10000, v252
v_mfma_f32_16x16x32_bf16 v[208:211], a[236:239], a[176:179], v[208:211]
v_mfma_f32_16x16x32_bf16 v[208:211], a[240:243], a[180:183], v[208:211]
v_mfma_f32_16x16x32_bf16 v[204:207], a[236:239], a[168:171], v[204:207]
v_mfma_f32_16x16x32_bf16 v[204:207], a[240:243], a[172:175], v[204:207]
v_mfma_f32_16x16x32_bf16 v[200:203], a[236:239], a[160:163], v[200:203]
v_mfma_f32_16x16x32_bf16 v[200:203], a[240:243], a[164:167], v[200:203]
v_mfma_f32_16x16x32_bf16 v[196:199], a[236:239], a[152:155], v[196:199]
v_mfma_f32_16x16x32_bf16 v[196:199], a[240:243], a[156:159], v[196:199]
v_mfma_f32_16x16x32_bf16 v[192:195], a[236:239], a[144:147], v[192:195]
buffer_load_dwordx4 a[236:239], v254, s[8:11], s20 offen offset:3072
v_mfma_f32_16x16x32_bf16 v[192:195], a[240:243], a[148:151], v[192:195]
s_waitcnt vmcnt(10)
s_add_u32 s20, s20, 4096
v_mfma_f32_16x16x32_bf16 v[224:227], a[244:247], a[144:147], v[224:227]
ds_read_b128 a[144:147], v252 offset:0
buffer_load_dwordx4 a[240:243], v254, s[8:11], s20 offen offset:0
v_mfma_f32_16x16x32_bf16 v[224:227], a[248:251], a[148:151], v[224:227]
ds_read_b128 a[148:151], v252 offset:512
v_mfma_f32_16x16x32_bf16 v[228:231], a[244:247], a[152:155], v[228:231]
ds_read_b128 a[152:155], v252 offset:2048
v_mfma_f32_16x16x32_bf16 v[228:231], a[248:251], a[156:159], v[228:231]
ds_read_b128 a[156:159], v252 offset:2560
v_mfma_f32_16x16x32_bf16 v[232:235], a[244:247], a[160:163], v[232:235]
ds_read_b128 a[160:163], v252 offset:4096
v_min_u32 v244, v244, v245
v_mfma_f32_16x16x32_bf16 v[232:235], a[248:251], a[164:167], v[232:235]
ds_read_b128 a[164:167], v252 offset:4608
v_min3_u32 v244, v244, v246, v247
v_mfma_f32_16x16x32_bf16 v[236:239], a[244:247], a[168:171], v[236:239]
ds_read_b128 a[168:171], v252 offset:6144
v_cmp_lt_u32 vcc, s22, v244
v_mfma_f32_16x16x32_bf16 v[236:239], a[248:251], a[172:175], v[236:239]
ds_read_b128 a[172:175], v252 offset:6656
v_mfma_f32_16x16x32_bf16 a[0:3], a[244:247], a[176:179], a[0:3]
ds_read_b128 a[176:179], v252 offset:8192
s_cmp_eq_u64 vcc, -1
s_cbranch_scc0 L_spinAwf
L_retAwf:
v_mfma_f32_16x16x32_bf16 a[0:3], a[248:251], a[180:183], a[0:3]
ds_read_b128 a[180:183], v252 offset:8704
v_mfma_f32_16x16x32_bf16 a[4:7], a[244:247], a[184:187], a[4:7]
ds_read_b128 a[184:187], v252 offset:10240
v_mfma_f32_16x16x32_bf16 a[4:7], a[248:251], a[188:191], a[4:7]
ds_read_b128 a[188:191], v252 offset:10752
v_mfma_f32_16x16x32_bf16 a[8:11], a[244:247], a[192:195], a[8:11]
ds_read_b128 a[192:195], v252 offset:12288
v_mfma_f32_16x16x32_bf16 a[8:11], a[248:251], a[196:199], a[8:11]
ds_read_b128 a[196:199], v252 offset:12800
v_mfma_f32_16x16x32_bf16 a[12:15], a[244:247], a[200:203], a[12:15]
ds_read_b128 a[200:203], v252 offset:14336
v_mfma_f32_16x16x32_bf16 a[12:15], a[248:251], a[204:207], a[12:15]
s_waitcnt vmcnt(8) lgkmcnt(11)
ds_read_b128 a[204:207], v252 offset:14848
v_mfma_f32_16x16x32_bf16 v[0:3], a[208:211], a[144:147], v[0:3]
s_add_u32 m0, s34, 114688
buffer_load_dwordx4 a[244:247], v254, s[8:11], s20 offen offset:1024
v_mfma_f32_16x16x32_bf16 v[0:3], a[212:215], a[148:151], v[0:3]
buffer_load_dwordx4 v255, s[12:15], s32 offen  lds
v_mfma_f32_16x16x32_bf16 v[4:7], a[208:211], a[152:155], v[4:7]
s_add_u32 s32, s32, 16384
buffer_load_dwordx4 a[248:251], v254, s[8:11], s20 offen offset:2048
v_mfma_f32_16x16x32_bf16 v[4:7], a[212:215], a[156:159], v[4:7]
s_waitcnt lgkmcnt(8)
v_mfma_f32_16x16x32_bf16 v[8:11], a[208:211], a[160:163], v[8:11]
v_mfma_f32_16x16x32_bf16 v[8:11], a[212:215], a[164:167], v[8:11]
v_mfma_f32_16x16x32_bf16 v[12:15], a[208:211], a[168:171], v[12:15]
v_mfma_f32_16x16x32_bf16 v[12:15], a[212:215], a[172:175], v[12:15]
s_waitcnt lgkmcnt(4)
v_mfma_f32_16x16x32_bf16 v[16:19], a[208:211], a[176:179], v[16:19]
v_mfma_f32_16x16x32_bf16 v[16:19], a[212:215], a[180:183], v[16:19]
v_mfma_f32_16x16x32_bf16 v[20:23], a[208:211], a[184:187], v[20:23]
v_mfma_f32_16x16x32_bf16 v[20:23], a[212:215], a[188:191], v[20:23]
s_waitcnt lgkmcnt(0)
v_mfma_f32_16x16x32_bf16 v[24:27], a[208:211], a[192:195], v[24:27]
v_mfma_f32_16x16x32_bf16 v[24:27], a[212:215], a[196:199], v[24:27]
v_mfma_f32_16x16x32_bf16 v[28:31], a[208:211], a[200:203], v[28:31]
buffer_load_dwordx4 a[208:211], v254, s[8:11], s20 offen offset:3072
v_mfma_f32_16x16x32_bf16 v[28:31], a[212:215], a[204:207], v[28:31]
s_waitcnt vmcnt(9)
s_add_u32 s20, s20, 4096
v_mfma_f32_16x16x32_bf16 v[60:63], a[216:219], a[200:203], v[60:63]
buffer_load_dwordx4 a[212:215], v254, s[8:11], s20 offen offset:0
v_mfma_f32_16x16x32_bf16 v[60:63], a[220:223], a[204:207], v[60:63]
v_mfma_f32_16x16x32_bf16 v[56:59], a[216:219], a[192:195], v[56:59]
v_mfma_f32_16x16x32_bf16 v[56:59], a[220:223], a[196:199], v[56:59]
v_mfma_f32_16x16x32_bf16 v[52:55], a[216:219], a[184:187], v[52:55]
v_mfma_f32_16x16x32_bf16 v[52:55], a[220:223], a[188:191], v[52:55]
s_getpc_b64 s[4:5]
s_mov_b32 s6, L_codeend - .
v_mfma_f32_16x16x32_bf16 v[48:51], a[216:219], a[176:179], v[48:51]
s_mov_b32 s7, 0x00020000
v_mfma_f32_16x16x32_bf16 v[48:51], a[220:223], a[180:183], v[48:51]
s_lshr_b32 s43, s2, 3
v_mfma_f32_16x16x32_bf16 v[44:47], a[216:219], a[168:171], v[44:47]
s_add_u32 m0, s34, 115712
s_lshl_b32 s43, s43, 7
v_mfma_f32_16x16x32_bf16 v[44:47], a[220:223], a[172:175], v[44:47]
buffer_load_dwordx4 v255, s[12:15], s32 offen  lds
v_and_b32 v248, 0x1f0, v254
v_mfma_f32_16x16x32_bf16 v[40:43], a[216:219], a[160:163], v[40:43]
s_add_u32 s32, s32, 16384
v_lshlrev_b32 v248, 8, v248
v_mfma_f32_16x16x32_bf16 v[40:43], a[220:223], a[164:167], v[40:43]
buffer_load_dword v249, v248, s[4:7], s43 offen
v_mfma_f32_16x16x32_bf16 v[36:39], a[216:219], a[152:155], v[36:39]
v_mfma_f32_16x16x32_bf16 v[36:39], a[220:223], a[156:159], v[36:39]
v_mfma_f32_16x16x32_bf16 v[32:35], a[216:219], a[144:147], v[32:35]
buffer_load_dwordx4 a[216:219], v254, s[8:11], s20 offen offset:1024
v_mfma_f32_16x16x32_bf16 v[32:35], a[220:223], a[148:151], v[32:35]
s_waitcnt vmcnt(11)
v_mfma_f32_16x16x32_bf16 v[64:67], a[224:227], a[144:147], v[64:67]
buffer_load_dwordx4 a[220:223], v254, s[8:11], s20 offen offset:2048
v_mfma_f32_16x16x32_bf16 v[64:67], a[228:231], a[148:151], v[64:67]
v_mfma_f32_16x16x32_bf16 v[68:71], a[224:227], a[152:155], v[68:71]
v_mfma_f32_16x16x32_bf16 v[68:71], a[228:231], a[156:159], v[68:71]
v_mfma_f32_16x16x32_bf16 v[72:75], a[224:227], a[160:163], v[72:75]
v_mfma_f32_16x16x32_bf16 v[72:75], a[228:231], a[164:167], v[72:75]
v_mfma_f32_16x16x32_bf16 v[76:79], a[224:227], a[168:171], v[76:79]
v_mfma_f32_16x16x32_bf16 v[76:79], a[228:231], a[172:175], v[76:79]
v_mfma_f32_16x16x32_bf16 v[80:83], a[224:227], a[176:179], v[80:83]
v_mfma_f32_16x16x32_bf16 v[80:83], a[228:231], a[180:183], v[80:83]
v_mfma_f32_16x16x32_bf16 v[84:87], a[224:227], a[184:187], v[84:87]
v_mfma_f32_16x16x32_bf16 v[84:87], a[228:231], a[188:191], v[84:87]
v_mfma_f32_16x16x32_bf16 v[88:91], a[224:227], a[192:195], v[88:91]
v_mfma_f32_16x16x32_bf16 v[88:91], a[228:231], a[196:199], v[88:91]
v_mfma_f32_16x16x32_bf16 v[92:95], a[224:227], a[200:203], v[92:95]
buffer_load_dwordx4 a[224:227], v254, s[8:11], s20 offen offset:3072
v_mfma_f32_16x16x32_bf16 v[92:95], a[228:231], a[204:207], v[92:95]
s_waitcnt vmcnt(11)
s_add_u32 s20, s20, 4096
v_mfma_f32_16x16x32_bf16 v[124:127], a[232:235], a[200:203], v[124:127]
s_add_u32 m0, s34, 116736
buffer_load_dwordx4 a[228:231], v254, s[8:11], s20 offen offset:0
v_mfma_f32_16x16x32_bf16 v[124:127], a[236:239], a[204:207], v[124:127]
buffer_load_dwordx4 v255, s[12:15], s32 offen  lds
v_mfma_f32_16x16x32_bf16 v[120:123], a[232:235], a[192:195], v[120:123]
s_add_u32 s32, s32, 16384
v_mfma_f32_16x16x32_bf16 v[120:123], a[236:239], a[196:199], v[120:123]
v_mfma_f32_16x16x32_bf16 v[116:119], a[232:235], a[184:187], v[116:119]
v_mfma_f32_16x16x32_bf16 v[116:119], a[236:239], a[188:191], v[116:119]
v_mfma_f32_16x16x32_bf16 v[112:115], a[232:235], a[176:179], v[112:115]
v_mfma_f32_16x16x32_bf16 v[112:115], a[236:239], a[180:183], v[112:115]
v_mfma_f32_16x16x32_bf16 v[108:111], a[232:235], a[168:171], v[108:111]
v_mfma_f32_16x16x32_bf16 v[108:111], a[236:239], a[172:175], v[108:111]
v_mfma_f32_16x16x32_bf16 v[104:107], a[232:235], a[160:163], v[104:107]
v_mfma_f32_16x16x32_bf16 v[104:107], a[236:239], a[164:167], v[104:107]
v_mfma_f32_16x16x32_bf16 v[100:103], a[232:235], a[152:155], v[100:103]
v_mfma_f32_16x16x32_bf16 v[100:103], a[236:239], a[156:159], v[100:103]
v_mfma_f32_16x16x32_bf16 v[96:99], a[232:235], a[144:147], v[96:99]
buffer_load_dwordx4 a[232:235], v254, s[8:11], s20 offen offset:1024
v_mfma_f32_16x16x32_bf16 v[96:99], a[236:239], a[148:151], v[96:99]
s_waitcnt vmcnt(12)
v_mfma_f32_16x16x32_bf16 v[128:131], a[240:243], a[144:147], v[128:131]
buffer_load_dwordx4 a[236:239], v254, s[8:11], s20 offen offset:2048
v_mfma_f32_16x16x32_bf16 v[128:131], a[244:247], a[148:151], v[128:131]
v_mfma_f32_16x16x32_bf16 v[132:135], a[240:243], a[152:155], v[132:135]
v_mfma_f32_16x16x32_bf16 v[132:135], a[244:247], a[156:159], v[132:135]
v_mfma_f32_16x16x32_bf16 v[136:139], a[240:243], a[160:163], v[136:139]
v_mfma_f32_16x16x32_bf16 v[136:139], a[244:247], a[164:167], v[136:139]
v_mfma_f32_16x16x32_bf16 v[140:143], a[240:243], a[168:171], v[140:143]
v_mfma_f32_16x16x32_bf16 v[140:143], a[244:247], a[172:175], v[140:143]
v_mfma_f32_16x16x32_bf16 v[144:147], a[240:243], a[176:179], v[144:147]
s_add_u32 m0, s34, 117760
v_mfma_f32_16x16x32_bf16 v[144:147], a[244:247], a[180:183], v[144:147]
buffer_load_dwordx4 v255, s[12:15], s32 offen  lds
v_mfma_f32_16x16x32_bf16 v[148:151], a[240:243], a[184:187], v[148:151]
s_add_u32 s32, s32, 4294918272
v_mfma_f32_16x16x32_bf16 v[148:151], a[244:247], a[188:191], v[148:151]
v_mfma_f32_16x16x32_bf16 v[152:155], a[240:243], a[192:195], v[152:155]
v_mfma_f32_16x16x32_bf16 v[152:155], a[244:247], a[196:199], v[152:155]
v_mfma_f32_16x16x32_bf16 v[156:159], a[240:243], a[200:203], v[156:159]
buffer_load_dwordx4 a[240:243], v254, s[8:11], s20 offen offset:3072
v_mfma_f32_16x16x32_bf16 v[156:159], a[244:247], a[204:207], v[156:159]
s_waitcnt vmcnt(12)
s_add_u32 s20, s20, 4096
v_mfma_f32_16x16x32_bf16 v[188:191], a[248:251], a[200:203], v[188:191]
buffer_load_dwordx4 a[244:247], v254, s[8:11], s20 offen offset:0
v_mfma_f32_16x16x32_bf16 v[188:191], a[208:211], a[204:207], v[188:191]
v_mfma_f32_16x16x32_bf16 v[184:187], a[248:251], a[192:195], v[184:187]
v_mfma_f32_16x16x32_bf16 v[184:187], a[208:211], a[196:199], v[184:187]
v_mfma_f32_16x16x32_bf16 v[180:183], a[248:251], a[184:187], v[180:183]
v_mfma_f32_16x16x32_bf16 v[180:183], a[208:211], a[188:191], v[180:183]
v_mfma_f32_16x16x32_bf16 v[176:179], a[248:251], a[176:179], v[176:179]
v_mfma_f32_16x16x32_bf16 v[176:179], a[208:211], a[180:183], v[176:179]
v_mfma_f32_16x16x32_bf16 v[172:175], a[248:251], a[168:171], v[172:175]
v_mfma_f32_16x16x32_bf16 v[172:175], a[208:211], a[172:175], v[172:175]
s_barrier
v_mfma_f32_16x16x32_bf16 v[168:171], a[248:251], a[160:163], v[168:171]
v_mfma_f32_16x16x32_bf16 v[168:171], a[208:211], a[164:167], v[168:171]
v_mfma_f32_16x16x32_bf16 v[164:167], a[248:251], a[152:155], v[164:167]
v_mfma_f32_16x16x32_bf16 v[164:167], a[208:211], a[156:159], v[164:167]
v_mfma_f32_16x16x32_bf16 v[160:163], a[248:251], a[144:147], v[160:163]
buffer_load_dwordx4 a[248:251], v254, s[8:11], s20 offen offset:1024
v_mfma_f32_16x16x32_bf16 v[160:163], a[208:211], a[148:151], v[160:163]
s_waitcnt vmcnt(10)
v_mfma_f32_16x16x32_bf16 v[192:195], a[212:215], a[144:147], v[192:195]
s_add_u32 m0, s39, 34816
buffer_load_dwordx4 a[208:211], v254, s[8:11], s20 offen offset:2048
v_mfma_f32_16x16x32_bf16 v[192:195], a[216:219], a[148:151], v[192:195]
buffer_load_dwordx4 v250, s[52:55], s40 offen  lds
v_mfma_f32_16x16x32_bf16 v[196:199], a[212:215], a[152:155], v[196:199]
s_add_u32 s40, s40, 32768
v_mfma_f32_16x16x32_bf16 v[196:199], a[216:219], a[156:159], v[196:199]
v_mfma_f32_16x16x32_bf16 v[200:203], a[212:215], a[160:163], v[200:203]
s_add_u32 m0, s39, 35840
v_mfma_f32_16x16x32_bf16 v[200:203], a[216:219], a[164:167], v[200:203]
buffer_load_dwordx4 v250, s[52:55], s40 offen  lds
v_mfma_f32_16x16x32_bf16 v[204:207], a[212:215], a[168:171], v[204:207]
s_add_u32 s40, s40, 2064384
v_mfma_f32_16x16x32_bf16 v[204:207], a[216:219], a[172:175], v[204:207]
v_mfma_f32_16x16x32_bf16 v[208:211], a[212:215], a[176:179], v[208:211]
v_mfma_f32_16x16x32_bf16 v[208:211], a[216:219], a[180:183], v[208:211]
v_mfma_f32_16x16x32_bf16 v[212:215], a[212:215], a[184:187], v[212:215]
v_mfma_f32_16x16x32_bf16 v[212:215], a[216:219], a[188:191], v[212:215]
v_mfma_f32_16x16x32_bf16 v[216:219], a[212:215], a[192:195], v[216:219]
v_mfma_f32_16x16x32_bf16 v[216:219], a[216:219], a[196:199], v[216:219]
v_mfma_f32_16x16x32_bf16 v[220:223], a[212:215], a[200:203], v[220:223]
buffer_load_dwordx4 a[212:215], v254, s[8:11], s20 offen offset:3072
v_mfma_f32_16x16x32_bf16 v[220:223], a[216:219], a[204:207], v[220:223]
s_waitcnt vmcnt(12)
s_add_u32 s20, s20, 4096
v_mfma_f32_16x16x32_bf16 a[12:15], a[220:223], a[200:203], a[12:15]
ds_read_b128 a[200:203], v252 offset:30720
v_mfma_f32_16x16x32_bf16 a[12:15], a[224:227], a[204:207], a[12:15]
ds_read_b128 a[204:207], v252 offset:31232
v_mfma_f32_16x16x32_bf16 a[8:11], a[220:223], a[192:195], a[8:11]
ds_read_b128 a[192:195], v252 offset:28672
v_mfma_f32_16x16x32_bf16 a[8:11], a[224:227], a[196:199], a[8:11]
ds_read_b128 a[196:199], v252 offset:29184
v_mfma_f32_16x16x32_bf16 a[4:7], a[220:223], a[184:187], a[4:7]
ds_read_b128 a[184:187], v252 offset:26624
v_mfma_f32_16x16x32_bf16 a[4:7], a[224:227], a[188:191], a[4:7]
ds_read_b128 a[188:191], v252 offset:27136
v_mfma_f32_16x16x32_bf16 a[0:3], a[220:223], a[176:179], a[0:3]
ds_read_b128 a[176:179], v252 offset:24576
v_mfma_f32_16x16x32_bf16 a[0:3], a[224:227], a[180:183], a[0:3]
ds_read_b128 a[180:183], v252 offset:25088
v_mfma_f32_16x16x32_bf16 v[236:239], a[220:223], a[168:171], v[236:239]
ds_read_b128 a[168:171], v252 offset:22528
v_mfma_f32_16x16x32_bf16 v[236:239], a[224:227], a[172:175], v[236:239]
ds_read_b128 a[172:175], v252 offset:23040
v_mfma_f32_16x16x32_bf16 v[232:235], a[220:223], a[160:163], v[232:235]
ds_read_b128 a[160:163], v252 offset:20480
v_mfma_f32_16x16x32_bf16 v[232:235], a[224:227], a[164:167], v[232:235]
ds_read_b128 a[164:167], v252 offset:20992
v_mfma_f32_16x16x32_bf16 v[228:231], a[220:223], a[152:155], v[228:231]
ds_read_b128 a[152:155], v252 offset:18432
v_mfma_f32_16x16x32_bf16 v[228:231], a[224:227], a[156:159], v[228:231]
ds_read_b128 a[156:159], v252 offset:18944
v_mfma_f32_16x16x32_bf16 v[224:227], a[220:223], a[144:147], v[224:227]
ds_read_b128 a[144:147], v252 offset:16384
v_mfma_f32_16x16x32_bf16 v[224:227], a[224:227], a[148:151], v[224:227]
s_waitcnt vmcnt(9) lgkmcnt(11)
ds_read_b128 a[148:151], v252 offset:16896
v_mfma_f32_16x16x32_bf16 v[28:31], a[228:231], a[200:203], v[28:31]
buffer_load_dwordx4 a[220:223], v254, s[8:11], s20 offen offset:0
v_mfma_f32_16x16x32_bf16 v[28:31], a[232:235], a[204:207], v[28:31]
v_mfma_f32_16x16x32_bf16 v[24:27], a[228:231], a[192:195], v[24:27]
buffer_load_dwordx4 a[224:227], v254, s[8:11], s20 offen offset:1024
v_mfma_f32_16x16x32_bf16 v[24:27], a[232:235], a[196:199], v[24:27]
s_waitcnt lgkmcnt(8)
v_mfma_f32_16x16x32_bf16 v[20:23], a[228:231], a[184:187], v[20:23]
v_mfma_f32_16x16x32_bf16 v[20:23], a[232:235], a[188:191], v[20:23]
v_mfma_f32_16x16x32_bf16 v[16:19], a[228:231], a[176:179], v[16:19]
v_mfma_f32_16x16x32_bf16 v[16:19], a[232:235], a[180:183], v[16:19]
s_waitcnt lgkmcnt(4)
v_mfma_f32_16x16x32_bf16 v[12:15], a[228:231], a[168:171], v[12:15]
v_mfma_f32_16x16x32_bf16 v[12:15], a[232:235], a[172:175], v[12:15]
v_mfma_f32_16x16x32_bf16 v[8:11], a[228:231], a[160:163], v[8:11]
v_mfma_f32_16x16x32_bf16 v[8:11], a[232:235], a[164:167], v[8:11]
s_waitcnt lgkmcnt(0)
v_mfma_f32_16x16x32_bf16 v[4:7], a[228:231], a[152:155], v[4:7]
v_mfma_f32_16x16x32_bf16 v[4:7], a[232:235], a[156:159], v[4:7]
v_mfma_f32_16x16x32_bf16 v[0:3], a[228:231], a[144:147], v[0:3]
buffer_load_dwordx4 a[228:231], v254, s[8:11], s20 offen offset:2048
v_mfma_f32_16x16x32_bf16 v[0:3], a[232:235], a[148:151], v[0:3]
s_waitcnt vmcnt(9)
v_mfma_f32_16x16x32_bf16 v[32:35], a[236:239], a[144:147], v[32:35]
buffer_load_dwordx4 a[232:235], v254, s[8:11], s20 offen offset:3072
v_mfma_f32_16x16x32_bf16 v[32:35], a[240:243], a[148:151], v[32:35]
s_add_u32 s20, s20, 4096
v_mfma_f32_16x16x32_bf16 v[36:39], a[236:239], a[152:155], v[36:39]
v_mfma_f32_16x16x32_bf16 v[36:39], a[240:243], a[156:159], v[36:39]
v_mfma_f32_16x16x32_bf16 v[40:43], a[236:239], a[160:163], v[40:43]
v_mfma_f32_16x16x32_bf16 v[40:43], a[240:243], a[164:167], v[40:43]
v_mfma_f32_16x16x32_bf16 v[44:47], a[236:239], a[168:171], v[44:47]
v_mfma_f32_16x16x32_bf16 v[44:47], a[240:243], a[172:175], v[44:47]
v_mfma_f32_16x16x32_bf16 v[48:51], a[236:239], a[176:179], v[48:51]
v_mfma_f32_16x16x32_bf16 v[48:51], a[240:243], a[180:183], v[48:51]
v_mfma_f32_16x16x32_bf16 v[52:55], a[236:239], a[184:187], v[52:55]
v_mfma_f32_16x16x32_bf16 v[52:55], a[240:243], a[188:191], v[52:55]
v_mfma_f32_16x16x32_bf16 v[56:59], a[236:239], a[192:195], v[56:59]
v_mfma_f32_16x16x32_bf16 v[56:59], a[240:243], a[196:199], v[56:59]
v_mfma_f32_16x16x32_bf16 v[60:63], a[236:239], a[200:203], v[60:63]
buffer_load_dwordx4 a[236:239], v254, s[8:11], s20 offen offset:0
v_mfma_f32_16x16x32_bf16 v[60:63], a[240:243], a[204:207], v[60:63]
s_waitcnt vmcnt(9)
v_mfma_f32_16x16x32_bf16 v[92:95], a[244:247], a[200:203], v[92:95]
buffer_load_dwordx4 a[240:243], v254, s[8:11], s20 offen offset:1024
v_mfma_f32_16x16x32_bf16 v[92:95], a[248:251], a[204:207], v[92:95]
v_mfma_f32_16x16x32_bf16 v[88:91], a[244:247], a[192:195], v[88:91]
v_mfma_f32_16x16x32_bf16 v[88:91], a[248:251], a[196:199], v[88:91]
v_mfma_f32_16x16x32_bf16 v[84:87], a[244:247], a[184:187], v[84:87]
v_mfma_f32_16x16x32_bf16 v[84:87], a[248:251], a[188:191], v[84:87]
v_mfma_f32_16x16x32_bf16 v[80:83], a[244:247], a[176:179], v[80:83]
v_mfma_f32_16x16x32_bf16 v[80:83], a[248:251], a[180:183], v[80:83]
v_mfma_f32_16x16x32_bf16 v[76:79], a[244:247], a[168:171], v[76:79]
v_mfma_f32_16x16x32_bf16 v[76:79], a[248:251], a[172:175], v[76:79]
v_mfma_f32_16x16x32_bf16 v[72:75], a[244:247], a[160:163], v[72:75]
v_mfma_f32_16x16x32_bf16 v[72:75], a[248:251], a[164:167], v[72:75]
v_mfma_f32_16x16x32_bf16 v[68:71], a[244:247], a[152:155], v[68:71]
v_mfma_f32_16x16x32_bf16 v[68:71], a[248:251], a[156:159], v[68:71]
v_mfma_f32_16x16x32_bf16 v[64:67], a[244:247], a[144:147], v[64:67]
buffer_load_dwordx4 a[244:247], v254, s[8:11], s20 offen offset:2048
v_mfma_f32_16x16x32_bf16 v[64:67], a[248:251], a[148:151], v[64:67]
s_waitcnt vmcnt(7)
v_mfma_f32_16x16x32_bf16 v[96:99], a[208:211], a[144:147], v[96:99]
buffer_load_dwordx4 a[248:251], v254, s[8:11], s20 offen offset:3072
v_mfma_f32_16x16x32_bf16 v[96:99], a[212:215], a[148:151], v[96:99]
s_add_u32 s20, s20, 4096
v_mfma_f32_16x16x32_bf16 v[100:103], a[208:211], a[152:155], v[100:103]
v_mfma_f32_16x16x32_bf16 v[100:103], a[212:215], a[156:159], v[100:103]
v_mfma_f32_16x16x32_bf16 v[104:107], a[208:211], a[160:163], v[104:107]
v_mfma_f32_16x16x32_bf16 v[104:107], a[212:215], a[164:167], v[104:107]
v_mfma_f32_16x16x32_bf16 v[108:111], a[208:211], a[168:171], v[108:111]
v_mfma_f32_16x16x32_bf16 v[108:111], a[212:215], a[172:175], v[108:111]
v_mfma_f32_16x16x32_bf16 v[112:115], a[208:211], a[176:179], v[112:115]
v_mfma_f32_16x16x32_bf16 v[112:115], a[212:215], a[180:183], v[112:115]
v_mfma_f32_16x16x32_bf16 v[116:119], a[208:211], a[184:187], v[116:119]
v_mfma_f32_16x16x32_bf16 v[116:119], a[212:215], a[188:191], v[116:119]
v_mfma_f32_16x16x32_bf16 v[120:123], a[208:211], a[192:195], v[120:123]
v_mfma_f32_16x16x32_bf16 v[120:123], a[212:215], a[196:199], v[120:123]
v_mfma_f32_16x16x32_bf16 v[124:127], a[208:211], a[200:203], v[124:127]
buffer_load_dwordx4 a[208:211], v254, s[8:11], s20 offen offset:0
v_mfma_f32_16x16x32_bf16 v[124:127], a[212:215], a[204:207], v[124:127]
s_waitcnt vmcnt(7)
v_mfma_f32_16x16x32_bf16 v[156:159], a[220:223], a[200:203], v[156:159]
buffer_load_dwordx4 a[212:215], v254, s[8:11], s20 offen offset:1024
v_mfma_f32_16x16x32_bf16 v[156:159], a[224:227], a[204:207], v[156:159]
v_mfma_f32_16x16x32_bf16 v[152:155], a[220:223], a[192:195], v[152:155]
buffer_load_dwordx4 a[216:219], v254, s[8:11], s20 offen offset:2048
v_mfma_f32_16x16x32_bf16 v[152:155], a[224:227], a[196:199], v[152:155]
v_mfma_f32_16x16x32_bf16 v[148:151], a[220:223], a[184:187], v[148:151]
v_mfma_f32_16x16x32_bf16 v[148:151], a[224:227], a[188:191], v[148:151]
v_mfma_f32_16x16x32_bf16 v[144:147], a[220:223], a[176:179], v[144:147]
v_mfma_f32_16x16x32_bf16 v[144:147], a[224:227], a[180:183], v[144:147]
v_mfma_f32_16x16x32_bf16 v[140:143], a[220:223], a[168:171], v[140:143]
v_mfma_f32_16x16x32_bf16 v[140:143], a[224:227], a[172:175], v[140:143]
v_mfma_f32_16x16x32_bf16 v[136:139], a[220:223], a[160:163], v[136:139]
v_mfma_f32_16x16x32_bf16 v[136:139], a[224:227], a[164:167], v[136:139]
v_mfma_f32_16x16x32_bf16 v[132:135], a[220:223], a[152:155], v[132:135]
ds_read_b64_tr_b16 v[240:241], v251 offset:34816
v_mfma_f32_16x16x32_bf16 v[132:135], a[224:227], a[156:159], v[132:135]
ds_read_b64_tr_b16 v[242:243], v251 offset:35072
v_mfma_f32_16x16x32_bf16 v[128:131], a[220:223], a[144:147], v[128:131]
buffer_load_dwordx4 a[220:223], v254, s[8:11], s20 offen offset:3072
v_mfma_f32_16x16x32_bf16 v[128:131], a[224:227], a[148:151], v[128:131]
s_waitcnt vmcnt(8)
s_add_u32 s20, s20, 4096
v_mfma_f32_16x16x32_bf16 v[160:163], a[228:231], a[144:147], v[160:163]
buffer_load_dwordx4 a[224:227], v254, s[8:11], s20 offen offset:0
v_mfma_f32_16x16x32_bf16 v[160:163], a[232:235], a[148:151], v[160:163]
ds_read_b64_tr_b16 v[244:245], v251 offset:34824
v_mfma_f32_16x16x32_bf16 v[164:167], a[228:231], a[152:155], v[164:167]
ds_read_b64_tr_b16 v[246:247], v251 offset:35080
v_mfma_f32_16x16x32_bf16 v[164:167], a[232:235], a[156:159], v[164:167]
v_mfma_f32_16x16x32_bf16 v[168:171], a[228:231], a[160:163], v[168:171]
v_mfma_f32_16x16x32_bf16 v[168:171], a[232:235], a[164:167], v[168:171]
v_mfma_f32_16x16x32_bf16 v[172:175], a[228:231], a[168:171], v[172:175]
v_mfma_f32_16x16x32_bf16 v[172:175], a[232:235], a[172:175], v[172:175]
v_mfma_f32_16x16x32_bf16 v[176:179], a[228:231], a[176:179], v[176:179]
v_mfma_f32_16x16x32_bf16 v[176:179], a[232:235], a[180:183], v[176:179]
s_barrier
v_mfma_f32_16x16x32_bf16 v[180:183], a[228:231], a[184:187], v[180:183]
s_waitcnt lgkmcnt(2)
buffer_store_dwordx4 v[240:243], v254, s[8:11], s41 offen offset:0 sc1
v_mfma_f32_16x16x32_bf16 v[180:183], a[232:235], a[188:191], v[180:183]
v_mfma_f32_16x16x32_bf16 v[184:187], a[228:231], a[192:195], v[184:187]
v_mfma_f32_16x16x32_bf16 v[184:187], a[232:235], a[196:199], v[184:187]
v_mfma_f32_16x16x32_bf16 v[188:191], a[228:231], a[200:203], v[188:191]
buffer_load_dwordx4 a[228:231], v254, s[8:11], s20 offen offset:1024
v_mfma_f32_16x16x32_bf16 v[188:191], a[232:235], a[204:207], v[188:191]
s_waitcnt vmcnt(9)
v_mfma_f32_16x16x32_bf16 v[220:223], a[236:239], a[200:203], v[220:223]
buffer_load_dwordx4 a[232:235], v254, s[8:11], s20 offen offset:2048
v_mfma_f32_16x16x32_bf16 v[220:223], a[240:243], a[204:207], v[220:223]
v_mfma_f32_16x16x32_bf16 v[216:219], a[236:239], a[192:195], v[216:219]
v_mfma_f32_16x16x32_bf16 v[216:219], a[240:243], a[196:199], v[216:219]
v_mfma_f32_16x16x32_bf16 v[212:215], a[236:239], a[184:187], v[212:215]
v_mfma_f32_16x16x32_bf16 v[212:215], a[240:243], a[188:191], v[212:215]
v_mfma_f32_16x16x32_bf16 v[208:211], a[236:239], a[176:179], v[208:211]
v_mfma_f32_16x16x32_bf16 v[208:211], a[240:243], a[180:183], v[208:211]
v_mfma_f32_16x16x32_bf16 v[204:207], a[236:239], a[168:171], v[204:207]
v_mfma_f32_16x16x32_bf16 v[204:207], a[240:243], a[172:175], v[204:207]
v_mfma_f32_16x16x32_bf16 v[200:203], a[236:239], a[160:163], v[200:203]
v_mfma_f32_16x16x32_bf16 v[200:203], a[240:243], a[164:167], v[200:203]
v_mfma_f32_16x16x32_bf16 v[196:199], a[236:239], a[152:155], v[196:199]
v_mfma_f32_16x16x32_bf16 v[196:199], a[240:243], a[156:159], v[196:199]
v_mfma_f32_16x16x32_bf16 v[192:195], a[236:239], a[144:147], v[192:195]
buffer_load_dwordx4 a[236:239], v254, s[8:11], s20 offen offset:3072
v_mfma_f32_16x16x32_bf16 v[192:195], a[240:243], a[148:151], v[192:195]
s_waitcnt vmcnt(9)
s_add_u32 s20, s20, 4096
v_mfma_f32_16x16x32_bf16 v[224:227], a[244:247], a[144:147], v[224:227]
ds_read_b128 a[144:147], v252 offset:32768
buffer_load_dwordx4 a[240:243], v254, s[8:11], s20 offen offset:0
v_mfma_f32_16x16x32_bf16 v[224:227], a[248:251], a[148:151], v[224:227]
ds_read_b128 a[148:151], v252 offset:33280
v_mfma_f32_16x16x32_bf16 v[228:231], a[244:247], a[152:155], v[228:231]
ds_read_b128 a[152:155], v252 offset:34816
v_mfma_f32_16x16x32_bf16 v[228:231], a[248:251], a[156:159], v[228:231]
ds_read_b128 a[156:159], v252 offset:35328
v_mfma_f32_16x16x32_bf16 v[232:235], a[244:247], a[160:163], v[232:235]
ds_read_b128 a[160:163], v252 offset:36864
v_mfma_f32_16x16x32_bf16 v[232:235], a[248:251], a[164:167], v[232:235]
ds_read_b128 a[164:167], v252 offset:37376
v_mfma_f32_16x16x32_bf16 v[236:239], a[244:247], a[168:171], v[236:239]
ds_read_b128 a[168:171], v252 offset:38912
v_mfma_f32_16x16x32_bf16 v[236:239], a[248:251], a[172:175], v[236:239]
ds_read_b128 a[172:175], v252 offset:39424
v_mfma_f32_16x16x32_bf16 a[0:3], a[244:247], a[176:179], a[0:3]
ds_read_b128 a[176:179], v252 offset:40960
v_mfma_f32_16x16x32_bf16 a[0:3], a[248:251], a[180:183], a[0:3]
ds_read_b128 a[180:183], v252 offset:41472
v_mfma_f32_16x16x32_bf16 a[4:7], a[244:247], a[184:187], a[4:7]
ds_read_b128 a[184:187], v252 offset:43008
v_mfma_f32_16x16x32_bf16 a[4:7], a[248:251], a[188:191], a[4:7]
ds_read_b128 a[188:191], v252 offset:43520
v_mfma_f32_16x16x32_bf16 a[8:11], a[244:247], a[192:195], a[8:11]
ds_read_b128 a[192:195], v252 offset:45056
v_mfma_f32_16x16x32_bf16 a[8:11], a[248:251], a[196:199], a[8:11]
ds_read_b128 a[196:199], v252 offset:45568
v_mfma_f32_16x16x32_bf16 a[12:15], a[244:247], a[200:203], a[12:15]
ds_read_b128 a[200:203], v252 offset:47104
v_mfma_f32_16x16x32_bf16 a[12:15], a[248:251], a[204:207], a[12:15]
s_waitcnt vmcnt(8) lgkmcnt(11)
ds_read_b128 a[204:207], v252 offset:47616
v_mfma_f32_16x16x32_bf16 v[0:3], a[208:211], a[144:147], v[0:3]
buffer_load_dwordx4 a[244:247], v254, s[8:11], s20 offen offset:1024
v_mfma_f32_16x16x32_bf16 v[0:3], a[212:215], a[148:151], v[0:3]
buffer_store_dwordx4 v[244:247], v254, s[8:11], s41 offen offset:2048 sc1
v_mfma_f32_16x16x32_bf16 v[4:7], a[208:211], a[152:155], v[4:7]
s_add_u32 s41, s41, 262144
buffer_load_dwordx4 a[248:251], v254, s[8:11], s20 offen offset:2048
v_mfma_f32_16x16x32_bf16 v[4:7], a[212:215], a[156:159], v[4:7]
s_waitcnt lgkmcnt(8)
v_mfma_f32_16x16x32_bf16 v[8:11], a[208:211], a[160:163], v[8:11]
v_mfma_f32_16x16x32_bf16 v[8:11], a[212:215], a[164:167], v[8:11]
v_add_u32 v252, s25, v253
v_mfma_f32_16x16x32_bf16 v[12:15], a[208:211], a[168:171], v[12:15]
v_mfma_f32_16x16x32_bf16 v[12:15], a[212:215], a[172:175], v[12:15]
s_waitcnt lgkmcnt(4)
ds_read_b128 a[16:19], v252 offset:0
v_mfma_f32_16x16x32_bf16 v[16:19], a[208:211], a[176:179], v[16:19]
v_mfma_f32_16x16x32_bf16 v[16:19], a[212:215], a[180:183], v[16:19]
ds_read_b128 a[20:23], v252 offset:2048
v_mfma_f32_16x16x32_bf16 v[20:23], a[208:211], a[184:187], v[20:23]
v_mfma_f32_16x16x32_bf16 v[20:23], a[212:215], a[188:191], v[20:23]
s_waitcnt lgkmcnt(2)
ds_read_b128 a[24:27], v252 offset:4096
v_mfma_f32_16x16x32_bf16 v[24:27], a[208:211], a[192:195], v[24:27]
v_mfma_f32_16x16x32_bf16 v[24:27], a[212:215], a[196:199], v[24:27]
ds_read_b128 a[28:31], v252 offset:6144
v_mfma_f32_16x16x32_bf16 v[28:31], a[208:211], a[200:203], v[28:31]
buffer_load_dwordx4 a[208:211], v254, s[8:11], s20 offen offset:3072
v_mfma_f32_16x16x32_bf16 v[28:31], a[212:215], a[204:207], v[28:31]
s_waitcnt vmcnt(10)
s_add_u32 s20, s20, 4096
v_mfma_f32_16x16x32_bf16 v[60:63], a[216:219], a[200:203], v[60:63]
buffer_load_dwordx4 a[212:215], v254, s[8:11], s20 offen offset:0
v_mfma_f32_16x16x32_bf16 v[60:63], a[220:223], a[204:207], v[60:63]
ds_read_b128 a[32:35], v252 offset:8192
v_mfma_f32_16x16x32_bf16 v[56:59], a[216:219], a[192:195], v[56:59]
s_add_u32 s60, s44, s24
s_addc_u32 s61, s45, 0
v_mfma_f32_16x16x32_bf16 v[56:59], a[220:223], a[196:199], v[56:59]
s_mov_b32 s62, 64
ds_read_b128 a[36:39], v252 offset:10240
v_mfma_f32_16x16x32_bf16 v[52:55], a[216:219], a[184:187], v[52:55]
v_mfma_f32_16x16x32_bf16 v[52:55], a[220:223], a[188:191], v[52:55]
ds_read_b128 a[40:43], v252 offset:12288
v_mfma_f32_16x16x32_bf16 v[48:51], a[216:219], a[176:179], v[48:51]
v_mfma_f32_16x16x32_bf16 v[48:51], a[220:223], a[180:183], v[48:51]
ds_read_b128 a[44:47], v252 offset:14336
v_mfma_f32_16x16x32_bf16 v[44:47], a[216:219], a[168:171], v[44:47]
v_mfma_f32_16x16x32_bf16 v[44:47], a[220:223], a[172:175], v[44:47]
ds_read_b128 a[48:51], v252 offset:512
v_mfma_f32_16x16x32_bf16 v[40:43], a[216:219], a[160:163], v[40:43]
v_mfma_f32_16x16x32_bf16 v[40:43], a[220:223], a[164:167], v[40:43]
ds_read_b128 a[52:55], v252 offset:2560
v_mfma_f32_16x16x32_bf16 v[36:39], a[216:219], a[152:155], v[36:39]
v_mfma_f32_16x16x32_bf16 v[36:39], a[220:223], a[156:159], v[36:39]
ds_read_b128 a[56:59], v252 offset:4608
v_mfma_f32_16x16x32_bf16 v[32:35], a[216:219], a[144:147], v[32:35]
buffer_load_dwordx4 a[216:219], v254, s[8:11], s20 offen offset:1024
v_mfma_f32_16x16x32_bf16 v[32:35], a[220:223], a[148:151], v[32:35]
s_waitcnt vmcnt(9)
ds_read_b128 a[60:63], v252 offset:6656
v_and_b32 v255, 0x200, v254
v_mfma_f32_16x16x32_bf16 v[64:67], a[224:227], a[144:147], v[64:67]
buffer_load_dwordx4 a[220:223], v254, s[8:11], s20 offen offset:2048
v_add3_u32 v255, v255, v254, s25
v_mfma_f32_16x16x32_bf16 v[64:67], a[228:231], a[148:151], v[64:67]
ds_read_b128 a[64:67], v252 offset:8704
v_mfma_f32_16x16x32_bf16 v[68:71], a[224:227], a[152:155], v[68:71]
v_mfma_f32_16x16x32_bf16 v[68:71], a[228:231], a[156:159], v[68:71]
ds_read_b128 a[68:71], v252 offset:10752
v_mfma_f32_16x16x32_bf16 v[72:75], a[224:227], a[160:163], v[72:75]
v_mfma_f32_16x16x32_bf16 v[72:75], a[228:231], a[164:167], v[72:75]
ds_read_b128 a[72:75], v252 offset:12800
v_mfma_f32_16x16x32_bf16 v[76:79], a[224:227], a[168:171], v[76:79]
v_mfma_f32_16x16x32_bf16 v[76:79], a[228:231], a[172:175], v[76:79]
ds_read_b128 a[76:79], v252 offset:14848
v_mfma_f32_16x16x32_bf16 v[80:83], a[224:227], a[176:179], v[80:83]
v_mfma_f32_16x16x32_bf16 v[80:83], a[228:231], a[180:183], v[80:83]
v_mfma_f32_16x16x32_bf16 v[84:87], a[224:227], a[184:187], v[84:87]
v_mfma_f32_16x16x32_bf16 v[84:87], a[228:231], a[188:191], v[84:87]
v_mfma_f32_16x16x32_bf16 v[88:91], a[224:227], a[192:195], v[88:91]
v_mfma_f32_16x16x32_bf16 v[88:91], a[228:231], a[196:199], v[88:91]
v_mfma_f32_16x16x32_bf16 v[92:95], a[224:227], a[200:203], v[92:95]
buffer_load_dwordx4 a[224:227], v254, s[8:11], s20 offen offset:3072
v_mfma_f32_16x16x32_bf16 v[92:95], a[228:231], a[204:207], v[92:95]
s_waitcnt vmcnt(9)
s_add_u32 s20, s20, 4096
v_mfma_f32_16x16x32_bf16 v[124:127], a[232:235], a[200:203], v[124:127]
buffer_load_dwordx4 a[228:231], v254, s[8:11], s20 offen offset:0
v_mfma_f32_16x16x32_bf16 v[124:127], a[236:239], a[204:207], v[124:127]
v_mfma_f32_16x16x32_bf16 v[120:123], a[232:235], a[192:195], v[120:123]
v_mfma_f32_16x16x32_bf16 v[120:123], a[236:239], a[196:199], v[120:123]
v_mfma_f32_16x16x32_bf16 v[116:119], a[232:235], a[184:187], v[116:119]
v_mfma_f32_16x16x32_bf16 v[116:119], a[236:239], a[188:191], v[116:119]
v_mfma_f32_16x16x32_bf16 v[112:115], a[232:235], a[176:179], v[112:115]
v_mfma_f32_16x16x32_bf16 v[112:115], a[236:239], a[180:183], v[112:115]
v_mfma_f32_16x16x32_bf16 v[108:111], a[232:235], a[168:171], v[108:111]
v_mfma_f32_16x16x32_bf16 v[108:111], a[236:239], a[172:175], v[108:111]
v_mfma_f32_16x16x32_bf16 v[104:107], a[232:235], a[160:163], v[104:107]
v_mfma_f32_16x16x32_bf16 v[104:107], a[236:239], a[164:167], v[104:107]
v_mfma_f32_16x16x32_bf16 v[100:103], a[232:235], a[152:155], v[100:103]
v_mfma_f32_16x16x32_bf16 v[100:103], a[236:239], a[156:159], v[100:103]
v_mfma_f32_16x16x32_bf16 v[96:99], a[232:235], a[144:147], v[96:99]
buffer_load_dwordx4 a[232:235], v254, s[8:11], s20 offen offset:1024
v_mfma_f32_16x16x32_bf16 v[96:99], a[236:239], a[148:151], v[96:99]
s_waitcnt vmcnt(9)
s_and_b32 s42, s22, 1
v_mfma_f32_16x16x32_bf16 v[128:131], a[240:243], a[144:147], v[128:131]
s_add_u32 s42, s42, 1
buffer_load_dwordx4 a[236:239], v254, s[8:11], s20 offen offset:2048
v_mfma_f32_16x16x32_bf16 v[128:131], a[244:247], a[148:151], v[128:131]
s_mul_i32 s43, s42, 41943040
v_mfma_f32_16x16x32_bf16 v[132:135], a[240:243], a[152:155], v[132:135]
s_add_u32 s12, s44, s43
s_addc_u32 s13, s45, 0
v_mfma_f32_16x16x32_bf16 v[132:135], a[244:247], a[156:159], v[132:135]
s_mov_b32 s16, s12
v_mfma_f32_16x16x32_bf16 v[136:139], a[240:243], a[160:163], v[136:139]
s_mov_b32 s17, s13
v_mfma_f32_16x16x32_bf16 v[136:139], a[244:247], a[164:167], v[136:139]
s_mov_b32 s14, 33685504
v_mfma_f32_16x16x32_bf16 v[140:143], a[240:243], a[168:171], v[140:143]
s_mov_b32 s32, s33
v_mfma_f32_16x16x32_bf16 v[140:143], a[244:247], a[172:175], v[140:143]
s_mov_b32 s30, s31
v_mfma_f32_16x16x32_bf16 v[144:147], a[240:243], a[176:179], v[144:147]
v_mfma_f32_16x16x32_bf16 v[144:147], a[244:247], a[180:183], v[144:147]
v_mfma_f32_16x16x32_bf16 v[148:151], a[240:243], a[184:187], v[148:151]
v_mfma_f32_16x16x32_bf16 v[148:151], a[244:247], a[188:191], v[148:151]
v_mfma_f32_16x16x32_bf16 v[152:155], a[240:243], a[192:195], v[152:155]
v_mfma_f32_16x16x32_bf16 v[152:155], a[244:247], a[196:199], v[152:155]
v_mfma_f32_16x16x32_bf16 v[156:159], a[240:243], a[200:203], v[156:159]
buffer_load_dwordx4 a[240:243], v254, s[8:11], s20 offen offset:3072
v_mfma_f32_16x16x32_bf16 v[156:159], a[244:247], a[204:207], v[156:159]
s_waitcnt vmcnt(8)
s_add_u32 s20, s20, 4096
v_mfma_f32_16x16x32_bf16 v[188:191], a[248:251], a[200:203], v[188:191]
buffer_load_dwordx4 a[244:247], v254, s[8:11], s20 offen offset:0
v_mfma_f32_16x16x32_bf16 v[188:191], a[208:211], a[204:207], v[188:191]
v_mfma_f32_16x16x32_bf16 v[184:187], a[248:251], a[192:195], v[184:187]
v_mfma_f32_16x16x32_bf16 v[184:187], a[208:211], a[196:199], v[184:187]
v_mfma_f32_16x16x32_bf16 v[180:183], a[248:251], a[184:187], v[180:183]
v_mfma_f32_16x16x32_bf16 v[180:183], a[208:211], a[188:191], v[180:183]
v_mfma_f32_16x16x32_bf16 v[176:179], a[248:251], a[176:179], v[176:179]
v_mfma_f32_16x16x32_bf16 v[176:179], a[208:211], a[180:183], v[176:179]
v_mfma_f32_16x16x32_bf16 v[172:175], a[248:251], a[168:171], v[172:175]
v_mfma_f32_16x16x32_bf16 v[172:175], a[208:211], a[172:175], v[172:175]
s_barrier
v_mfma_f32_16x16x32_bf16 v[168:171], a[248:251], a[160:163], v[168:171]
v_mfma_f32_16x16x32_bf16 v[168:171], a[208:211], a[164:167], v[168:171]
v_mfma_f32_16x16x32_bf16 v[164:167], a[248:251], a[152:155], v[164:167]
v_mfma_f32_16x16x32_bf16 v[164:167], a[208:211], a[156:159], v[164:167]
v_mov_b32 v248, 2
v_mfma_f32_16x16x32_bf16 v[160:163], a[248:251], a[144:147], v[160:163]
buffer_load_dwordx4 a[248:251], v254, s[8:11], s20 offen offset:1024
v_mfma_f32_16x16x32_bf16 v[160:163], a[208:211], a[148:151], v[160:163]
s_waitcnt vmcnt(8)
v_mfma_f32_16x16x32_bf16 v[192:195], a[212:215], a[144:147], v[192:195]
buffer_load_dwordx4 a[208:211], v254, s[8:11], s20 offen offset:2048
v_mfma_f32_16x16x32_bf16 v[192:195], a[216:219], a[148:151], v[192:195]
buffer_store_dword v248, off, s[8:11], s50 sc1
v_mfma_f32_16x16x32_bf16 v[196:199], a[212:215], a[152:155], v[196:199]
v_mfma_f32_16x16x32_bf16 v[196:199], a[216:219], a[156:159], v[196:199]
v_mfma_f32_16x16x32_bf16 v[200:203], a[212:215], a[160:163], v[200:203]
v_mfma_f32_16x16x32_bf16 v[200:203], a[216:219], a[164:167], v[200:203]
v_mfma_f32_16x16x32_bf16 v[204:207], a[212:215], a[168:171], v[204:207]
v_mfma_f32_16x16x32_bf16 v[204:207], a[216:219], a[172:175], v[204:207]
v_mfma_f32_16x16x32_bf16 v[208:211], a[212:215], a[176:179], v[208:211]
v_mfma_f32_16x16x32_bf16 v[208:211], a[216:219], a[180:183], v[208:211]
v_mfma_f32_16x16x32_bf16 v[212:215], a[212:215], a[184:187], v[212:215]
v_mfma_f32_16x16x32_bf16 v[212:215], a[216:219], a[188:191], v[212:215]
v_mfma_f32_16x16x32_bf16 v[216:219], a[212:215], a[192:195], v[216:219]
v_mfma_f32_16x16x32_bf16 v[216:219], a[216:219], a[196:199], v[216:219]
v_mfma_f32_16x16x32_bf16 v[220:223], a[212:215], a[200:203], v[220:223]
buffer_load_dwordx4 a[212:215], v254, s[8:11], s20 offen offset:3072
v_add_u32 v252, 0x10000, v253
v_mfma_f32_16x16x32_bf16 v[220:223], a[216:219], a[204:207], v[220:223]
s_waitcnt vmcnt(9)
s_add_u32 s20, s20, 4096
v_mfma_f32_16x16x32_bf16 a[12:15], a[220:223], a[200:203], a[12:15]
ds_read_b128 a[200:203], v252 offset:63488
v_mfma_f32_16x16x32_bf16 a[12:15], a[224:227], a[204:207], a[12:15]
ds_read_b128 a[204:207], v252 offset:64000
v_mfma_f32_16x16x32_bf16 a[8:11], a[220:223], a[192:195], a[8:11]
ds_read_b128 a[192:195], v252 offset:61440
v_mfma_f32_16x16x32_bf16 a[8:11], a[224:227], a[196:199], a[8:11]
ds_read_b128 a[196:199], v252 offset:61952
v_mfma_f32_16x16x32_bf16 a[4:7], a[220:223], a[184:187], a[4:7]
ds_read_b128 a[184:187], v252 offset:59392
v_mfma_f32_16x16x32_bf16 a[4:7], a[224:227], a[188:191], a[4:7]
ds_read_b128 a[188:191], v252 offset:59904
v_mfma_f32_16x16x32_bf16 a[0:3], a[220:223], a[176:179], a[0:3]
ds_read_b128 a[176:179], v252 offset:57344
v_mfma_f32_16x16x32_bf16 a[0:3], a[224:227], a[180:183], a[0:3]
ds_read_b128 a[180:183], v252 offset:57856
v_mfma_f32_16x16x32_bf16 v[236:239], a[220:223], a[168:171], v[236:239]
ds_read_b128 a[168:171], v252 offset:55296
v_mfma_f32_16x16x32_bf16 v[236:239], a[224:227], a[172:175], v[236:239]
ds_read_b128 a[172:175], v252 offset:55808
v_mfma_f32_16x16x32_bf16 v[232:235], a[220:223], a[160:163], v[232:235]
ds_read_b128 a[160:163], v252 offset:53248
v_mfma_f32_16x16x32_bf16 v[232:235], a[224:227], a[164:167], v[232:235]
ds_read_b128 a[164:167], v252 offset:53760
v_mfma_f32_16x16x32_bf16 v[228:231], a[220:223], a[152:155], v[228:231]
ds_read_b128 a[152:155], v252 offset:51200
v_mfma_f32_16x16x32_bf16 v[228:231], a[224:227], a[156:159], v[228:231]
ds_read_b128 a[156:159], v252 offset:51712
v_mfma_f32_16x16x32_bf16 v[224:227], a[220:223], a[144:147], v[224:227]
ds_read_b128 a[144:147], v252 offset:49152
v_mfma_f32_16x16x32_bf16 v[224:227], a[224:227], a[148:151], v[224:227]
s_waitcnt vmcnt(7) lgkmcnt(11)
ds_read_b128 a[148:151], v252 offset:49664
v_mfma_f32_16x16x32_bf16 v[28:31], a[228:231], a[200:203], v[28:31]
buffer_load_dwordx4 a[220:223], v254, s[8:11], s20 offen offset:0
v_mfma_f32_16x16x32_bf16 v[28:31], a[232:235], a[204:207], v[28:31]
v_mfma_f32_16x16x32_bf16 v[24:27], a[228:231], a[192:195], v[24:27]
buffer_load_dwordx4 a[224:227], v254, s[8:11], s20 offen offset:1024
v_mfma_f32_16x16x32_bf16 v[24:27], a[232:235], a[196:199], v[24:27]
s_waitcnt lgkmcnt(8)
v_mfma_f32_16x16x32_bf16 v[20:23], a[228:231], a[184:187], v[20:23]
v_mfma_f32_16x16x32_bf16 v[20:23], a[232:235], a[188:191], v[20:23]
v_add_u32 v252, s25, v253
v_mfma_f32_16x16x32_bf16 v[16:19], a[228:231], a[176:179], v[16:19]
v_mfma_f32_16x16x32_bf16 v[16:19], a[232:235], a[180:183], v[16:19]
s_waitcnt lgkmcnt(4)
ds_read_b128 a[80:83], v252 offset:16384
v_mfma_f32_16x16x32_bf16 v[12:15], a[228:231], a[168:171], v[12:15]
ds_read_b128 a[84:87], v252 offset:18432
v_mfma_f32_16x16x32_bf16 v[12:15], a[232:235], a[172:175], v[12:15]
ds_read_b128 a[88:91], v252 offset:20480
v_mfma_f32_16x16x32_bf16 v[8:11], a[228:231], a[160:163], v[8:11]
ds_read_b128 a[92:95], v252 offset:22528
v_mfma_f32_16x16x32_bf16 v[8:11], a[232:235], a[164:167], v[8:11]
s_waitcnt lgkmcnt(4)
ds_read_b128 a[96:99], v252 offset:24576
v_mfma_f32_16x16x32_bf16 v[4:7], a[228:231], a[152:155], v[4:7]
ds_read_b128 a[100:103], v252 offset:26624
v_mfma_f32_16x16x32_bf16 v[4:7], a[232:235], a[156:159], v[4:7]
ds_read_b128 a[104:107], v252 offset:28672
v_mfma_f32_4x4x4_16b_bf16 v[240:243], a[252:253], a[16:17], 0
v_mfma_f32_16x16x32_bf16 v[0:3], a[228:231], a[144:147], v[0:3]
buffer_load_dwordx4 a[228:231], v254, s[8:11], s20 offen offset:2048
v_mfma_f32_16x16x32_bf16 v[0:3], a[232:235], a[148:151], v[0:3]
s_waitcnt vmcnt(8)
ds_read_b128 a[108:111], v252 offset:30720
v_mfma_f32_4x4x4_16b_bf16 v[244:247], a[252:253], a[18:19], 0
v_mfma_f32_16x16x32_bf16 v[32:35], a[236:239], a[144:147], v[32:35]
buffer_load_dwordx4 a[232:235], v254, s[8:11], s20 offen offset:3072
v_mfma_f32_16x16x32_bf16 v[32:35], a[240:243], a[148:151], v[32:35]
s_add_u32 s20, s20, 4096
s_barrier
v_mfma_f32_16x16x32_bf16 v[36:39], a[236:239], a[152:155], v[36:39]
ds_read_b128 a[112:115], v252 offset:16896
v_mfma_f32_16x16x32_bf16 v[36:39], a[240:243], a[156:159], v[36:39]
ds_read_b128 a[116:119], v252 offset:18944
v_mfma_f32_16x16x32_bf16 v[40:43], a[236:239], a[160:163], v[40:43]
ds_read_b128 a[120:123], v252 offset:20992
v_mul_f32 v240, v240, v0
v_mul_f32 v241, v241, v1
v_mfma_f32_16x16x32_bf16 v[40:43], a[240:243], a[164:167], v[40:43]
ds_read_b128 a[124:127], v252 offset:23040
v_mul_f32 v242, v242, v2
v_mul_f32 v243, v243, v3
v_mfma_f32_16x16x32_bf16 v[44:47], a[236:239], a[168:171], v[44:47]
ds_read_b128 a[128:131], v252 offset:25088
v_cvt_pk_bf16_f32 v248, v240, v241
v_cvt_pk_bf16_f32 v249, v242, v243
v_mfma_f32_4x4x4_16b_bf16 v[240:243], a[252:253], a[20:21], 0
v_mul_f32 v244, v244, v32
v_mul_f32 v245, v245, v33
v_mfma_f32_16x16x32_bf16 v[44:47], a[240:243], a[172:175], v[44:47]
ds_read_b128 a[132:135], v252 offset:27136
v_mul_f32 v246, v246, v34
v_mul_f32 v247, v247, v35
v_mfma_f32_16x16x32_bf16 v[48:51], a[236:239], a[176:179], v[48:51]
ds_read_b128 a[136:139], v252 offset:29184
v_cvt_pk_bf16_f32 v250, v244, v245
v_cvt_pk_bf16_f32 v251, v246, v247
v_mfma_f32_4x4x4_16b_bf16 v[244:247], a[252:253], a[22:23], 0
ds_write_b128 v252, v[248:251] offset:0
v_mfma_f32_16x16x32_bf16 v[48:51], a[240:243], a[180:183], v[48:51]
ds_read_b128 a[140:143], v252 offset:31232
v_mul_f32 v240, v240, v4
v_mul_f32 v241, v241, v5
v_mfma_f32_16x16x32_bf16 v[52:55], a[236:239], a[184:187], v[52:55]
v_mul_f32 v242, v242, v6
v_mul_f32 v243, v243, v7
v_mfma_f32_16x16x32_bf16 v[52:55], a[240:243], a[188:191], v[52:55]
v_cvt_pk_bf16_f32 v248, v240, v241
v_cvt_pk_bf16_f32 v249, v242, v243
v_mfma_f32_4x4x4_16b_bf16 v[240:243], a[252:253], a[24:25], 0
v_mul_f32 v244, v244, v36
v_mul_f32 v245, v245, v37
v_mfma_f32_16x16x32_bf16 v[56:59], a[236:239], a[192:195], v[56:59]
v_mul_f32 v246, v246, v38
v_mul_f32 v247, v247, v39
v_mfma_f32_16x16x32_bf16 v[56:59], a[240:243], a[196:199], v[56:59]
v_cvt_pk_bf16_f32 v250, v244, v245
v_cvt_pk_bf16_f32 v251, v246, v247
v_mfma_f32_4x4x4_16b_bf16 v[244:247], a[252:253], a[26:27], 0
ds_write_b128 v252, v[248:251] offset:2048
v_mfma_f32_16x16x32_bf16 v[60:63], a[236:239], a[200:203], v[60:63]
buffer_load_dwordx4 a[236:239], v254, s[8:11], s20 offen offset:0
v_mul_f32 v240, v240, v8
v_mfma_f32_16x16x32_bf16 v[60:63], a[240:243], a[204:207], v[60:63]
s_waitcnt vmcnt(8)
v_mul_f32 v241, v241, v9
v_mul_f32 v242, v242, v10
v_mfma_f32_16x16x32_bf16 v[92:95], a[244:247], a[200:203], v[92:95]
buffer_load_dwordx4 a[240:243], v254, s[8:11], s20 offen offset:1024
v_mul_f32 v243, v243, v11
v_mfma_f32_16x16x32_bf16 v[92:95], a[248:251], a[204:207], v[92:95]
v_cvt_pk_bf16_f32 v248, v240, v241
v_cvt_pk_bf16_f32 v249, v242, v243
v_mfma_f32_4x4x4_16b_bf16 v[240:243], a[252:253], a[28:29], 0
v_mul_f32 v244, v244, v40
v_mul_f32 v245, v245, v41
v_mfma_f32_16x16x32_bf16 v[88:91], a[244:247], a[192:195], v[88:91]
s_waitcnt lgkmcnt(1)
v_mul_f32 v246, v246, v42
v_mul_f32 v247, v247, v43
v_mfma_f32_16x16x32_bf16 v[88:91], a[248:251], a[196:199], v[88:91]
v_cvt_pk_bf16_f32 v250, v244, v245
v_cvt_pk_bf16_f32 v251, v246, v247
v_mfma_f32_4x4x4_16b_bf16 v[244:247], a[252:253], a[30:31], 0
ds_write_b128 v252, v[248:251] offset:4096
v_mfma_f32_16x16x32_bf16 v[84:87], a[244:247], a[184:187], v[84:87]
v_mul_f32 v240, v240, v12
v_mul_f32 v241, v241, v13
v_mfma_f32_16x16x32_bf16 v[84:87], a[248:251], a[188:191], v[84:87]
v_mul_f32 v242, v242, v14
v_mul_f32 v243, v243, v15
v_mfma_f32_16x16x32_bf16 v[80:83], a[244:247], a[176:179], v[80:83]
v_cvt_pk_bf16_f32 v248, v240, v241
v_cvt_pk_bf16_f32 v249, v242, v243
v_mfma_f32_4x4x4_16b_bf16 v[240:243], a[252:253], a[32:33], 0
v_mul_f32 v244, v244, v44
v_mul_f32 v245, v245, v45
v_mfma_f32_16x16x32_bf16 v[80:83], a[248:251], a[180:183], v[80:83]
v_mul_f32 v246, v246, v46
v_mul_f32 v247, v247, v47
v_mfma_f32_16x16x32_bf16 v[76:79], a[244:247], a[168:171], v[76:79]
v_cvt_pk_bf16_f32 v250, v244, v245
v_cvt_pk_bf16_f32 v251, v246, v247
v_mfma_f32_4x4x4_16b_bf16 v[244:247], a[252:253], a[34:35], 0
ds_write_b128 v252, v[248:251] offset:6144
v_mfma_f32_16x16x32_bf16 v[76:79], a[248:251], a[172:175], v[76:79]
v_mul_f32 v240, v240, v16
v_mul_f32 v241, v241, v17
v_mfma_f32_16x16x32_bf16 v[72:75], a[244:247], a[160:163], v[72:75]
v_mul_f32 v242, v242, v18
v_mul_f32 v243, v243, v19
v_mfma_f32_16x16x32_bf16 v[72:75], a[248:251], a[164:167], v[72:75]
v_cvt_pk_bf16_f32 v248, v240, v241
v_cvt_pk_bf16_f32 v249, v242, v243
v_mfma_f32_4x4x4_16b_bf16 v[240:243], a[252:253], a[36:37], 0
v_mul_f32 v244, v244, v48
v_mul_f32 v245, v245, v49
v_mfma_f32_16x16x32_bf16 v[68:71], a[244:247], a[152:155], v[68:71]
v_mul_f32 v246, v246, v50
v_mul_f32 v247, v247, v51
v_mfma_f32_16x16x32_bf16 v[68:71], a[248:251], a[156:159], v[68:71]
v_cvt_pk_bf16_f32 v250, v244, v245
v_cvt_pk_bf16_f32 v251, v246, v247
v_mfma_f32_4x4x4_16b_bf16 v[244:247], a[252:253], a[38:39], 0
ds_write_b128 v252, v[248:251] offset:8192
v_mfma_f32_16x16x32_bf16 v[64:67], a[244:247], a[144:147], v[64:67]
buffer_load_dwordx4 a[244:247], v254, s[8:11], s20 offen offset:2048
v_mul_f32 v240, v240, v20
v_mfma_f32_16x16x32_bf16 v[64:67], a[248:251], a[148:151], v[64:67]
s_waitcnt vmcnt(7)
v_mul_f32 v241, v241, v21
v_mul_f32 v242, v242, v22
v_mfma_f32_16x16x32_bf16 v[96:99], a[208:211], a[144:147], v[96:99]
buffer_load_dwordx4 a[248:251], v254, s[8:11], s20 offen offset:3072
v_mul_f32 v243, v243, v23
v_mfma_f32_16x16x32_bf16 v[96:99], a[212:215], a[148:151], v[96:99]
s_add_u32 s20, s20, 4096
v_cvt_pk_bf16_f32 v248, v240, v241
v_cvt_pk_bf16_f32 v249, v242, v243
v_mfma_f32_4x4x4_16b_bf16 v[240:243], a[252:253], a[40:41], 0
v_mul_f32 v244, v244, v52
v_mul_f32 v245, v245, v53
v_mfma_f32_16x16x32_bf16 v[100:103], a[208:211], a[152:155], v[100:103]
v_mul_f32 v246, v246, v54
v_mul_f32 v247, v247, v55
v_mfma_f32_16x16x32_bf16 v[100:103], a[212:215], a[156:159], v[100:103]
v_cvt_pk_bf16_f32 v250, v244, v245
v_cvt_pk_bf16_f32 v251, v246, v247
v_mfma_f32_4x4x4_16b_bf16 v[244:247], a[252:253], a[42:43], 0
ds_write_b128 v252, v[248:251] offset:10240
v_mfma_f32_16x16x32_bf16 v[104:107], a[208:211], a[160:163], v[104:107]
v_mul_f32 v240, v240, v24
v_mul_f32 v241, v241, v25
v_mfma_f32_16x16x32_bf16 v[104:107], a[212:215], a[164:167], v[104:107]
v_mul_f32 v242, v242, v26
v_mul_f32 v243, v243, v27
v_mfma_f32_16x16x32_bf16 v[108:111], a[208:211], a[168:171], v[108:111]
v_cvt_pk_bf16_f32 v248, v240, v241
v_cvt_pk_bf16_f32 v249, v242, v243
v_mfma_f32_4x4x4_16b_bf16 v[240:243], a[252:253], a[44:45], 0
v_mul_f32 v244, v244, v56
v_mul_f32 v245, v245, v57
v_mfma_f32_16x16x32_bf16 v[108:111], a[212:215], a[172:175], v[108:111]
v_mul_f32 v246, v246, v58
v_mul_f32 v247, v247, v59
v_mfma_f32_16x16x32_bf16 v[112:115], a[208:211], a[176:179], v[112:115]
v_cvt_pk_bf16_f32 v250, v244, v245
v_cvt_pk_bf16_f32 v251, v246, v247
v_mfma_f32_4x4x4_16b_bf16 v[244:247], a[252:253], a[46:47], 0
ds_write_b128 v252, v[248:251] offset:12288
v_mfma_f32_16x16x32_bf16 v[112:115], a[212:215], a[180:183], v[112:115]
v_mul_f32 v240, v240, v28
v_mul_f32 v241, v241, v29
v_mfma_f32_16x16x32_bf16 v[116:119], a[208:211], a[184:187], v[116:119]
v_mul_f32 v242, v242, v30
v_mul_f32 v243, v243, v31
v_mfma_f32_16x16x32_bf16 v[116:119], a[212:215], a[188:191], v[116:119]
v_cvt_pk_bf16_f32 v248, v240, v241
v_cvt_pk_bf16_f32 v249, v242, v243
v_mfma_f32_4x4x4_16b_bf16 v[240:243], a[252:253], a[48:49], 0
v_mul_f32 v244, v244, v60
v_mul_f32 v245, v245, v61
v_mfma_f32_16x16x32_bf16 v[120:123], a[208:211], a[192:195], v[120:123]
v_mul_f32 v246, v246, v62
v_mul_f32 v247, v247, v63
v_mfma_f32_16x16x32_bf16 v[120:123], a[212:215], a[196:199], v[120:123]
v_cvt_pk_bf16_f32 v250, v244, v245
v_cvt_pk_bf16_f32 v251, v246, v247
v_mfma_f32_4x4x4_16b_bf16 v[244:247], a[252:253], a[50:51], 0
ds_write_b128 v252, v[248:251] offset:14336
v_mfma_f32_16x16x32_bf16 v[124:127], a[208:211], a[200:203], v[124:127]
buffer_load_dwordx4 a[208:211], v254, s[8:11], s20 offen offset:0
v_mul_f32 v240, v240, v64
v_mfma_f32_16x16x32_bf16 v[124:127], a[212:215], a[204:207], v[124:127]
s_waitcnt vmcnt(7)
v_mul_f32 v241, v241, v65
v_mul_f32 v242, v242, v66
v_mfma_f32_16x16x32_bf16 v[156:159], a[220:223], a[200:203], v[156:159]
buffer_load_dwordx4 a[212:215], v254, s[8:11], s20 offen offset:1024
v_mul_f32 v243, v243, v67
v_mfma_f32_16x16x32_bf16 v[156:159], a[224:227], a[204:207], v[156:159]
v_cvt_pk_bf16_f32 v248, v240, v241
v_cvt_pk_bf16_f32 v249, v242, v243
v_mfma_f32_4x4x4_16b_bf16 v[240:243], a[252:253], a[52:53], 0
v_mul_f32 v244, v244, v96
v_mul_f32 v245, v245, v97
v_mfma_f32_16x16x32_bf16 v[152:155], a[220:223], a[192:195], v[152:155]
buffer_load_dwordx4 a[216:219], v254, s[8:11], s20 offen offset:2048
v_mul_f32 v246, v246, v98
v_mfma_f32_16x16x32_bf16 v[152:155], a[224:227], a[196:199], v[152:155]
v_mul_f32 v247, v247, v99
v_cvt_pk_bf16_f32 v250, v244, v245
v_mfma_f32_16x16x32_bf16 v[148:151], a[220:223], a[184:187], v[148:151]
v_cvt_pk_bf16_f32 v251, v246, v247
v_mfma_f32_4x4x4_16b_bf16 v[244:247], a[252:253], a[54:55], 0
ds_write_b128 v252, v[248:251] offset:512
v_mfma_f32_16x16x32_bf16 v[148:151], a[224:227], a[188:191], v[148:151]
v_mul_f32 v240, v240, v68
v_mul_f32 v241, v241, v69
v_mfma_f32_16x16x32_bf16 v[144:147], a[220:223], a[176:179], v[144:147]
v_mul_f32 v242, v242, v70
v_mul_f32 v243, v243, v71
v_mfma_f32_16x16x32_bf16 v[144:147], a[224:227], a[180:183], v[144:147]
v_cvt_pk_bf16_f32 v248, v240, v241
v_cvt_pk_bf16_f32 v249, v242, v243
v_mfma_f32_4x4x4_16b_bf16 v[240:243], a[252:253], a[56:57], 0
v_mul_f32 v244, v244, v100
v_mul_f32 v245, v245, v101
v_mfma_f32_16x16x32_bf16 v[140:143], a[220:223], a[168:171], v[140:143]
v_mul_f32 v246, v246, v102
v_mul_f32 v247, v247, v103
v_mfma_f32_16x16x32_bf16 v[140:143], a[224:227], a[172:175], v[140:143]
v_cvt_pk_bf16_f32 v250, v244, v245
v_cvt_pk_bf16_f32 v251, v246, v247
v_mfma_f32_4x4x4_16b_bf16 v[244:247], a[252:253], a[58:59], 0
ds_write_b128 v252, v[248:251] offset:2560
v_mfma_f32_16x16x32_bf16 v[136:139], a[220:223], a[160:163], v[136:139]
v_mul_f32 v240, v240, v72
v_mul_f32 v241, v241, v73
v_mfma_f32_16x16x32_bf16 v[136:139], a[224:227], a[164:167], v[136:139]
v_mul_f32 v242, v242, v74
v_mul_f32 v243, v243, v75
v_mfma_f32_16x16x32_bf16 v[132:135], a[220:223], a[152:155], v[132:135]
v_cvt_pk_bf16_f32 v248, v240, v241
v_cvt_pk_bf16_f32 v249, v242, v243
v_mfma_f32_4x4x4_16b_bf16 v[240:243], a[252:253], a[60:61], 0
v_mul_f32 v244, v244, v104
v_mul_f32 v245, v245, v105
v_mfma_f32_16x16x32_bf16 v[132:135], a[224:227], a[156:159], v[132:135]
v_mul_f32 v246, v246, v106
v_mul_f32 v247, v247, v107
v_mfma_f32_16x16x32_bf16 v[128:131], a[220:223], a[144:147], v[128:131]
buffer_load_dwordx4 a[220:223], v254, s[8:11], s20 offen offset:3072
v_cvt_pk_bf16_f32 v250, v244, v245
v_mfma_f32_16x16x32_bf16 v[128:131], a[224:227], a[148:151], v[128:131]
s_waitcnt vmcnt(8)
s_add_u32 s20, s20, 4096
v_cvt_pk_bf16_f32 v251, v246, v247
v_mfma_f32_4x4x4_16b_bf16 v[244:247], a[252:253], a[62:63], 0
ds_write_b128 v252, v[248:251] offset:4608
v_mfma_f32_16x16x32_bf16 v[160:163], a[228:231], a[144:147], v[160:163]
buffer_load_dwordx4 a[224:227], v254, s[8:11], s20 offen offset:0
v_mul_f32 v240, v240, v76
v_mfma_f32_16x16x32_bf16 v[160:163], a[232:235], a[148:151], v[160:163]
v_mul_f32 v241, v241, v77
v_mul_f32 v242, v242, v78
v_mfma_f32_16x16x32_bf16 v[164:167], a[228:231], a[152:155], v[164:167]
v_mul_f32 v243, v243, v79
v_cvt_pk_bf16_f32 v248, v240, v241
v_mfma_f32_16x16x32_bf16 v[164:167], a[232:235], a[156:159], v[164:167]
v_cvt_pk_bf16_f32 v249, v242, v243
v_mfma_f32_4x4x4_16b_bf16 v[240:243], a[252:253], a[64:65], 0
v_mul_f32 v244, v244, v108
v_mul_f32 v245, v245, v109
v_mfma_f32_16x16x32_bf16 v[168:171], a[228:231], a[160:163], v[168:171]
v_mul_f32 v246, v246, v110
v_mul_f32 v247, v247, v111
v_mfma_f32_16x16x32_bf16 v[168:171], a[232:235], a[164:167], v[168:171]
v_cvt_pk_bf16_f32 v250, v244, v245
v_cvt_pk_bf16_f32 v251, v246, v247
v_mfma_f32_4x4x4_16b_bf16 v[244:247], a[252:253], a[66:67], 0
ds_write_b128 v252, v[248:251] offset:6656
v_mfma_f32_16x16x32_bf16 v[172:175], a[228:231], a[168:171], v[172:175]
v_mul_f32 v240, v240, v80
v_mul_f32 v241, v241, v81
v_mfma_f32_16x16x32_bf16 v[172:175], a[232:235], a[172:175], v[172:175]
v_mul_f32 v242, v242, v82
v_mul_f32 v243, v243, v83
v_mfma_f32_16x16x32_bf16 v[176:179], a[228:231], a[176:179], v[176:179]
v_cvt_pk_bf16_f32 v248, v240, v241
v_cvt_pk_bf16_f32 v249, v242, v243
v_mfma_f32_4x4x4_16b_bf16 v[240:243], a[252:253], a[68:69], 0
v_mul_f32 v244, v244, v112
v_mul_f32 v245, v245, v113
v_mfma_f32_16x16x32_bf16 v[176:179], a[232:235], a[180:183], v[176:179]
v_mul_f32 v246, v246, v114
v_mul_f32 v247, v247, v115
v_mfma_f32_16x16x32_bf16 v[180:183], a[228:231], a[184:187], v[180:183]
v_cvt_pk_bf16_f32 v250, v244, v245
v_cvt_pk_bf16_f32 v251, v246, v247
v_mfma_f32_4x4x4_16b_bf16 v[244:247], a[252:253], a[70:71], 0
ds_write_b128 v252, v[248:251] offset:8704
v_mfma_f32_16x16x32_bf16 v[180:183], a[232:235], a[188:191], v[180:183]
v_mul_f32 v240, v240, v84
v_mul_f32 v241, v241, v85
v_mfma_f32_16x16x32_bf16 v[184:187], a[228:231], a[192:195], v[184:187]
v_mul_f32 v242, v242, v86
v_mul_f32 v243, v243, v87
v_mfma_f32_16x16x32_bf16 v[184:187], a[232:235], a[196:199], v[184:187]
v_cvt_pk_bf16_f32 v248, v240, v241
v_cvt_pk_bf16_f32 v249, v242, v243
v_mfma_f32_4x4x4_16b_bf16 v[240:243], a[252:253], a[72:73], 0
v_mul_f32 v244, v244, v116
v_mul_f32 v245, v245, v117
v_mfma_f32_16x16x32_bf16 v[188:191], a[228:231], a[200:203], v[188:191]
buffer_load_dwordx4 a[228:231], v254, s[8:11], s20 offen offset:1024
v_mul_f32 v246, v246, v118
v_mfma_f32_16x16x32_bf16 v[188:191], a[232:235], a[204:207], v[188:191]
s_waitcnt vmcnt(8)
v_mul_f32 v247, v247, v119
v_cvt_pk_bf16_f32 v250, v244, v245
v_mfma_f32_16x16x32_bf16 v[220:223], a[236:239], a[200:203], v[220:223]
buffer_load_dwordx4 a[232:235], v254, s[8:11], s20 offen offset:2048
v_cvt_pk_bf16_f32 v251, v246, v247
v_mfma_f32_4x4x4_16b_bf16 v[244:247], a[252:253], a[74:75], 0
ds_write_b128 v252, v[248:251] offset:10752
v_mfma_f32_16x16x32_bf16 v[220:223], a[240:243], a[204:207], v[220:223]
v_mul_f32 v240, v240, v88
v_mul_f32 v241, v241, v89
v_mfma_f32_16x16x32_bf16 v[216:219], a[236:239], a[192:195], v[216:219]
v_mul_f32 v242, v242, v90
v_mul_f32 v243, v243, v91
v_mfma_f32_16x16x32_bf16 v[216:219], a[240:243], a[196:199], v[216:219]
v_cvt_pk_bf16_f32 v248, v240, v241
v_cvt_pk_bf16_f32 v249, v242, v243
v_mfma_f32_4x4x4_16b_bf16 v[240:243], a[252:253], a[76:77], 0
v_mul_f32 v244, v244, v120
v_mul_f32 v245, v245, v121
v_mfma_f32_16x16x32_bf16 v[212:215], a[236:239], a[184:187], v[212:215]
v_mul_f32 v246, v246, v122
v_mul_f32 v247, v247, v123
v_mfma_f32_16x16x32_bf16 v[212:215], a[240:243], a[188:191], v[212:215]
v_cvt_pk_bf16_f32 v250, v244, v245
v_cvt_pk_bf16_f32 v251, v246, v247
v_mfma_f32_4x4x4_16b_bf16 v[244:247], a[252:253], a[78:79], 0
ds_write_b128 v252, v[248:251] offset:12800
v_mfma_f32_16x16x32_bf16 v[208:211], a[236:239], a[176:179], v[208:211]
v_mul_f32 v240, v240, v92
v_mul_f32 v241, v241, v93
v_mfma_f32_16x16x32_bf16 v[208:211], a[240:243], a[180:183], v[208:211]
v_mul_f32 v242, v242, v94
v_mul_f32 v243, v243, v95
v_mfma_f32_16x16x32_bf16 v[204:207], a[236:239], a[168:171], v[204:207]
v_cvt_pk_bf16_f32 v248, v240, v241
v_cvt_pk_bf16_f32 v249, v242, v243
v_mfma_f32_4x4x4_16b_bf16 v[240:243], a[252:253], a[80:81], 0
v_mul_f32 v244, v244, v124
v_mul_f32 v245, v245, v125
v_mfma_f32_16x16x32_bf16 v[204:207], a[240:243], a[172:175], v[204:207]
v_mul_f32 v246, v246, v126
v_mul_f32 v247, v247, v127
v_mfma_f32_16x16x32_bf16 v[200:203], a[236:239], a[160:163], v[200:203]
v_cvt_pk_bf16_f32 v250, v244, v245
v_cvt_pk_bf16_f32 v251, v246, v247
v_mfma_f32_4x4x4_16b_bf16 v[244:247], a[252:253], a[82:83], 0
ds_write_b128 v252, v[248:251] offset:14848
v_mfma_f32_16x16x32_bf16 v[200:203], a[240:243], a[164:167], v[200:203]
v_mul_f32 v240, v240, v128
v_mul_f32 v241, v241, v129
v_mfma_f32_16x16x32_bf16 v[196:199], a[236:239], a[152:155], v[196:199]
v_mul_f32 v242, v242, v130
v_mul_f32 v243, v243, v131
v_mfma_f32_16x16x32_bf16 v[196:199], a[240:243], a[156:159], v[196:199]
v_cvt_pk_bf16_f32 v248, v240, v241
v_cvt_pk_bf16_f32 v249, v242, v243
v_mfma_f32_4x4x4_16b_bf16 v[240:243], a[252:253], a[84:85], 0
v_mul_f32 v244, v244, v160
v_mul_f32 v245, v245, v161
v_mfma_f32_16x16x32_bf16 v[192:195], a[236:239], a[144:147], v[192:195]
buffer_load_dwordx4 a[236:239], v254, s[8:11], s20 offen offset:3072
v_mul_f32 v246, v246, v162
v_mfma_f32_16x16x32_bf16 v[192:195], a[240:243], a[148:151], v[192:195]
s_waitcnt vmcnt(8)
s_add_u32 s20, s20, 4096
v_mul_f32 v247, v247, v163
v_mfma_f32_16x16x32_bf16 v[224:227], a[244:247], a[144:147], v[224:227]
ds_read_b128 a[144:147], v252 offset:0
buffer_load_dwordx4 a[240:243], v254, s[8:11], s20 offen offset:0
v_cvt_pk_bf16_f32 v250, v244, v245
v_mfma_f32_16x16x32_bf16 v[224:227], a[248:251], a[148:151], v[224:227]
ds_read_b128 a[148:151], v252 offset:512
v_cvt_pk_bf16_f32 v251, v246, v247
v_mfma_f32_4x4x4_16b_bf16 v[244:247], a[252:253], a[86:87], 0
ds_write_b128 v252, v[248:251] offset:16384
v_mfma_f32_16x16x32_bf16 v[228:231], a[244:247], a[152:155], v[228:231]
ds_read_b128 a[152:155], v252 offset:2048
v_mul_f32 v240, v240, v132
v_mfma_f32_16x16x32_bf16 v[228:231], a[248:251], a[156:159], v[228:231]
ds_read_b128 a[156:159], v252 offset:2560
v_mul_f32 v241, v241, v133
v_mfma_f32_16x16x32_bf16 v[232:235], a[244:247], a[160:163], v[232:235]
ds_read_b128 a[160:163], v252 offset:4096
v_mul_f32 v242, v242, v134
v_mfma_f32_16x16x32_bf16 v[232:235], a[248:251], a[164:167], v[232:235]
ds_read_b128 a[164:167], v252 offset:4608
v_mul_f32 v243, v243, v135
v_mfma_f32_16x16x32_bf16 v[236:239], a[244:247], a[168:171], v[236:239]
ds_read_b128 a[168:171], v252 offset:6144
v_cvt_pk_bf16_f32 v248, v240, v241
v_mfma_f32_16x16x32_bf16 v[236:239], a[248:251], a[172:175], v[236:239]
ds_read_b128 a[172:175], v252 offset:6656
v_cvt_pk_bf16_f32 v249, v242, v243
v_mfma_f32_4x4x4_16b_bf16 v[240:243], a[252:253], a[88:89], 0
v_mul_f32 v244, v244, v164
v_mul_f32 v245, v245, v165
v_mfma_f32_16x16x32_bf16 a[0:3], a[244:247], a[176:179], a[0:3]
ds_read_b128 a[176:179], v252 offset:8192
v_mul_f32 v246, v246, v166
v_mfma_f32_16x16x32_bf16 a[0:3], a[248:251], a[180:183], a[0:3]
ds_read_b128 a[180:183], v252 offset:8704
v_mul_f32 v247, v247, v167
v_mfma_f32_16x16x32_bf16 a[4:7], a[244:247], a[184:187], a[4:7]
ds_read_b128 a[184:187], v252 offset:10240
v_cvt_pk_bf16_f32 v250, v244, v245
v_mfma_f32_16x16x32_bf16 a[4:7], a[248:251], a[188:191], a[4:7]
ds_read_b128 a[188:191], v252 offset:10752
v_cvt_pk_bf16_f32 v251, v246, v247
v_mfma_f32_4x4x4_16b_bf16 v[244:247], a[252:253], a[90:91], 0
ds_write_b128 v252, v[248:251] offset:18432
v_mfma_f32_16x16x32_bf16 a[8:11], a[244:247], a[192:195], a[8:11]
ds_read_b128 a[192:195], v252 offset:12288
v_mul_f32 v240, v240, v136
v_mfma_f32_16x16x32_bf16 a[8:11], a[248:251], a[196:199], a[8:11]
ds_read_b128 a[196:199], v252 offset:12800
v_mul_f32 v241, v241, v137
v_mfma_f32_16x16x32_bf16 a[12:15], a[244:247], a[200:203], a[12:15]
ds_read_b128 a[200:203], v252 offset:14336
v_mul_f32 v242, v242, v138
v_mfma_f32_16x16x32_bf16 a[12:15], a[248:251], a[204:207], a[12:15]
ds_read_b128 a[204:207], v252 offset:14848
s_mov_b32 s22, 1
.p2align 3
L_loop:
s_waitcnt vmcnt(7) lgkmcnt(13)
v_mul_f32 v243, v243, v139
v_cvt_pk_bf16_f32 v248, v240, v241
v_mfma_f32_16x16x32_bf16 v[0:3], a[208:211], a[144:147], v[0:3]
buffer_load_dwordx4 a[244:247], v254, s[8:11], s20 offen offset:1024
v_cvt_pk_bf16_f32 v249, v242, v243
v_mfma_f32_4x4x4_16b_bf16 v[240:243], a[252:253], a[92:93], 0
v_mul_f32 v244, v244, v168
v_mul_f32 v245, v245, v169
v_mfma_f32_16x16x32_bf16 v[0:3], a[212:215], a[148:151], v[0:3]
v_mul_f32 v246, v246, v170
v_mul_f32 v247, v247, v171
v_mfma_f32_16x16x32_bf16 v[4:7], a[208:211], a[152:155], v[4:7]
buffer_load_dwordx4 a[248:251], v254, s[8:11], s20 offen offset:2048
v_cvt_pk_bf16_f32 v250, v244, v245
v_mfma_f32_16x16x32_bf16 v[4:7], a[212:215], a[156:159], v[4:7]
s_waitcnt lgkmcnt(9)
v_cvt_pk_bf16_f32 v251, v246, v247
v_mfma_f32_4x4x4_16b_bf16 v[244:247], a[252:253], a[94:95], 0
ds_write_b128 v252, v[248:251] offset:20480
v_mfma_f32_16x16x32_bf16 v[8:11], a[208:211], a[160:163], v[8:11]
v_mul_f32 v240, v240, v140
v_mul_f32 v241, v241, v141
v_mfma_f32_16x16x32_bf16 v[8:11], a[212:215], a[164:167], v[8:11]
v_mul_f32 v242, v242, v142
v_mul_f32 v243, v243, v143
v_mfma_f32_16x16x32_bf16 v[12:15], a[208:211], a[168:171], v[12:15]
v_cvt_pk_bf16_f32 v248, v240, v241
v_cvt_pk_bf16_f32 v249, v242, v243
v_mfma_f32_4x4x4_16b_bf16 v[240:243], a[252:253], a[96:97], 0
v_mul_f32 v244, v244, v172
v_mul_f32 v245, v245, v173
v_mfma_f32_16x16x32_bf16 v[12:15], a[212:215], a[172:175], v[12:15]
s_waitcnt lgkmcnt(6)
v_mul_f32 v246, v246, v174
v_mul_f32 v247, v247, v175
v_mfma_f32_16x16x32_bf16 v[16:19], a[208:211], a[176:179], v[16:19]
v_cvt_pk_bf16_f32 v250, v244, v245
v_cvt_pk_bf16_f32 v251, v246, v247
v_mfma_f32_4x4x4_16b_bf16 v[244:247], a[252:253], a[98:99], 0
ds_write_b128 v252, v[248:251] offset:22528
v_mfma_f32_16x16x32_bf16 v[16:19], a[212:215], a[180:183], v[16:19]
v_mul_f32 v240, v240, v144
v_mul_f32 v241, v241, v145
v_mfma_f32_16x16x32_bf16 v[20:23], a[208:211], a[184:187], v[20:23]
v_mul_f32 v242, v242, v146
v_mul_f32 v243, v243, v147
v_mfma_f32_16x16x32_bf16 v[20:23], a[212:215], a[188:191], v[20:23]
s_waitcnt lgkmcnt(2)
v_cvt_pk_bf16_f32 v248, v240, v241
v_cvt_pk_bf16_f32 v249, v242, v243
v_mfma_f32_4x4x4_16b_bf16 v[240:243], a[252:253], a[100:101], 0
v_mul_f32 v244, v244, v176
v_mul_f32 v245, v245, v177
v_mfma_f32_16x16x32_bf16 v[24:27], a[208:211], a[192:195], v[24:27]
v_mul_f32 v246, v246, v178
v_mul_f32 v247, v247, v179
v_mfma_f32_16x16x32_bf16 v[24:27], a[212:215], a[196:199], v[24:27]
v_cvt_pk_bf16_f32 v250, v244, v245
v_cvt_pk_bf16_f32 v251, v246, v247
v_mfma_f32_4x4x4_16b_bf16 v[244:247], a[252:253], a[102:103], 0
ds_write_b128 v252, v[248:251] offset:24576
v_mfma_f32_16x16x32_bf16 v[28:31], a[208:211], a[200:203], v[28:31]
buffer_load_dwordx4 a[208:211], v254, s[8:11], s20 offen offset:3072
v_mul_f32 v240, v240, v148
v_mfma_f32_16x16x32_bf16 v[28:31], a[212:215], a[204:207], v[28:31]
s_waitcnt vmcnt(8)
s_add_u32 s20, s20, 4096
v_mul_f32 v241, v241, v149
v_mfma_f32_16x16x32_bf16 v[60:63], a[216:219], a[200:203], v[60:63]
buffer_load_dwordx4 a[212:215], v254, s[8:11], s20 offen offset:0
v_mul_f32 v242, v242, v150
v_mfma_f32_16x16x32_bf16 v[60:63], a[220:223], a[204:207], v[60:63]
v_mul_f32 v243, v243, v151
v_cvt_pk_bf16_f32 v248, v240, v241
v_mfma_f32_16x16x32_bf16 v[56:59], a[216:219], a[192:195], v[56:59]
v_cvt_pk_bf16_f32 v249, v242, v243
v_mfma_f32_4x4x4_16b_bf16 v[240:243], a[252:253], a[104:105], 0
v_mul_f32 v244, v244, v180
v_mul_f32 v245, v245, v181
v_mfma_f32_16x16x32_bf16 v[56:59], a[220:223], a[196:199], v[56:59]
v_mul_f32 v246, v246, v182
v_mul_f32 v247, v247, v183
v_mfma_f32_16x16x32_bf16 v[52:55], a[216:219], a[184:187], v[52:55]
v_cvt_pk_bf16_f32 v250, v244, v245
v_cvt_pk_bf16_f32 v251, v246, v247
v_mfma_f32_4x4x4_16b_bf16 v[244:247], a[252:253], a[106:107], 0
ds_write_b128 v252, v[248:251] offset:26624
v_mfma_f32_16x16x32_bf16 v[52:55], a[220:223], a[188:191], v[52:55]
v_mul_f32 v240, v240, v152
v_mul_f32 v241, v241, v153
v_mfma_f32_16x16x32_bf16 v[48:51], a[216:219], a[176:179], v[48:51]
v_mul_f32 v242, v242, v154
v_mul_f32 v243, v243, v155
v_mfma_f32_16x16x32_bf16 v[48:51], a[220:223], a[180:183], v[48:51]
v_cvt_pk_bf16_f32 v248, v240, v241
v_cvt_pk_bf16_f32 v249, v242, v243
v_mfma_f32_4x4x4_16b_bf16 v[240:243], a[252:253], a[108:109], 0
v_mul_f32 v244, v244, v184
v_mul_f32 v245, v245, v185
v_mfma_f32_16x16x32_bf16 v[44:47], a[216:219], a[168:171], v[44:47]
v_mul_f32 v246, v246, v186
v_mul_f32 v247, v247, v187
v_mfma_f32_16x16x32_bf16 v[44:47], a[220:223], a[172:175], v[44:47]
v_cvt_pk_bf16_f32 v250, v244, v245
v_cvt_pk_bf16_f32 v251, v246, v247
v_mfma_f32_4x4x4_16b_bf16 v[244:247], a[252:253], a[110:111], 0
ds_write_b128 v252, v[248:251] offset:28672
v_mfma_f32_16x16x32_bf16 v[40:43], a[216:219], a[160:163], v[40:43]
v_mul_f32 v240, v240, v156
v_mul_f32 v241, v241, v157
v_mfma_f32_16x16x32_bf16 v[40:43], a[220:223], a[164:167], v[40:43]
v_mul_f32 v242, v242, v158
v_mul_f32 v243, v243, v159
v_mfma_f32_16x16x32_bf16 v[36:39], a[216:219], a[152:155], v[36:39]
v_cvt_pk_bf16_f32 v248, v240, v241
v_cvt_pk_bf16_f32 v249, v242, v243
v_mfma_f32_4x4x4_16b_bf16 v[240:243], a[252:253], a[112:113], 0
v_mul_f32 v244, v244, v188
v_mul_f32 v245, v245, v189
v_mfma_f32_16x16x32_bf16 v[36:39], a[220:223], a[156:159], v[36:39]
v_mul_f32 v246, v246, v190
v_mul_f32 v247, v247, v191
v_mfma_f32_16x16x32_bf16 v[32:35], a[216:219], a[144:147], v[32:35]
buffer_load_dwordx4 a[216:219], v254, s[8:11], s20 offen offset:1024
v_cvt_pk_bf16_f32 v250, v244, v245
v_mfma_f32_16x16x32_bf16 v[32:35], a[220:223], a[148:151], v[32:35]
s_waitcnt vmcnt(8)
v_cvt_pk_bf16_f32 v251, v246, v247
v_mfma_f32_4x4x4_16b_bf16 v[244:247], a[252:253], a[114:115], 0
ds_write_b128 v252, v[248:251] offset:30720
v_mfma_f32_16x16x32_bf16 v[64:67], a[224:227], a[144:147], v[64:67]
buffer_load_dwordx4 a[220:223], v254, s[8:11], s20 offen offset:2048
v_mul_f32 v240, v240, v192
v_mfma_f32_16x16x32_bf16 v[64:67], a[228:231], a[148:151], v[64:67]
v_mul_f32 v241, v241, v193
v_mul_f32 v242, v242, v194
v_mfma_f32_16x16x32_bf16 v[68:71], a[224:227], a[152:155], v[68:71]
v_mul_f32 v243, v243, v195
v_cvt_pk_bf16_f32 v248, v240, v241
v_mfma_f32_16x16x32_bf16 v[68:71], a[228:231], a[156:159], v[68:71]
v_cvt_pk_bf16_f32 v249, v242, v243
v_mfma_f32_4x4x4_16b_bf16 v[240:243], a[252:253], a[116:117], 0
v_mul_f32 v244, v244, v224
v_mul_f32 v245, v245, v225
v_mfma_f32_16x16x32_bf16 v[72:75], a[224:227], a[160:163], v[72:75]
v_mul_f32 v246, v246, v226
v_mul_f32 v247, v247, v227
v_mfma_f32_16x16x32_bf16 v[72:75], a[228:231], a[164:167], v[72:75]
v_cvt_pk_bf16_f32 v250, v244, v245
v_cvt_pk_bf16_f32 v251, v246, v247
v_mfma_f32_4x4x4_16b_bf16 v[244:247], a[252:253], a[118:119], 0
ds_write_b128 v252, v[248:251] offset:16896
v_mfma_f32_16x16x32_bf16 v[76:79], a[224:227], a[168:171], v[76:79]
v_mul_f32 v240, v240, v196
v_mul_f32 v241, v241, v197
v_mfma_f32_16x16x32_bf16 v[76:79], a[228:231], a[172:175], v[76:79]
v_mul_f32 v242, v242, v198
v_mul_f32 v243, v243, v199
v_mfma_f32_16x16x32_bf16 v[80:83], a[224:227], a[176:179], v[80:83]
v_cvt_pk_bf16_f32 v248, v240, v241
v_cvt_pk_bf16_f32 v249, v242, v243
v_mfma_f32_4x4x4_16b_bf16 v[240:243], a[252:253], a[120:121], 0
v_mul_f32 v244, v244, v228
v_mul_f32 v245, v245, v229
v_mfma_f32_16x16x32_bf16 v[80:83], a[228:231], a[180:183], v[80:83]
v_mul_f32 v246, v246, v230
v_mul_f32 v247, v247, v231
v_mfma_f32_16x16x32_bf16 v[84:87], a[224:227], a[184:187], v[84:87]
v_cvt_pk_bf16_f32 v250, v244, v245
v_cvt_pk_bf16_f32 v251, v246, v247
v_mfma_f32_4x4x4_16b_bf16 v[244:247], a[252:253], a[122:123], 0
ds_write_b128 v252, v[248:251] offset:18944
v_mfma_f32_16x16x32_bf16 v[84:87], a[228:231], a[188:191], v[84:87]
v_mul_f32 v240, v240, v200
v_mul_f32 v241, v241, v201
v_mfma_f32_16x16x32_bf16 v[88:91], a[224:227], a[192:195], v[88:91]
v_mul_f32 v242, v242, v202
v_mul_f32 v243, v243, v203
v_mfma_f32_16x16x32_bf16 v[88:91], a[228:231], a[196:199], v[88:91]
v_cvt_pk_bf16_f32 v248, v240, v241
v_cvt_pk_bf16_f32 v249, v242, v243
v_mfma_f32_4x4x4_16b_bf16 v[240:243], a[252:253], a[124:125], 0
v_mul_f32 v244, v244, v232
v_mul_f32 v245, v245, v233
v_mfma_f32_16x16x32_bf16 v[92:95], a[224:227], a[200:203], v[92:95]
buffer_load_dwordx4 a[224:227], v254, s[8:11], s20 offen offset:3072
v_mul_f32 v246, v246, v234
v_mfma_f32_16x16x32_bf16 v[92:95], a[228:231], a[204:207], v[92:95]
s_waitcnt vmcnt(8)
s_add_u32 s20, s20, 4096
v_mul_f32 v247, v247, v235
v_mfma_f32_16x16x32_bf16 v[124:127], a[232:235], a[200:203], v[124:127]
buffer_load_dwordx4 a[228:231], v254, s[8:11], s20 offen offset:0
v_cvt_pk_bf16_f32 v250, v244, v245
v_mfma_f32_16x16x32_bf16 v[124:127], a[236:239], a[204:207], v[124:127]
v_cvt_pk_bf16_f32 v251, v246, v247
v_mfma_f32_4x4x4_16b_bf16 v[244:247], a[252:253], a[126:127], 0
ds_write_b128 v252, v[248:251] offset:20992
v_mfma_f32_16x16x32_bf16 v[120:123], a[232:235], a[192:195], v[120:123]
v_mul_f32 v240, v240, v204
v_mul_f32 v241, v241, v205
v_mfma_f32_16x16x32_bf16 v[120:123], a[236:239], a[196:199], v[120:123]
v_mul_f32 v242, v242, v206
v_mul_f32 v243, v243, v207
v_mfma_f32_16x16x32_bf16 v[116:119], a[232:235], a[184:187], v[116:119]
v_cvt_pk_bf16_f32 v248, v240, v241
v_cvt_pk_bf16_f32 v249, v242, v243
v_mfma_f32_4x4x4_16b_bf16 v[240:243], a[252:253], a[128:129], 0
v_mul_f32 v244, v244, v236
v_mul_f32 v245, v245, v237
v_mfma_f32_16x16x32_bf16 v[116:119], a[236:239], a[188:191], v[116:119]
v_mul_f32 v246, v246, v238
v_mul_f32 v247, v247, v239
v_mfma_f32_16x16x32_bf16 v[112:115], a[232:235], a[176:179], v[112:115]
v_cvt_pk_bf16_f32 v250, v244, v245
v_cvt_pk_bf16_f32 v251, v246, v247
v_mfma_f32_4x4x4_16b_bf16 v[244:247], a[252:253], a[130:131], 0
ds_write_b128 v252, v[248:251] offset:23040
v_mfma_f32_16x16x32_bf16 v[112:115], a[236:239], a[180:183], v[112:115]
v_mul_f32 v240, v240, v208
v_mul_f32 v241, v241, v209
v_mfma_f32_16x16x32_bf16 v[108:111], a[232:235], a[168:171], v[108:111]
v_mul_f32 v242, v242, v210
v_mul_f32 v243, v243, v211
v_mfma_f32_16x16x32_bf16 v[108:111], a[236:239], a[172:175], v[108:111]
v_cvt_pk_bf16_f32 v248, v240, v241
v_cvt_pk_bf16_f32 v249, v242, v243
v_mfma_f32_4x4x4_16b_bf16 v[240:243], a[252:253], a[132:133], 0
v_accvgpr_read_b32 v250, a0
v_mul_f32 v244, v244, v250
v_mfma_f32_16x16x32_bf16 v[104:107], a[232:235], a[160:163], v[104:107]
v_accvgpr_read_b32 v251, a1
v_mul_f32 v245, v245, v251
v_mfma_f32_16x16x32_bf16 v[104:107], a[236:239], a[164:167], v[104:107]
v_accvgpr_read_b32 v250, a2
v_mul_f32 v246, v246, v250
v_mfma_f32_16x16x32_bf16 v[100:103], a[232:235], a[152:155], v[100:103]
v_accvgpr_read_b32 v251, a3
v_mul_f32 v247, v247, v251
v_mfma_f32_16x16x32_bf16 v[100:103], a[236:239], a[156:159], v[100:103]
v_cvt_pk_bf16_f32 v250, v244, v245
v_cvt_pk_bf16_f32 v251, v246, v247
v_mfma_f32_4x4x4_16b_bf16 v[244:247], a[252:253], a[134:135], 0
ds_write_b128 v252, v[248:251] offset:25088
v_mfma_f32_16x16x32_bf16 v[96:99], a[232:235], a[144:147], v[96:99]
buffer_load_dwordx4 a[232:235], v254, s[8:11], s20 offen offset:1024
v_mul_f32 v240, v240, v212
v_mfma_f32_16x16x32_bf16 v[96:99], a[236:239], a[148:151], v[96:99]
s_waitcnt vmcnt(8)
v_mul_f32 v241, v241, v213
v_mul_f32 v242, v242, v214
v_mfma_f32_16x16x32_bf16 v[128:131], a[240:243], a[144:147], v[128:131]
buffer_load_dwordx4 a[236:239], v254, s[8:11], s20 offen offset:2048
v_mul_f32 v243, v243, v215
v_mfma_f32_16x16x32_bf16 v[128:131], a[244:247], a[148:151], v[128:131]
v_cvt_pk_bf16_f32 v248, v240, v241
v_cvt_pk_bf16_f32 v249, v242, v243
v_mfma_f32_4x4x4_16b_bf16 v[240:243], a[252:253], a[136:137], 0
v_accvgpr_read_b32 v250, a4
v_mul_f32 v244, v244, v250
v_mfma_f32_16x16x32_bf16 v[132:135], a[240:243], a[152:155], v[132:135]
v_accvgpr_read_b32 v251, a5
v_mul_f32 v245, v245, v251
v_mfma_f32_16x16x32_bf16 v[132:135], a[244:247], a[156:159], v[132:135]
v_accvgpr_read_b32 v250, a6
v_mul_f32 v246, v246, v250
v_mfma_f32_16x16x32_bf16 v[136:139], a[240:243], a[160:163], v[136:139]
v_accvgpr_read_b32 v251, a7
v_mul_f32 v247, v247, v251
v_mfma_f32_16x16x32_bf16 v[136:139], a[244:247], a[164:167], v[136:139]
v_cvt_pk_bf16_f32 v250, v244, v245
v_cvt_pk_bf16_f32 v251, v246, v247
v_mfma_f32_4x4x4_16b_bf16 v[244:247], a[252:253], a[138:139], 0
ds_write_b128 v252, v[248:251] offset:27136
v_mfma_f32_16x16x32_bf16 v[140:143], a[240:243], a[168:171], v[140:143]
v_mul_f32 v240, v240, v216
v_mul_f32 v241, v241, v217
v_mfma_f32_16x16x32_bf16 v[140:143], a[244:247], a[172:175], v[140:143]
v_mul_f32 v242, v242, v218
v_mul_f32 v243, v243, v219
v_mfma_f32_16x16x32_bf16 v[144:147], a[240:243], a[176:179], v[144:147]
v_cvt_pk_bf16_f32 v248, v240, v241
v_cvt_pk_bf16_f32 v249, v242, v243
v_mfma_f32_4x4x4_16b_bf16 v[240:243], a[252:253], a[140:141], 0
v_accvgpr_read_b32 v250, a8
v_mul_f32 v244, v244, v250
v_mfma_f32_16x16x32_bf16 v[144:147], a[244:247], a[180:183], v[144:147]
v_accvgpr_read_b32 v251, a9
v_mul_f32 v245, v245, v251
v_mfma_f32_16x16x32_bf16 v[148:151], a[240:243], a[184:187], v[148:151]
v_accvgpr_read_b32 v250, a10
v_mul_f32 v246, v246, v250
v_mfma_f32_16x16x32_bf16 v[148:151], a[244:247], a[188:191], v[148:151]
v_accvgpr_read_b32 v251, a11
v_mul_f32 v247, v247, v251
v_mfma_f32_16x16x32_bf16 v[152:155], a[240:243], a[192:195], v[152:155]
v_cvt_pk_bf16_f32 v250, v244, v245
v_cvt_pk_bf16_f32 v251, v246, v247
v_mfma_f32_4x4x4_16b_bf16 v[244:247], a[252:253], a[142:143], 0
ds_write_b128 v252, v[248:251] offset:29184
v_mfma_f32_16x16x32_bf16 v[152:155], a[244:247], a[196:199], v[152:155]
v_mul_f32 v240, v240, v220
v_mul_f32 v241, v241, v221
v_mfma_f32_16x16x32_bf16 v[156:159], a[240:243], a[200:203], v[156:159]
buffer_load_dwordx4 a[240:243], v254, s[8:11], s20 offen offset:3072
v_mul_f32 v242, v242, v222
v_mfma_f32_16x16x32_bf16 v[156:159], a[244:247], a[204:207], v[156:159]
s_waitcnt vmcnt(8)
s_add_u32 s20, s20, 4096
v_mul_f32 v243, v243, v223
v_mfma_f32_16x16x32_bf16 v[188:191], a[248:251], a[200:203], v[188:191]
buffer_load_dwordx4 a[244:247], v254, s[8:11], s20 offen offset:0
v_cvt_pk_bf16_f32 v248, v240, v241
v_mfma_f32_16x16x32_bf16 v[188:191], a[208:211], a[204:207], v[188:191]
v_cvt_pk_bf16_f32 v249, v242, v243
v_accvgpr_read_b32 v250, a12
v_mfma_f32_16x16x32_bf16 v[184:187], a[248:251], a[192:195], v[184:187]
v_mul_f32 v244, v244, v250
v_accvgpr_read_b32 v251, a13
v_mfma_f32_16x16x32_bf16 v[184:187], a[208:211], a[196:199], v[184:187]
v_mul_f32 v245, v245, v251
v_accvgpr_read_b32 v250, a14
v_mfma_f32_16x16x32_bf16 v[180:183], a[248:251], a[184:187], v[180:183]
v_mul_f32 v246, v246, v250
v_accvgpr_read_b32 v251, a15
v_mfma_f32_16x16x32_bf16 v[180:183], a[208:211], a[188:191], v[180:183]
v_mul_f32 v247, v247, v251
v_cvt_pk_bf16_f32 v250, v244, v245
v_mfma_f32_16x16x32_bf16 v[176:179], a[248:251], a[176:179], v[176:179]
v_cvt_pk_bf16_f32 v251, v246, v247
v_mfma_f32_16x16x32_bf16 v[176:179], a[208:211], a[180:183], v[176:179]
ds_write_b128 v252, v[248:251] offset:31232
v_mfma_f32_16x16x32_bf16 v[172:175], a[248:251], a[168:171], v[172:175]
v_mfma_f32_16x16x32_bf16 v[172:175], a[208:211], a[172:175], v[172:175]
v_mbcnt_lo_u32_b32 v240, -1, 0
v_mfma_f32_16x16x32_bf16 v[168:171], a[248:251], a[160:163], v[168:171]
v_mbcnt_hi_u32_b32 v240, -1, v240
v_mfma_f32_16x16x32_bf16 v[168:171], a[208:211], a[164:167], v[168:171]
v_and_b32 v243, 3, v240
v_mfma_f32_16x16x32_bf16 v[164:167], a[248:251], a[152:155], v[164:167]
v_lshlrev_b32 v243, 1, v243
v_mfma_f32_16x16x32_bf16 v[164:167], a[208:211], a[156:159], v[164:167]
v_and_b32 v242, 4, v240
v_mfma_f32_16x16x32_bf16 v[160:163], a[248:251], a[144:147], v[160:163]
buffer_load_dwordx4 a[248:251], v254, s[8:11], s20 offen offset:1024
v_lshl_add_u32 v243, v242, 3, v243
v_mfma_f32_16x16x32_bf16 v[160:163], a[208:211], a[148:151], v[160:163]
s_waitcnt vmcnt(8)
v_lshrrev_b32 v242, 5, v240
v_mfma_f32_16x16x32_bf16 v[192:195], a[212:215], a[144:147], v[192:195]
buffer_load_dwordx4 a[208:211], v254, s[8:11], s20 offen offset:2048
v_lshl_add_u32 v243, v242, 4, v243
v_mfma_f32_16x16x32_bf16 v[192:195], a[216:219], a[148:151], v[192:195]
buffer_load_ushort v244, v243, s[56:59], s21 offen offset:0
v_mfma_f32_16x16x32_bf16 v[196:199], a[212:215], a[152:155], v[196:199]
v_mfma_f32_16x16x32_bf16 v[196:199], a[216:219], a[156:159], v[196:199]
v_mfma_f32_16x16x32_bf16 v[200:203], a[212:215], a[160:163], v[200:203]
v_mfma_f32_16x16x32_bf16 v[200:203], a[216:219], a[164:167], v[200:203]
buffer_load_ushort v240, v243, s[56:59], s21 offen offset:8
v_mfma_f32_16x16x32_bf16 v[204:207], a[212:215], a[168:171], v[204:207]
v_mfma_f32_16x16x32_bf16 v[204:207], a[216:219], a[172:175], v[204:207]
v_mfma_f32_16x16x32_bf16 v[208:211], a[212:215], a[176:179], v[208:211]
v_mfma_f32_16x16x32_bf16 v[208:211], a[216:219], a[180:183], v[208:211]
buffer_load_ushort v245, v243, s[56:59], s21 offen offset:64
v_mfma_f32_16x16x32_bf16 v[212:215], a[212:215], a[184:187], v[212:215]
v_mfma_f32_16x16x32_bf16 v[212:215], a[216:219], a[188:191], v[212:215]
v_mfma_f32_16x16x32_bf16 v[216:219], a[212:215], a[192:195], v[216:219]
v_mfma_f32_16x16x32_bf16 v[216:219], a[216:219], a[196:199], v[216:219]
buffer_load_ushort v241, v243, s[56:59], s21 offen offset:72
v_mfma_f32_16x16x32_bf16 v[220:223], a[212:215], a[200:203], v[220:223]
buffer_load_dwordx4 a[212:215], v254, s[8:11], s20 offen offset:3072
v_mfma_f32_16x16x32_bf16 v[220:223], a[216:219], a[204:207], v[220:223]
s_waitcnt vmcnt(12)
s_add_u32 s20, s20, 4096
v_mfma_f32_16x16x32_bf16 a[12:15], a[220:223], a[200:203], a[12:15]
ds_read_b128 a[200:203], v252 offset:30720
v_mfma_f32_16x16x32_bf16 a[12:15], a[224:227], a[204:207], a[12:15]
ds_read_b128 a[204:207], v252 offset:31232
buffer_load_ushort v246, v243, s[56:59], s21 offen offset:128
v_mfma_f32_16x16x32_bf16 a[8:11], a[220:223], a[192:195], a[8:11]
ds_read_b128 a[192:195], v252 offset:28672
v_mfma_f32_16x16x32_bf16 a[8:11], a[224:227], a[196:199], a[8:11]
ds_read_b128 a[196:199], v252 offset:29184
v_mfma_f32_16x16x32_bf16 a[4:7], a[220:223], a[184:187], a[4:7]
ds_read_b128 a[184:187], v252 offset:26624
v_mfma_f32_16x16x32_bf16 a[4:7], a[224:227], a[188:191], a[4:7]
ds_read_b128 a[188:191], v252 offset:27136
buffer_load_ushort v242, v243, s[56:59], s21 offen offset:136
v_mfma_f32_16x16x32_bf16 a[0:3], a[220:223], a[176:179], a[0:3]
ds_read_b128 a[176:179], v252 offset:24576
v_mfma_f32_16x16x32_bf16 a[0:3], a[224:227], a[180:183], a[0:3]
ds_read_b128 a[180:183], v252 offset:25088
v_mfma_f32_16x16x32_bf16 v[236:239], a[220:223], a[168:171], v[236:239]
ds_read_b128 a[168:171], v252 offset:22528
v_mfma_f32_16x16x32_bf16 v[236:239], a[224:227], a[172:175], v[236:239]
ds_read_b128 a[172:175], v252 offset:23040
v_mfma_f32_16x16x32_bf16 v[232:235], a[220:223], a[160:163], v[232:235]
ds_read_b128 a[160:163], v252 offset:20480
v_mfma_f32_16x16x32_bf16 v[232:235], a[224:227], a[164:167], v[232:235]
ds_read_b128 a[164:167], v252 offset:20992
v_mfma_f32_16x16x32_bf16 v[228:231], a[220:223], a[152:155], v[228:231]
ds_read_b128 a[152:155], v252 offset:18432
v_mfma_f32_16x16x32_bf16 v[228:231], a[224:227], a[156:159], v[228:231]
ds_read_b128 a[156:159], v252 offset:18944
v_mfma_f32_16x16x32_bf16 v[224:227], a[220:223], a[144:147], v[224:227]
ds_read_b128 a[144:147], v252 offset:16384
v_mfma_f32_16x16x32_bf16 v[224:227], a[224:227], a[148:151], v[224:227]
s_waitcnt vmcnt(12) lgkmcnt(11)
ds_read_b128 a[148:151], v252 offset:16896
v_mfma_f32_16x16x32_bf16 v[28:31], a[228:231], a[200:203], v[28:31]
buffer_load_dwordx4 a[220:223], v254, s[8:11], s20 offen offset:0
v_mfma_f32_16x16x32_bf16 v[28:31], a[232:235], a[204:207], v[28:31]
buffer_load_ushort v247, v243, s[56:59], s21 offen offset:192
v_mfma_f32_16x16x32_bf16 v[24:27], a[228:231], a[192:195], v[24:27]
buffer_load_dwordx4 a[224:227], v254, s[8:11], s20 offen offset:1024
v_mfma_f32_16x16x32_bf16 v[24:27], a[232:235], a[196:199], v[24:27]
s_waitcnt lgkmcnt(8)
v_mfma_f32_16x16x32_bf16 v[20:23], a[228:231], a[184:187], v[20:23]
v_mfma_f32_16x16x32_bf16 v[20:23], a[232:235], a[188:191], v[20:23]
buffer_load_ushort v243, v243, s[56:59], s21 offen offset:200
v_mfma_f32_16x16x32_bf16 v[16:19], a[228:231], a[176:179], v[16:19]
v_mfma_f32_16x16x32_bf16 v[16:19], a[232:235], a[180:183], v[16:19]
s_waitcnt lgkmcnt(4)
v_mfma_f32_16x16x32_bf16 v[12:15], a[228:231], a[168:171], v[12:15]
v_mfma_f32_16x16x32_bf16 v[12:15], a[232:235], a[172:175], v[12:15]
s_add_u32 s21, s21, 2048
v_mfma_f32_16x16x32_bf16 v[8:11], a[228:231], a[160:163], v[8:11]
ds_read_b128 v[248:251], v255 offset:0
v_mfma_f32_16x16x32_bf16 v[8:11], a[232:235], a[164:167], v[8:11]
s_waitcnt lgkmcnt(1)
v_mfma_f32_16x16x32_bf16 v[4:7], a[228:231], a[152:155], v[4:7]
v_mfma_f32_16x16x32_bf16 v[4:7], a[232:235], a[156:159], v[4:7]
v_mfma_f32_16x16x32_bf16 v[0:3], a[228:231], a[144:147], v[0:3]
buffer_load_dwordx4 a[228:231], v254, s[8:11], s20 offen offset:2048
v_mfma_f32_16x16x32_bf16 v[0:3], a[232:235], a[148:151], v[0:3]
s_waitcnt vmcnt(15)
v_mfma_f32_16x16x32_bf16 v[32:35], a[236:239], a[144:147], v[32:35]
buffer_load_dwordx4 a[232:235], v254, s[8:11], s20 offen offset:3072
v_mfma_f32_16x16x32_bf16 v[32:35], a[240:243], a[148:151], v[32:35]
s_add_u32 s20, s20, 4096
v_mfma_f32_16x16x32_bf16 v[36:39], a[236:239], a[152:155], v[36:39]
v_mfma_f32_16x16x32_bf16 v[36:39], a[240:243], a[156:159], v[36:39]
v_mfma_f32_16x16x32_bf16 v[40:43], a[236:239], a[160:163], v[40:43]
v_mfma_f32_16x16x32_bf16 v[40:43], a[240:243], a[164:167], v[40:43]
s_waitcnt lgkmcnt(0)
buffer_store_dwordx4 v[248:251], v255, s[16:19], s30 offen offset:0 sc1
v_mfma_f32_16x16x32_bf16 v[44:47], a[236:239], a[168:171], v[44:47]
v_mfma_f32_16x16x32_bf16 v[44:47], a[240:243], a[172:175], v[44:47]
v_mfma_f32_16x16x32_bf16 v[48:51], a[236:239], a[176:179], v[48:51]
v_mfma_f32_16x16x32_bf16 v[48:51], a[240:243], a[180:183], v[48:51]
s_barrier
v_mfma_f32_16x16x32_bf16 v[52:55], a[236:239], a[184:187], v[52:55]
ds_read_b128 v[248:251], v255 offset:2048
v_mfma_f32_16x16x32_bf16 v[52:55], a[240:243], a[188:191], v[52:55]
v_mfma_f32_16x16x32_bf16 v[56:59], a[236:239], a[192:195], v[56:59]
v_mfma_f32_16x16x32_bf16 v[56:59], a[240:243], a[196:199], v[56:59]
v_mfma_f32_16x16x32_bf16 v[60:63], a[236:239], a[200:203], v[60:63]
buffer_load_dwordx4 a[236:239], v254, s[8:11], s20 offen offset:0
v_mfma_f32_16x16x32_bf16 v[60:63], a[240:243], a[204:207], v[60:63]
s_waitcnt vmcnt(16)
v_mfma_f32_16x16x32_bf16 v[92:95], a[244:247], a[200:203], v[92:95]
buffer_load_dwordx4 a[240:243], v254, s[8:11], s20 offen offset:1024
v_mfma_f32_16x16x32_bf16 v[92:95], a[248:251], a[204:207], v[92:95]
v_mfma_f32_16x16x32_bf16 v[88:91], a[244:247], a[192:195], v[88:91]
v_mfma_f32_16x16x32_bf16 v[88:91], a[248:251], a[196:199], v[88:91]
v_mfma_f32_16x16x32_bf16 v[84:87], a[244:247], a[184:187], v[84:87]
v_mfma_f32_16x16x32_bf16 v[84:87], a[248:251], a[188:191], v[84:87]
s_waitcnt lgkmcnt(0)
buffer_store_dwordx4 v[248:251], v255, s[16:19], s30 offen offset:2048 sc1
v_mfma_f32_16x16x32_bf16 v[80:83], a[244:247], a[176:179], v[80:83]
s_add_u32 s30, s30, 4096
v_mfma_f32_16x16x32_bf16 v[80:83], a[248:251], a[180:183], v[80:83]
v_mfma_f32_16x16x32_bf16 v[76:79], a[244:247], a[168:171], v[76:79]
v_mfma_f32_16x16x32_bf16 v[76:79], a[248:251], a[172:175], v[76:79]
v_mfma_f32_16x16x32_bf16 v[72:75], a[244:247], a[160:163], v[72:75]
ds_read_b128 v[248:251], v255 offset:4096
v_mfma_f32_16x16x32_bf16 v[72:75], a[248:251], a[164:167], v[72:75]
v_mfma_f32_16x16x32_bf16 v[68:71], a[244:247], a[152:155], v[68:71]
v_mfma_f32_16x16x32_bf16 v[68:71], a[248:251], a[156:159], v[68:71]
v_mfma_f32_16x16x32_bf16 v[64:67], a[244:247], a[144:147], v[64:67]
buffer_load_dwordx4 a[244:247], v254, s[8:11], s20 offen offset:2048
v_mfma_f32_16x16x32_bf16 v[64:67], a[248:251], a[148:151], v[64:67]
s_waitcnt vmcnt(13)
v_mfma_f32_16x16x32_bf16 v[96:99], a[208:211], a[144:147], v[96:99]
buffer_load_dwordx4 a[248:251], v254, s[8:11], s20 offen offset:3072
v_mfma_f32_16x16x32_bf16 v[96:99], a[212:215], a[148:151], v[96:99]
s_add_u32 s20, s20, 4096
v_mfma_f32_16x16x32_bf16 v[100:103], a[208:211], a[152:155], v[100:103]
v_mfma_f32_16x16x32_bf16 v[100:103], a[212:215], a[156:159], v[100:103]
v_mfma_f32_16x16x32_bf16 v[104:107], a[208:211], a[160:163], v[104:107]
v_mfma_f32_16x16x32_bf16 v[104:107], a[212:215], a[164:167], v[104:107]
s_waitcnt lgkmcnt(0)
buffer_store_dwordx4 v[248:251], v255, s[16:19], s30 offen offset:0 sc1
v_mfma_f32_16x16x32_bf16 v[108:111], a[208:211], a[168:171], v[108:111]
v_mfma_f32_16x16x32_bf16 v[108:111], a[212:215], a[172:175], v[108:111]
v_mfma_f32_16x16x32_bf16 v[112:115], a[208:211], a[176:179], v[112:115]
v_mfma_f32_16x16x32_bf16 v[112:115], a[212:215], a[180:183], v[112:115]
v_mfma_f32_16x16x32_bf16 v[116:119], a[208:211], a[184:187], v[116:119]
v_mfma_f32_16x16x32_bf16 v[116:119], a[212:215], a[188:191], v[116:119]
v_mfma_f32_16x16x32_bf16 v[120:123], a[208:211], a[192:195], v[120:123]
v_mfma_f32_16x16x32_bf16 v[120:123], a[212:215], a[196:199], v[120:123]
v_mfma_f32_16x16x32_bf16 v[124:127], a[208:211], a[200:203], v[124:127]
buffer_load_dwordx4 a[208:211], v254, s[8:11], s20 offen offset:0
v_mfma_f32_16x16x32_bf16 v[124:127], a[212:215], a[204:207], v[124:127]
s_waitcnt vmcnt(11)
v_mfma_f32_16x16x32_bf16 v[156:159], a[220:223], a[200:203], v[156:159]
buffer_load_dwordx4 a[212:215], v254, s[8:11], s20 offen offset:1024
v_mfma_f32_16x16x32_bf16 v[156:159], a[224:227], a[204:207], v[156:159]
v_mfma_f32_16x16x32_bf16 v[152:155], a[220:223], a[192:195], v[152:155]
buffer_load_dwordx4 a[216:219], v254, s[8:11], s20 offen offset:2048
v_mfma_f32_16x16x32_bf16 v[152:155], a[224:227], a[196:199], v[152:155]
v_mfma_f32_16x16x32_bf16 v[148:151], a[220:223], a[184:187], v[148:151]
v_mfma_f32_16x16x32_bf16 v[148:151], a[224:227], a[188:191], v[148:151]
v_mfma_f32_16x16x32_bf16 v[144:147], a[220:223], a[176:179], v[144:147]
v_mfma_f32_16x16x32_bf16 v[144:147], a[224:227], a[180:183], v[144:147]
v_mfma_f32_16x16x32_bf16 v[140:143], a[220:223], a[168:171], v[140:143]
v_mfma_f32_16x16x32_bf16 v[140:143], a[224:227], a[172:175], v[140:143]
v_mfma_f32_16x16x32_bf16 v[136:139], a[220:223], a[160:163], v[136:139]
ds_read_b128 v[248:251], v255 offset:6144
v_mfma_f32_16x16x32_bf16 v[136:139], a[224:227], a[164:167], v[136:139]
v_mfma_f32_16x16x32_bf16 v[132:135], a[220:223], a[152:155], v[132:135]
v_mfma_f32_16x16x32_bf16 v[132:135], a[224:227], a[156:159], v[132:135]
v_mfma_f32_16x16x32_bf16 v[128:131], a[220:223], a[144:147], v[128:131]
buffer_load_dwordx4 a[220:223], v254, s[8:11], s20 offen offset:3072
v_mfma_f32_16x16x32_bf16 v[128:131], a[224:227], a[148:151], v[128:131]
s_waitcnt vmcnt(11)
s_add_u32 s20, s20, 4096
v_mfma_f32_16x16x32_bf16 v[160:163], a[228:231], a[144:147], v[160:163]
buffer_load_dwordx4 a[224:227], v254, s[8:11], s20 offen offset:0
v_lshl_or_b32 v244, v240, 16, v244
v_mfma_f32_16x16x32_bf16 v[160:163], a[232:235], a[148:151], v[160:163]
v_lshl_or_b32 v245, v241, 16, v245
v_mfma_f32_16x16x32_bf16 v[164:167], a[228:231], a[152:155], v[164:167]
v_lshl_or_b32 v246, v242, 16, v246
v_mfma_f32_16x16x32_bf16 v[164:167], a[232:235], a[156:159], v[164:167]
v_lshl_or_b32 v247, v243, 16, v247
v_mfma_f32_16x16x32_bf16 v[168:171], a[228:231], a[160:163], v[168:171]
v_mov_b32 v241, 0
v_mfma_f32_16x16x32_bf16 v[168:171], a[232:235], a[164:167], v[168:171]
s_waitcnt lgkmcnt(0)
buffer_store_dwordx4 v[248:251], v255, s[16:19], s30 offen offset:2048 sc1
v_mov_b32 v242, 0
v_mfma_f32_16x16x32_bf16 v[172:175], a[228:231], a[168:171], v[172:175]
s_add_u32 s30, s30, 4096
v_mov_b32 v243, 0
v_mfma_f32_16x16x32_bf16 v[172:175], a[232:235], a[172:175], v[172:175]
v_add_u32 v252, s26, v253
v_mfma_f32_16x16x32_bf16 v[176:179], a[228:231], a[176:179], v[176:179]
v_mfma_f32_16x16x32_bf16 v[176:179], a[232:235], a[180:183], v[176:179]
v_mfma_f32_16x16x32_bf16 v[180:183], a[228:231], a[184:187], v[180:183]
ds_read_b128 v[248:251], v255 offset:8192
v_mfma_f32_16x16x32_bf16 v[180:183], a[232:235], a[188:191], v[180:183]
v_mfma_f32_16x16x32_bf16 v[184:187], a[228:231], a[192:195], v[184:187]
v_mfma_f32_16x16x32_bf16 v[184:187], a[232:235], a[196:199], v[184:187]
v_mfma_f32_16x16x32_bf16 v[188:191], a[228:231], a[200:203], v[188:191]
buffer_load_dwordx4 a[228:231], v254, s[8:11], s20 offen offset:1024
v_mfma_f32_16x16x32_bf16 v[188:191], a[232:235], a[204:207], v[188:191]
s_waitcnt vmcnt(11)
v_mfma_f32_16x16x32_bf16 v[220:223], a[236:239], a[200:203], v[220:223]
buffer_load_dwordx4 a[232:235], v254, s[8:11], s20 offen offset:2048
v_mfma_f32_16x16x32_bf16 v[220:223], a[240:243], a[204:207], v[220:223]
v_mfma_f32_16x16x32_bf16 v[216:219], a[236:239], a[192:195], v[216:219]
v_mfma_f32_16x16x32_bf16 v[216:219], a[240:243], a[196:199], v[216:219]
v_mfma_f32_16x16x32_bf16 v[212:215], a[236:239], a[184:187], v[212:215]
v_mfma_f32_16x16x32_bf16 v[212:215], a[240:243], a[188:191], v[212:215]
s_waitcnt lgkmcnt(0)
buffer_store_dwordx4 v[248:251], v255, s[16:19], s30 offen offset:0 sc1
v_mfma_f32_16x16x32_bf16 v[208:211], a[236:239], a[176:179], v[208:211]
v_mfma_f32_16x16x32_bf16 v[208:211], a[240:243], a[180:183], v[208:211]
v_mfma_f32_16x16x32_bf16 v[204:207], a[236:239], a[168:171], v[204:207]
v_mfma_f32_16x16x32_bf16 v[204:207], a[240:243], a[172:175], v[204:207]
v_mfma_f32_16x16x32_bf16 v[200:203], a[236:239], a[160:163], v[200:203]
v_mfma_f32_16x16x32_bf16 v[200:203], a[240:243], a[164:167], v[200:203]
v_mfma_f32_16x16x32_bf16 v[196:199], a[236:239], a[152:155], v[196:199]
v_mfma_f32_16x16x32_bf16 v[196:199], a[240:243], a[156:159], v[196:199]
v_mfma_f32_16x16x32_bf16 v[192:195], a[236:239], a[144:147], v[192:195]
buffer_load_dwordx4 a[236:239], v254, s[8:11], s20 offen offset:3072
v_mfma_f32_16x16x32_bf16 v[192:195], a[240:243], a[148:151], v[192:195]
s_waitcnt vmcnt(11)
s_add_u32 s20, s20, 4096
buffer_load_dwordx4 a[240:243], v254, s[8:11], s20 offen offset:0
v_mfma_f32_16x16x32_bf16 v[224:227], a[244:247], a[144:147], v[224:227]
ds_read_b128 a[144:147], v252 offset:0
v_mfma_f32_16x16x32_bf16 v[224:227], a[248:251], a[148:151], v[224:227]
ds_read_b128 a[148:151], v252 offset:512
v_mfma_f32_16x16x32_bf16 v[228:231], a[244:247], a[152:155], v[228:231]
ds_read_b128 a[152:155], v252 offset:2048
v_mfma_f32_16x16x32_bf16 v[228:231], a[248:251], a[156:159], v[228:231]
ds_read_b128 a[156:159], v252 offset:2560
v_mfma_f32_16x16x32_bf16 v[232:235], a[244:247], a[160:163], v[232:235]
ds_read_b128 a[160:163], v252 offset:4096
v_mfma_f32_16x16x32_bf16 v[232:235], a[248:251], a[164:167], v[232:235]
ds_read_b128 a[164:167], v252 offset:4608
v_mfma_f32_16x16x32_bf16 v[236:239], a[244:247], a[168:171], v[236:239]
ds_read_b128 a[168:171], v252 offset:6144
v_mfma_f32_16x16x32_bf16 v[236:239], a[248:251], a[172:175], v[236:239]
ds_read_b128 a[172:175], v252 offset:6656
v_mfma_f32_16x16x32_bf16 a[0:3], a[244:247], a[176:179], a[0:3]
ds_read_b128 a[176:179], v252 offset:8192
v_mfma_f32_16x16x32_bf16 a[0:3], a[248:251], a[180:183], a[0:3]
ds_read_b128 a[180:183], v252 offset:8704
v_mfma_f32_16x16x32_bf16 a[4:7], a[244:247], a[184:187], a[4:7]
ds_read_b128 a[184:187], v252 offset:10240
v_mfma_f32_16x16x32_bf16 a[4:7], a[248:251], a[188:191], a[4:7]
ds_read_b128 a[188:191], v252 offset:10752
v_mfma_f32_16x16x32_bf16 a[8:11], a[244:247], a[192:195], a[8:11]
ds_read_b128 a[192:195], v252 offset:12288
v_mfma_f32_16x16x32_bf16 a[8:11], a[248:251], a[196:199], a[8:11]
ds_read_b128 a[196:199], v252 offset:12800
v_mfma_f32_16x16x32_bf16 a[12:15], a[244:247], a[200:203], a[12:15]
ds_read_b128 a[200:203], v252 offset:14336
v_mfma_f32_16x16x32_bf16 a[12:15], a[248:251], a[204:207], a[12:15]
s_waitcnt vmcnt(9) lgkmcnt(11)
ds_read_b128 a[204:207], v252 offset:14848
v_mfma_f32_16x16x32_bf16 v[0:3], a[208:211], a[144:147], v[0:3]
buffer_load_dwordx4 a[244:247], v254, s[8:11], s20 offen offset:1024
v_mfma_f32_16x16x32_bf16 v[0:3], a[212:215], a[148:151], v[0:3]
v_mfma_f32_16x16x32_bf16 v[4:7], a[208:211], a[152:155], v[4:7]
buffer_load_dwordx4 a[248:251], v254, s[8:11], s20 offen offset:2048
v_mfma_f32_16x16x32_bf16 v[4:7], a[212:215], a[156:159], v[4:7]
s_waitcnt lgkmcnt(8)
v_mfma_f32_16x16x32_bf16 v[8:11], a[208:211], a[160:163], v[8:11]
v_mfma_f32_16x16x32_bf16 v[8:11], a[212:215], a[164:167], v[8:11]
v_mfma_f32_16x16x32_bf16 v[12:15], a[208:211], a[168:171], v[12:15]
v_mfma_f32_16x16x32_bf16 v[12:15], a[212:215], a[172:175], v[12:15]
s_waitcnt lgkmcnt(4)
v_mfma_f32_16x16x32_bf16 v[16:19], a[208:211], a[176:179], v[16:19]
v_mfma_f32_16x16x32_bf16 v[16:19], a[212:215], a[180:183], v[16:19]
v_mfma_f32_16x16x32_bf16 v[20:23], a[208:211], a[184:187], v[20:23]
ds_read_b128 v[248:251], v255 offset:10240
v_mfma_f32_16x16x32_bf16 v[20:23], a[212:215], a[188:191], v[20:23]
s_waitcnt lgkmcnt(1)
v_mfma_f32_16x16x32_bf16 v[24:27], a[208:211], a[192:195], v[24:27]
v_mfma_f32_16x16x32_bf16 v[24:27], a[212:215], a[196:199], v[24:27]
v_mfma_f32_16x16x32_bf16 v[28:31], a[208:211], a[200:203], v[28:31]
buffer_load_dwordx4 a[208:211], v254, s[8:11], s20 offen offset:3072
v_mfma_f32_16x16x32_bf16 v[28:31], a[212:215], a[204:207], v[28:31]
s_waitcnt vmcnt(10)
s_add_u32 s20, s20, 4096
v_mfma_f32_16x16x32_bf16 v[60:63], a[216:219], a[200:203], v[60:63]
buffer_load_dwordx4 a[212:215], v254, s[8:11], s20 offen offset:0
v_mfma_f32_16x16x32_bf16 v[60:63], a[220:223], a[204:207], v[60:63]
v_mfma_f32_16x16x32_bf16 v[56:59], a[216:219], a[192:195], v[56:59]
v_mfma_f32_16x16x32_bf16 v[56:59], a[220:223], a[196:199], v[56:59]
v_mfma_f32_16x16x32_bf16 v[52:55], a[216:219], a[184:187], v[52:55]
v_mfma_f32_16x16x32_bf16 v[52:55], a[220:223], a[188:191], v[52:55]
s_waitcnt lgkmcnt(0)
buffer_store_dwordx4 v[248:251], v255, s[16:19], s30 offen offset:2048 sc1
v_mfma_f32_16x16x32_bf16 v[48:51], a[216:219], a[176:179], v[48:51]
s_add_u32 s30, s30, 4096
v_mfma_f32_16x16x32_bf16 v[48:51], a[220:223], a[180:183], v[48:51]
v_accvgpr_read_b32 v240, a254
v_mfma_f32_16x16x32_bf16 v[44:47], a[216:219], a[168:171], v[44:47]
v_mfma_f32_16x16x32_bf16 v[44:47], a[220:223], a[172:175], v[44:47]
v_mfma_f32_16x16x32_bf16 v[40:43], a[216:219], a[160:163], v[40:43]
ds_read_b128 v[248:251], v255 offset:12288
v_mfma_f32_16x16x32_bf16 v[40:43], a[220:223], a[164:167], v[40:43]
v_mfma_f32_16x16x32_bf16 v[36:39], a[216:219], a[152:155], v[36:39]
v_mfma_f32_16x16x32_bf16 v[36:39], a[220:223], a[156:159], v[36:39]
v_mfma_f32_16x16x32_bf16 v[32:35], a[216:219], a[144:147], v[32:35]
buffer_load_dwordx4 a[216:219], v254, s[8:11], s20 offen offset:1024
v_mfma_f32_16x16x32_bf16 v[32:35], a[220:223], a[148:151], v[32:35]
s_waitcnt vmcnt(10)
v_mfma_f32_16x16x32_bf16 v[64:67], a[224:227], a[144:147], v[64:67]
buffer_load_dwordx4 a[220:223], v254, s[8:11], s20 offen offset:2048
v_mfma_f32_16x16x32_bf16 v[64:67], a[228:231], a[148:151], v[64:67]
v_mfma_f32_16x16x32_bf16 v[68:71], a[224:227], a[152:155], v[68:71]
v_mfma_f32_16x16x32_bf16 v[68:71], a[228:231], a[156:159], v[68:71]
v_mfma_f32_16x16x32_bf16 v[72:75], a[224:227], a[160:163], v[72:75]
v_mfma_f32_16x16x32_bf16 v[72:75], a[228:231], a[164:167], v[72:75]
s_waitcnt lgkmcnt(0)
v_mfma_f32_32x32x16_bf16 v[0:15], v[244:247], v[240:243], v[0:15]
buffer_store_dwordx4 v[248:251], v255, s[16:19], s30 offen offset:0 sc1
v_mfma_f32_16x16x32_bf16 v[76:79], a[224:227], a[168:171], v[76:79]
v_mfma_f32_16x16x32_bf16 v[76:79], a[228:231], a[172:175], v[76:79]
v_mfma_f32_16x16x32_bf16 v[80:83], a[224:227], a[176:179], v[80:83]
v_mfma_f32_16x16x32_bf16 v[80:83], a[228:231], a[180:183], v[80:83]
v_mfma_f32_16x16x32_bf16 v[84:87], a[224:227], a[184:187], v[84:87]
ds_read_b128 v[248:251], v255 offset:14336
v_mfma_f32_16x16x32_bf16 v[84:87], a[228:231], a[188:191], v[84:87]
v_mfma_f32_16x16x32_bf16 v[88:91], a[224:227], a[192:195], v[88:91]
v_mfma_f32_16x16x32_bf16 v[88:91], a[228:231], a[196:199], v[88:91]
v_mfma_f32_16x16x32_bf16 v[92:95], a[224:227], a[200:203], v[92:95]
buffer_load_dwordx4 a[224:227], v254, s[8:11], s20 offen offset:3072
v_mfma_f32_16x16x32_bf16 v[92:95], a[228:231], a[204:207], v[92:95]
s_waitcnt vmcnt(10)
s_add_u32 s20, s20, 4096
v_mfma_f32_16x16x32_bf16 v[124:127], a[232:235], a[200:203], v[124:127]
buffer_load_dwordx4 a[228:231], v254, s[8:11], s20 offen offset:0
v_mfma_f32_16x16x32_bf16 v[124:127], a[236:239], a[204:207], v[124:127]
v_mfma_f32_16x16x32_bf16 v[120:123], a[232:235], a[192:195], v[120:123]
v_mfma_f32_16x16x32_bf16 v[120:123], a[236:239], a[196:199], v[120:123]
v_mfma_f32_16x16x32_bf16 v[116:119], a[232:235], a[184:187], v[116:119]
v_mfma_f32_16x16x32_bf16 v[116:119], a[236:239], a[188:191], v[116:119]
s_waitcnt lgkmcnt(0)
v_mfma_f32_32x32x16_bf16 v[16:31], v[244:247], v[240:243], v[16:31]
buffer_store_dwordx4 v[248:251], v255, s[16:19], s30 offen offset:2048 sc1
v_mfma_f32_16x16x32_bf16 v[112:115], a[232:235], a[176:179], v[112:115]
s_add_u32 s30, s30, 20480
v_mfma_f32_16x16x32_bf16 v[112:115], a[236:239], a[180:183], v[112:115]
v_mfma_f32_16x16x32_bf16 v[108:111], a[232:235], a[168:171], v[108:111]
v_mfma_f32_16x16x32_bf16 v[108:111], a[236:239], a[172:175], v[108:111]
v_mfma_f32_16x16x32_bf16 v[104:107], a[232:235], a[160:163], v[104:107]
v_mfma_f32_16x16x32_bf16 v[104:107], a[236:239], a[164:167], v[104:107]
v_mfma_f32_16x16x32_bf16 v[100:103], a[232:235], a[152:155], v[100:103]
v_mfma_f32_16x16x32_bf16 v[100:103], a[236:239], a[156:159], v[100:103]
v_mfma_f32_16x16x32_bf16 v[96:99], a[232:235], a[144:147], v[96:99]
buffer_load_dwordx4 a[232:235], v254, s[8:11], s20 offen offset:1024
v_mfma_f32_16x16x32_bf16 v[96:99], a[236:239], a[148:151], v[96:99]
s_waitcnt vmcnt(11)
v_mfma_f32_16x16x32_bf16 v[128:131], a[240:243], a[144:147], v[128:131]
buffer_load_dwordx4 a[236:239], v254, s[8:11], s20 offen offset:2048
v_mfma_f32_16x16x32_bf16 v[128:131], a[244:247], a[148:151], v[128:131]
v_mfma_f32_16x16x32_bf16 v[132:135], a[240:243], a[152:155], v[132:135]
v_mfma_f32_16x16x32_bf16 v[132:135], a[244:247], a[156:159], v[132:135]
v_mfma_f32_16x16x32_bf16 v[136:139], a[240:243], a[160:163], v[136:139]
v_mfma_f32_16x16x32_bf16 v[136:139], a[244:247], a[164:167], v[136:139]
v_mfma_f32_16x16x32_bf16 v[140:143], a[240:243], a[168:171], v[140:143]
v_mfma_f32_16x16x32_bf16 v[140:143], a[244:247], a[172:175], v[140:143]
v_lshlrev_b32 v240, 16, v240
v_mfma_f32_16x16x32_bf16 v[144:147], a[240:243], a[176:179], v[144:147]
v_mfma_f32_16x16x32_bf16 v[144:147], a[244:247], a[180:183], v[144:147]
v_mfma_f32_16x16x32_bf16 v[148:151], a[240:243], a[184:187], v[148:151]
ds_read_b128 v[248:251], v255 offset:512
v_mfma_f32_16x16x32_bf16 v[148:151], a[244:247], a[188:191], v[148:151]
v_mfma_f32_16x16x32_bf16 v[152:155], a[240:243], a[192:195], v[152:155]
v_mfma_f32_16x16x32_bf16 v[152:155], a[244:247], a[196:199], v[152:155]
v_mfma_f32_16x16x32_bf16 v[156:159], a[240:243], a[200:203], v[156:159]
buffer_load_dwordx4 a[240:243], v254, s[8:11], s20 offen offset:3072
v_mfma_f32_16x16x32_bf16 v[156:159], a[244:247], a[204:207], v[156:159]
s_waitcnt vmcnt(11)
s_add_u32 s20, s20, 4096
v_mfma_f32_16x16x32_bf16 v[188:191], a[248:251], a[200:203], v[188:191]
buffer_load_dwordx4 a[244:247], v254, s[8:11], s20 offen offset:0
v_mfma_f32_16x16x32_bf16 v[188:191], a[208:211], a[204:207], v[188:191]
v_mfma_f32_16x16x32_bf16 v[184:187], a[248:251], a[192:195], v[184:187]
v_mfma_f32_16x16x32_bf16 v[184:187], a[208:211], a[196:199], v[184:187]
v_mfma_f32_16x16x32_bf16 v[180:183], a[248:251], a[184:187], v[180:183]
v_mfma_f32_16x16x32_bf16 v[180:183], a[208:211], a[188:191], v[180:183]
s_waitcnt lgkmcnt(0)
v_mfma_f32_32x32x16_bf16 v[32:47], v[244:247], v[240:243], v[32:47]
buffer_store_dwordx4 v[248:251], v255, s[16:19], s30 offen offset:0 sc1
v_mfma_f32_16x16x32_bf16 v[176:179], a[248:251], a[176:179], v[176:179]
v_mfma_f32_16x16x32_bf16 v[176:179], a[208:211], a[180:183], v[176:179]
v_mfma_f32_16x16x32_bf16 v[172:175], a[248:251], a[168:171], v[172:175]
v_mfma_f32_16x16x32_bf16 v[172:175], a[208:211], a[172:175], v[172:175]
v_mfma_f32_16x16x32_bf16 v[168:171], a[248:251], a[160:163], v[168:171]
ds_read_b128 v[248:251], v255 offset:2560
v_mfma_f32_16x16x32_bf16 v[168:171], a[208:211], a[164:167], v[168:171]
v_mfma_f32_16x16x32_bf16 v[164:167], a[248:251], a[152:155], v[164:167]
v_mfma_f32_16x16x32_bf16 v[164:167], a[208:211], a[156:159], v[164:167]
v_mfma_f32_16x16x32_bf16 v[160:163], a[248:251], a[144:147], v[160:163]
buffer_load_dwordx4 a[248:251], v254, s[8:11], s20 offen offset:1024
v_mfma_f32_16x16x32_bf16 v[160:163], a[208:211], a[148:151], v[160:163]
s_waitcnt vmcnt(11)
v_mfma_f32_16x16x32_bf16 v[192:195], a[212:215], a[144:147], v[192:195]
buffer_load_dwordx4 a[208:211], v254, s[8:11], s20 offen offset:2048
v_mfma_f32_16x16x32_bf16 v[192:195], a[216:219], a[148:151], v[192:195]
v_mfma_f32_16x16x32_bf16 v[196:199], a[212:215], a[152:155], v[196:199]
v_mfma_f32_16x16x32_bf16 v[196:199], a[216:219], a[156:159], v[196:199]
v_mfma_f32_16x16x32_bf16 v[200:203], a[212:215], a[160:163], v[200:203]
v_mfma_f32_16x16x32_bf16 v[200:203], a[216:219], a[164:167], v[200:203]
s_waitcnt lgkmcnt(0)
v_mfma_f32_32x32x16_bf16 v[48:63], v[244:247], v[240:243], v[48:63]
buffer_store_dwordx4 v[248:251], v255, s[16:19], s30 offen offset:2048 sc1
v_mfma_f32_16x16x32_bf16 v[204:207], a[212:215], a[168:171], v[204:207]
s_add_u32 s30, s30, 4096
v_mfma_f32_16x16x32_bf16 v[204:207], a[216:219], a[172:175], v[204:207]
v_mfma_f32_16x16x32_bf16 v[208:211], a[212:215], a[176:179], v[208:211]
v_mfma_f32_16x16x32_bf16 v[208:211], a[216:219], a[180:183], v[208:211]
v_mfma_f32_16x16x32_bf16 v[212:215], a[212:215], a[184:187], v[212:215]
v_mfma_f32_16x16x32_bf16 v[212:215], a[216:219], a[188:191], v[212:215]
v_mfma_f32_16x16x32_bf16 v[216:219], a[212:215], a[192:195], v[216:219]
v_mfma_f32_16x16x32_bf16 v[216:219], a[216:219], a[196:199], v[216:219]
v_mfma_f32_16x16x32_bf16 v[220:223], a[212:215], a[200:203], v[220:223]
buffer_load_dwordx4 a[212:215], v254, s[8:11], s20 offen offset:3072
v_mfma_f32_16x16x32_bf16 v[220:223], a[216:219], a[204:207], v[220:223]
s_waitcnt vmcnt(11)
s_add_u32 s20, s20, 4096
v_mfma_f32_16x16x32_bf16 a[12:15], a[220:223], a[200:203], a[12:15]
ds_read_b128 a[200:203], v252 offset:30720
v_mfma_f32_16x16x32_bf16 a[12:15], a[224:227], a[204:207], a[12:15]
ds_read_b128 a[204:207], v252 offset:31232
v_mfma_f32_16x16x32_bf16 a[8:11], a[220:223], a[192:195], a[8:11]
ds_read_b128 a[192:195], v252 offset:28672
v_mfma_f32_16x16x32_bf16 a[8:11], a[224:227], a[196:199], a[8:11]
ds_read_b128 a[196:199], v252 offset:29184
v_mfma_f32_16x16x32_bf16 a[4:7], a[220:223], a[184:187], a[4:7]
ds_read_b128 a[184:187], v252 offset:26624
v_mfma_f32_16x16x32_bf16 a[4:7], a[224:227], a[188:191], a[4:7]
ds_read_b128 a[188:191], v252 offset:27136
v_mfma_f32_16x16x32_bf16 a[0:3], a[220:223], a[176:179], a[0:3]
ds_read_b128 a[176:179], v252 offset:24576
v_mfma_f32_16x16x32_bf16 a[0:3], a[224:227], a[180:183], a[0:3]
ds_read_b128 a[180:183], v252 offset:25088
v_mfma_f32_16x16x32_bf16 v[236:239], a[220:223], a[168:171], v[236:239]
ds_read_b128 a[168:171], v252 offset:22528
v_mfma_f32_16x16x32_bf16 v[236:239], a[224:227], a[172:175], v[236:239]
ds_read_b128 a[172:175], v252 offset:23040
v_mfma_f32_16x16x32_bf16 v[232:235], a[220:223], a[160:163], v[232:235]
ds_read_b128 a[160:163], v252 offset:20480
v_mfma_f32_16x16x32_bf16 v[232:235], a[224:227], a[164:167], v[232:235]
ds_read_b128 a[164:167], v252 offset:20992
v_mfma_f32_16x16x32_bf16 v[228:231], a[220:223], a[152:155], v[228:231]
ds_read_b128 a[152:155], v252 offset:18432
v_mfma_f32_16x16x32_bf16 v[228:231], a[224:227], a[156:159], v[228:231]
ds_read_b128 a[156:159], v252 offset:18944
v_mfma_f32_16x16x32_bf16 v[224:227], a[220:223], a[144:147], v[224:227]
ds_read_b128 a[144:147], v252 offset:16384
v_mfma_f32_16x16x32_bf16 v[224:227], a[224:227], a[148:151], v[224:227]
s_waitcnt vmcnt(8) lgkmcnt(11)
ds_read_b128 a[148:151], v252 offset:16896
v_mfma_f32_16x16x32_bf16 v[28:31], a[228:231], a[200:203], v[28:31]
buffer_load_dwordx4 a[220:223], v254, s[8:11], s20 offen offset:0
v_mfma_f32_16x16x32_bf16 v[28:31], a[232:235], a[204:207], v[28:31]
v_mfma_f32_16x16x32_bf16 v[24:27], a[228:231], a[192:195], v[24:27]
buffer_load_dwordx4 a[224:227], v254, s[8:11], s20 offen offset:1024
v_mfma_f32_16x16x32_bf16 v[24:27], a[232:235], a[196:199], v[24:27]
s_waitcnt lgkmcnt(8)
v_mfma_f32_16x16x32_bf16 v[20:23], a[228:231], a[184:187], v[20:23]
v_mfma_f32_16x16x32_bf16 v[20:23], a[232:235], a[188:191], v[20:23]
v_mfma_f32_16x16x32_bf16 v[16:19], a[228:231], a[176:179], v[16:19]
s_add_u32 s36, s36, 1
v_mfma_f32_16x16x32_bf16 v[16:19], a[232:235], a[180:183], v[16:19]
s_waitcnt lgkmcnt(4)
v_mov_b32 v248, s36
v_mfma_f32_16x16x32_bf16 v[12:15], a[228:231], a[168:171], v[12:15]
buffer_store_dword v248, off, s[8:11], s23 sc1
v_mfma_f32_16x16x32_bf16 v[12:15], a[232:235], a[172:175], v[12:15]
v_mfma_f32_16x16x32_bf16 v[8:11], a[228:231], a[160:163], v[8:11]
ds_read_b128 v[248:251], v255 offset:4608
v_mfma_f32_16x16x32_bf16 v[8:11], a[232:235], a[164:167], v[8:11]
s_waitcnt lgkmcnt(1)
v_mfma_f32_16x16x32_bf16 v[4:7], a[228:231], a[152:155], v[4:7]
v_mfma_f32_16x16x32_bf16 v[4:7], a[232:235], a[156:159], v[4:7]
v_mfma_f32_16x16x32_bf16 v[0:3], a[228:231], a[144:147], v[0:3]
buffer_load_dwordx4 a[228:231], v254, s[8:11], s20 offen offset:2048
v_mfma_f32_16x16x32_bf16 v[0:3], a[232:235], a[148:151], v[0:3]
s_waitcnt vmcnt(10)
v_mfma_f32_16x16x32_bf16 v[32:35], a[236:239], a[144:147], v[32:35]
buffer_load_dwordx4 a[232:235], v254, s[8:11], s20 offen offset:3072
v_mfma_f32_16x16x32_bf16 v[32:35], a[240:243], a[148:151], v[32:35]
s_add_u32 s20, s20, 4096
v_mfma_f32_16x16x32_bf16 v[36:39], a[236:239], a[152:155], v[36:39]
v_mfma_f32_16x16x32_bf16 v[36:39], a[240:243], a[156:159], v[36:39]
v_mfma_f32_16x16x32_bf16 v[40:43], a[236:239], a[160:163], v[40:43]
v_mfma_f32_16x16x32_bf16 v[40:43], a[240:243], a[164:167], v[40:43]
s_waitcnt lgkmcnt(0)
buffer_store_dwordx4 v[248:251], v255, s[16:19], s30 offen offset:0 sc1
v_mfma_f32_16x16x32_bf16 v[44:47], a[236:239], a[168:171], v[44:47]
v_mfma_f32_16x16x32_bf16 v[44:47], a[240:243], a[172:175], v[44:47]
v_mfma_f32_16x16x32_bf16 v[48:51], a[236:239], a[176:179], v[48:51]
v_mfma_f32_16x16x32_bf16 v[48:51], a[240:243], a[180:183], v[48:51]
v_mfma_f32_16x16x32_bf16 v[52:55], a[236:239], a[184:187], v[52:55]
ds_read_b128 v[248:251], v255 offset:6656
v_mfma_f32_16x16x32_bf16 v[52:55], a[240:243], a[188:191], v[52:55]
v_mfma_f32_16x16x32_bf16 v[56:59], a[236:239], a[192:195], v[56:59]
v_mfma_f32_16x16x32_bf16 v[56:59], a[240:243], a[196:199], v[56:59]
v_mfma_f32_16x16x32_bf16 v[60:63], a[236:239], a[200:203], v[60:63]
buffer_load_dwordx4 a[236:239], v254, s[8:11], s20 offen offset:0
v_mfma_f32_16x16x32_bf16 v[60:63], a[240:243], a[204:207], v[60:63]
s_waitcnt vmcnt(10)
v_mfma_f32_16x16x32_bf16 v[92:95], a[244:247], a[200:203], v[92:95]
buffer_load_dwordx4 a[240:243], v254, s[8:11], s20 offen offset:1024
v_mfma_f32_16x16x32_bf16 v[92:95], a[248:251], a[204:207], v[92:95]
v_mfma_f32_16x16x32_bf16 v[88:91], a[244:247], a[192:195], v[88:91]
v_mfma_f32_16x16x32_bf16 v[88:91], a[248:251], a[196:199], v[88:91]
v_mfma_f32_16x16x32_bf16 v[84:87], a[244:247], a[184:187], v[84:87]
v_mfma_f32_16x16x32_bf16 v[84:87], a[248:251], a[188:191], v[84:87]
s_waitcnt lgkmcnt(0)
buffer_store_dwordx4 v[248:251], v255, s[16:19], s30 offen offset:2048 sc1
v_mfma_f32_16x16x32_bf16 v[80:83], a[244:247], a[176:179], v[80:83]
s_add_u32 s30, s30, 4096
v_mfma_f32_16x16x32_bf16 v[80:83], a[248:251], a[180:183], v[80:83]
v_mfma_f32_16x16x32_bf16 v[76:79], a[244:247], a[168:171], v[76:79]
v_mfma_f32_16x16x32_bf16 v[76:79], a[248:251], a[172:175], v[76:79]
v_mfma_f32_16x16x32_bf16 v[72:75], a[244:247], a[160:163], v[72:75]
ds_read_b128 v[248:251], v255 offset:8704
v_mfma_f32_16x16x32_bf16 v[72:75], a[248:251], a[164:167], v[72:75]
v_mfma_f32_16x16x32_bf16 v[68:71], a[244:247], a[152:155], v[68:71]
v_mfma_f32_16x16x32_bf16 v[68:71], a[248:251], a[156:159], v[68:71]
v_mfma_f32_16x16x32_bf16 v[64:67], a[244:247], a[144:147], v[64:67]
buffer_load_dwordx4 a[244:247], v254, s[8:11], s20 offen offset:2048
v_mfma_f32_16x16x32_bf16 v[64:67], a[248:251], a[148:151], v[64:67]
s_waitcnt vmcnt(10)
v_mfma_f32_16x16x32_bf16 v[96:99], a[208:211], a[144:147], v[96:99]
buffer_load_dwordx4 a[248:251], v254, s[8:11], s20 offen offset:3072
v_mfma_f32_16x16x32_bf16 v[96:99], a[212:215], a[148:151], v[96:99]
s_add_u32 s20, s20, 4096
v_mfma_f32_16x16x32_bf16 v[100:103], a[208:211], a[152:155], v[100:103]
v_mfma_f32_16x16x32_bf16 v[100:103], a[212:215], a[156:159], v[100:103]
v_mfma_f32_16x16x32_bf16 v[104:107], a[208:211], a[160:163], v[104:107]
v_mfma_f32_16x16x32_bf16 v[104:107], a[212:215], a[164:167], v[104:107]
s_waitcnt lgkmcnt(0)
buffer_store_dwordx4 v[248:251], v255, s[16:19], s30 offen offset:0 sc1
v_mfma_f32_16x16x32_bf16 v[108:111], a[208:211], a[168:171], v[108:111]
v_mfma_f32_16x16x32_bf16 v[108:111], a[212:215], a[172:175], v[108:111]
v_mfma_f32_16x16x32_bf16 v[112:115], a[208:211], a[176:179], v[112:115]
v_mfma_f32_16x16x32_bf16 v[112:115], a[212:215], a[180:183], v[112:115]
v_mfma_f32_16x16x32_bf16 v[116:119], a[208:211], a[184:187], v[116:119]
v_mfma_f32_16x16x32_bf16 v[116:119], a[212:215], a[188:191], v[116:119]
v_mfma_f32_16x16x32_bf16 v[120:123], a[208:211], a[192:195], v[120:123]
v_mfma_f32_16x16x32_bf16 v[120:123], a[212:215], a[196:199], v[120:123]
v_mfma_f32_16x16x32_bf16 v[124:127], a[208:211], a[200:203], v[124:127]
buffer_load_dwordx4 a[208:211], v254, s[8:11], s20 offen offset:0
v_mfma_f32_16x16x32_bf16 v[124:127], a[212:215], a[204:207], v[124:127]
s_waitcnt vmcnt(11)
v_mfma_f32_16x16x32_bf16 v[156:159], a[220:223], a[200:203], v[156:159]
buffer_load_dwordx4 a[212:215], v254, s[8:11], s20 offen offset:1024
v_mfma_f32_16x16x32_bf16 v[156:159], a[224:227], a[204:207], v[156:159]
v_mfma_f32_16x16x32_bf16 v[152:155], a[220:223], a[192:195], v[152:155]
buffer_load_dwordx4 a[216:219], v254, s[8:11], s20 offen offset:2048
v_mfma_f32_16x16x32_bf16 v[152:155], a[224:227], a[196:199], v[152:155]
v_mfma_f32_16x16x32_bf16 v[148:151], a[220:223], a[184:187], v[148:151]
v_mfma_f32_16x16x32_bf16 v[148:151], a[224:227], a[188:191], v[148:151]
v_mfma_f32_16x16x32_bf16 v[144:147], a[220:223], a[176:179], v[144:147]
v_mfma_f32_16x16x32_bf16 v[144:147], a[224:227], a[180:183], v[144:147]
v_accvgpr_read_b32 v241, a254
v_mfma_f32_16x16x32_bf16 v[140:143], a[220:223], a[168:171], v[140:143]
v_mov_b32 v240, 0
v_mfma_f32_16x16x32_bf16 v[140:143], a[224:227], a[172:175], v[140:143]
v_mfma_f32_16x16x32_bf16 v[136:139], a[220:223], a[160:163], v[136:139]
ds_read_b128 v[248:251], v255 offset:10752
v_mfma_f32_16x16x32_bf16 v[136:139], a[224:227], a[164:167], v[136:139]
v_mfma_f32_16x16x32_bf16 v[132:135], a[220:223], a[152:155], v[132:135]
v_mfma_f32_16x16x32_bf16 v[132:135], a[224:227], a[156:159], v[132:135]
v_mfma_f32_16x16x32_bf16 v[128:131], a[220:223], a[144:147], v[128:131]
buffer_load_dwordx4 a[220:223], v254, s[8:11], s20 offen offset:3072
v_mfma_f32_16x16x32_bf16 v[128:131], a[224:227], a[148:151], v[128:131]
s_waitcnt vmcnt(11)
s_add_u32 s20, s20, 4096
v_mfma_f32_16x16x32_bf16 v[160:163], a[228:231], a[144:147], v[160:163]
buffer_load_dwordx4 a[224:227], v254, s[8:11], s20 offen offset:0
v_mfma_f32_16x16x32_bf16 v[160:163], a[232:235], a[148:151], v[160:163]
v_mfma_f32_16x16x32_bf16 v[164:167], a[228:231], a[152:155], v[164:167]
v_mfma_f32_16x16x32_bf16 v[164:167], a[232:235], a[156:159], v[164:167]
v_mfma_f32_16x16x32_bf16 v[168:171], a[228:231], a[160:163], v[168:171]
v_mfma_f32_16x16x32_bf16 v[168:171], a[232:235], a[164:167], v[168:171]
s_waitcnt lgkmcnt(0)
v_mfma_f32_32x32x16_bf16 v[64:79], v[244:247], v[240:243], v[64:79]
buffer_store_dwordx4 v[248:251], v255, s[16:19], s30 offen offset:2048 sc1
v_mfma_f32_16x16x32_bf16 v[172:175], a[228:231], a[168:171], v[172:175]
s_add_u32 s30, s30, 4096
v_mfma_f32_16x16x32_bf16 v[172:175], a[232:235], a[172:175], v[172:175]
v_add_u32 v252, s27, v253
v_mfma_f32_16x16x32_bf16 v[176:179], a[228:231], a[176:179], v[176:179]
v_mfma_f32_16x16x32_bf16 v[176:179], a[232:235], a[180:183], v[176:179]
v_mfma_f32_16x16x32_bf16 v[180:183], a[228:231], a[184:187], v[180:183]
ds_read_b128 v[248:251], v255 offset:12800
v_mfma_f32_16x16x32_bf16 v[180:183], a[232:235], a[188:191], v[180:183]
v_mfma_f32_16x16x32_bf16 v[184:187], a[228:231], a[192:195], v[184:187]
v_mfma_f32_16x16x32_bf16 v[184:187], a[232:235], a[196:199], v[184:187]
v_mfma_f32_16x16x32_bf16 v[188:191], a[228:231], a[200:203], v[188:191]
buffer_load_dwordx4 a[228:231], v254, s[8:11], s20 offen offset:1024
v_mfma_f32_16x16x32_bf16 v[188:191], a[232:235], a[204:207], v[188:191]
s_waitcnt vmcnt(11)
v_mfma_f32_16x16x32_bf16 v[220:223], a[236:239], a[200:203], v[220:223]
buffer_load_dwordx4 a[232:235], v254, s[8:11], s20 offen offset:2048
v_mfma_f32_16x16x32_bf16 v[220:223], a[240:243], a[204:207], v[220:223]
v_mfma_f32_16x16x32_bf16 v[216:219], a[236:239], a[192:195], v[216:219]
v_mfma_f32_16x16x32_bf16 v[216:219], a[240:243], a[196:199], v[216:219]
v_mfma_f32_16x16x32_bf16 v[212:215], a[236:239], a[184:187], v[212:215]
v_mfma_f32_16x16x32_bf16 v[212:215], a[240:243], a[188:191], v[212:215]
s_waitcnt lgkmcnt(0)
v_mfma_f32_32x32x16_bf16 v[80:95], v[244:247], v[240:243], v[80:95]
buffer_store_dwordx4 v[248:251], v255, s[16:19], s30 offen offset:0 sc1
v_mfma_f32_16x16x32_bf16 v[208:211], a[236:239], a[176:179], v[208:211]
v_mfma_f32_16x16x32_bf16 v[208:211], a[240:243], a[180:183], v[208:211]
v_mfma_f32_16x16x32_bf16 v[204:207], a[236:239], a[168:171], v[204:207]
v_mfma_f32_16x16x32_bf16 v[204:207], a[240:243], a[172:175], v[204:207]
v_mfma_f32_16x16x32_bf16 v[200:203], a[236:239], a[160:163], v[200:203]
v_mfma_f32_16x16x32_bf16 v[200:203], a[240:243], a[164:167], v[200:203]
v_mfma_f32_16x16x32_bf16 v[196:199], a[236:239], a[152:155], v[196:199]
v_mfma_f32_16x16x32_bf16 v[196:199], a[240:243], a[156:159], v[196:199]
v_mfma_f32_16x16x32_bf16 v[192:195], a[236:239], a[144:147], v[192:195]
buffer_load_dwordx4 a[236:239], v254, s[8:11], s20 offen offset:3072
v_mfma_f32_16x16x32_bf16 v[192:195], a[240:243], a[148:151], v[192:195]
s_waitcnt vmcnt(11)
s_add_u32 s20, s20, 4096
buffer_load_dwordx4 a[240:243], v254, s[8:11], s20 offen offset:0
v_mfma_f32_16x16x32_bf16 v[224:227], a[244:247], a[144:147], v[224:227]
ds_read_b128 a[144:147], v252 offset:0
v_mfma_f32_16x16x32_bf16 v[224:227], a[248:251], a[148:151], v[224:227]
ds_read_b128 a[148:151], v252 offset:512
v_mfma_f32_16x16x32_bf16 v[228:231], a[244:247], a[152:155], v[228:231]
ds_read_b128 a[152:155], v252 offset:2048
v_mfma_f32_16x16x32_bf16 v[228:231], a[248:251], a[156:159], v[228:231]
ds_read_b128 a[156:159], v252 offset:2560
v_mfma_f32_16x16x32_bf16 v[232:235], a[244:247], a[160:163], v[232:235]
ds_read_b128 a[160:163], v252 offset:4096
v_mfma_f32_16x16x32_bf16 v[232:235], a[248:251], a[164:167], v[232:235]
ds_read_b128 a[164:167], v252 offset:4608
v_mfma_f32_16x16x32_bf16 v[236:239], a[244:247], a[168:171], v[236:239]
ds_read_b128 a[168:171], v252 offset:6144
v_mfma_f32_16x16x32_bf16 v[236:239], a[248:251], a[172:175], v[236:239]
ds_read_b128 a[172:175], v252 offset:6656
v_mfma_f32_16x16x32_bf16 a[0:3], a[244:247], a[176:179], a[0:3]
ds_read_b128 a[176:179], v252 offset:8192
v_mfma_f32_16x16x32_bf16 a[0:3], a[248:251], a[180:183], a[0:3]
ds_read_b128 a[180:183], v252 offset:8704
v_mfma_f32_16x16x32_bf16 a[4:7], a[244:247], a[184:187], a[4:7]
ds_read_b128 a[184:187], v252 offset:10240
v_mfma_f32_16x16x32_bf16 a[4:7], a[248:251], a[188:191], a[4:7]
ds_read_b128 a[188:191], v252 offset:10752
v_mfma_f32_16x16x32_bf16 a[8:11], a[244:247], a[192:195], a[8:11]
ds_read_b128 a[192:195], v252 offset:12288
v_mfma_f32_16x16x32_bf16 a[8:11], a[248:251], a[196:199], a[8:11]
ds_read_b128 a[196:199], v252 offset:12800
v_mfma_f32_16x16x32_bf16 a[12:15], a[244:247], a[200:203], a[12:15]
ds_read_b128 a[200:203], v252 offset:14336
v_mfma_f32_16x16x32_bf16 a[12:15], a[248:251], a[204:207], a[12:15]
s_waitcnt vmcnt(9) lgkmcnt(11)
ds_read_b128 a[204:207], v252 offset:14848
v_mfma_f32_16x16x32_bf16 v[0:3], a[208:211], a[144:147], v[0:3]
buffer_load_dwordx4 a[244:247], v254, s[8:11], s20 offen offset:1024
v_mfma_f32_16x16x32_bf16 v[0:3], a[212:215], a[148:151], v[0:3]
v_mfma_f32_16x16x32_bf16 v[4:7], a[208:211], a[152:155], v[4:7]
buffer_load_dwordx4 a[248:251], v254, s[8:11], s20 offen offset:2048
v_mfma_f32_16x16x32_bf16 v[4:7], a[212:215], a[156:159], v[4:7]
s_waitcnt lgkmcnt(8)
v_mfma_f32_16x16x32_bf16 v[8:11], a[208:211], a[160:163], v[8:11]
v_mfma_f32_16x16x32_bf16 v[8:11], a[212:215], a[164:167], v[8:11]
v_mfma_f32_16x16x32_bf16 v[12:15], a[208:211], a[168:171], v[12:15]
v_mfma_f32_16x16x32_bf16 v[12:15], a[212:215], a[172:175], v[12:15]
s_waitcnt lgkmcnt(4)
v_lshlrev_b32 v241, 16, v241
v_mfma_f32_16x16x32_bf16 v[16:19], a[208:211], a[176:179], v[16:19]
v_mfma_f32_16x16x32_bf16 v[16:19], a[212:215], a[180:183], v[16:19]
v_mfma_f32_16x16x32_bf16 v[20:23], a[208:211], a[184:187], v[20:23]
ds_read_b128 v[248:251], v255 offset:14848
v_mfma_f32_16x16x32_bf16 v[20:23], a[212:215], a[188:191], v[20:23]
s_waitcnt lgkmcnt(1)
v_mfma_f32_16x16x32_bf16 v[24:27], a[208:211], a[192:195], v[24:27]
v_mfma_f32_16x16x32_bf16 v[24:27], a[212:215], a[196:199], v[24:27]
v_mfma_f32_16x16x32_bf16 v[28:31], a[208:211], a[200:203], v[28:31]
buffer_load_dwordx4 a[208:211], v254, s[8:11], s20 offen offset:3072
v_mfma_f32_16x16x32_bf16 v[28:31], a[212:215], a[204:207], v[28:31]
s_waitcnt vmcnt(10)
s_add_u32 s20, s20, 4096
v_mfma_f32_16x16x32_bf16 v[60:63], a[216:219], a[200:203], v[60:63]
buffer_load_dwordx4 a[212:215], v254, s[8:11], s20 offen offset:0
v_mfma_f32_16x16x32_bf16 v[60:63], a[220:223], a[204:207], v[60:63]
v_mfma_f32_16x16x32_bf16 v[56:59], a[216:219], a[192:195], v[56:59]
v_mfma_f32_16x16x32_bf16 v[56:59], a[220:223], a[196:199], v[56:59]
v_mfma_f32_16x16x32_bf16 v[52:55], a[216:219], a[184:187], v[52:55]
v_mfma_f32_16x16x32_bf16 v[52:55], a[220:223], a[188:191], v[52:55]
s_waitcnt lgkmcnt(0)
v_mfma_f32_32x32x16_bf16 v[96:111], v[244:247], v[240:243], v[96:111]
buffer_store_dwordx4 v[248:251], v255, s[16:19], s30 offen offset:2048 sc1
v_mfma_f32_16x16x32_bf16 v[48:51], a[216:219], a[176:179], v[48:51]
s_add_u32 s30, s30, 20480
v_mfma_f32_16x16x32_bf16 v[48:51], a[220:223], a[180:183], v[48:51]
v_mfma_f32_16x16x32_bf16 v[44:47], a[216:219], a[168:171], v[44:47]
v_mfma_f32_16x16x32_bf16 v[44:47], a[220:223], a[172:175], v[44:47]
v_mfma_f32_16x16x32_bf16 v[40:43], a[216:219], a[160:163], v[40:43]
v_mfma_f32_16x16x32_bf16 v[40:43], a[220:223], a[164:167], v[40:43]
v_mfma_f32_16x16x32_bf16 v[36:39], a[216:219], a[152:155], v[36:39]
v_mfma_f32_16x16x32_bf16 v[36:39], a[220:223], a[156:159], v[36:39]
v_mfma_f32_16x16x32_bf16 v[32:35], a[216:219], a[144:147], v[32:35]
buffer_load_dwordx4 a[216:219], v254, s[8:11], s20 offen offset:1024
v_mfma_f32_16x16x32_bf16 v[32:35], a[220:223], a[148:151], v[32:35]
s_waitcnt vmcnt(10)
v_mfma_f32_16x16x32_bf16 v[64:67], a[224:227], a[144:147], v[64:67]
buffer_load_dwordx4 a[220:223], v254, s[8:11], s20 offen offset:2048
v_mfma_f32_16x16x32_bf16 v[64:67], a[228:231], a[148:151], v[64:67]
v_mfma_f32_16x16x32_bf16 v[68:71], a[224:227], a[152:155], v[68:71]
v_mfma_f32_16x16x32_bf16 v[68:71], a[228:231], a[156:159], v[68:71]
v_mfma_f32_16x16x32_bf16 v[72:75], a[224:227], a[160:163], v[72:75]
v_mfma_f32_16x16x32_bf16 v[72:75], a[228:231], a[164:167], v[72:75]
v_mfma_f32_16x16x32_bf16 v[76:79], a[224:227], a[168:171], v[76:79]
v_mfma_f32_16x16x32_bf16 v[76:79], a[228:231], a[172:175], v[76:79]
v_mfma_f32_16x16x32_bf16 v[80:83], a[224:227], a[176:179], v[80:83]
v_mfma_f32_16x16x32_bf16 v[80:83], a[228:231], a[180:183], v[80:83]
v_mfma_f32_16x16x32_bf16 v[84:87], a[224:227], a[184:187], v[84:87]
ds_read_b128 v[248:251], v255 offset:16384
v_mfma_f32_16x16x32_bf16 v[84:87], a[228:231], a[188:191], v[84:87]
v_mfma_f32_16x16x32_bf16 v[88:91], a[224:227], a[192:195], v[88:91]
v_mfma_f32_16x16x32_bf16 v[88:91], a[228:231], a[196:199], v[88:91]
v_mfma_f32_16x16x32_bf16 v[92:95], a[224:227], a[200:203], v[92:95]
buffer_load_dwordx4 a[224:227], v254, s[8:11], s20 offen offset:3072
v_mfma_f32_16x16x32_bf16 v[92:95], a[228:231], a[204:207], v[92:95]
s_waitcnt vmcnt(9)
s_add_u32 s20, s20, 4096
v_mfma_f32_16x16x32_bf16 v[124:127], a[232:235], a[200:203], v[124:127]
buffer_load_dwordx4 a[228:231], v254, s[8:11], s20 offen offset:0
v_mfma_f32_16x16x32_bf16 v[124:127], a[236:239], a[204:207], v[124:127]
v_mfma_f32_16x16x32_bf16 v[120:123], a[232:235], a[192:195], v[120:123]
v_mfma_f32_16x16x32_bf16 v[120:123], a[236:239], a[196:199], v[120:123]
v_mfma_f32_16x16x32_bf16 v[116:119], a[232:235], a[184:187], v[116:119]
v_mfma_f32_16x16x32_bf16 v[116:119], a[236:239], a[188:191], v[116:119]
s_waitcnt lgkmcnt(0)
buffer_store_dwordx4 v[248:251], v255, s[16:19], s30 offen offset:0 sc1
v_mfma_f32_16x16x32_bf16 v[112:115], a[232:235], a[176:179], v[112:115]
v_mfma_f32_16x16x32_bf16 v[112:115], a[236:239], a[180:183], v[112:115]
v_mfma_f32_16x16x32_bf16 v[108:111], a[232:235], a[168:171], v[108:111]
v_mfma_f32_16x16x32_bf16 v[108:111], a[236:239], a[172:175], v[108:111]
v_mfma_f32_16x16x32_bf16 v[104:107], a[232:235], a[160:163], v[104:107]
ds_read_b128 v[248:251], v255 offset:18432
v_mfma_f32_16x16x32_bf16 v[104:107], a[236:239], a[164:167], v[104:107]
v_mfma_f32_16x16x32_bf16 v[100:103], a[232:235], a[152:155], v[100:103]
v_mfma_f32_16x16x32_bf16 v[100:103], a[236:239], a[156:159], v[100:103]
v_mfma_f32_16x16x32_bf16 v[96:99], a[232:235], a[144:147], v[96:99]
buffer_load_dwordx4 a[232:235], v254, s[8:11], s20 offen offset:1024
v_mfma_f32_16x16x32_bf16 v[96:99], a[236:239], a[148:151], v[96:99]
s_waitcnt vmcnt(10)
v_mfma_f32_16x16x32_bf16 v[128:131], a[240:243], a[144:147], v[128:131]
buffer_load_dwordx4 a[236:239], v254, s[8:11], s20 offen offset:2048
v_mfma_f32_16x16x32_bf16 v[128:131], a[244:247], a[148:151], v[128:131]
v_mfma_f32_16x16x32_bf16 v[132:135], a[240:243], a[152:155], v[132:135]
v_mfma_f32_16x16x32_bf16 v[132:135], a[244:247], a[156:159], v[132:135]
v_mfma_f32_16x16x32_bf16 v[136:139], a[240:243], a[160:163], v[136:139]
v_mfma_f32_16x16x32_bf16 v[136:139], a[244:247], a[164:167], v[136:139]
s_waitcnt lgkmcnt(0)
buffer_store_dwordx4 v[248:251], v255, s[16:19], s30 offen offset:2048 sc1
v_mfma_f32_16x16x32_bf16 v[140:143], a[240:243], a[168:171], v[140:143]
s_add_u32 s30, s30, 4096
v_mfma_f32_16x16x32_bf16 v[140:143], a[244:247], a[172:175], v[140:143]
v_mfma_f32_16x16x32_bf16 v[144:147], a[240:243], a[176:179], v[144:147]
v_mfma_f32_16x16x32_bf16 v[144:147], a[244:247], a[180:183], v[144:147]
v_mfma_f32_16x16x32_bf16 v[148:151], a[240:243], a[184:187], v[148:151]
v_mfma_f32_16x16x32_bf16 v[148:151], a[244:247], a[188:191], v[148:151]
buffer_load_dword a255, v254, s[60:63], 0 offen sc1
v_mfma_f32_16x16x32_bf16 v[152:155], a[240:243], a[192:195], v[152:155]
v_mfma_f32_16x16x32_bf16 v[152:155], a[244:247], a[196:199], v[152:155]
v_mfma_f32_16x16x32_bf16 v[156:159], a[240:243], a[200:203], v[156:159]
buffer_load_dwordx4 a[240:243], v254, s[8:11], s20 offen offset:3072
v_mfma_f32_16x16x32_bf16 v[156:159], a[244:247], a[204:207], v[156:159]
s_waitcnt vmcnt(12)
s_add_u32 s20, s20, 4096
v_mfma_f32_16x16x32_bf16 v[188:191], a[248:251], a[200:203], v[188:191]
buffer_load_dwordx4 a[244:247], v254, s[8:11], s20 offen offset:0
v_mfma_f32_16x16x32_bf16 v[188:191], a[208:211], a[204:207], v[188:191]
v_mfma_f32_16x16x32_bf16 v[184:187], a[248:251], a[192:195], v[184:187]
v_mfma_f32_16x16x32_bf16 v[184:187], a[208:211], a[196:199], v[184:187]
v_mfma_f32_16x16x32_bf16 v[180:183], a[248:251], a[184:187], v[180:183]
v_mfma_f32_16x16x32_bf16 v[180:183], a[208:211], a[188:191], v[180:183]
v_mfma_f32_16x16x32_bf16 v[176:179], a[248:251], a[176:179], v[176:179]
v_mfma_f32_16x16x32_bf16 v[176:179], a[208:211], a[180:183], v[176:179]
v_mfma_f32_16x16x32_bf16 v[172:175], a[248:251], a[168:171], v[172:175]
v_mfma_f32_16x16x32_bf16 v[172:175], a[208:211], a[172:175], v[172:175]
v_mfma_f32_16x16x32_bf16 v[168:171], a[248:251], a[160:163], v[168:171]
ds_read_b128 v[248:251], v255 offset:20480
v_mfma_f32_16x16x32_bf16 v[168:171], a[208:211], a[164:167], v[168:171]
v_mfma_f32_16x16x32_bf16 v[164:167], a[248:251], a[152:155], v[164:167]
v_mfma_f32_16x16x32_bf16 v[164:167], a[208:211], a[156:159], v[164:167]
v_mfma_f32_16x16x32_bf16 v[160:163], a[248:251], a[144:147], v[160:163]
buffer_load_dwordx4 a[248:251], v254, s[8:11], s20 offen offset:1024
v_mfma_f32_16x16x32_bf16 v[160:163], a[208:211], a[148:151], v[160:163]
s_waitcnt vmcnt(11)
v_mfma_f32_16x16x32_bf16 v[192:195], a[212:215], a[144:147], v[192:195]
buffer_load_dwordx4 a[208:211], v254, s[8:11], s20 offen offset:2048
v_mfma_f32_16x16x32_bf16 v[192:195], a[216:219], a[148:151], v[192:195]
v_mfma_f32_16x16x32_bf16 v[196:199], a[212:215], a[152:155], v[196:199]
v_mfma_f32_16x16x32_bf16 v[196:199], a[216:219], a[156:159], v[196:199]
v_mfma_f32_16x16x32_bf16 v[200:203], a[212:215], a[160:163], v[200:203]
v_mfma_f32_16x16x32_bf16 v[200:203], a[216:219], a[164:167], v[200:203]
s_waitcnt lgkmcnt(0)
v_mfma_f32_32x32x16_bf16 v[112:127], v[244:247], v[240:243], v[112:127]
buffer_store_dwordx4 v[248:251], v255, s[16:19], s30 offen offset:0 sc1
v_mfma_f32_16x16x32_bf16 v[204:207], a[212:215], a[168:171], v[204:207]
s_add_u32 s36, s36, 1
v_mfma_f32_16x16x32_bf16 v[204:207], a[216:219], a[172:175], v[204:207]
v_mov_b32 v248, s36
v_mfma_f32_16x16x32_bf16 v[208:211], a[212:215], a[176:179], v[208:211]
buffer_store_dword v248, off, s[8:11], s23 sc1
v_mfma_f32_16x16x32_bf16 v[208:211], a[216:219], a[180:183], v[208:211]
v_mfma_f32_16x16x32_bf16 v[212:215], a[212:215], a[184:187], v[212:215]
v_mfma_f32_16x16x32_bf16 v[212:215], a[216:219], a[188:191], v[212:215]
v_mfma_f32_16x16x32_bf16 v[216:219], a[212:215], a[192:195], v[216:219]
v_mfma_f32_16x16x32_bf16 v[216:219], a[216:219], a[196:199], v[216:219]
v_mfma_f32_16x16x32_bf16 v[220:223], a[212:215], a[200:203], v[220:223]
buffer_load_dwordx4 a[212:215], v254, s[8:11], s20 offen offset:3072
v_mfma_f32_16x16x32_bf16 v[220:223], a[216:219], a[204:207], v[220:223]
s_waitcnt vmcnt(13)
s_add_u32 s20, s20, 4096
v_mfma_f32_16x16x32_bf16 a[12:15], a[220:223], a[200:203], a[12:15]
ds_read_b128 a[200:203], v252 offset:30720
v_mfma_f32_16x16x32_bf16 a[12:15], a[224:227], a[204:207], a[12:15]
ds_read_b128 a[204:207], v252 offset:31232
v_mfma_f32_16x16x32_bf16 a[8:11], a[220:223], a[192:195], a[8:11]
ds_read_b128 a[192:195], v252 offset:28672
v_mfma_f32_16x16x32_bf16 a[8:11], a[224:227], a[196:199], a[8:11]
ds_read_b128 a[196:199], v252 offset:29184
v_mfma_f32_16x16x32_bf16 a[4:7], a[220:223], a[184:187], a[4:7]
ds_read_b128 a[184:187], v252 offset:26624
v_mfma_f32_16x16x32_bf16 a[4:7], a[224:227], a[188:191], a[4:7]
ds_read_b128 a[188:191], v252 offset:27136
v_mfma_f32_16x16x32_bf16 a[0:3], a[220:223], a[176:179], a[0:3]
ds_read_b128 a[176:179], v252 offset:24576
v_mfma_f32_16x16x32_bf16 a[0:3], a[224:227], a[180:183], a[0:3]
ds_read_b128 a[180:183], v252 offset:25088
v_mfma_f32_16x16x32_bf16 v[236:239], a[220:223], a[168:171], v[236:239]
ds_read_b128 a[168:171], v252 offset:22528
v_mfma_f32_16x16x32_bf16 v[236:239], a[224:227], a[172:175], v[236:239]
ds_read_b128 a[172:175], v252 offset:23040
v_mfma_f32_16x16x32_bf16 v[232:235], a[220:223], a[160:163], v[232:235]
ds_read_b128 a[160:163], v252 offset:20480
v_mfma_f32_16x16x32_bf16 v[232:235], a[224:227], a[164:167], v[232:235]
ds_read_b128 a[164:167], v252 offset:20992
v_mfma_f32_16x16x32_bf16 v[228:231], a[220:223], a[152:155], v[228:231]
ds_read_b128 a[152:155], v252 offset:18432
v_mfma_f32_16x16x32_bf16 v[228:231], a[224:227], a[156:159], v[228:231]
ds_read_b128 a[156:159], v252 offset:18944
v_mfma_f32_16x16x32_bf16 v[224:227], a[220:223], a[144:147], v[224:227]
ds_read_b128 a[144:147], v252 offset:16384
v_mfma_f32_16x16x32_bf16 v[224:227], a[224:227], a[148:151], v[224:227]
s_waitcnt vmcnt(10) lgkmcnt(11)
ds_read_b128 a[148:151], v252 offset:16896
v_mfma_f32_16x16x32_bf16 v[28:31], a[228:231], a[200:203], v[28:31]
buffer_load_dwordx4 a[220:223], v254, s[8:11], s20 offen offset:0
v_mfma_f32_16x16x32_bf16 v[28:31], a[232:235], a[204:207], v[28:31]
v_mfma_f32_16x16x32_bf16 v[24:27], a[228:231], a[192:195], v[24:27]
buffer_load_dwordx4 a[224:227], v254, s[8:11], s20 offen offset:1024
v_mfma_f32_16x16x32_bf16 v[24:27], a[232:235], a[196:199], v[24:27]
s_waitcnt lgkmcnt(8)
v_mfma_f32_16x16x32_bf16 v[20:23], a[228:231], a[184:187], v[20:23]
v_mfma_f32_16x16x32_bf16 v[20:23], a[232:235], a[188:191], v[20:23]
v_mfma_f32_16x16x32_bf16 v[16:19], a[228:231], a[176:179], v[16:19]
s_add_u32 s35, s35, 1
v_mfma_f32_16x16x32_bf16 v[16:19], a[232:235], a[180:183], v[16:19]
s_waitcnt vmcnt(9) lgkmcnt(4)
v_accvgpr_read_b32 v242, a254
v_accvgpr_read_b32 v249, a255
v_mfma_f32_16x16x32_bf16 v[12:15], a[228:231], a[168:171], v[12:15]
v_mov_b32 v241, 0
v_cmp_le_u32 vcc, s35, v249
v_mfma_f32_16x16x32_bf16 v[12:15], a[232:235], a[172:175], v[12:15]
s_and_b32 s42, vcc_lo, 15
s_cmp_eq_u32 s42, 15
s_cbranch_scc0 L_spinBx0
L_retBx0:
v_mfma_f32_16x16x32_bf16 v[8:11], a[228:231], a[160:163], v[8:11]
ds_read_b128 v[248:251], v255 offset:22528
v_mfma_f32_16x16x32_bf16 v[8:11], a[232:235], a[164:167], v[8:11]
s_waitcnt lgkmcnt(1)
v_mfma_f32_16x16x32_bf16 v[4:7], a[228:231], a[152:155], v[4:7]
v_mfma_f32_16x16x32_bf16 v[4:7], a[232:235], a[156:159], v[4:7]
v_mfma_f32_16x16x32_bf16 v[0:3], a[228:231], a[144:147], v[0:3]
buffer_load_dwordx4 a[228:231], v254, s[8:11], s20 offen offset:2048
v_mfma_f32_16x16x32_bf16 v[0:3], a[232:235], a[148:151], v[0:3]
s_waitcnt vmcnt(9)
v_mfma_f32_16x16x32_bf16 v[32:35], a[236:239], a[144:147], v[32:35]
buffer_load_dwordx4 a[232:235], v254, s[8:11], s20 offen offset:3072
v_mfma_f32_16x16x32_bf16 v[32:35], a[240:243], a[148:151], v[32:35]
s_add_u32 s20, s20, 4096
v_mfma_f32_16x16x32_bf16 v[36:39], a[236:239], a[152:155], v[36:39]
v_mfma_f32_16x16x32_bf16 v[36:39], a[240:243], a[156:159], v[36:39]
s_add_u32 m0, s34, 131072
v_mfma_f32_16x16x32_bf16 v[40:43], a[236:239], a[160:163], v[40:43]
buffer_load_dwordx4 v254, s[12:15], s32 offen sc1 lds
v_mfma_f32_16x16x32_bf16 v[40:43], a[240:243], a[164:167], v[40:43]
s_waitcnt lgkmcnt(0)
v_mfma_f32_32x32x16_bf16 v[128:143], v[244:247], v[240:243], v[128:143]
buffer_store_dwordx4 v[248:251], v255, s[16:19], s30 offen offset:2048 sc1
v_mfma_f32_16x16x32_bf16 v[44:47], a[236:239], a[168:171], v[44:47]
s_add_u32 s30, s30, 4096
s_add_u32 s32, s32, 1024
v_mfma_f32_16x16x32_bf16 v[44:47], a[240:243], a[172:175], v[44:47]
v_mfma_f32_16x16x32_bf16 v[48:51], a[236:239], a[176:179], v[48:51]
v_mfma_f32_16x16x32_bf16 v[48:51], a[240:243], a[180:183], v[48:51]
v_mfma_f32_16x16x32_bf16 v[52:55], a[236:239], a[184:187], v[52:55]
v_mfma_f32_16x16x32_bf16 v[52:55], a[240:243], a[188:191], v[52:55]
v_mfma_f32_16x16x32_bf16 v[56:59], a[236:239], a[192:195], v[56:59]
v_mfma_f32_16x16x32_bf16 v[56:59], a[240:243], a[196:199], v[56:59]
v_mfma_f32_16x16x32_bf16 v[60:63], a[236:239], a[200:203], v[60:63]
buffer_load_dwordx4 a[236:239], v254, s[8:11], s20 offen offset:0
v_mfma_f32_16x16x32_bf16 v[60:63], a[240:243], a[204:207], v[60:63]
s_waitcnt vmcnt(11)
v_mfma_f32_16x16x32_bf16 v[92:95], a[244:247], a[200:203], v[92:95]
buffer_load_dwordx4 a[240:243], v254, s[8:11], s20 offen offset:1024
v_mfma_f32_16x16x32_bf16 v[92:95], a[248:251], a[204:207], v[92:95]
v_mfma_f32_16x16x32_bf16 v[88:91], a[244:247], a[192:195], v[88:91]
v_mfma_f32_16x16x32_bf16 v[88:91], a[248:251], a[196:199], v[88:91]
v_mfma_f32_16x16x32_bf16 v[84:87], a[244:247], a[184:187], v[84:87]
v_mfma_f32_16x16x32_bf16 v[84:87], a[248:251], a[188:191], v[84:87]
v_mfma_f32_16x16x32_bf16 v[80:83], a[244:247], a[176:179], v[80:83]
v_mfma_f32_16x16x32_bf16 v[80:83], a[248:251], a[180:183], v[80:83]
v_mfma_f32_16x16x32_bf16 v[76:79], a[244:247], a[168:171], v[76:79]
v_mfma_f32_16x16x32_bf16 v[76:79], a[248:251], a[172:175], v[76:79]
v_mfma_f32_16x16x32_bf16 v[72:75], a[244:247], a[160:163], v[72:75]
v_mfma_f32_16x16x32_bf16 v[72:75], a[248:251], a[164:167], v[72:75]
v_mfma_f32_16x16x32_bf16 v[68:71], a[244:247], a[152:155], v[68:71]
v_mfma_f32_16x16x32_bf16 v[68:71], a[248:251], a[156:159], v[68:71]
v_mfma_f32_16x16x32_bf16 v[64:67], a[244:247], a[144:147], v[64:67]
buffer_load_dwordx4 a[244:247], v254, s[8:11], s20 offen offset:2048
v_mfma_f32_16x16x32_bf16 v[64:67], a[248:251], a[148:151], v[64:67]
s_waitcnt vmcnt(9)
v_mfma_f32_16x16x32_bf16 v[96:99], a[208:211], a[144:147], v[96:99]
buffer_load_dwordx4 a[248:251], v254, s[8:11], s20 offen offset:3072
v_mfma_f32_16x16x32_bf16 v[96:99], a[212:215], a[148:151], v[96:99]
s_add_u32 s20, s20, 4096
v_mfma_f32_16x16x32_bf16 v[100:103], a[208:211], a[152:155], v[100:103]
v_mfma_f32_16x16x32_bf16 v[100:103], a[212:215], a[156:159], v[100:103]
s_add_u32 m0, s34, 132096
v_mfma_f32_16x16x32_bf16 v[104:107], a[208:211], a[160:163], v[104:107]
buffer_load_dwordx4 v254, s[12:15], s32 offen sc1 lds
v_mfma_f32_16x16x32_bf16 v[104:107], a[212:215], a[164:167], v[104:107]
v_mfma_f32_16x16x32_bf16 v[108:111], a[208:211], a[168:171], v[108:111]
s_add_u32 s32, s32, 1024
v_mfma_f32_16x16x32_bf16 v[108:111], a[212:215], a[172:175], v[108:111]
v_mfma_f32_16x16x32_bf16 v[112:115], a[208:211], a[176:179], v[112:115]
v_mfma_f32_16x16x32_bf16 v[112:115], a[212:215], a[180:183], v[112:115]
v_mfma_f32_16x16x32_bf16 v[116:119], a[208:211], a[184:187], v[116:119]
ds_read_b128 v[248:251], v255 offset:24576
v_mfma_f32_16x16x32_bf16 v[116:119], a[212:215], a[188:191], v[116:119]
v_mfma_f32_16x16x32_bf16 v[120:123], a[208:211], a[192:195], v[120:123]
v_mfma_f32_16x16x32_bf16 v[120:123], a[212:215], a[196:199], v[120:123]
v_mfma_f32_16x16x32_bf16 v[124:127], a[208:211], a[200:203], v[124:127]
buffer_load_dwordx4 a[208:211], v254, s[8:11], s20 offen offset:0
v_mfma_f32_16x16x32_bf16 v[124:127], a[212:215], a[204:207], v[124:127]
s_waitcnt vmcnt(10)
v_mfma_f32_16x16x32_bf16 v[156:159], a[220:223], a[200:203], v[156:159]
buffer_load_dwordx4 a[212:215], v254, s[8:11], s20 offen offset:1024
v_mfma_f32_16x16x32_bf16 v[156:159], a[224:227], a[204:207], v[156:159]
v_mfma_f32_16x16x32_bf16 v[152:155], a[220:223], a[192:195], v[152:155]
buffer_load_dwordx4 a[216:219], v254, s[8:11], s20 offen offset:2048
v_mfma_f32_16x16x32_bf16 v[152:155], a[224:227], a[196:199], v[152:155]
s_add_u32 m0, s34, 133120
v_mfma_f32_16x16x32_bf16 v[148:151], a[220:223], a[184:187], v[148:151]
buffer_load_dwordx4 v254, s[12:15], s32 offen sc1 lds
v_mfma_f32_16x16x32_bf16 v[148:151], a[224:227], a[188:191], v[148:151]
s_waitcnt lgkmcnt(0)
buffer_store_dwordx4 v[248:251], v255, s[16:19], s30 offen offset:0 sc1
v_mfma_f32_16x16x32_bf16 v[144:147], a[220:223], a[176:179], v[144:147]
s_add_u32 s32, s32, 1024
v_mfma_f32_16x16x32_bf16 v[144:147], a[224:227], a[180:183], v[144:147]
v_mfma_f32_16x16x32_bf16 v[140:143], a[220:223], a[168:171], v[140:143]
v_mfma_f32_16x16x32_bf16 v[140:143], a[224:227], a[172:175], v[140:143]
v_mfma_f32_16x16x32_bf16 v[136:139], a[220:223], a[160:163], v[136:139]
v_mfma_f32_16x16x32_bf16 v[136:139], a[224:227], a[164:167], v[136:139]
v_mfma_f32_16x16x32_bf16 v[132:135], a[220:223], a[152:155], v[132:135]
v_mfma_f32_16x16x32_bf16 v[132:135], a[224:227], a[156:159], v[132:135]
v_mfma_f32_16x16x32_bf16 v[128:131], a[220:223], a[144:147], v[128:131]
buffer_load_dwordx4 a[220:223], v254, s[8:11], s20 offen offset:3072
v_mfma_f32_16x16x32_bf16 v[128:131], a[224:227], a[148:151], v[128:131]
s_waitcnt vmcnt(13)
s_add_u32 s20, s20, 4096
v_mfma_f32_16x16x32_bf16 v[160:163], a[228:231], a[144:147], v[160:163]
buffer_load_dwordx4 a[224:227], v254, s[8:11], s20 offen offset:0
v_mfma_f32_16x16x32_bf16 v[160:163], a[232:235], a[148:151], v[160:163]
v_mfma_f32_16x16x32_bf16 v[164:167], a[228:231], a[152:155], v[164:167]
v_mfma_f32_16x16x32_bf16 v[164:167], a[232:235], a[156:159], v[164:167]
s_add_u32 m0, s34, 134144
v_mfma_f32_16x16x32_bf16 v[168:171], a[228:231], a[160:163], v[168:171]
buffer_load_dwordx4 v254, s[12:15], s32 offen sc1 lds
v_mfma_f32_16x16x32_bf16 v[168:171], a[232:235], a[164:167], v[168:171]
v_mfma_f32_16x16x32_bf16 v[172:175], a[228:231], a[168:171], v[172:175]
s_add_u32 s32, s32, 13312
v_mfma_f32_16x16x32_bf16 v[172:175], a[232:235], a[172:175], v[172:175]
v_add_u32 v252, s28, v253
v_mfma_f32_16x16x32_bf16 v[176:179], a[228:231], a[176:179], v[176:179]
v_mfma_f32_16x16x32_bf16 v[176:179], a[232:235], a[180:183], v[176:179]
v_mfma_f32_16x16x32_bf16 v[180:183], a[228:231], a[184:187], v[180:183]
ds_read_b128 v[248:251], v255 offset:26624
v_mfma_f32_16x16x32_bf16 v[180:183], a[232:235], a[188:191], v[180:183]
v_mfma_f32_16x16x32_bf16 v[184:187], a[228:231], a[192:195], v[184:187]
v_mfma_f32_16x16x32_bf16 v[184:187], a[232:235], a[196:199], v[184:187]
v_mfma_f32_16x16x32_bf16 v[188:191], a[228:231], a[200:203], v[188:191]
buffer_load_dwordx4 a[228:231], v254, s[8:11], s20 offen offset:1024
v_mfma_f32_16x16x32_bf16 v[188:191], a[232:235], a[204:207], v[188:191]
s_waitcnt vmcnt(12)
v_mfma_f32_16x16x32_bf16 v[220:223], a[236:239], a[200:203], v[220:223]
buffer_load_dwordx4 a[232:235], v254, s[8:11], s20 offen offset:2048
v_mfma_f32_16x16x32_bf16 v[220:223], a[240:243], a[204:207], v[220:223]
v_mfma_f32_16x16x32_bf16 v[216:219], a[236:239], a[192:195], v[216:219]
v_mfma_f32_16x16x32_bf16 v[216:219], a[240:243], a[196:199], v[216:219]
s_add_u32 m0, s34, 147456
v_mfma_f32_16x16x32_bf16 v[212:215], a[236:239], a[184:187], v[212:215]
buffer_load_dwordx4 v254, s[12:15], s32 offen sc1 lds
v_mfma_f32_16x16x32_bf16 v[212:215], a[240:243], a[188:191], v[212:215]
s_waitcnt lgkmcnt(0)
v_mfma_f32_32x32x16_bf16 v[144:159], v[244:247], v[240:243], v[144:159]
buffer_store_dwordx4 v[248:251], v255, s[16:19], s30 offen offset:2048 sc1
v_mfma_f32_16x16x32_bf16 v[208:211], a[236:239], a[176:179], v[208:211]
s_add_u32 s30, s30, 4096
s_add_u32 s32, s32, 1024
v_mfma_f32_16x16x32_bf16 v[208:211], a[240:243], a[180:183], v[208:211]
v_mfma_f32_16x16x32_bf16 v[204:207], a[236:239], a[168:171], v[204:207]
v_mfma_f32_16x16x32_bf16 v[204:207], a[240:243], a[172:175], v[204:207]
v_mfma_f32_16x16x32_bf16 v[200:203], a[236:239], a[160:163], v[200:203]
v_mfma_f32_16x16x32_bf16 v[200:203], a[240:243], a[164:167], v[200:203]
v_mfma_f32_16x16x32_bf16 v[196:199], a[236:239], a[152:155], v[196:199]
v_mfma_f32_16x16x32_bf16 v[196:199], a[240:243], a[156:159], v[196:199]
v_mfma_f32_16x16x32_bf16 v[192:195], a[236:239], a[144:147], v[192:195]
buffer_load_dwordx4 a[236:239], v254, s[8:11], s20 offen offset:3072
v_mfma_f32_16x16x32_bf16 v[192:195], a[240:243], a[148:151], v[192:195]
s_waitcnt vmcnt(14)
s_add_u32 s20, s20, 4096
buffer_load_dwordx4 a[240:243], v254, s[8:11], s20 offen offset:0
v_mfma_f32_16x16x32_bf16 v[224:227], a[244:247], a[144:147], v[224:227]
ds_read_b128 a[144:147], v252 offset:0
v_mfma_f32_16x16x32_bf16 v[224:227], a[248:251], a[148:151], v[224:227]
ds_read_b128 a[148:151], v252 offset:512
v_mfma_f32_16x16x32_bf16 v[228:231], a[244:247], a[152:155], v[228:231]
ds_read_b128 a[152:155], v252 offset:2048
v_mfma_f32_16x16x32_bf16 v[228:231], a[248:251], a[156:159], v[228:231]
ds_read_b128 a[156:159], v252 offset:2560
v_mfma_f32_16x16x32_bf16 v[232:235], a[244:247], a[160:163], v[232:235]
ds_read_b128 a[160:163], v252 offset:4096
v_mfma_f32_16x16x32_bf16 v[232:235], a[248:251], a[164:167], v[232:235]
ds_read_b128 a[164:167], v252 offset:4608
v_mfma_f32_16x16x32_bf16 v[236:239], a[244:247], a[168:171], v[236:239]
ds_read_b128 a[168:171], v252 offset:6144
v_mfma_f32_16x16x32_bf16 v[236:239], a[248:251], a[172:175], v[236:239]
ds_read_b128 a[172:175], v252 offset:6656
v_mfma_f32_16x16x32_bf16 a[0:3], a[244:247], a[176:179], a[0:3]
ds_read_b128 a[176:179], v252 offset:8192
v_mfma_f32_16x16x32_bf16 a[0:3], a[248:251], a[180:183], a[0:3]
ds_read_b128 a[180:183], v252 offset:8704
v_mfma_f32_16x16x32_bf16 a[4:7], a[244:247], a[184:187], a[4:7]
ds_read_b128 a[184:187], v252 offset:10240
v_mfma_f32_16x16x32_bf16 a[4:7], a[248:251], a[188:191], a[4:7]
ds_read_b128 a[188:191], v252 offset:10752
v_mfma_f32_16x16x32_bf16 a[8:11], a[244:247], a[192:195], a[8:11]
ds_read_b128 a[192:195], v252 offset:12288
v_mfma_f32_16x16x32_bf16 a[8:11], a[248:251], a[196:199], a[8:11]
ds_read_b128 a[196:199], v252 offset:12800
v_mfma_f32_16x16x32_bf16 a[12:15], a[244:247], a[200:203], a[12:15]
ds_read_b128 a[200:203], v252 offset:14336
v_mfma_f32_16x16x32_bf16 a[12:15], a[248:251], a[204:207], a[12:15]
s_waitcnt vmcnt(12) lgkmcnt(11)
ds_read_b128 a[204:207], v252 offset:14848
v_mfma_f32_16x16x32_bf16 v[0:3], a[208:211], a[144:147], v[0:3]
buffer_load_dwordx4 a[244:247], v254, s[8:11], s20 offen offset:1024
v_mfma_f32_16x16x32_bf16 v[0:3], a[212:215], a[148:151], v[0:3]
v_mfma_f32_16x16x32_bf16 v[4:7], a[208:211], a[152:155], v[4:7]
buffer_load_dwordx4 a[248:251], v254, s[8:11], s20 offen offset:2048
v_mfma_f32_16x16x32_bf16 v[4:7], a[212:215], a[156:159], v[4:7]
s_waitcnt lgkmcnt(8)
v_mfma_f32_16x16x32_bf16 v[8:11], a[208:211], a[160:163], v[8:11]
v_mfma_f32_16x16x32_bf16 v[8:11], a[212:215], a[164:167], v[8:11]
v_mfma_f32_16x16x32_bf16 v[12:15], a[208:211], a[168:171], v[12:15]
v_mfma_f32_16x16x32_bf16 v[12:15], a[212:215], a[172:175], v[12:15]
s_waitcnt lgkmcnt(4)
v_lshlrev_b32 v242, 16, v242
v_mfma_f32_16x16x32_bf16 v[16:19], a[208:211], a[176:179], v[16:19]
v_mfma_f32_16x16x32_bf16 v[16:19], a[212:215], a[180:183], v[16:19]
v_mfma_f32_16x16x32_bf16 v[20:23], a[208:211], a[184:187], v[20:23]
ds_read_b128 v[248:251], v255 offset:28672
v_mfma_f32_16x16x32_bf16 v[20:23], a[212:215], a[188:191], v[20:23]
s_waitcnt lgkmcnt(1)
v_mfma_f32_16x16x32_bf16 v[24:27], a[208:211], a[192:195], v[24:27]
v_mfma_f32_16x16x32_bf16 v[24:27], a[212:215], a[196:199], v[24:27]
v_mfma_f32_16x16x32_bf16 v[28:31], a[208:211], a[200:203], v[28:31]
buffer_load_dwordx4 a[208:211], v254, s[8:11], s20 offen offset:3072
v_mfma_f32_16x16x32_bf16 v[28:31], a[212:215], a[204:207], v[28:31]
s_waitcnt vmcnt(11)
s_add_u32 s20, s20, 4096
v_mfma_f32_16x16x32_bf16 v[60:63], a[216:219], a[200:203], v[60:63]
buffer_load_dwordx4 a[212:215], v254, s[8:11], s20 offen offset:0
v_mfma_f32_16x16x32_bf16 v[60:63], a[220:223], a[204:207], v[60:63]
v_mfma_f32_16x16x32_bf16 v[56:59], a[216:219], a[192:195], v[56:59]
v_mfma_f32_16x16x32_bf16 v[56:59], a[220:223], a[196:199], v[56:59]
s_add_u32 m0, s34, 148480
v_mfma_f32_16x16x32_bf16 v[52:55], a[216:219], a[184:187], v[52:55]
buffer_load_dwordx4 v254, s[12:15], s32 offen sc1 lds
v_mfma_f32_16x16x32_bf16 v[52:55], a[220:223], a[188:191], v[52:55]
s_waitcnt lgkmcnt(0)
v_mfma_f32_32x32x16_bf16 v[160:175], v[244:247], v[240:243], v[160:175]
buffer_store_dwordx4 v[248:251], v255, s[16:19], s30 offen offset:0 sc1
v_mfma_f32_16x16x32_bf16 v[48:51], a[216:219], a[176:179], v[48:51]
s_add_u32 s32, s32, 1024
v_mfma_f32_16x16x32_bf16 v[48:51], a[220:223], a[180:183], v[48:51]
v_mfma_f32_16x16x32_bf16 v[44:47], a[216:219], a[168:171], v[44:47]
v_mfma_f32_16x16x32_bf16 v[44:47], a[220:223], a[172:175], v[44:47]
v_mfma_f32_16x16x32_bf16 v[40:43], a[216:219], a[160:163], v[40:43]
v_mfma_f32_16x16x32_bf16 v[40:43], a[220:223], a[164:167], v[40:43]
v_mfma_f32_16x16x32_bf16 v[36:39], a[216:219], a[152:155], v[36:39]
v_mfma_f32_16x16x32_bf16 v[36:39], a[220:223], a[156:159], v[36:39]
v_mfma_f32_16x16x32_bf16 v[32:35], a[216:219], a[144:147], v[32:35]
buffer_load_dwordx4 a[216:219], v254, s[8:11], s20 offen offset:1024
v_mfma_f32_16x16x32_bf16 v[32:35], a[220:223], a[148:151], v[32:35]
s_waitcnt vmcnt(12)
v_mfma_f32_16x16x32_bf16 v[64:67], a[224:227], a[144:147], v[64:67]
buffer_load_dwordx4 a[220:223], v254, s[8:11], s20 offen offset:2048
v_mfma_f32_16x16x32_bf16 v[64:67], a[228:231], a[148:151], v[64:67]
v_mfma_f32_16x16x32_bf16 v[68:71], a[224:227], a[152:155], v[68:71]
v_mfma_f32_16x16x32_bf16 v[68:71], a[228:231], a[156:159], v[68:71]
v_mfma_f32_16x16x32_bf16 v[72:75], a[224:227], a[160:163], v[72:75]
v_mfma_f32_16x16x32_bf16 v[72:75], a[228:231], a[164:167], v[72:75]
v_mfma_f32_16x16x32_bf16 v[76:79], a[224:227], a[168:171], v[76:79]
v_mfma_f32_16x16x32_bf16 v[76:79], a[228:231], a[172:175], v[76:79]
v_mfma_f32_16x16x32_bf16 v[80:83], a[224:227], a[176:179], v[80:83]
v_mfma_f32_16x16x32_bf16 v[80:83], a[228:231], a[180:183], v[80:83]
v_mfma_f32_16x16x32_bf16 v[84:87], a[224:227], a[184:187], v[84:87]
v_mfma_f32_16x16x32_bf16 v[84:87], a[228:231], a[188:191], v[84:87]
v_mfma_f32_16x16x32_bf16 v[88:91], a[224:227], a[192:195], v[88:91]
v_mfma_f32_16x16x32_bf16 v[88:91], a[228:231], a[196:199], v[88:91]
v_mfma_f32_16x16x32_bf16 v[92:95], a[224:227], a[200:203], v[92:95]
buffer_load_dwordx4 a[224:227], v254, s[8:11], s20 offen offset:3072
v_mfma_f32_16x16x32_bf16 v[92:95], a[228:231], a[204:207], v[92:95]
s_waitcnt vmcnt(10)
s_add_u32 s20, s20, 4096
v_mfma_f32_16x16x32_bf16 v[124:127], a[232:235], a[200:203], v[124:127]
buffer_load_dwordx4 a[228:231], v254, s[8:11], s20 offen offset:0
v_mfma_f32_16x16x32_bf16 v[124:127], a[236:239], a[204:207], v[124:127]
v_mfma_f32_16x16x32_bf16 v[120:123], a[232:235], a[192:195], v[120:123]
v_mfma_f32_16x16x32_bf16 v[120:123], a[236:239], a[196:199], v[120:123]
s_add_u32 m0, s34, 149504
v_mfma_f32_16x16x32_bf16 v[116:119], a[232:235], a[184:187], v[116:119]
buffer_load_dwordx4 v254, s[12:15], s32 offen sc1 lds
v_mfma_f32_16x16x32_bf16 v[116:119], a[236:239], a[188:191], v[116:119]
v_mfma_f32_16x16x32_bf16 v[112:115], a[232:235], a[176:179], v[112:115]
s_add_u32 s32, s32, 1024
v_mfma_f32_16x16x32_bf16 v[112:115], a[236:239], a[180:183], v[112:115]
v_mfma_f32_16x16x32_bf16 v[108:111], a[232:235], a[168:171], v[108:111]
v_mfma_f32_16x16x32_bf16 v[108:111], a[236:239], a[172:175], v[108:111]
v_mfma_f32_16x16x32_bf16 v[104:107], a[232:235], a[160:163], v[104:107]
ds_read_b128 v[248:251], v255 offset:30720
v_mfma_f32_16x16x32_bf16 v[104:107], a[236:239], a[164:167], v[104:107]
v_mfma_f32_16x16x32_bf16 v[100:103], a[232:235], a[152:155], v[100:103]
v_mfma_f32_16x16x32_bf16 v[100:103], a[236:239], a[156:159], v[100:103]
v_mfma_f32_16x16x32_bf16 v[96:99], a[232:235], a[144:147], v[96:99]
buffer_load_dwordx4 a[232:235], v254, s[8:11], s20 offen offset:1024
v_mfma_f32_16x16x32_bf16 v[96:99], a[236:239], a[148:151], v[96:99]
s_waitcnt vmcnt(11)
v_mfma_f32_16x16x32_bf16 v[128:131], a[240:243], a[144:147], v[128:131]
buffer_load_dwordx4 a[236:239], v254, s[8:11], s20 offen offset:2048
v_mfma_f32_16x16x32_bf16 v[128:131], a[244:247], a[148:151], v[128:131]
v_mfma_f32_16x16x32_bf16 v[132:135], a[240:243], a[152:155], v[132:135]
v_mfma_f32_16x16x32_bf16 v[132:135], a[244:247], a[156:159], v[132:135]
s_add_u32 m0, s34, 150528
v_mfma_f32_16x16x32_bf16 v[136:139], a[240:243], a[160:163], v[136:139]
buffer_load_dwordx4 v254, s[12:15], s32 offen sc1 lds
v_mfma_f32_16x16x32_bf16 v[136:139], a[244:247], a[164:167], v[136:139]
s_waitcnt lgkmcnt(0)
buffer_store_dwordx4 v[248:251], v255, s[16:19], s30 offen offset:2048 sc1
v_mfma_f32_16x16x32_bf16 v[140:143], a[240:243], a[168:171], v[140:143]
s_add_u32 s30, s30, 20480
s_add_u32 s32, s32, 13312
v_mfma_f32_16x16x32_bf16 v[140:143], a[244:247], a[172:175], v[140:143]
v_mfma_f32_16x16x32_bf16 v[144:147], a[240:243], a[176:179], v[144:147]
v_mfma_f32_16x16x32_bf16 v[144:147], a[244:247], a[180:183], v[144:147]
v_mfma_f32_16x16x32_bf16 v[148:151], a[240:243], a[184:187], v[148:151]
v_mfma_f32_16x16x32_bf16 v[148:151], a[244:247], a[188:191], v[148:151]
v_mfma_f32_16x16x32_bf16 v[152:155], a[240:243], a[192:195], v[152:155]
v_mfma_f32_16x16x32_bf16 v[152:155], a[244:247], a[196:199], v[152:155]
v_mfma_f32_16x16x32_bf16 v[156:159], a[240:243], a[200:203], v[156:159]
buffer_load_dwordx4 a[240:243], v254, s[8:11], s20 offen offset:3072
v_mfma_f32_16x16x32_bf16 v[156:159], a[244:247], a[204:207], v[156:159]
s_waitcnt vmcnt(13)
s_add_u32 s20, s20, 4096
v_mfma_f32_16x16x32_bf16 v[188:191], a[248:251], a[200:203], v[188:191]
buffer_load_dwordx4 a[244:247], v254, s[8:11], s20 offen offset:0
v_mfma_f32_16x16x32_bf16 v[188:191], a[208:211], a[204:207], v[188:191]
v_mfma_f32_16x16x32_bf16 v[184:187], a[248:251], a[192:195], v[184:187]
v_mfma_f32_16x16x32_bf16 v[184:187], a[208:211], a[196:199], v[184:187]
v_mfma_f32_16x16x32_bf16 v[180:183], a[248:251], a[184:187], v[180:183]
v_mfma_f32_16x16x32_bf16 v[180:183], a[208:211], a[188:191], v[180:183]
v_mfma_f32_16x16x32_bf16 v[176:179], a[248:251], a[176:179], v[176:179]
v_mfma_f32_16x16x32_bf16 v[176:179], a[208:211], a[180:183], v[176:179]
v_mfma_f32_16x16x32_bf16 v[172:175], a[248:251], a[168:171], v[172:175]
v_mfma_f32_16x16x32_bf16 v[172:175], a[208:211], a[172:175], v[172:175]
v_mfma_f32_16x16x32_bf16 v[168:171], a[248:251], a[160:163], v[168:171]
ds_read_b128 v[248:251], v255 offset:16896
v_mfma_f32_16x16x32_bf16 v[168:171], a[208:211], a[164:167], v[168:171]
v_mfma_f32_16x16x32_bf16 v[164:167], a[248:251], a[152:155], v[164:167]
v_mfma_f32_16x16x32_bf16 v[164:167], a[208:211], a[156:159], v[164:167]
v_mfma_f32_16x16x32_bf16 v[160:163], a[248:251], a[144:147], v[160:163]
buffer_load_dwordx4 a[248:251], v254, s[8:11], s20 offen offset:1024
v_mfma_f32_16x16x32_bf16 v[160:163], a[208:211], a[148:151], v[160:163]
s_waitcnt vmcnt(11)
v_mfma_f32_16x16x32_bf16 v[192:195], a[212:215], a[144:147], v[192:195]
buffer_load_dwordx4 a[208:211], v254, s[8:11], s20 offen offset:2048
v_mfma_f32_16x16x32_bf16 v[192:195], a[216:219], a[148:151], v[192:195]
v_mfma_f32_16x16x32_bf16 v[196:199], a[212:215], a[152:155], v[196:199]
v_mfma_f32_16x16x32_bf16 v[196:199], a[216:219], a[156:159], v[196:199]
v_mfma_f32_16x16x32_bf16 v[200:203], a[212:215], a[160:163], v[200:203]
v_mfma_f32_16x16x32_bf16 v[200:203], a[216:219], a[164:167], v[200:203]
s_waitcnt lgkmcnt(0)
buffer_store_dwordx4 v[248:251], v255, s[16:19], s30 offen offset:0 sc1
v_mfma_f32_16x16x32_bf16 v[204:207], a[212:215], a[168:171], v[204:207]
v_mfma_f32_16x16x32_bf16 v[204:207], a[216:219], a[172:175], v[204:207]
v_mfma_f32_16x16x32_bf16 v[208:211], a[212:215], a[176:179], v[208:211]
v_mfma_f32_16x16x32_bf16 v[208:211], a[216:219], a[180:183], v[208:211]
v_mfma_f32_16x16x32_bf16 v[212:215], a[212:215], a[184:187], v[212:215]
v_mfma_f32_16x16x32_bf16 v[212:215], a[216:219], a[188:191], v[212:215]
v_mfma_f32_16x16x32_bf16 v[216:219], a[212:215], a[192:195], v[216:219]
v_mfma_f32_16x16x32_bf16 v[216:219], a[216:219], a[196:199], v[216:219]
v_mfma_f32_16x16x32_bf16 v[220:223], a[212:215], a[200:203], v[220:223]
buffer_load_dwordx4 a[212:215], v254, s[8:11], s20 offen offset:3072
v_mfma_f32_16x16x32_bf16 v[220:223], a[216:219], a[204:207], v[220:223]
s_waitcnt vmcnt(12)
s_add_u32 s20, s20, 4096
v_mfma_f32_16x16x32_bf16 a[12:15], a[220:223], a[200:203], a[12:15]
ds_read_b128 a[200:203], v252 offset:30720
v_mfma_f32_16x16x32_bf16 a[12:15], a[224:227], a[204:207], a[12:15]
ds_read_b128 a[204:207], v252 offset:31232
v_mfma_f32_16x16x32_bf16 a[8:11], a[220:223], a[192:195], a[8:11]
ds_read_b128 a[192:195], v252 offset:28672
v_mfma_f32_16x16x32_bf16 a[8:11], a[224:227], a[196:199], a[8:11]
ds_read_b128 a[196:199], v252 offset:29184
v_mfma_f32_16x16x32_bf16 a[4:7], a[220:223], a[184:187], a[4:7]
ds_read_b128 a[184:187], v252 offset:26624
v_mfma_f32_16x16x32_bf16 a[4:7], a[224:227], a[188:191], a[4:7]
ds_read_b128 a[188:191], v252 offset:27136
v_mfma_f32_16x16x32_bf16 a[0:3], a[220:223], a[176:179], a[0:3]
ds_read_b128 a[176:179], v252 offset:24576
v_mfma_f32_16x16x32_bf16 a[0:3], a[224:227], a[180:183], a[0:3]
ds_read_b128 a[180:183], v252 offset:25088
v_mfma_f32_16x16x32_bf16 v[236:239], a[220:223], a[168:171], v[236:239]
ds_read_b128 a[168:171], v252 offset:22528
v_mfma_f32_16x16x32_bf16 v[236:239], a[224:227], a[172:175], v[236:239]
ds_read_b128 a[172:175], v252 offset:23040
v_mfma_f32_16x16x32_bf16 v[232:235], a[220:223], a[160:163], v[232:235]
ds_read_b128 a[160:163], v252 offset:20480
v_mfma_f32_16x16x32_bf16 v[232:235], a[224:227], a[164:167], v[232:235]
ds_read_b128 a[164:167], v252 offset:20992
v_mfma_f32_16x16x32_bf16 v[228:231], a[220:223], a[152:155], v[228:231]
ds_read_b128 a[152:155], v252 offset:18432
v_mfma_f32_16x16x32_bf16 v[228:231], a[224:227], a[156:159], v[228:231]
ds_read_b128 a[156:159], v252 offset:18944
v_mfma_f32_16x16x32_bf16 v[224:227], a[220:223], a[144:147], v[224:227]
ds_read_b128 a[144:147], v252 offset:16384
v_mfma_f32_16x16x32_bf16 v[224:227], a[224:227], a[148:151], v[224:227]
s_waitcnt vmcnt(9) lgkmcnt(11)
ds_read_b128 a[148:151], v252 offset:16896
v_mfma_f32_16x16x32_bf16 v[28:31], a[228:231], a[200:203], v[28:31]
buffer_load_dwordx4 a[220:223], v254, s[8:11], s20 offen offset:0
v_mfma_f32_16x16x32_bf16 v[28:31], a[232:235], a[204:207], v[28:31]
v_mfma_f32_16x16x32_bf16 v[24:27], a[228:231], a[192:195], v[24:27]
buffer_load_dwordx4 a[224:227], v254, s[8:11], s20 offen offset:1024
v_mfma_f32_16x16x32_bf16 v[24:27], a[232:235], a[196:199], v[24:27]
s_waitcnt lgkmcnt(8)
v_mfma_f32_16x16x32_bf16 v[20:23], a[228:231], a[184:187], v[20:23]
v_mfma_f32_16x16x32_bf16 v[20:23], a[232:235], a[188:191], v[20:23]
v_mfma_f32_16x16x32_bf16 v[16:19], a[228:231], a[176:179], v[16:19]
v_mfma_f32_16x16x32_bf16 v[16:19], a[232:235], a[180:183], v[16:19]
s_waitcnt lgkmcnt(4)
v_mfma_f32_16x16x32_bf16 v[12:15], a[228:231], a[168:171], v[12:15]
v_mfma_f32_16x16x32_bf16 v[12:15], a[232:235], a[172:175], v[12:15]
v_mfma_f32_16x16x32_bf16 v[8:11], a[228:231], a[160:163], v[8:11]
ds_read_b128 v[248:251], v255 offset:18944
v_mfma_f32_16x16x32_bf16 v[8:11], a[232:235], a[164:167], v[8:11]
s_waitcnt lgkmcnt(1)
buffer_load_dword a255, v254, s[60:63], 0 offen sc1
v_mfma_f32_16x16x32_bf16 v[4:7], a[228:231], a[152:155], v[4:7]
v_mfma_f32_16x16x32_bf16 v[4:7], a[232:235], a[156:159], v[4:7]
v_mfma_f32_16x16x32_bf16 v[0:3], a[228:231], a[144:147], v[0:3]
buffer_load_dwordx4 a[228:231], v254, s[8:11], s20 offen offset:2048
v_mfma_f32_16x16x32_bf16 v[0:3], a[232:235], a[148:151], v[0:3]
s_waitcnt vmcnt(9)
v_mfma_f32_16x16x32_bf16 v[32:35], a[236:239], a[144:147], v[32:35]
buffer_load_dwordx4 a[232:235], v254, s[8:11], s20 offen offset:3072
v_mfma_f32_16x16x32_bf16 v[32:35], a[240:243], a[148:151], v[32:35]
s_add_u32 s20, s20, 4096
v_mfma_f32_16x16x32_bf16 v[36:39], a[236:239], a[152:155], v[36:39]
v_mfma_f32_16x16x32_bf16 v[36:39], a[240:243], a[156:159], v[36:39]
v_mfma_f32_16x16x32_bf16 v[40:43], a[236:239], a[160:163], v[40:43]
v_mfma_f32_16x16x32_bf16 v[40:43], a[240:243], a[164:167], v[40:43]
s_waitcnt lgkmcnt(0)
v_mfma_f32_32x32x16_bf16 v[176:191], v[244:247], v[240:243], v[176:191]
buffer_store_dwordx4 v[248:251], v255, s[16:19], s30 offen offset:2048 sc1
v_mfma_f32_16x16x32_bf16 v[44:47], a[236:239], a[168:171], v[44:47]
s_add_u32 s30, s30, 4096
s_add_u32 s36, s36, 1
v_mfma_f32_16x16x32_bf16 v[44:47], a[240:243], a[172:175], v[44:47]
v_mov_b32 v248, s36
v_mfma_f32_16x16x32_bf16 v[48:51], a[236:239], a[176:179], v[48:51]
buffer_store_dword v248, off, s[8:11], s23 sc1
v_mfma_f32_16x16x32_bf16 v[48:51], a[240:243], a[180:183], v[48:51]
v_mfma_f32_16x16x32_bf16 v[52:55], a[236:239], a[184:187], v[52:55]
v_mfma_f32_16x16x32_bf16 v[52:55], a[240:243], a[188:191], v[52:55]
v_mfma_f32_16x16x32_bf16 v[56:59], a[236:239], a[192:195], v[56:59]
v_mfma_f32_16x16x32_bf16 v[56:59], a[240:243], a[196:199], v[56:59]
v_mfma_f32_16x16x32_bf16 v[60:63], a[236:239], a[200:203], v[60:63]
buffer_load_dwordx4 a[236:239], v254, s[8:11], s20 offen offset:0
v_mfma_f32_16x16x32_bf16 v[60:63], a[240:243], a[204:207], v[60:63]
s_waitcnt vmcnt(11)
v_mfma_f32_16x16x32_bf16 v[92:95], a[244:247], a[200:203], v[92:95]
buffer_load_dwordx4 a[240:243], v254, s[8:11], s20 offen offset:1024
v_mfma_f32_16x16x32_bf16 v[92:95], a[248:251], a[204:207], v[92:95]
v_mfma_f32_16x16x32_bf16 v[88:91], a[244:247], a[192:195], v[88:91]
v_mfma_f32_16x16x32_bf16 v[88:91], a[248:251], a[196:199], v[88:91]
v_mfma_f32_16x16x32_bf16 v[84:87], a[244:247], a[184:187], v[84:87]
v_mfma_f32_16x16x32_bf16 v[84:87], a[248:251], a[188:191], v[84:87]
v_mfma_f32_16x16x32_bf16 v[80:83], a[244:247], a[176:179], v[80:83]
v_mfma_f32_16x16x32_bf16 v[80:83], a[248:251], a[180:183], v[80:83]
v_accvgpr_read_b32 v243, a254
v_mfma_f32_16x16x32_bf16 v[76:79], a[244:247], a[168:171], v[76:79]
v_mov_b32 v242, 0
v_mfma_f32_16x16x32_bf16 v[76:79], a[248:251], a[172:175], v[76:79]
v_mfma_f32_16x16x32_bf16 v[72:75], a[244:247], a[160:163], v[72:75]
ds_read_b128 v[248:251], v255 offset:20992
v_mfma_f32_16x16x32_bf16 v[72:75], a[248:251], a[164:167], v[72:75]
v_mfma_f32_16x16x32_bf16 v[68:71], a[244:247], a[152:155], v[68:71]
v_mfma_f32_16x16x32_bf16 v[68:71], a[248:251], a[156:159], v[68:71]
v_mfma_f32_16x16x32_bf16 v[64:67], a[244:247], a[144:147], v[64:67]
buffer_load_dwordx4 a[244:247], v254, s[8:11], s20 offen offset:2048
v_mfma_f32_16x16x32_bf16 v[64:67], a[248:251], a[148:151], v[64:67]
s_waitcnt vmcnt(10)
v_mfma_f32_16x16x32_bf16 v[96:99], a[208:211], a[144:147], v[96:99]
buffer_load_dwordx4 a[248:251], v254, s[8:11], s20 offen offset:3072
v_mfma_f32_16x16x32_bf16 v[96:99], a[212:215], a[148:151], v[96:99]
s_add_u32 s20, s20, 4096
v_mfma_f32_16x16x32_bf16 v[100:103], a[208:211], a[152:155], v[100:103]
v_mfma_f32_16x16x32_bf16 v[100:103], a[212:215], a[156:159], v[100:103]
v_mfma_f32_16x16x32_bf16 v[104:107], a[208:211], a[160:163], v[104:107]
v_mfma_f32_16x16x32_bf16 v[104:107], a[212:215], a[164:167], v[104:107]
s_waitcnt lgkmcnt(0)
v_mfma_f32_32x32x16_bf16 v[192:207], v[244:247], v[240:243], v[192:207]
buffer_store_dwordx4 v[248:251], v255, s[16:19], s30 offen offset:0 sc1
v_mfma_f32_16x16x32_bf16 v[108:111], a[208:211], a[168:171], v[108:111]
v_mfma_f32_16x16x32_bf16 v[108:111], a[212:215], a[172:175], v[108:111]
v_mfma_f32_16x16x32_bf16 v[112:115], a[208:211], a[176:179], v[112:115]
v_mfma_f32_16x16x32_bf16 v[112:115], a[212:215], a[180:183], v[112:115]
v_mfma_f32_16x16x32_bf16 v[116:119], a[208:211], a[184:187], v[116:119]
ds_read_b128 v[248:251], v255 offset:23040
v_mfma_f32_16x16x32_bf16 v[116:119], a[212:215], a[188:191], v[116:119]
v_mfma_f32_16x16x32_bf16 v[120:123], a[208:211], a[192:195], v[120:123]
s_barrier
v_mfma_f32_16x16x32_bf16 v[120:123], a[212:215], a[196:199], v[120:123]
v_mfma_f32_16x16x32_bf16 v[124:127], a[208:211], a[200:203], v[124:127]
buffer_load_dwordx4 a[208:211], v254, s[8:11], s20 offen offset:0
v_mfma_f32_16x16x32_bf16 v[124:127], a[212:215], a[204:207], v[124:127]
s_waitcnt vmcnt(11)
v_mfma_f32_16x16x32_bf16 v[156:159], a[220:223], a[200:203], v[156:159]
buffer_load_dwordx4 a[212:215], v254, s[8:11], s20 offen offset:1024
v_mfma_f32_16x16x32_bf16 v[156:159], a[224:227], a[204:207], v[156:159]
v_mfma_f32_16x16x32_bf16 v[152:155], a[220:223], a[192:195], v[152:155]
buffer_load_dwordx4 a[216:219], v254, s[8:11], s20 offen offset:2048
v_mfma_f32_16x16x32_bf16 v[152:155], a[224:227], a[196:199], v[152:155]
v_mfma_f32_16x16x32_bf16 v[148:151], a[220:223], a[184:187], v[148:151]
v_mfma_f32_16x16x32_bf16 v[148:151], a[224:227], a[188:191], v[148:151]
s_waitcnt lgkmcnt(0)
v_mfma_f32_32x32x16_bf16 v[208:223], v[244:247], v[240:243], v[208:223]
buffer_store_dwordx4 v[248:251], v255, s[16:19], s30 offen offset:2048 sc1
v_mfma_f32_16x16x32_bf16 v[144:147], a[220:223], a[176:179], v[144:147]
s_add_u32 s30, s30, 4096
s_add_u32 s35, s35, 1
v_mfma_f32_16x16x32_bf16 v[144:147], a[224:227], a[180:183], v[144:147]
s_waitcnt vmcnt(13)
v_accvgpr_read_b32 v249, a255
v_mfma_f32_16x16x32_bf16 v[140:143], a[220:223], a[168:171], v[140:143]
v_cmp_le_u32 vcc, s35, v249
v_mfma_f32_16x16x32_bf16 v[140:143], a[224:227], a[172:175], v[140:143]
s_and_b32 s42, vcc_lo, 15
s_cmp_eq_u32 s42, 15
s_cbranch_scc0 L_spinBx1
L_retBx1:
v_mfma_f32_16x16x32_bf16 v[136:139], a[220:223], a[160:163], v[136:139]
v_mfma_f32_16x16x32_bf16 v[136:139], a[224:227], a[164:167], v[136:139]
v_mfma_f32_16x16x32_bf16 v[132:135], a[220:223], a[152:155], v[132:135]
v_mfma_f32_16x16x32_bf16 v[132:135], a[224:227], a[156:159], v[132:135]
v_mfma_f32_16x16x32_bf16 v[128:131], a[220:223], a[144:147], v[128:131]
buffer_load_dwordx4 a[220:223], v254, s[8:11], s20 offen offset:3072
v_mfma_f32_16x16x32_bf16 v[128:131], a[224:227], a[148:151], v[128:131]
s_waitcnt vmcnt(12)
s_add_u32 s20, s20, 4096
v_mfma_f32_16x16x32_bf16 v[160:163], a[228:231], a[144:147], v[160:163]
buffer_load_dwordx4 a[224:227], v254, s[8:11], s20 offen offset:0
v_mfma_f32_16x16x32_bf16 v[160:163], a[232:235], a[148:151], v[160:163]
v_mfma_f32_16x16x32_bf16 v[164:167], a[228:231], a[152:155], v[164:167]
v_mfma_f32_16x16x32_bf16 v[164:167], a[232:235], a[156:159], v[164:167]
s_add_u32 m0, s34, 0
v_mfma_f32_16x16x32_bf16 v[168:171], a[228:231], a[160:163], v[168:171]
buffer_load_dwordx4 v254, s[12:15], s32 offen sc1 lds
v_mfma_f32_16x16x32_bf16 v[168:171], a[232:235], a[164:167], v[168:171]
v_mfma_f32_16x16x32_bf16 v[172:175], a[228:231], a[168:171], v[172:175]
s_add_u32 s32, s32, 1024
v_mfma_f32_16x16x32_bf16 v[172:175], a[232:235], a[172:175], v[172:175]
v_add_u32 v252, 0x20000, v253
v_mfma_f32_16x16x32_bf16 v[176:179], a[228:231], a[176:179], v[176:179]
v_mfma_f32_16x16x32_bf16 v[176:179], a[232:235], a[180:183], v[176:179]
v_mfma_f32_16x16x32_bf16 v[180:183], a[228:231], a[184:187], v[180:183]
ds_read_b128 v[248:251], v255 offset:25088
v_mfma_f32_16x16x32_bf16 v[180:183], a[232:235], a[188:191], v[180:183]
v_mfma_f32_16x16x32_bf16 v[184:187], a[228:231], a[192:195], v[184:187]
v_mfma_f32_16x16x32_bf16 v[184:187], a[232:235], a[196:199], v[184:187]
v_mfma_f32_16x16x32_bf16 v[188:191], a[228:231], a[200:203], v[188:191]
buffer_load_dwordx4 a[228:231], v254, s[8:11], s20 offen offset:1024
v_mfma_f32_16x16x32_bf16 v[188:191], a[232:235], a[204:207], v[188:191]
s_waitcnt vmcnt(11)
v_mfma_f32_16x16x32_bf16 v[220:223], a[236:239], a[200:203], v[220:223]
buffer_load_dwordx4 a[232:235], v254, s[8:11], s20 offen offset:2048
v_mfma_f32_16x16x32_bf16 v[220:223], a[240:243], a[204:207], v[220:223]
v_mfma_f32_16x16x32_bf16 v[216:219], a[236:239], a[192:195], v[216:219]
v_mfma_f32_16x16x32_bf16 v[216:219], a[240:243], a[196:199], v[216:219]
s_add_u32 m0, s34, 1024
v_mfma_f32_16x16x32_bf16 v[212:215], a[236:239], a[184:187], v[212:215]
buffer_load_dwordx4 v254, s[12:15], s32 offen sc1 lds
v_mfma_f32_16x16x32_bf16 v[212:215], a[240:243], a[188:191], v[212:215]
s_waitcnt lgkmcnt(0)
buffer_store_dwordx4 v[248:251], v255, s[16:19], s30 offen offset:0 sc1
v_mfma_f32_16x16x32_bf16 v[208:211], a[236:239], a[176:179], v[208:211]
s_add_u32 s32, s32, 1024
v_mfma_f32_16x16x32_bf16 v[208:211], a[240:243], a[180:183], v[208:211]
v_mfma_f32_16x16x32_bf16 v[204:207], a[236:239], a[168:171], v[204:207]
v_mfma_f32_16x16x32_bf16 v[204:207], a[240:243], a[172:175], v[204:207]
v_mfma_f32_16x16x32_bf16 v[200:203], a[236:239], a[160:163], v[200:203]
v_mfma_f32_16x16x32_bf16 v[200:203], a[240:243], a[164:167], v[200:203]
v_mfma_f32_16x16x32_bf16 v[196:199], a[236:239], a[152:155], v[196:199]
v_mfma_f32_16x16x32_bf16 v[196:199], a[240:243], a[156:159], v[196:199]
v_mfma_f32_16x16x32_bf16 v[192:195], a[236:239], a[144:147], v[192:195]
buffer_load_dwordx4 a[236:239], v254, s[8:11], s20 offen offset:3072
v_mfma_f32_16x16x32_bf16 v[192:195], a[240:243], a[148:151], v[192:195]
s_waitcnt vmcnt(13)
s_add_u32 s20, s20, 4096
buffer_load_dwordx4 a[240:243], v254, s[8:11], s20 offen offset:0
v_mfma_f32_16x16x32_bf16 v[224:227], a[244:247], a[144:147], v[224:227]
ds_read_b128 a[144:147], v252 offset:0
v_mfma_f32_16x16x32_bf16 v[224:227], a[248:251], a[148:151], v[224:227]
ds_read_b128 a[148:151], v252 offset:512
v_mfma_f32_16x16x32_bf16 v[228:231], a[244:247], a[152:155], v[228:231]
ds_read_b128 a[152:155], v252 offset:2048
v_mfma_f32_16x16x32_bf16 v[228:231], a[248:251], a[156:159], v[228:231]
ds_read_b128 a[156:159], v252 offset:2560
v_mfma_f32_16x16x32_bf16 v[232:235], a[244:247], a[160:163], v[232:235]
ds_read_b128 a[160:163], v252 offset:4096
v_mfma_f32_16x16x32_bf16 v[232:235], a[248:251], a[164:167], v[232:235]
ds_read_b128 a[164:167], v252 offset:4608
v_mfma_f32_16x16x32_bf16 v[236:239], a[244:247], a[168:171], v[236:239]
ds_read_b128 a[168:171], v252 offset:6144
v_mfma_f32_16x16x32_bf16 v[236:239], a[248:251], a[172:175], v[236:239]
ds_read_b128 a[172:175], v252 offset:6656
v_mfma_f32_16x16x32_bf16 a[0:3], a[244:247], a[176:179], a[0:3]
ds_read_b128 a[176:179], v252 offset:8192
v_mfma_f32_16x16x32_bf16 a[0:3], a[248:251], a[180:183], a[0:3]
ds_read_b128 a[180:183], v252 offset:8704
v_mfma_f32_16x16x32_bf16 a[4:7], a[244:247], a[184:187], a[4:7]
ds_read_b128 a[184:187], v252 offset:10240
v_mfma_f32_16x16x32_bf16 a[4:7], a[248:251], a[188:191], a[4:7]
ds_read_b128 a[188:191], v252 offset:10752
v_mfma_f32_16x16x32_bf16 a[8:11], a[244:247], a[192:195], a[8:11]
ds_read_b128 a[192:195], v252 offset:12288
v_mfma_f32_16x16x32_bf16 a[8:11], a[248:251], a[196:199], a[8:11]
ds_read_b128 a[196:199], v252 offset:12800
v_mfma_f32_16x16x32_bf16 a[12:15], a[244:247], a[200:203], a[12:15]
ds_read_b128 a[200:203], v252 offset:14336
v_mfma_f32_16x16x32_bf16 a[12:15], a[248:251], a[204:207], a[12:15]
s_waitcnt vmcnt(11) lgkmcnt(11)
ds_read_b128 a[204:207], v252 offset:14848
v_mfma_f32_16x16x32_bf16 v[0:3], a[208:211], a[144:147], v[0:3]
buffer_load_dwordx4 a[244:247], v254, s[8:11], s20 offen offset:1024
v_mfma_f32_16x16x32_bf16 v[0:3], a[212:215], a[148:151], v[0:3]
v_mfma_f32_16x16x32_bf16 v[4:7], a[208:211], a[152:155], v[4:7]
buffer_load_dwordx4 a[248:251], v254, s[8:11], s20 offen offset:2048
v_mfma_f32_16x16x32_bf16 v[4:7], a[212:215], a[156:159], v[4:7]
s_waitcnt lgkmcnt(8)
v_mfma_f32_16x16x32_bf16 v[8:11], a[208:211], a[160:163], v[8:11]
v_mfma_f32_16x16x32_bf16 v[8:11], a[212:215], a[164:167], v[8:11]
v_mfma_f32_16x16x32_bf16 v[12:15], a[208:211], a[168:171], v[12:15]
v_mfma_f32_16x16x32_bf16 v[12:15], a[212:215], a[172:175], v[12:15]
s_waitcnt lgkmcnt(4)
v_lshlrev_b32 v243, 16, v243
v_mfma_f32_16x16x32_bf16 v[16:19], a[208:211], a[176:179], v[16:19]
v_mfma_f32_16x16x32_bf16 v[16:19], a[212:215], a[180:183], v[16:19]
v_mfma_f32_16x16x32_bf16 v[20:23], a[208:211], a[184:187], v[20:23]
ds_read_b128 v[248:251], v255 offset:27136
v_mfma_f32_16x16x32_bf16 v[20:23], a[212:215], a[188:191], v[20:23]
s_waitcnt lgkmcnt(1)
v_mfma_f32_16x16x32_bf16 v[24:27], a[208:211], a[192:195], v[24:27]
v_mfma_f32_16x16x32_bf16 v[24:27], a[212:215], a[196:199], v[24:27]
v_mfma_f32_16x16x32_bf16 v[28:31], a[208:211], a[200:203], v[28:31]
buffer_load_dwordx4 a[208:211], v254, s[8:11], s20 offen offset:3072
v_mfma_f32_16x16x32_bf16 v[28:31], a[212:215], a[204:207], v[28:31]
s_waitcnt vmcnt(11)
s_add_u32 s20, s20, 4096
v_mfma_f32_16x16x32_bf16 v[60:63], a[216:219], a[200:203], v[60:63]
buffer_load_dwordx4 a[212:215], v254, s[8:11], s20 offen offset:0
v_mfma_f32_16x16x32_bf16 v[60:63], a[220:223], a[204:207], v[60:63]
v_mfma_f32_16x16x32_bf16 v[56:59], a[216:219], a[192:195], v[56:59]
v_mfma_f32_16x16x32_bf16 v[56:59], a[220:223], a[196:199], v[56:59]
s_add_u32 m0, s34, 2048
v_mfma_f32_16x16x32_bf16 v[52:55], a[216:219], a[184:187], v[52:55]
buffer_load_dwordx4 v254, s[12:15], s32 offen sc1 lds
v_mfma_f32_16x16x32_bf16 v[52:55], a[220:223], a[188:191], v[52:55]
s_waitcnt lgkmcnt(0)
v_mfma_f32_32x32x16_bf16 v[224:239], v[244:247], v[240:243], v[224:239]
buffer_store_dwordx4 v[248:251], v255, s[16:19], s30 offen offset:2048 sc1
v_mfma_f32_16x16x32_bf16 v[48:51], a[216:219], a[176:179], v[48:51]
s_add_u32 s30, s30, 4096
s_add_u32 s32, s32, 1024
v_mfma_f32_16x16x32_bf16 v[48:51], a[220:223], a[180:183], v[48:51]
v_mfma_f32_16x16x32_bf16 v[44:47], a[216:219], a[168:171], v[44:47]
v_mfma_f32_16x16x32_bf16 v[44:47], a[220:223], a[172:175], v[44:47]
v_mfma_f32_16x16x32_bf16 v[40:43], a[216:219], a[160:163], v[40:43]
v_mfma_f32_16x16x32_bf16 v[40:43], a[220:223], a[164:167], v[40:43]
v_mfma_f32_16x16x32_bf16 v[36:39], a[216:219], a[152:155], v[36:39]
v_mfma_f32_16x16x32_bf16 v[36:39], a[220:223], a[156:159], v[36:39]
v_mfma_f32_16x16x32_bf16 v[32:35], a[216:219], a[144:147], v[32:35]
buffer_load_dwordx4 a[216:219], v254, s[8:11], s20 offen offset:1024
v_mfma_f32_16x16x32_bf16 v[32:35], a[220:223], a[148:151], v[32:35]
s_waitcnt vmcnt(12)
v_mfma_f32_16x16x32_bf16 v[64:67], a[224:227], a[144:147], v[64:67]
buffer_load_dwordx4 a[220:223], v254, s[8:11], s20 offen offset:2048
v_mfma_f32_16x16x32_bf16 v[64:67], a[228:231], a[148:151], v[64:67]
v_mfma_f32_16x16x32_bf16 v[68:71], a[224:227], a[152:155], v[68:71]
v_mfma_f32_16x16x32_bf16 v[68:71], a[228:231], a[156:159], v[68:71]
v_mfma_f32_16x16x32_bf16 v[72:75], a[224:227], a[160:163], v[72:75]
v_mfma_f32_16x16x32_bf16 v[72:75], a[228:231], a[164:167], v[72:75]
v_mfma_f32_16x16x32_bf16 v[76:79], a[224:227], a[168:171], v[76:79]
v_mfma_f32_16x16x32_bf16 v[76:79], a[228:231], a[172:175], v[76:79]
v_mfma_f32_16x16x32_bf16 v[80:83], a[224:227], a[176:179], v[80:83]
v_mfma_f32_16x16x32_bf16 v[80:83], a[228:231], a[180:183], v[80:83]
v_mfma_f32_16x16x32_bf16 v[84:87], a[224:227], a[184:187], v[84:87]
ds_read_b128 v[248:251], v255 offset:29184
v_mfma_f32_16x16x32_bf16 v[84:87], a[228:231], a[188:191], v[84:87]
v_mfma_f32_16x16x32_bf16 v[88:91], a[224:227], a[192:195], v[88:91]
v_mfma_f32_16x16x32_bf16 v[88:91], a[228:231], a[196:199], v[88:91]
v_mfma_f32_16x16x32_bf16 v[92:95], a[224:227], a[200:203], v[92:95]
buffer_load_dwordx4 a[224:227], v254, s[8:11], s20 offen offset:3072
v_mfma_f32_16x16x32_bf16 v[92:95], a[228:231], a[204:207], v[92:95]
s_waitcnt vmcnt(10)
s_add_u32 s20, s20, 4096
v_mfma_f32_16x16x32_bf16 v[124:127], a[232:235], a[200:203], v[124:127]
buffer_load_dwordx4 a[228:231], v254, s[8:11], s20 offen offset:0
v_mfma_f32_16x16x32_bf16 v[124:127], a[236:239], a[204:207], v[124:127]
v_mfma_f32_16x16x32_bf16 v[120:123], a[232:235], a[192:195], v[120:123]
v_mfma_f32_16x16x32_bf16 v[120:123], a[236:239], a[196:199], v[120:123]
s_add_u32 m0, s34, 3072
v_mfma_f32_16x16x32_bf16 v[116:119], a[232:235], a[184:187], v[116:119]
buffer_load_dwordx4 v254, s[12:15], s32 offen sc1 lds
v_mfma_f32_16x16x32_bf16 v[116:119], a[236:239], a[188:191], v[116:119]
s_waitcnt lgkmcnt(0)
v_mfma_f32_32x32x16_bf16 a[0:15], v[244:247], v[240:243], a[0:15]
buffer_store_dwordx4 v[248:251], v255, s[16:19], s30 offen offset:0 sc1
v_mfma_f32_16x16x32_bf16 v[112:115], a[232:235], a[176:179], v[112:115]
s_add_u32 s32, s32, 13312
v_mfma_f32_16x16x32_bf16 v[112:115], a[236:239], a[180:183], v[112:115]
v_mfma_f32_16x16x32_bf16 v[108:111], a[232:235], a[168:171], v[108:111]
v_mfma_f32_16x16x32_bf16 v[108:111], a[236:239], a[172:175], v[108:111]
v_mfma_f32_16x16x32_bf16 v[104:107], a[232:235], a[160:163], v[104:107]
v_mfma_f32_16x16x32_bf16 v[104:107], a[236:239], a[164:167], v[104:107]
v_mfma_f32_16x16x32_bf16 v[100:103], a[232:235], a[152:155], v[100:103]
v_mfma_f32_16x16x32_bf16 v[100:103], a[236:239], a[156:159], v[100:103]
v_mfma_f32_16x16x32_bf16 v[96:99], a[232:235], a[144:147], v[96:99]
buffer_load_dwordx4 a[232:235], v254, s[8:11], s20 offen offset:1024
v_mfma_f32_16x16x32_bf16 v[96:99], a[236:239], a[148:151], v[96:99]
s_waitcnt vmcnt(12)
v_mfma_f32_16x16x32_bf16 v[128:131], a[240:243], a[144:147], v[128:131]
buffer_load_dwordx4 a[236:239], v254, s[8:11], s20 offen offset:2048
v_mfma_f32_16x16x32_bf16 v[128:131], a[244:247], a[148:151], v[128:131]
v_mfma_f32_16x16x32_bf16 v[132:135], a[240:243], a[152:155], v[132:135]
v_mfma_f32_16x16x32_bf16 v[132:135], a[244:247], a[156:159], v[132:135]
s_add_u32 m0, s34, 32768
v_mfma_f32_16x16x32_bf16 v[136:139], a[240:243], a[160:163], v[136:139]
buffer_load_dwordx4 v254, s[12:15], s32 offen sc1 lds
v_mfma_f32_16x16x32_bf16 v[136:139], a[244:247], a[164:167], v[136:139]
v_mfma_f32_16x16x32_bf16 v[140:143], a[240:243], a[168:171], v[140:143]
s_add_u32 s32, s32, 1024
v_mfma_f32_16x16x32_bf16 v[140:143], a[244:247], a[172:175], v[140:143]
v_mfma_f32_16x16x32_bf16 v[144:147], a[240:243], a[176:179], v[144:147]
v_mfma_f32_16x16x32_bf16 v[144:147], a[244:247], a[180:183], v[144:147]
v_mfma_f32_16x16x32_bf16 v[148:151], a[240:243], a[184:187], v[148:151]
v_mfma_f32_16x16x32_bf16 v[148:151], a[244:247], a[188:191], v[148:151]
v_mfma_f32_16x16x32_bf16 v[152:155], a[240:243], a[192:195], v[152:155]
v_mfma_f32_16x16x32_bf16 v[152:155], a[244:247], a[196:199], v[152:155]
v_mfma_f32_16x16x32_bf16 v[156:159], a[240:243], a[200:203], v[156:159]
buffer_load_dwordx4 a[240:243], v254, s[8:11], s20 offen offset:3072
v_mfma_f32_16x16x32_bf16 v[156:159], a[244:247], a[204:207], v[156:159]
s_waitcnt vmcnt(13)
s_add_u32 s20, s20, 4096
v_mfma_f32_16x16x32_bf16 v[188:191], a[248:251], a[200:203], v[188:191]
buffer_load_dwordx4 a[244:247], v254, s[8:11], s20 offen offset:0
v_mfma_f32_16x16x32_bf16 v[188:191], a[208:211], a[204:207], v[188:191]
v_mfma_f32_16x16x32_bf16 v[184:187], a[248:251], a[192:195], v[184:187]
v_mfma_f32_16x16x32_bf16 v[184:187], a[208:211], a[196:199], v[184:187]
s_add_u32 m0, s34, 33792
v_mfma_f32_16x16x32_bf16 v[180:183], a[248:251], a[184:187], v[180:183]
buffer_load_dwordx4 v254, s[12:15], s32 offen sc1 lds
v_mfma_f32_16x16x32_bf16 v[180:183], a[208:211], a[188:191], v[180:183]
v_mfma_f32_16x16x32_bf16 v[176:179], a[248:251], a[176:179], v[176:179]
s_add_u32 s32, s32, 1024
v_mfma_f32_16x16x32_bf16 v[176:179], a[208:211], a[180:183], v[176:179]
v_mfma_f32_16x16x32_bf16 v[172:175], a[248:251], a[168:171], v[172:175]
v_mfma_f32_16x16x32_bf16 v[172:175], a[208:211], a[172:175], v[172:175]
v_mfma_f32_16x16x32_bf16 v[168:171], a[248:251], a[160:163], v[168:171]
ds_read_b128 v[248:251], v255 offset:31232
v_mfma_f32_16x16x32_bf16 v[168:171], a[208:211], a[164:167], v[168:171]
v_mfma_f32_16x16x32_bf16 v[164:167], a[248:251], a[152:155], v[164:167]
v_mfma_f32_16x16x32_bf16 v[164:167], a[208:211], a[156:159], v[164:167]
v_mfma_f32_16x16x32_bf16 v[160:163], a[248:251], a[144:147], v[160:163]
buffer_load_dwordx4 a[248:251], v254, s[8:11], s20 offen offset:1024
v_mfma_f32_16x16x32_bf16 v[160:163], a[208:211], a[148:151], v[160:163]
s_waitcnt vmcnt(12)
v_mfma_f32_16x16x32_bf16 v[192:195], a[212:215], a[144:147], v[192:195]
buffer_load_dwordx4 a[208:211], v254, s[8:11], s20 offen offset:2048
v_mfma_f32_16x16x32_bf16 v[192:195], a[216:219], a[148:151], v[192:195]
v_mfma_f32_16x16x32_bf16 v[196:199], a[212:215], a[152:155], v[196:199]
v_mfma_f32_16x16x32_bf16 v[196:199], a[216:219], a[156:159], v[196:199]
s_add_u32 m0, s34, 34816
v_mfma_f32_16x16x32_bf16 v[200:203], a[212:215], a[160:163], v[200:203]
buffer_load_dwordx4 v254, s[12:15], s32 offen sc1 lds
v_mfma_f32_16x16x32_bf16 v[200:203], a[216:219], a[164:167], v[200:203]
s_waitcnt lgkmcnt(0)
buffer_store_dwordx4 v[248:251], v255, s[16:19], s30 offen offset:2048 sc1
v_mfma_f32_16x16x32_bf16 v[204:207], a[212:215], a[168:171], v[204:207]
s_add_u32 s30, s30, 20480
s_add_u32 s32, s32, 1024
v_mfma_f32_16x16x32_bf16 v[204:207], a[216:219], a[172:175], v[204:207]
v_mfma_f32_16x16x32_bf16 v[208:211], a[212:215], a[176:179], v[208:211]
v_mfma_f32_16x16x32_bf16 v[208:211], a[216:219], a[180:183], v[208:211]
v_mfma_f32_16x16x32_bf16 v[212:215], a[212:215], a[184:187], v[212:215]
v_mfma_f32_16x16x32_bf16 v[212:215], a[216:219], a[188:191], v[212:215]
buffer_load_dword a255, v254, s[60:63], 0 offen sc1
v_mfma_f32_16x16x32_bf16 v[216:219], a[212:215], a[192:195], v[216:219]
v_mfma_f32_16x16x32_bf16 v[216:219], a[216:219], a[196:199], v[216:219]
v_mfma_f32_16x16x32_bf16 v[220:223], a[212:215], a[200:203], v[220:223]
buffer_load_dwordx4 a[212:215], v254, s[8:11], s20 offen offset:3072
v_mfma_f32_16x16x32_bf16 v[220:223], a[216:219], a[204:207], v[220:223]
s_waitcnt vmcnt(15)
s_add_u32 s20, s20, 4096
v_mfma_f32_16x16x32_bf16 a[12:15], a[220:223], a[200:203], a[12:15]
ds_read_b128 a[200:203], v252 offset:30720
v_mfma_f32_16x16x32_bf16 a[12:15], a[224:227], a[204:207], a[12:15]
ds_read_b128 a[204:207], v252 offset:31232
v_mfma_f32_16x16x32_bf16 a[8:11], a[220:223], a[192:195], a[8:11]
ds_read_b128 a[192:195], v252 offset:28672
v_mfma_f32_16x16x32_bf16 a[8:11], a[224:227], a[196:199], a[8:11]
ds_read_b128 a[196:199], v252 offset:29184
v_mfma_f32_16x16x32_bf16 a[4:7], a[220:223], a[184:187], a[4:7]
ds_read_b128 a[184:187], v252 offset:26624
v_mfma_f32_16x16x32_bf16 a[4:7], a[224:227], a[188:191], a[4:7]
ds_read_b128 a[188:191], v252 offset:27136
v_mfma_f32_16x16x32_bf16 a[0:3], a[220:223], a[176:179], a[0:3]
ds_read_b128 a[176:179], v252 offset:24576
v_mfma_f32_16x16x32_bf16 a[0:3], a[224:227], a[180:183], a[0:3]
ds_read_b128 a[180:183], v252 offset:25088
v_mfma_f32_16x16x32_bf16 v[236:239], a[220:223], a[168:171], v[236:239]
ds_read_b128 a[168:171], v252 offset:22528
v_mfma_f32_16x16x32_bf16 v[236:239], a[224:227], a[172:175], v[236:239]
ds_read_b128 a[172:175], v252 offset:23040
v_mfma_f32_16x16x32_bf16 v[232:235], a[220:223], a[160:163], v[232:235]
ds_read_b128 a[160:163], v252 offset:20480
v_mfma_f32_16x16x32_bf16 v[232:235], a[224:227], a[164:167], v[232:235]
ds_read_b128 a[164:167], v252 offset:20992
v_mfma_f32_16x16x32_bf16 v[228:231], a[220:223], a[152:155], v[228:231]
ds_read_b128 a[152:155], v252 offset:18432
v_mfma_f32_16x16x32_bf16 v[228:231], a[224:227], a[156:159], v[228:231]
ds_read_b128 a[156:159], v252 offset:18944
v_mfma_f32_16x16x32_bf16 v[224:227], a[220:223], a[144:147], v[224:227]
ds_read_b128 a[144:147], v252 offset:16384
v_mfma_f32_16x16x32_bf16 v[224:227], a[224:227], a[148:151], v[224:227]
s_waitcnt vmcnt(11) lgkmcnt(11)
ds_read_b128 a[148:151], v252 offset:16896
v_mfma_f32_16x16x32_bf16 v[28:31], a[228:231], a[200:203], v[28:31]
buffer_load_dwordx4 a[220:223], v254, s[8:11], s20 offen offset:0
v_mfma_f32_16x16x32_bf16 v[28:31], a[232:235], a[204:207], v[28:31]
v_mfma_f32_16x16x32_bf16 v[24:27], a[228:231], a[192:195], v[24:27]
buffer_load_dwordx4 a[224:227], v254, s[8:11], s20 offen offset:1024
v_mfma_f32_16x16x32_bf16 v[24:27], a[232:235], a[196:199], v[24:27]
s_waitcnt lgkmcnt(8)
v_mfma_f32_16x16x32_bf16 v[20:23], a[228:231], a[184:187], v[20:23]
v_mfma_f32_16x16x32_bf16 v[20:23], a[232:235], a[188:191], v[20:23]
v_mfma_f32_16x16x32_bf16 v[16:19], a[228:231], a[176:179], v[16:19]
v_mfma_f32_16x16x32_bf16 v[16:19], a[232:235], a[180:183], v[16:19]
s_waitcnt lgkmcnt(4)
v_mfma_f32_16x16x32_bf16 v[12:15], a[228:231], a[168:171], v[12:15]
v_mfma_f32_16x16x32_bf16 v[12:15], a[232:235], a[172:175], v[12:15]
v_mfma_f32_16x16x32_bf16 v[8:11], a[228:231], a[160:163], v[8:11]
v_mfma_f32_16x16x32_bf16 v[8:11], a[232:235], a[164:167], v[8:11]
s_waitcnt lgkmcnt(0)
v_mfma_f32_16x16x32_bf16 v[4:7], a[228:231], a[152:155], v[4:7]
v_mfma_f32_16x16x32_bf16 v[4:7], a[232:235], a[156:159], v[4:7]
v_mfma_f32_16x16x32_bf16 v[0:3], a[228:231], a[144:147], v[0:3]
buffer_load_dwordx4 a[228:231], v254, s[8:11], s20 offen offset:2048
v_mfma_f32_16x16x32_bf16 v[0:3], a[232:235], a[148:151], v[0:3]
s_waitcnt vmcnt(11)
v_mfma_f32_16x16x32_bf16 v[32:35], a[236:239], a[144:147], v[32:35]
buffer_load_dwordx4 a[232:235], v254, s[8:11], s20 offen offset:3072
v_mfma_f32_16x16x32_bf16 v[32:35], a[240:243], a[148:151], v[32:35]
s_add_u32 s20, s20, 4096
v_mfma_f32_16x16x32_bf16 v[36:39], a[236:239], a[152:155], v[36:39]
v_mfma_f32_16x16x32_bf16 v[36:39], a[240:243], a[156:159], v[36:39]
s_add_u32 m0, s34, 35840
v_mfma_f32_16x16x32_bf16 v[40:43], a[236:239], a[160:163], v[40:43]
buffer_load_dwordx4 v254, s[12:15], s32 offen sc1 lds
v_mfma_f32_16x16x32_bf16 v[40:43], a[240:243], a[164:167], v[40:43]
v_mfma_f32_16x16x32_bf16 v[44:47], a[236:239], a[168:171], v[44:47]
s_add_u32 s32, s32, 13312
v_mfma_f32_16x16x32_bf16 v[44:47], a[240:243], a[172:175], v[44:47]
v_mfma_f32_16x16x32_bf16 v[48:51], a[236:239], a[176:179], v[48:51]
v_mfma_f32_16x16x32_bf16 v[48:51], a[240:243], a[180:183], v[48:51]
v_mfma_f32_16x16x32_bf16 v[52:55], a[236:239], a[184:187], v[52:55]
v_mfma_f32_16x16x32_bf16 v[52:55], a[240:243], a[188:191], v[52:55]
v_mfma_f32_16x16x32_bf16 v[56:59], a[236:239], a[192:195], v[56:59]
v_mfma_f32_16x16x32_bf16 v[56:59], a[240:243], a[196:199], v[56:59]
v_mfma_f32_16x16x32_bf16 v[60:63], a[236:239], a[200:203], v[60:63]
buffer_load_dwordx4 a[236:239], v254, s[8:11], s20 offen offset:0
v_mfma_f32_16x16x32_bf16 v[60:63], a[240:243], a[204:207], v[60:63]
s_waitcnt vmcnt(11)
v_mfma_f32_16x16x32_bf16 v[92:95], a[244:247], a[200:203], v[92:95]
buffer_load_dwordx4 a[240:243], v254, s[8:11], s20 offen offset:1024
v_mfma_f32_16x16x32_bf16 v[92:95], a[248:251], a[204:207], v[92:95]
v_mfma_f32_16x16x32_bf16 v[88:91], a[244:247], a[192:195], v[88:91]
v_mfma_f32_16x16x32_bf16 v[88:91], a[248:251], a[196:199], v[88:91]
v_mfma_f32_16x16x32_bf16 v[84:87], a[244:247], a[184:187], v[84:87]
v_mfma_f32_16x16x32_bf16 v[84:87], a[248:251], a[188:191], v[84:87]
v_mfma_f32_16x16x32_bf16 v[80:83], a[244:247], a[176:179], v[80:83]
s_add_u32 s35, s35, 1
v_mfma_f32_16x16x32_bf16 v[80:83], a[248:251], a[180:183], v[80:83]
s_waitcnt vmcnt(8)
v_accvgpr_read_b32 v249, a255
v_mfma_f32_16x16x32_bf16 v[76:79], a[244:247], a[168:171], v[76:79]
v_cmp_le_u32 vcc, s35, v249
v_mfma_f32_16x16x32_bf16 v[76:79], a[248:251], a[172:175], v[76:79]
s_and_b32 s42, vcc_lo, 15
s_cmp_eq_u32 s42, 15
s_cbranch_scc0 L_spinBx2
L_retBx2:
v_mfma_f32_16x16x32_bf16 v[72:75], a[244:247], a[160:163], v[72:75]
v_mfma_f32_16x16x32_bf16 v[72:75], a[248:251], a[164:167], v[72:75]
v_mfma_f32_16x16x32_bf16 v[68:71], a[244:247], a[152:155], v[68:71]
v_mfma_f32_16x16x32_bf16 v[68:71], a[248:251], a[156:159], v[68:71]
v_mfma_f32_16x16x32_bf16 v[64:67], a[244:247], a[144:147], v[64:67]
buffer_load_dwordx4 a[244:247], v254, s[8:11], s20 offen offset:2048
v_mfma_f32_16x16x32_bf16 v[64:67], a[248:251], a[148:151], v[64:67]
s_waitcnt vmcnt(8)
v_mfma_f32_16x16x32_bf16 v[96:99], a[208:211], a[144:147], v[96:99]
buffer_load_dwordx4 a[248:251], v254, s[8:11], s20 offen offset:3072
v_mfma_f32_16x16x32_bf16 v[96:99], a[212:215], a[148:151], v[96:99]
s_add_u32 s20, s20, 4096
v_mfma_f32_16x16x32_bf16 v[100:103], a[208:211], a[152:155], v[100:103]
v_mfma_f32_16x16x32_bf16 v[100:103], a[212:215], a[156:159], v[100:103]
s_add_u32 m0, s34, 65536
v_mfma_f32_16x16x32_bf16 v[104:107], a[208:211], a[160:163], v[104:107]
buffer_load_dwordx4 v254, s[12:15], s32 offen sc1 lds
v_mfma_f32_16x16x32_bf16 v[104:107], a[212:215], a[164:167], v[104:107]
v_mfma_f32_16x16x32_bf16 v[108:111], a[208:211], a[168:171], v[108:111]
s_add_u32 s36, s36, 1
s_add_u32 s32, s32, 1024
v_mfma_f32_16x16x32_bf16 v[108:111], a[212:215], a[172:175], v[108:111]
v_mov_b32 v248, s36
v_mfma_f32_16x16x32_bf16 v[112:115], a[208:211], a[176:179], v[112:115]
buffer_store_dword v248, off, s[8:11], s23 sc1
v_mfma_f32_16x16x32_bf16 v[112:115], a[212:215], a[180:183], v[112:115]
v_mfma_f32_16x16x32_bf16 v[116:119], a[208:211], a[184:187], v[116:119]
v_mfma_f32_16x16x32_bf16 v[116:119], a[212:215], a[188:191], v[116:119]
v_mfma_f32_16x16x32_bf16 v[120:123], a[208:211], a[192:195], v[120:123]
v_mfma_f32_16x16x32_bf16 v[120:123], a[212:215], a[196:199], v[120:123]
v_mfma_f32_16x16x32_bf16 v[124:127], a[208:211], a[200:203], v[124:127]
buffer_load_dwordx4 a[208:211], v254, s[8:11], s20 offen offset:0
v_mfma_f32_16x16x32_bf16 v[124:127], a[212:215], a[204:207], v[124:127]
s_waitcnt vmcnt(10)
v_mfma_f32_16x16x32_bf16 v[156:159], a[220:223], a[200:203], v[156:159]
buffer_load_dwordx4 a[212:215], v254, s[8:11], s20 offen offset:1024
v_mfma_f32_16x16x32_bf16 v[156:159], a[224:227], a[204:207], v[156:159]
v_mfma_f32_16x16x32_bf16 v[152:155], a[220:223], a[192:195], v[152:155]
buffer_load_dwordx4 a[216:219], v254, s[8:11], s20 offen offset:2048
v_mfma_f32_16x16x32_bf16 v[152:155], a[224:227], a[196:199], v[152:155]
s_add_u32 m0, s34, 66560
v_mfma_f32_16x16x32_bf16 v[148:151], a[220:223], a[184:187], v[148:151]
buffer_load_dwordx4 v254, s[12:15], s32 offen sc1 lds
v_mfma_f32_16x16x32_bf16 v[148:151], a[224:227], a[188:191], v[148:151]
v_mfma_f32_16x16x32_bf16 v[144:147], a[220:223], a[176:179], v[144:147]
s_add_u32 s32, s32, 1024
v_mfma_f32_16x16x32_bf16 v[144:147], a[224:227], a[180:183], v[144:147]
v_mfma_f32_16x16x32_bf16 v[140:143], a[220:223], a[168:171], v[140:143]
v_mfma_f32_16x16x32_bf16 v[140:143], a[224:227], a[172:175], v[140:143]
v_mfma_f32_16x16x32_bf16 v[136:139], a[220:223], a[160:163], v[136:139]
v_mfma_f32_16x16x32_bf16 v[136:139], a[224:227], a[164:167], v[136:139]
v_mfma_f32_16x16x32_bf16 v[132:135], a[220:223], a[152:155], v[132:135]
v_mfma_f32_16x16x32_bf16 v[132:135], a[224:227], a[156:159], v[132:135]
v_mfma_f32_16x16x32_bf16 v[128:131], a[220:223], a[144:147], v[128:131]
buffer_load_dwordx4 a[220:223], v254, s[8:11], s20 offen offset:3072
v_mfma_f32_16x16x32_bf16 v[128:131], a[224:227], a[148:151], v[128:131]
s_waitcnt vmcnt(12)
s_add_u32 s20, s20, 4096
v_mfma_f32_16x16x32_bf16 v[160:163], a[228:231], a[144:147], v[160:163]
buffer_load_dwordx4 a[224:227], v254, s[8:11], s20 offen offset:0
v_mfma_f32_16x16x32_bf16 v[160:163], a[232:235], a[148:151], v[160:163]
v_mfma_f32_16x16x32_bf16 v[164:167], a[228:231], a[152:155], v[164:167]
v_mfma_f32_16x16x32_bf16 v[164:167], a[232:235], a[156:159], v[164:167]
s_add_u32 m0, s34, 67584
v_mfma_f32_16x16x32_bf16 v[168:171], a[228:231], a[160:163], v[168:171]
buffer_load_dwordx4 v254, s[12:15], s32 offen sc1 lds
v_mfma_f32_16x16x32_bf16 v[168:171], a[232:235], a[164:167], v[168:171]
v_mfma_f32_16x16x32_bf16 v[172:175], a[228:231], a[168:171], v[172:175]
s_add_u32 s32, s32, 1024
v_mfma_f32_16x16x32_bf16 v[172:175], a[232:235], a[172:175], v[172:175]
v_add_u32 v252, 0x0, v253
v_mfma_f32_16x16x32_bf16 v[176:179], a[228:231], a[176:179], v[176:179]
v_mfma_f32_16x16x32_bf16 v[176:179], a[232:235], a[180:183], v[176:179]
v_mfma_f32_16x16x32_bf16 v[180:183], a[228:231], a[184:187], v[180:183]
v_mfma_f32_16x16x32_bf16 v[180:183], a[232:235], a[188:191], v[180:183]
v_mfma_f32_16x16x32_bf16 v[184:187], a[228:231], a[192:195], v[184:187]
v_mfma_f32_16x16x32_bf16 v[184:187], a[232:235], a[196:199], v[184:187]
v_mfma_f32_16x16x32_bf16 v[188:191], a[228:231], a[200:203], v[188:191]
buffer_load_dwordx4 a[228:231], v254, s[8:11], s20 offen offset:1024
v_mfma_f32_16x16x32_bf16 v[188:191], a[232:235], a[204:207], v[188:191]
s_waitcnt vmcnt(12)
v_mfma_f32_16x16x32_bf16 v[220:223], a[236:239], a[200:203], v[220:223]
buffer_load_dwordx4 a[232:235], v254, s[8:11], s20 offen offset:2048
v_mfma_f32_16x16x32_bf16 v[220:223], a[240:243], a[204:207], v[220:223]
v_mfma_f32_16x16x32_bf16 v[216:219], a[236:239], a[192:195], v[216:219]
v_mfma_f32_16x16x32_bf16 v[216:219], a[240:243], a[196:199], v[216:219]
s_add_u32 m0, s34, 68608
v_mfma_f32_16x16x32_bf16 v[212:215], a[236:239], a[184:187], v[212:215]
buffer_load_dwordx4 v254, s[12:15], s32 offen sc1 lds
v_mfma_f32_16x16x32_bf16 v[212:215], a[240:243], a[188:191], v[212:215]
v_mfma_f32_16x16x32_bf16 v[208:211], a[236:239], a[176:179], v[208:211]
s_add_u32 s32, s32, 13312
v_mfma_f32_16x16x32_bf16 v[208:211], a[240:243], a[180:183], v[208:211]
v_mfma_f32_16x16x32_bf16 v[204:207], a[236:239], a[168:171], v[204:207]
v_mfma_f32_16x16x32_bf16 v[204:207], a[240:243], a[172:175], v[204:207]
v_mfma_f32_16x16x32_bf16 v[200:203], a[236:239], a[160:163], v[200:203]
v_mfma_f32_16x16x32_bf16 v[200:203], a[240:243], a[164:167], v[200:203]
v_mfma_f32_16x16x32_bf16 v[196:199], a[236:239], a[152:155], v[196:199]
s_barrier
v_mfma_f32_16x16x32_bf16 v[196:199], a[240:243], a[156:159], v[196:199]
v_mfma_f32_16x16x32_bf16 v[192:195], a[236:239], a[144:147], v[192:195]
buffer_load_dwordx4 a[236:239], v254, s[8:11], s20 offen offset:3072
v_mfma_f32_16x16x32_bf16 v[192:195], a[240:243], a[148:151], v[192:195]
s_waitcnt vmcnt(13)
s_add_u32 s20, s20, 4096
buffer_load_dwordx4 a[240:243], v254, s[8:11], s20 offen offset:0
v_mfma_f32_16x16x32_bf16 v[224:227], a[244:247], a[144:147], v[224:227]
ds_read_b128 a[144:147], v252 offset:0
v_mfma_f32_16x16x32_bf16 v[224:227], a[248:251], a[148:151], v[224:227]
ds_read_b128 a[148:151], v252 offset:512
v_mfma_f32_16x16x32_bf16 v[228:231], a[244:247], a[152:155], v[228:231]
ds_read_b128 a[152:155], v252 offset:2048
v_mfma_f32_16x16x32_bf16 v[228:231], a[248:251], a[156:159], v[228:231]
ds_read_b128 a[156:159], v252 offset:2560
v_mfma_f32_16x16x32_bf16 v[232:235], a[244:247], a[160:163], v[232:235]
ds_read_b128 a[160:163], v252 offset:4096
v_mfma_f32_16x16x32_bf16 v[232:235], a[248:251], a[164:167], v[232:235]
ds_read_b128 a[164:167], v252 offset:4608
v_mfma_f32_16x16x32_bf16 v[236:239], a[244:247], a[168:171], v[236:239]
ds_read_b128 a[168:171], v252 offset:6144
v_mfma_f32_16x16x32_bf16 v[236:239], a[248:251], a[172:175], v[236:239]
ds_read_b128 a[172:175], v252 offset:6656
v_mfma_f32_16x16x32_bf16 a[0:3], a[244:247], a[176:179], a[0:3]
ds_read_b128 a[176:179], v252 offset:8192
v_mfma_f32_16x16x32_bf16 a[0:3], a[248:251], a[180:183], a[0:3]
ds_read_b128 a[180:183], v252 offset:8704
v_mfma_f32_16x16x32_bf16 a[4:7], a[244:247], a[184:187], a[4:7]
ds_read_b128 a[184:187], v252 offset:10240
v_mfma_f32_16x16x32_bf16 a[4:7], a[248:251], a[188:191], a[4:7]
ds_read_b128 a[188:191], v252 offset:10752
v_mfma_f32_16x16x32_bf16 a[8:11], a[244:247], a[192:195], a[8:11]
ds_read_b128 a[192:195], v252 offset:12288
v_mfma_f32_16x16x32_bf16 a[8:11], a[248:251], a[196:199], a[8:11]
ds_read_b128 a[196:199], v252 offset:12800
v_mfma_f32_16x16x32_bf16 a[12:15], a[244:247], a[200:203], a[12:15]
ds_read_b128 a[200:203], v252 offset:14336
v_mfma_f32_16x16x32_bf16 a[12:15], a[248:251], a[204:207], a[12:15]
s_waitcnt vmcnt(10) lgkmcnt(11)
ds_read_b128 a[204:207], v252 offset:14848
v_mfma_f32_16x16x32_bf16 v[0:3], a[208:211], a[144:147], v[0:3]
buffer_load_dwordx4 a[244:247], v254, s[8:11], s20 offen offset:1024
v_mfma_f32_16x16x32_bf16 v[0:3], a[212:215], a[148:151], v[0:3]
v_mfma_f32_16x16x32_bf16 v[4:7], a[208:211], a[152:155], v[4:7]
buffer_load_dwordx4 a[248:251], v254, s[8:11], s20 offen offset:2048
v_mfma_f32_16x16x32_bf16 v[4:7], a[212:215], a[156:159], v[4:7]
s_waitcnt lgkmcnt(8)
v_mfma_f32_16x16x32_bf16 v[8:11], a[208:211], a[160:163], v[8:11]
v_mfma_f32_16x16x32_bf16 v[8:11], a[212:215], a[164:167], v[8:11]
v_mfma_f32_16x16x32_bf16 v[12:15], a[208:211], a[168:171], v[12:15]
v_mfma_f32_16x16x32_bf16 v[12:15], a[212:215], a[172:175], v[12:15]
s_waitcnt lgkmcnt(4)
v_mfma_f32_16x16x32_bf16 v[16:19], a[208:211], a[176:179], v[16:19]
v_mfma_f32_16x16x32_bf16 v[16:19], a[212:215], a[180:183], v[16:19]
v_mfma_f32_16x16x32_bf16 v[20:23], a[208:211], a[184:187], v[20:23]
v_mfma_f32_16x16x32_bf16 v[20:23], a[212:215], a[188:191], v[20:23]
s_waitcnt lgkmcnt(0)
v_mfma_f32_16x16x32_bf16 v[24:27], a[208:211], a[192:195], v[24:27]
v_mfma_f32_16x16x32_bf16 v[24:27], a[212:215], a[196:199], v[24:27]
v_mfma_f32_16x16x32_bf16 v[28:31], a[208:211], a[200:203], v[28:31]
buffer_load_dwordx4 a[208:211], v254, s[8:11], s20 offen offset:3072
v_mfma_f32_16x16x32_bf16 v[28:31], a[212:215], a[204:207], v[28:31]
s_waitcnt vmcnt(10)
s_add_u32 s20, s20, 4096
v_mfma_f32_16x16x32_bf16 v[60:63], a[216:219], a[200:203], v[60:63]
buffer_load_dwordx4 a[212:215], v254, s[8:11], s20 offen offset:0
v_mfma_f32_16x16x32_bf16 v[60:63], a[220:223], a[204:207], v[60:63]
v_mfma_f32_16x16x32_bf16 v[56:59], a[216:219], a[192:195], v[56:59]
v_mfma_f32_16x16x32_bf16 v[56:59], a[220:223], a[196:199], v[56:59]
s_add_u32 m0, s34, 98304
v_mfma_f32_16x16x32_bf16 v[52:55], a[216:219], a[184:187], v[52:55]
buffer_load_dwordx4 v254, s[12:15], s32 offen sc1 lds
v_mfma_f32_16x16x32_bf16 v[52:55], a[220:223], a[188:191], v[52:55]
s_getpc_b64 s[4:5]
s_mov_b32 s6, L_codeend - .
v_mfma_f32_16x16x32_bf16 v[48:51], a[216:219], a[176:179], v[48:51]
s_add_u32 s32, s32, 1024
s_mov_b32 s7, 0x00020000
v_mfma_f32_16x16x32_bf16 v[48:51], a[220:223], a[180:183], v[48:51]
s_lshr_b32 s43, s2, 3
v_mfma_f32_16x16x32_bf16 v[44:47], a[216:219], a[168:171], v[44:47]
s_lshl_b32 s43, s43, 7
v_mfma_f32_16x16x32_bf16 v[44:47], a[220:223], a[172:175], v[44:47]
v_and_b32 v240, 0x1f0, v254
v_mfma_f32_16x16x32_bf16 v[40:43], a[216:219], a[160:163], v[40:43]
v_lshlrev_b32 v240, 8, v240
v_mfma_f32_16x16x32_bf16 v[40:43], a[220:223], a[164:167], v[40:43]
buffer_load_dword v241, v240, s[4:7], s43 offen
v_mfma_f32_16x16x32_bf16 v[36:39], a[216:219], a[152:155], v[36:39]
v_mfma_f32_16x16x32_bf16 v[36:39], a[220:223], a[156:159], v[36:39]
v_mfma_f32_16x16x32_bf16 v[32:35], a[216:219], a[144:147], v[32:35]
buffer_load_dwordx4 a[216:219], v254, s[8:11], s20 offen offset:1024
v_mfma_f32_16x16x32_bf16 v[32:35], a[220:223], a[148:151], v[32:35]
s_waitcnt vmcnt(11)
v_mfma_f32_16x16x32_bf16 v[64:67], a[224:227], a[144:147], v[64:67]
buffer_load_dwordx4 a[220:223], v254, s[8:11], s20 offen offset:2048
v_mfma_f32_16x16x32_bf16 v[64:67], a[228:231], a[148:151], v[64:67]
v_mfma_f32_16x16x32_bf16 v[68:71], a[224:227], a[152:155], v[68:71]
v_mfma_f32_16x16x32_bf16 v[68:71], a[228:231], a[156:159], v[68:71]
s_add_u32 m0, s34, 99328
v_mfma_f32_16x16x32_bf16 v[72:75], a[224:227], a[160:163], v[72:75]
buffer_load_dwordx4 v254, s[12:15], s32 offen sc1 lds
v_mfma_f32_16x16x32_bf16 v[72:75], a[228:231], a[164:167], v[72:75]
v_mfma_f32_16x16x32_bf16 v[76:79], a[224:227], a[168:171], v[76:79]
s_add_u32 s32, s32, 1024
v_mfma_f32_16x16x32_bf16 v[76:79], a[228:231], a[172:175], v[76:79]
v_mfma_f32_16x16x32_bf16 v[80:83], a[224:227], a[176:179], v[80:83]
v_mfma_f32_16x16x32_bf16 v[80:83], a[228:231], a[180:183], v[80:83]
v_mfma_f32_16x16x32_bf16 v[84:87], a[224:227], a[184:187], v[84:87]
v_mfma_f32_16x16x32_bf16 v[84:87], a[228:231], a[188:191], v[84:87]
v_mfma_f32_16x16x32_bf16 v[88:91], a[224:227], a[192:195], v[88:91]
v_mfma_f32_16x16x32_bf16 v[88:91], a[228:231], a[196:199], v[88:91]
v_mfma_f32_16x16x32_bf16 v[92:95], a[224:227], a[200:203], v[92:95]
buffer_load_dwordx4 a[224:227], v254, s[8:11], s20 offen offset:3072
v_mfma_f32_16x16x32_bf16 v[92:95], a[228:231], a[204:207], v[92:95]
s_waitcnt vmcnt(11)
s_add_u32 s20, s20, 4096
v_mfma_f32_16x16x32_bf16 v[124:127], a[232:235], a[200:203], v[124:127]
buffer_load_dwordx4 a[228:231], v254, s[8:11], s20 offen offset:0
v_mfma_f32_16x16x32_bf16 v[124:127], a[236:239], a[204:207], v[124:127]
v_mfma_f32_16x16x32_bf16 v[120:123], a[232:235], a[192:195], v[120:123]
v_mfma_f32_16x16x32_bf16 v[120:123], a[236:239], a[196:199], v[120:123]
s_add_u32 m0, s34, 100352
v_mfma_f32_16x16x32_bf16 v[116:119], a[232:235], a[184:187], v[116:119]
buffer_load_dwordx4 v254, s[12:15], s32 offen sc1 lds
v_mfma_f32_16x16x32_bf16 v[116:119], a[236:239], a[188:191], v[116:119]
v_mfma_f32_16x16x32_bf16 v[112:115], a[232:235], a[176:179], v[112:115]
s_add_u32 s32, s32, 1024
v_mfma_f32_16x16x32_bf16 v[112:115], a[236:239], a[180:183], v[112:115]
v_mfma_f32_16x16x32_bf16 v[108:111], a[232:235], a[168:171], v[108:111]
v_mfma_f32_16x16x32_bf16 v[108:111], a[236:239], a[172:175], v[108:111]
v_mfma_f32_16x16x32_bf16 v[104:107], a[232:235], a[160:163], v[104:107]
v_mfma_f32_16x16x32_bf16 v[104:107], a[236:239], a[164:167], v[104:107]
buffer_load_dword a255, v254, s[60:63], 0 offen sc1
v_mfma_f32_16x16x32_bf16 v[100:103], a[232:235], a[152:155], v[100:103]
v_mfma_f32_16x16x32_bf16 v[100:103], a[236:239], a[156:159], v[100:103]
v_mfma_f32_16x16x32_bf16 v[96:99], a[232:235], a[144:147], v[96:99]
buffer_load_dwordx4 a[232:235], v254, s[8:11], s20 offen offset:1024
v_mfma_f32_16x16x32_bf16 v[96:99], a[236:239], a[148:151], v[96:99]
s_waitcnt vmcnt(13)
v_mfma_f32_16x16x32_bf16 v[128:131], a[240:243], a[144:147], v[128:131]
buffer_load_dwordx4 a[236:239], v254, s[8:11], s20 offen offset:2048
v_mfma_f32_16x16x32_bf16 v[128:131], a[244:247], a[148:151], v[128:131]
v_mfma_f32_16x16x32_bf16 v[132:135], a[240:243], a[152:155], v[132:135]
v_mfma_f32_16x16x32_bf16 v[132:135], a[244:247], a[156:159], v[132:135]
s_add_u32 m0, s34, 101376
v_mfma_f32_16x16x32_bf16 v[136:139], a[240:243], a[160:163], v[136:139]
buffer_load_dwordx4 v254, s[12:15], s32 offen sc1 lds
v_mfma_f32_16x16x32_bf16 v[136:139], a[244:247], a[164:167], v[136:139]
v_mfma_f32_16x16x32_bf16 v[140:143], a[240:243], a[168:171], v[140:143]
s_add_u32 s32, s32, 13312
v_mfma_f32_16x16x32_bf16 v[140:143], a[244:247], a[172:175], v[140:143]
v_mfma_f32_16x16x32_bf16 v[144:147], a[240:243], a[176:179], v[144:147]
v_mfma_f32_16x16x32_bf16 v[144:147], a[244:247], a[180:183], v[144:147]
v_mfma_f32_16x16x32_bf16 v[148:151], a[240:243], a[184:187], v[148:151]
v_mfma_f32_16x16x32_bf16 v[148:151], a[244:247], a[188:191], v[148:151]
v_mfma_f32_16x16x32_bf16 v[152:155], a[240:243], a[192:195], v[152:155]
v_mfma_f32_16x16x32_bf16 v[152:155], a[244:247], a[196:199], v[152:155]
v_mfma_f32_16x16x32_bf16 v[156:159], a[240:243], a[200:203], v[156:159]
buffer_load_dwordx4 a[240:243], v254, s[8:11], s20 offen offset:3072
v_mfma_f32_16x16x32_bf16 v[156:159], a[244:247], a[204:207], v[156:159]
s_waitcnt vmcnt(14)
s_add_u32 s20, s20, 4096
v_mfma_f32_16x16x32_bf16 v[188:191], a[248:251], a[200:203], v[188:191]
buffer_load_dwordx4 a[244:247], v254, s[8:11], s20 offen offset:0
v_mfma_f32_16x16x32_bf16 v[188:191], a[208:211], a[204:207], v[188:191]
v_mfma_f32_16x16x32_bf16 v[184:187], a[248:251], a[192:195], v[184:187]
v_mfma_f32_16x16x32_bf16 v[184:187], a[208:211], a[196:199], v[184:187]
v_mfma_f32_16x16x32_bf16 v[180:183], a[248:251], a[184:187], v[180:183]
v_mfma_f32_16x16x32_bf16 v[180:183], a[208:211], a[188:191], v[180:183]
v_mfma_f32_16x16x32_bf16 v[176:179], a[248:251], a[176:179], v[176:179]
v_mfma_f32_16x16x32_bf16 v[176:179], a[208:211], a[180:183], v[176:179]
v_mfma_f32_16x16x32_bf16 v[172:175], a[248:251], a[168:171], v[172:175]
v_mfma_f32_16x16x32_bf16 v[172:175], a[208:211], a[172:175], v[172:175]
v_mfma_f32_16x16x32_bf16 v[168:171], a[248:251], a[160:163], v[168:171]
v_mfma_f32_16x16x32_bf16 v[168:171], a[208:211], a[164:167], v[168:171]
v_mfma_f32_16x16x32_bf16 v[164:167], a[248:251], a[152:155], v[164:167]
v_mfma_f32_16x16x32_bf16 v[164:167], a[208:211], a[156:159], v[164:167]
v_mfma_f32_16x16x32_bf16 v[160:163], a[248:251], a[144:147], v[160:163]
buffer_load_dwordx4 a[248:251], v254, s[8:11], s20 offen offset:1024
v_mfma_f32_16x16x32_bf16 v[160:163], a[208:211], a[148:151], v[160:163]
s_waitcnt vmcnt(12)
v_mfma_f32_16x16x32_bf16 v[192:195], a[212:215], a[144:147], v[192:195]
buffer_load_dwordx4 a[208:211], v254, s[8:11], s20 offen offset:2048
v_mfma_f32_16x16x32_bf16 v[192:195], a[216:219], a[148:151], v[192:195]
v_mfma_f32_16x16x32_bf16 v[196:199], a[212:215], a[152:155], v[196:199]
v_mfma_f32_16x16x32_bf16 v[196:199], a[216:219], a[156:159], v[196:199]
v_mfma_f32_16x16x32_bf16 v[200:203], a[212:215], a[160:163], v[200:203]
v_mfma_f32_16x16x32_bf16 v[200:203], a[216:219], a[164:167], v[200:203]
v_mfma_f32_16x16x32_bf16 v[204:207], a[212:215], a[168:171], v[204:207]
v_mfma_f32_16x16x32_bf16 v[204:207], a[216:219], a[172:175], v[204:207]
v_mfma_f32_16x16x32_bf16 v[208:211], a[212:215], a[176:179], v[208:211]
v_mfma_f32_16x16x32_bf16 v[208:211], a[216:219], a[180:183], v[208:211]
v_mfma_f32_16x16x32_bf16 v[212:215], a[212:215], a[184:187], v[212:215]
v_mfma_f32_16x16x32_bf16 v[212:215], a[216:219], a[188:191], v[212:215]
v_mfma_f32_16x16x32_bf16 v[216:219], a[212:215], a[192:195], v[216:219]
v_mfma_f32_16x16x32_bf16 v[216:219], a[216:219], a[196:199], v[216:219]
v_mfma_f32_16x16x32_bf16 v[220:223], a[212:215], a[200:203], v[220:223]
buffer_load_dwordx4 a[212:215], v254, s[8:11], s20 offen offset:3072
v_mfma_f32_16x16x32_bf16 v[220:223], a[216:219], a[204:207], v[220:223]
s_waitcnt vmcnt(11)
s_add_u32 s20, s20, 4096
v_mfma_f32_16x16x32_bf16 a[12:15], a[220:223], a[200:203], a[12:15]
ds_read_b128 a[200:203], v252 offset:47104
v_mfma_f32_16x16x32_bf16 a[12:15], a[224:227], a[204:207], a[12:15]
ds_read_b128 a[204:207], v252 offset:47616
v_mfma_f32_16x16x32_bf16 a[8:11], a[220:223], a[192:195], a[8:11]
ds_read_b128 a[192:195], v252 offset:45056
v_mfma_f32_16x16x32_bf16 a[8:11], a[224:227], a[196:199], a[8:11]
ds_read_b128 a[196:199], v252 offset:45568
v_mfma_f32_16x16x32_bf16 a[4:7], a[220:223], a[184:187], a[4:7]
ds_read_b128 a[184:187], v252 offset:43008
v_mfma_f32_16x16x32_bf16 a[4:7], a[224:227], a[188:191], a[4:7]
ds_read_b128 a[188:191], v252 offset:43520
v_mfma_f32_16x16x32_bf16 a[0:3], a[220:223], a[176:179], a[0:3]
s_add_u32 s35, s35, 1
ds_read_b128 a[176:179], v252 offset:40960
v_mfma_f32_16x16x32_bf16 a[0:3], a[224:227], a[180:183], a[0:3]
s_waitcnt vmcnt(8)
ds_read_b128 a[180:183], v252 offset:41472
v_accvgpr_read_b32 v249, a255
v_mfma_f32_16x16x32_bf16 v[236:239], a[220:223], a[168:171], v[236:239]
ds_read_b128 a[168:171], v252 offset:38912
v_cmp_le_u32 vcc, s35, v249
v_mfma_f32_16x16x32_bf16 v[236:239], a[224:227], a[172:175], v[236:239]
ds_read_b128 a[172:175], v252 offset:39424
s_and_b32 s42, vcc_lo, 15
s_cmp_eq_u32 s42, 15
s_cbranch_scc0 L_spinBx3
L_retBx3:
v_mfma_f32_16x16x32_bf16 v[232:235], a[220:223], a[160:163], v[232:235]
ds_read_b128 a[160:163], v252 offset:36864
v_mfma_f32_16x16x32_bf16 v[232:235], a[224:227], a[164:167], v[232:235]
ds_read_b128 a[164:167], v252 offset:37376
v_mfma_f32_16x16x32_bf16 v[228:231], a[220:223], a[152:155], v[228:231]
ds_read_b128 a[152:155], v252 offset:34816
v_mfma_f32_16x16x32_bf16 v[228:231], a[224:227], a[156:159], v[228:231]
ds_read_b128 a[156:159], v252 offset:35328
v_mfma_f32_16x16x32_bf16 v[224:227], a[220:223], a[144:147], v[224:227]
ds_read_b128 a[144:147], v252 offset:32768
v_mfma_f32_16x16x32_bf16 v[224:227], a[224:227], a[148:151], v[224:227]
s_waitcnt vmcnt(7) lgkmcnt(11)
ds_read_b128 a[148:151], v252 offset:33280
v_mfma_f32_16x16x32_bf16 v[28:31], a[228:231], a[200:203], v[28:31]
buffer_load_dwordx4 a[220:223], v254, s[8:11], s20 offen offset:0
v_mfma_f32_16x16x32_bf16 v[28:31], a[232:235], a[204:207], v[28:31]
v_mbcnt_lo_u32_b32 v248, -1, 0
v_mfma_f32_16x16x32_bf16 v[24:27], a[228:231], a[192:195], v[24:27]
buffer_load_dwordx4 a[224:227], v254, s[8:11], s20 offen offset:1024
v_mbcnt_hi_u32_b32 v248, -1, v248
v_mfma_f32_16x16x32_bf16 v[24:27], a[232:235], a[196:199], v[24:27]
s_waitcnt lgkmcnt(8)
s_add_u32 m0, s34, 16384
v_and_b32 v248, 31, v248
v_mfma_f32_16x16x32_bf16 v[20:23], a[228:231], a[184:187], v[20:23]
buffer_load_dwordx4 v254, s[12:15], s32 offen sc1 lds
v_lshlrev_b32 v248, 8, v248
v_mfma_f32_16x16x32_bf16 v[20:23], a[232:235], a[188:191], v[20:23]
buffer_load_dwordx4 v[244:247], v248, s[8:11], s51 offen sc1
v_mfma_f32_16x16x32_bf16 v[16:19], a[228:231], a[176:179], v[16:19]
s_add_u32 s32, s32, 1024
v_mfma_f32_16x16x32_bf16 v[16:19], a[232:235], a[180:183], v[16:19]
s_waitcnt lgkmcnt(4)
v_mfma_f32_16x16x32_bf16 v[12:15], a[228:231], a[168:171], v[12:15]
v_mfma_f32_16x16x32_bf16 v[12:15], a[232:235], a[172:175], v[12:15]
v_mfma_f32_16x16x32_bf16 v[8:11], a[228:231], a[160:163], v[8:11]
v_mfma_f32_16x16x32_bf16 v[8:11], a[232:235], a[164:167], v[8:11]
s_waitcnt lgkmcnt(0)
v_mfma_f32_16x16x32_bf16 v[4:7], a[228:231], a[152:155], v[4:7]
v_mfma_f32_16x16x32_bf16 v[4:7], a[232:235], a[156:159], v[4:7]
v_mfma_f32_16x16x32_bf16 v[0:3], a[228:231], a[144:147], v[0:3]
buffer_load_dwordx4 a[228:231], v254, s[8:11], s20 offen offset:2048
v_mfma_f32_16x16x32_bf16 v[0:3], a[232:235], a[148:151], v[0:3]
s_waitcnt vmcnt(9)
v_mfma_f32_16x16x32_bf16 v[32:35], a[236:239], a[144:147], v[32:35]
buffer_load_dwordx4 a[232:235], v254, s[8:11], s20 offen offset:3072
v_mfma_f32_16x16x32_bf16 v[32:35], a[240:243], a[148:151], v[32:35]
s_add_u32 s20, s20, 4096
v_mfma_f32_16x16x32_bf16 v[36:39], a[236:239], a[152:155], v[36:39]
v_mfma_f32_16x16x32_bf16 v[36:39], a[240:243], a[156:159], v[36:39]
s_add_u32 m0, s34, 17408
v_mfma_f32_16x16x32_bf16 v[40:43], a[236:239], a[160:163], v[40:43]
buffer_load_dwordx4 v254, s[12:15], s32 offen sc1 lds
v_mfma_f32_16x16x32_bf16 v[40:43], a[240:243], a[164:167], v[40:43]
v_mfma_f32_16x16x32_bf16 v[44:47], a[236:239], a[168:171], v[44:47]
s_add_u32 s32, s32, 1024
v_mfma_f32_16x16x32_bf16 v[44:47], a[240:243], a[172:175], v[44:47]
v_mfma_f32_16x16x32_bf16 v[48:51], a[236:239], a[176:179], v[48:51]
v_mfma_f32_16x16x32_bf16 v[48:51], a[240:243], a[180:183], v[48:51]
v_mfma_f32_16x16x32_bf16 v[52:55], a[236:239], a[184:187], v[52:55]
v_mfma_f32_16x16x32_bf16 v[52:55], a[240:243], a[188:191], v[52:55]
v_mfma_f32_16x16x32_bf16 v[56:59], a[236:239], a[192:195], v[56:59]
v_mfma_f32_16x16x32_bf16 v[56:59], a[240:243], a[196:199], v[56:59]
v_mfma_f32_16x16x32_bf16 v[60:63], a[236:239], a[200:203], v[60:63]
buffer_load_dwordx4 a[236:239], v254, s[8:11], s20 offen offset:0
v_mfma_f32_16x16x32_bf16 v[60:63], a[240:243], a[204:207], v[60:63]
s_waitcnt vmcnt(10)
v_mfma_f32_16x16x32_bf16 v[92:95], a[244:247], a[200:203], v[92:95]
buffer_load_dwordx4 a[240:243], v254, s[8:11], s20 offen offset:1024
v_mfma_f32_16x16x32_bf16 v[92:95], a[248:251], a[204:207], v[92:95]
v_mfma_f32_16x16x32_bf16 v[88:91], a[244:247], a[192:195], v[88:91]
v_mfma_f32_16x16x32_bf16 v[88:91], a[248:251], a[196:199], v[88:91]
s_add_u32 m0, s34, 18432
v_mfma_f32_16x16x32_bf16 v[84:87], a[244:247], a[184:187], v[84:87]
buffer_load_dwordx4 v254, s[12:15], s32 offen sc1 lds
v_mfma_f32_16x16x32_bf16 v[84:87], a[248:251], a[188:191], v[84:87]
v_mfma_f32_16x16x32_bf16 v[80:83], a[244:247], a[176:179], v[80:83]
s_add_u32 s32, s32, 1024
v_mfma_f32_16x16x32_bf16 v[80:83], a[248:251], a[180:183], v[80:83]
v_mfma_f32_16x16x32_bf16 v[76:79], a[244:247], a[168:171], v[76:79]
v_mfma_f32_16x16x32_bf16 v[76:79], a[248:251], a[172:175], v[76:79]
v_mfma_f32_16x16x32_bf16 v[72:75], a[244:247], a[160:163], v[72:75]
v_mfma_f32_16x16x32_bf16 v[72:75], a[248:251], a[164:167], v[72:75]
v_mfma_f32_16x16x32_bf16 v[68:71], a[244:247], a[152:155], v[68:71]
v_mfma_f32_16x16x32_bf16 v[68:71], a[248:251], a[156:159], v[68:71]
v_mfma_f32_16x16x32_bf16 v[64:67], a[244:247], a[144:147], v[64:67]
buffer_load_dwordx4 a[244:247], v254, s[8:11], s20 offen offset:2048
v_mfma_f32_16x16x32_bf16 v[64:67], a[248:251], a[148:151], v[64:67]
s_waitcnt vmcnt(11)
v_mfma_f32_16x16x32_bf16 v[96:99], a[208:211], a[144:147], v[96:99]
buffer_load_dwordx4 a[248:251], v254, s[8:11], s20 offen offset:3072
v_mfma_f32_16x16x32_bf16 v[96:99], a[212:215], a[148:151], v[96:99]
s_add_u32 s20, s20, 4096
v_mfma_f32_16x16x32_bf16 v[100:103], a[208:211], a[152:155], v[100:103]
v_mfma_f32_16x16x32_bf16 v[100:103], a[212:215], a[156:159], v[100:103]
s_add_u32 m0, s34, 19456
v_mfma_f32_16x16x32_bf16 v[104:107], a[208:211], a[160:163], v[104:107]
buffer_load_dwordx4 v254, s[12:15], s32 offen sc1 lds
v_mfma_f32_16x16x32_bf16 v[104:107], a[212:215], a[164:167], v[104:107]
v_mfma_f32_16x16x32_bf16 v[108:111], a[208:211], a[168:171], v[108:111]
s_add_u32 s32, s32, 13312
v_mfma_f32_16x16x32_bf16 v[108:111], a[212:215], a[172:175], v[108:111]
v_mfma_f32_16x16x32_bf16 v[112:115], a[208:211], a[176:179], v[112:115]
v_mfma_f32_16x16x32_bf16 v[112:115], a[212:215], a[180:183], v[112:115]
v_mfma_f32_16x16x32_bf16 v[116:119], a[208:211], a[184:187], v[116:119]
v_mfma_f32_16x16x32_bf16 v[116:119], a[212:215], a[188:191], v[116:119]
v_mfma_f32_16x16x32_bf16 v[120:123], a[208:211], a[192:195], v[120:123]
v_mfma_f32_16x16x32_bf16 v[120:123], a[212:215], a[196:199], v[120:123]
v_mfma_f32_16x16x32_bf16 v[124:127], a[208:211], a[200:203], v[124:127]
buffer_load_dwordx4 a[208:211], v254, s[8:11], s20 offen offset:0
v_mfma_f32_16x16x32_bf16 v[124:127], a[212:215], a[204:207], v[124:127]
s_waitcnt vmcnt(12)
v_mfma_f32_16x16x32_bf16 v[156:159], a[220:223], a[200:203], v[156:159]
buffer_load_dwordx4 a[212:215], v254, s[8:11], s20 offen offset:1024
v_mfma_f32_16x16x32_bf16 v[156:159], a[224:227], a[204:207], v[156:159]
v_mfma_f32_16x16x32_bf16 v[152:155], a[220:223], a[192:195], v[152:155]
buffer_load_dwordx4 a[216:219], v254, s[8:11], s20 offen offset:2048
v_mfma_f32_16x16x32_bf16 v[152:155], a[224:227], a[196:199], v[152:155]
s_add_u32 m0, s34, 49152
v_mfma_f32_16x16x32_bf16 v[148:151], a[220:223], a[184:187], v[148:151]
buffer_load_dwordx4 v254, s[12:15], s32 offen sc1 lds
v_mfma_f32_16x16x32_bf16 v[148:151], a[224:227], a[188:191], v[148:151]
v_mfma_f32_16x16x32_bf16 v[144:147], a[220:223], a[176:179], v[144:147]
s_add_u32 s32, s32, 1024
v_mfma_f32_16x16x32_bf16 v[144:147], a[224:227], a[180:183], v[144:147]
v_mfma_f32_16x16x32_bf16 v[140:143], a[220:223], a[168:171], v[140:143]
v_mfma_f32_16x16x32_bf16 v[140:143], a[224:227], a[172:175], v[140:143]
v_mfma_f32_16x16x32_bf16 v[136:139], a[220:223], a[160:163], v[136:139]
v_mfma_f32_16x16x32_bf16 v[136:139], a[224:227], a[164:167], v[136:139]
v_mfma_f32_16x16x32_bf16 v[132:135], a[220:223], a[152:155], v[132:135]
v_mfma_f32_16x16x32_bf16 v[132:135], a[224:227], a[156:159], v[132:135]
v_mfma_f32_16x16x32_bf16 v[128:131], a[220:223], a[144:147], v[128:131]
buffer_load_dwordx4 a[220:223], v254, s[8:11], s20 offen offset:3072
v_mfma_f32_16x16x32_bf16 v[128:131], a[224:227], a[148:151], v[128:131]
s_waitcnt vmcnt(12)
s_add_u32 s20, s20, 4096
v_mfma_f32_16x16x32_bf16 v[160:163], a[228:231], a[144:147], v[160:163]
buffer_load_dwordx4 a[224:227], v254, s[8:11], s20 offen offset:0
v_mfma_f32_16x16x32_bf16 v[160:163], a[232:235], a[148:151], v[160:163]
v_mfma_f32_16x16x32_bf16 v[164:167], a[228:231], a[152:155], v[164:167]
v_mfma_f32_16x16x32_bf16 v[164:167], a[232:235], a[156:159], v[164:167]
s_add_u32 m0, s34, 50176
v_mfma_f32_16x16x32_bf16 v[168:171], a[228:231], a[160:163], v[168:171]
buffer_load_dwordx4 v254, s[12:15], s32 offen sc1 lds
v_mfma_f32_16x16x32_bf16 v[168:171], a[232:235], a[164:167], v[168:171]
v_mfma_f32_16x16x32_bf16 v[172:175], a[228:231], a[168:171], v[172:175]
s_add_u32 s32, s32, 1024
v_min_u32 v244, v244, v245
v_mfma_f32_16x16x32_bf16 v[172:175], a[232:235], a[172:175], v[172:175]
v_add_u32 v252, 0x10000, v253
v_min3_u32 v244, v244, v246, v247
v_mfma_f32_16x16x32_bf16 v[176:179], a[228:231], a[176:179], v[176:179]
v_cmp_lt_u32 vcc, s22, v244
v_mfma_f32_16x16x32_bf16 v[176:179], a[232:235], a[180:183], v[176:179]
v_mfma_f32_16x16x32_bf16 v[180:183], a[228:231], a[184:187], v[180:183]
s_cmp_eq_u64 vcc, -1
s_cbranch_scc0 L_spinBwf
L_retBwf:
v_mfma_f32_16x16x32_bf16 v[180:183], a[232:235], a[188:191], v[180:183]
v_mfma_f32_16x16x32_bf16 v[184:187], a[228:231], a[192:195], v[184:187]
v_mfma_f32_16x16x32_bf16 v[184:187], a[232:235], a[196:199], v[184:187]
v_mfma_f32_16x16x32_bf16 v[188:191], a[228:231], a[200:203], v[188:191]
buffer_load_dwordx4 a[228:231], v254, s[8:11], s20 offen offset:1024
v_mfma_f32_16x16x32_bf16 v[188:191], a[232:235], a[204:207], v[188:191]
s_waitcnt vmcnt(12)
v_mfma_f32_16x16x32_bf16 v[220:223], a[236:239], a[200:203], v[220:223]
buffer_load_dwordx4 a[232:235], v254, s[8:11], s20 offen offset:2048
v_mfma_f32_16x16x32_bf16 v[220:223], a[240:243], a[204:207], v[220:223]
v_mfma_f32_16x16x32_bf16 v[216:219], a[236:239], a[192:195], v[216:219]
v_mfma_f32_16x16x32_bf16 v[216:219], a[240:243], a[196:199], v[216:219]
s_add_u32 m0, s34, 51200
v_mfma_f32_16x16x32_bf16 v[212:215], a[236:239], a[184:187], v[212:215]
buffer_load_dwordx4 v254, s[12:15], s32 offen sc1 lds
v_mfma_f32_16x16x32_bf16 v[212:215], a[240:243], a[188:191], v[212:215]
v_mfma_f32_16x16x32_bf16 v[208:211], a[236:239], a[176:179], v[208:211]
s_add_u32 s32, s32, 1024
v_mfma_f32_16x16x32_bf16 v[208:211], a[240:243], a[180:183], v[208:211]
v_mfma_f32_16x16x32_bf16 v[204:207], a[236:239], a[168:171], v[204:207]
v_mfma_f32_16x16x32_bf16 v[204:207], a[240:243], a[172:175], v[204:207]
v_mfma_f32_16x16x32_bf16 v[200:203], a[236:239], a[160:163], v[200:203]
v_mfma_f32_16x16x32_bf16 v[200:203], a[240:243], a[164:167], v[200:203]
v_mfma_f32_16x16x32_bf16 v[196:199], a[236:239], a[152:155], v[196:199]
s_barrier
v_mfma_f32_16x16x32_bf16 v[196:199], a[240:243], a[156:159], v[196:199]
v_mfma_f32_16x16x32_bf16 v[192:195], a[236:239], a[144:147], v[192:195]
buffer_load_dwordx4 a[236:239], v254, s[8:11], s20 offen offset:3072
v_mfma_f32_16x16x32_bf16 v[192:195], a[240:243], a[148:151], v[192:195]
s_waitcnt vmcnt(12)
s_add_u32 s20, s20, 4096
buffer_load_dwordx4 a[240:243], v254, s[8:11], s20 offen offset:0
v_mfma_f32_16x16x32_bf16 v[224:227], a[244:247], a[144:147], v[224:227]
ds_read_b128 a[144:147], v252 offset:0
v_mfma_f32_16x16x32_bf16 v[224:227], a[248:251], a[148:151], v[224:227]
ds_read_b128 a[148:151], v252 offset:512
v_mfma_f32_16x16x32_bf16 v[228:231], a[244:247], a[152:155], v[228:231]
ds_read_b128 a[152:155], v252 offset:2048
v_mfma_f32_16x16x32_bf16 v[228:231], a[248:251], a[156:159], v[228:231]
s_add_u32 m0, s34, 52224
ds_read_b128 a[156:159], v252 offset:2560
v_mfma_f32_16x16x32_bf16 v[232:235], a[244:247], a[160:163], v[232:235]
ds_read_b128 a[160:163], v252 offset:4096
buffer_load_dwordx4 v254, s[12:15], s32 offen sc1 lds
v_mfma_f32_16x16x32_bf16 v[232:235], a[248:251], a[164:167], v[232:235]
ds_read_b128 a[164:167], v252 offset:4608
v_mfma_f32_16x16x32_bf16 v[236:239], a[244:247], a[168:171], v[236:239]
s_add_u32 s32, s32, 13312
ds_read_b128 a[168:171], v252 offset:6144
v_mfma_f32_16x16x32_bf16 v[236:239], a[248:251], a[172:175], v[236:239]
ds_read_b128 a[172:175], v252 offset:6656
v_mfma_f32_16x16x32_bf16 a[0:3], a[244:247], a[176:179], a[0:3]
ds_read_b128 a[176:179], v252 offset:8192
v_mfma_f32_16x16x32_bf16 a[0:3], a[248:251], a[180:183], a[0:3]
ds_read_b128 a[180:183], v252 offset:8704
v_mfma_f32_16x16x32_bf16 a[4:7], a[244:247], a[184:187], a[4:7]
ds_read_b128 a[184:187], v252 offset:10240
v_mfma_f32_16x16x32_bf16 a[4:7], a[248:251], a[188:191], a[4:7]
ds_read_b128 a[188:191], v252 offset:10752
v_mfma_f32_16x16x32_bf16 a[8:11], a[244:247], a[192:195], a[8:11]
ds_read_b128 a[192:195], v252 offset:12288
v_mfma_f32_16x16x32_bf16 a[8:11], a[248:251], a[196:199], a[8:11]
ds_read_b128 a[196:199], v252 offset:12800
v_mfma_f32_16x16x32_bf16 a[12:15], a[244:247], a[200:203], a[12:15]
ds_read_b128 a[200:203], v252 offset:14336
v_mfma_f32_16x16x32_bf16 a[12:15], a[248:251], a[204:207], a[12:15]
s_waitcnt vmcnt(11) lgkmcnt(11)
ds_read_b128 a[204:207], v252 offset:14848
s_cmp_eq_u32 s22, 5
s_cbranch_scc1 L_lz
v_mfma_f32_16x16x32_bf16 v[0:3], a[208:211], a[144:147], v[0:3]
buffer_load_dwordx4 a[244:247], v254, s[8:11], s20 offen offset:1024
v_mfma_f32_16x16x32_bf16 v[0:3], a[212:215], a[148:151], v[0:3]
v_lshrrev_b32 v248, 6, v254
v_mfma_f32_16x16x32_bf16 v[4:7], a[208:211], a[152:155], v[4:7]
buffer_load_dwordx4 a[248:251], v254, s[8:11], s20 offen offset:2048
v_and_b32 v250, 0x30, v254
v_mfma_f32_16x16x32_bf16 v[4:7], a[212:215], a[156:159], v[4:7]
s_waitcnt lgkmcnt(8)
v_lshl_add_u32 v250, v248, 11, v250
v_mfma_f32_16x16x32_bf16 v[8:11], a[208:211], a[160:163], v[8:11]
v_lshrrev_b32 v248, 8, v254
v_mfma_f32_16x16x32_bf16 v[8:11], a[212:215], a[164:167], v[8:11]
v_and_b32 v251, 0xf0, v254
v_mfma_f32_16x16x32_bf16 v[12:15], a[208:211], a[168:171], v[12:15]
v_lshl_add_u32 v251, v248, 9, v251
v_mfma_f32_16x16x32_bf16 v[12:15], a[212:215], a[172:175], v[12:15]
s_waitcnt lgkmcnt(4)
v_add_u32 v251, s39, v251
v_mfma_f32_16x16x32_bf16 v[16:19], a[208:211], a[176:179], v[16:19]
s_add_u32 s29, s22, 2
v_mfma_f32_16x16x32_bf16 v[16:19], a[212:215], a[180:183], v[16:19]
v_mfma_f32_16x16x32_bf16 v[20:23], a[208:211], a[184:187], v[20:23]
v_mfma_f32_16x16x32_bf16 v[20:23], a[212:215], a[188:191], v[20:23]
s_waitcnt lgkmcnt(0)
v_mfma_f32_16x16x32_bf16 v[24:27], a[208:211], a[192:195], v[24:27]
v_mfma_f32_16x16x32_bf16 v[24:27], a[212:215], a[196:199], v[24:27]
v_mfma_f32_16x16x32_bf16 v[28:31], a[208:211], a[200:203], v[28:31]
buffer_load_dwordx4 a[208:211], v254, s[8:11], s20 offen offset:3072
v_mfma_f32_16x16x32_bf16 v[28:31], a[212:215], a[204:207], v[28:31]
s_waitcnt vmcnt(11)
s_add_u32 s20, s20, 4096
v_mfma_f32_16x16x32_bf16 v[60:63], a[216:219], a[200:203], v[60:63]
buffer_load_dwordx4 a[212:215], v254, s[8:11], s20 offen offset:0
v_mfma_f32_16x16x32_bf16 v[60:63], a[220:223], a[204:207], v[60:63]
v_mfma_f32_16x16x32_bf16 v[56:59], a[216:219], a[192:195], v[56:59]
v_mfma_f32_16x16x32_bf16 v[56:59], a[220:223], a[196:199], v[56:59]
v_mfma_f32_16x16x32_bf16 v[52:55], a[216:219], a[184:187], v[52:55]
v_mfma_f32_16x16x32_bf16 v[52:55], a[220:223], a[188:191], v[52:55]
v_mfma_f32_16x16x32_bf16 v[48:51], a[216:219], a[176:179], v[48:51]
v_mfma_f32_16x16x32_bf16 v[48:51], a[220:223], a[180:183], v[48:51]
v_mfma_f32_16x16x32_bf16 v[44:47], a[216:219], a[168:171], v[44:47]
v_mfma_f32_16x16x32_bf16 v[44:47], a[220:223], a[172:175], v[44:47]
v_mfma_f32_16x16x32_bf16 v[40:43], a[216:219], a[160:163], v[40:43]
v_mfma_f32_16x16x32_bf16 v[40:43], a[220:223], a[164:167], v[40:43]
v_mfma_f32_16x16x32_bf16 v[36:39], a[216:219], a[152:155], v[36:39]
v_mfma_f32_16x16x32_bf16 v[36:39], a[220:223], a[156:159], v[36:39]
v_mfma_f32_16x16x32_bf16 v[32:35], a[216:219], a[144:147], v[32:35]
buffer_load_dwordx4 a[216:219], v254, s[8:11], s20 offen offset:1024
v_mfma_f32_16x16x32_bf16 v[32:35], a[220:223], a[148:151], v[32:35]
s_waitcnt vmcnt(10)
v_mfma_f32_16x16x32_bf16 v[64:67], a[224:227], a[144:147], v[64:67]
buffer_load_dwordx4 a[220:223], v254, s[8:11], s20 offen offset:2048
v_mfma_f32_16x16x32_bf16 v[64:67], a[228:231], a[148:151], v[64:67]
v_mfma_f32_16x16x32_bf16 v[68:71], a[224:227], a[152:155], v[68:71]
v_mfma_f32_16x16x32_bf16 v[68:71], a[228:231], a[156:159], v[68:71]
v_mfma_f32_16x16x32_bf16 v[72:75], a[224:227], a[160:163], v[72:75]
v_mfma_f32_16x16x32_bf16 v[72:75], a[228:231], a[164:167], v[72:75]
v_mfma_f32_16x16x32_bf16 v[76:79], a[224:227], a[168:171], v[76:79]
v_mfma_f32_16x16x32_bf16 v[76:79], a[228:231], a[172:175], v[76:79]
v_mfma_f32_16x16x32_bf16 v[80:83], a[224:227], a[176:179], v[80:83]
v_mfma_f32_16x16x32_bf16 v[80:83], a[228:231], a[180:183], v[80:83]
v_mfma_f32_16x16x32_bf16 v[84:87], a[224:227], a[184:187], v[84:87]
v_mfma_f32_16x16x32_bf16 v[84:87], a[228:231], a[188:191], v[84:87]
v_mfma_f32_16x16x32_bf16 v[88:91], a[224:227], a[192:195], v[88:91]
v_mfma_f32_16x16x32_bf16 v[88:91], a[228:231], a[196:199], v[88:91]
v_mfma_f32_16x16x32_bf16 v[92:95], a[224:227], a[200:203], v[92:95]
buffer_load_dwordx4 a[224:227], v254, s[8:11], s20 offen offset:3072
v_mfma_f32_16x16x32_bf16 v[92:95], a[228:231], a[204:207], v[92:95]
s_waitcnt vmcnt(9)
s_add_u32 s20, s20, 4096
v_mfma_f32_16x16x32_bf16 v[124:127], a[232:235], a[200:203], v[124:127]
buffer_load_dwordx4 a[228:231], v254, s[8:11], s20 offen offset:0
v_mfma_f32_16x16x32_bf16 v[124:127], a[236:239], a[204:207], v[124:127]
s_add_u32 m0, s39, 32768
v_mfma_f32_16x16x32_bf16 v[120:123], a[232:235], a[192:195], v[120:123]
buffer_load_dwordx4 v250, s[52:55], s40 offen  lds
v_mfma_f32_16x16x32_bf16 v[120:123], a[236:239], a[196:199], v[120:123]
s_add_u32 s40, s40, 32768
v_mfma_f32_16x16x32_bf16 v[116:119], a[232:235], a[184:187], v[116:119]
v_mfma_f32_16x16x32_bf16 v[116:119], a[236:239], a[188:191], v[116:119]
s_add_u32 m0, s39, 33792
v_mfma_f32_16x16x32_bf16 v[112:115], a[232:235], a[176:179], v[112:115]
buffer_load_dwordx4 v250, s[52:55], s40 offen  lds
v_mfma_f32_16x16x32_bf16 v[112:115], a[236:239], a[180:183], v[112:115]
s_add_u32 s40, s40, 2064384
v_mfma_f32_16x16x32_bf16 v[108:111], a[232:235], a[168:171], v[108:111]
v_mfma_f32_16x16x32_bf16 v[108:111], a[236:239], a[172:175], v[108:111]
v_mfma_f32_16x16x32_bf16 v[104:107], a[232:235], a[160:163], v[104:107]
v_mfma_f32_16x16x32_bf16 v[104:107], a[236:239], a[164:167], v[104:107]
v_mfma_f32_16x16x32_bf16 v[100:103], a[232:235], a[152:155], v[100:103]
v_mfma_f32_16x16x32_bf16 v[100:103], a[236:239], a[156:159], v[100:103]
v_mfma_f32_16x16x32_bf16 v[96:99], a[232:235], a[144:147], v[96:99]
buffer_load_dwordx4 a[232:235], v254, s[8:11], s20 offen offset:1024
v_mfma_f32_16x16x32_bf16 v[96:99], a[236:239], a[148:151], v[96:99]
s_waitcnt vmcnt(10)
v_mfma_f32_16x16x32_bf16 v[128:131], a[240:243], a[144:147], v[128:131]
buffer_load_dwordx4 a[236:239], v254, s[8:11], s20 offen offset:2048
v_mfma_f32_16x16x32_bf16 v[128:131], a[244:247], a[148:151], v[128:131]
v_mfma_f32_16x16x32_bf16 v[132:135], a[240:243], a[152:155], v[132:135]
v_mfma_f32_16x16x32_bf16 v[132:135], a[244:247], a[156:159], v[132:135]
v_mfma_f32_16x16x32_bf16 v[136:139], a[240:243], a[160:163], v[136:139]
v_mfma_f32_16x16x32_bf16 v[136:139], a[244:247], a[164:167], v[136:139]
v_mfma_f32_16x16x32_bf16 v[140:143], a[240:243], a[168:171], v[140:143]
v_mfma_f32_16x16x32_bf16 v[140:143], a[244:247], a[172:175], v[140:143]
v_mfma_f32_16x16x32_bf16 v[144:147], a[240:243], a[176:179], v[144:147]
v_mfma_f32_16x16x32_bf16 v[144:147], a[244:247], a[180:183], v[144:147]
v_mfma_f32_16x16x32_bf16 v[148:151], a[240:243], a[184:187], v[148:151]
v_mfma_f32_16x16x32_bf16 v[148:151], a[244:247], a[188:191], v[148:151]
v_mfma_f32_16x16x32_bf16 v[152:155], a[240:243], a[192:195], v[152:155]
v_mfma_f32_16x16x32_bf16 v[152:155], a[244:247], a[196:199], v[152:155]
v_mfma_f32_16x16x32_bf16 v[156:159], a[240:243], a[200:203], v[156:159]
buffer_load_dwordx4 a[240:243], v254, s[8:11], s20 offen offset:3072
v_mfma_f32_16x16x32_bf16 v[156:159], a[244:247], a[204:207], v[156:159]
s_waitcnt vmcnt(10)
s_add_u32 s20, s20, 4096
v_mfma_f32_16x16x32_bf16 v[188:191], a[248:251], a[200:203], v[188:191]
buffer_load_dwordx4 a[244:247], v254, s[8:11], s20 offen offset:0
v_mfma_f32_16x16x32_bf16 v[188:191], a[208:211], a[204:207], v[188:191]
v_mfma_f32_16x16x32_bf16 v[184:187], a[248:251], a[192:195], v[184:187]
v_mfma_f32_16x16x32_bf16 v[184:187], a[208:211], a[196:199], v[184:187]
v_mfma_f32_16x16x32_bf16 v[180:183], a[248:251], a[184:187], v[180:183]
v_mfma_f32_16x16x32_bf16 v[180:183], a[208:211], a[188:191], v[180:183]
v_mfma_f32_16x16x32_bf16 v[176:179], a[248:251], a[176:179], v[176:179]
v_mfma_f32_16x16x32_bf16 v[176:179], a[208:211], a[180:183], v[176:179]
v_mfma_f32_16x16x32_bf16 v[172:175], a[248:251], a[168:171], v[172:175]
v_mfma_f32_16x16x32_bf16 v[172:175], a[208:211], a[172:175], v[172:175]
v_mfma_f32_16x16x32_bf16 v[168:171], a[248:251], a[160:163], v[168:171]
v_mfma_f32_16x16x32_bf16 v[168:171], a[208:211], a[164:167], v[168:171]
v_mfma_f32_16x16x32_bf16 v[164:167], a[248:251], a[152:155], v[164:167]
v_mfma_f32_16x16x32_bf16 v[164:167], a[208:211], a[156:159], v[164:167]
v_mfma_f32_16x16x32_bf16 v[160:163], a[248:251], a[144:147], v[160:163]
buffer_load_dwordx4 a[248:251], v254, s[8:11], s20 offen offset:1024
v_mfma_f32_16x16x32_bf16 v[160:163], a[208:211], a[148:151], v[160:163]
s_waitcnt vmcnt(10)
v_mfma_f32_16x16x32_bf16 v[192:195], a[212:215], a[144:147], v[192:195]
buffer_load_dwordx4 a[208:211], v254, s[8:11], s20 offen offset:2048
v_mfma_f32_16x16x32_bf16 v[192:195], a[216:219], a[148:151], v[192:195]
v_mfma_f32_16x16x32_bf16 v[196:199], a[212:215], a[152:155], v[196:199]
v_mfma_f32_16x16x32_bf16 v[196:199], a[216:219], a[156:159], v[196:199]
v_mfma_f32_16x16x32_bf16 v[200:203], a[212:215], a[160:163], v[200:203]
v_mfma_f32_16x16x32_bf16 v[200:203], a[216:219], a[164:167], v[200:203]
v_mfma_f32_16x16x32_bf16 v[204:207], a[212:215], a[168:171], v[204:207]
v_mfma_f32_16x16x32_bf16 v[204:207], a[216:219], a[172:175], v[204:207]
v_mfma_f32_16x16x32_bf16 v[208:211], a[212:215], a[176:179], v[208:211]
v_mfma_f32_16x16x32_bf16 v[208:211], a[216:219], a[180:183], v[208:211]
v_mfma_f32_16x16x32_bf16 v[212:215], a[212:215], a[184:187], v[212:215]
v_mfma_f32_16x16x32_bf16 v[212:215], a[216:219], a[188:191], v[212:215]
v_mfma_f32_16x16x32_bf16 v[216:219], a[212:215], a[192:195], v[216:219]
v_mfma_f32_16x16x32_bf16 v[216:219], a[216:219], a[196:199], v[216:219]
v_mfma_f32_16x16x32_bf16 v[220:223], a[212:215], a[200:203], v[220:223]
buffer_load_dwordx4 a[212:215], v254, s[8:11], s20 offen offset:3072
v_mfma_f32_16x16x32_bf16 v[220:223], a[216:219], a[204:207], v[220:223]
s_waitcnt vmcnt(10)
s_add_u32 s20, s20, 4096
v_mfma_f32_16x16x32_bf16 a[12:15], a[220:223], a[200:203], a[12:15]
ds_read_b128 a[200:203], v252 offset:47104
v_mfma_f32_16x16x32_bf16 a[12:15], a[224:227], a[204:207], a[12:15]
ds_read_b128 a[204:207], v252 offset:47616
v_mfma_f32_16x16x32_bf16 a[8:11], a[220:223], a[192:195], a[8:11]
ds_read_b128 a[192:195], v252 offset:45056
v_mfma_f32_16x16x32_bf16 a[8:11], a[224:227], a[196:199], a[8:11]
ds_read_b128 a[196:199], v252 offset:45568
v_mfma_f32_16x16x32_bf16 a[4:7], a[220:223], a[184:187], a[4:7]
ds_read_b128 a[184:187], v252 offset:43008
v_mfma_f32_16x16x32_bf16 a[4:7], a[224:227], a[188:191], a[4:7]
ds_read_b128 a[188:191], v252 offset:43520
v_mfma_f32_16x16x32_bf16 a[0:3], a[220:223], a[176:179], a[0:3]
ds_read_b128 a[176:179], v252 offset:40960
v_mfma_f32_16x16x32_bf16 a[0:3], a[224:227], a[180:183], a[0:3]
ds_read_b128 a[180:183], v252 offset:41472
v_mfma_f32_16x16x32_bf16 v[236:239], a[220:223], a[168:171], v[236:239]
ds_read_b128 a[168:171], v252 offset:38912
v_mfma_f32_16x16x32_bf16 v[236:239], a[224:227], a[172:175], v[236:239]
ds_read_b128 a[172:175], v252 offset:39424
v_mfma_f32_16x16x32_bf16 v[232:235], a[220:223], a[160:163], v[232:235]
ds_read_b128 a[160:163], v252 offset:36864
v_mfma_f32_16x16x32_bf16 v[232:235], a[224:227], a[164:167], v[232:235]
ds_read_b128 a[164:167], v252 offset:37376
v_mfma_f32_16x16x32_bf16 v[228:231], a[220:223], a[152:155], v[228:231]
ds_read_b128 a[152:155], v252 offset:34816
v_mfma_f32_16x16x32_bf16 v[228:231], a[224:227], a[156:159], v[228:231]
ds_read_b128 a[156:159], v252 offset:35328
v_mfma_f32_16x16x32_bf16 v[224:227], a[220:223], a[144:147], v[224:227]
ds_read_b128 a[144:147], v252 offset:32768
v_mfma_f32_16x16x32_bf16 v[224:227], a[224:227], a[148:151], v[224:227]
s_waitcnt vmcnt(6) lgkmcnt(11)
ds_read_b128 a[148:151], v252 offset:33280
v_mfma_f32_16x16x32_bf16 v[28:31], a[228:231], a[200:203], v[28:31]
buffer_load_dwordx4 a[220:223], v254, s[8:11], s20 offen offset:0
v_mfma_f32_16x16x32_bf16 v[28:31], a[232:235], a[204:207], v[28:31]
v_mfma_f32_16x16x32_bf16 v[24:27], a[228:231], a[192:195], v[24:27]
buffer_load_dwordx4 a[224:227], v254, s[8:11], s20 offen offset:1024
v_mfma_f32_16x16x32_bf16 v[24:27], a[232:235], a[196:199], v[24:27]
s_waitcnt lgkmcnt(8)
v_mfma_f32_16x16x32_bf16 v[20:23], a[228:231], a[184:187], v[20:23]
v_mfma_f32_16x16x32_bf16 v[20:23], a[232:235], a[188:191], v[20:23]
v_mfma_f32_16x16x32_bf16 v[16:19], a[228:231], a[176:179], v[16:19]
v_mfma_f32_16x16x32_bf16 v[16:19], a[232:235], a[180:183], v[16:19]
s_waitcnt lgkmcnt(4)
v_mfma_f32_16x16x32_bf16 v[12:15], a[228:231], a[168:171], v[12:15]
v_mfma_f32_16x16x32_bf16 v[12:15], a[232:235], a[172:175], v[12:15]
v_mfma_f32_16x16x32_bf16 v[8:11], a[228:231], a[160:163], v[8:11]
v_mfma_f32_16x16x32_bf16 v[8:11], a[232:235], a[164:167], v[8:11]
s_waitcnt lgkmcnt(0)
v_mfma_f32_16x16x32_bf16 v[4:7], a[228:231], a[152:155], v[4:7]
v_mfma_f32_16x16x32_bf16 v[4:7], a[232:235], a[156:159], v[4:7]
v_mfma_f32_16x16x32_bf16 v[0:3], a[228:231], a[144:147], v[0:3]
buffer_load_dwordx4 a[228:231], v254, s[8:11], s20 offen offset:2048
v_mfma_f32_16x16x32_bf16 v[0:3], a[232:235], a[148:151], v[0:3]
s_waitcnt vmcnt(7)
v_mfma_f32_16x16x32_bf16 v[32:35], a[236:239], a[144:147], v[32:35]
buffer_load_dwordx4 a[232:235], v254, s[8:11], s20 offen offset:3072
v_mfma_f32_16x16x32_bf16 v[32:35], a[240:243], a[148:151], v[32:35]
s_add_u32 s20, s20, 4096
v_mfma_f32_16x16x32_bf16 v[36:39], a[236:239], a[152:155], v[36:39]
v_mfma_f32_16x16x32_bf16 v[36:39], a[240:243], a[156:159], v[36:39]
v_mfma_f32_16x16x32_bf16 v[40:43], a[236:239], a[160:163], v[40:43]
v_mfma_f32_16x16x32_bf16 v[40:43], a[240:243], a[164:167], v[40:43]
v_mfma_f32_16x16x32_bf16 v[44:47], a[236:239], a[168:171], v[44:47]
v_mfma_f32_16x16x32_bf16 v[44:47], a[240:243], a[172:175], v[44:47]
v_mfma_f32_16x16x32_bf16 v[48:51], a[236:239], a[176:179], v[48:51]
v_mfma_f32_16x16x32_bf16 v[48:51], a[240:243], a[180:183], v[48:51]
v_mfma_f32_16x16x32_bf16 v[52:55], a[236:239], a[184:187], v[52:55]
v_mfma_f32_16x16x32_bf16 v[52:55], a[240:243], a[188:191], v[52:55]
v_mfma_f32_16x16x32_bf16 v[56:59], a[236:239], a[192:195], v[56:59]
v_mfma_f32_16x16x32_bf16 v[56:59], a[240:243], a[196:199], v[56:59]
ds_read_b64_tr_b16 v[240:241], v251 offset:32768
v_mfma_f32_16x16x32_bf16 v[60:63], a[236:239], a[200:203], v[60:63]
buffer_load_dwordx4 a[236:239], v254, s[8:11], s20 offen offset:0
v_mfma_f32_16x16x32_bf16 v[60:63], a[240:243], a[204:207], v[60:63]
s_waitcnt vmcnt(7)
ds_read_b64_tr_b16 v[242:243], v251 offset:33024
v_mfma_f32_16x16x32_bf16 v[92:95], a[244:247], a[200:203], v[92:95]
buffer_load_dwordx4 a[240:243], v254, s[8:11], s20 offen offset:1024
v_mfma_f32_16x16x32_bf16 v[92:95], a[248:251], a[204:207], v[92:95]
ds_read_b64_tr_b16 v[244:245], v251 offset:32776
v_mfma_f32_16x16x32_bf16 v[88:91], a[244:247], a[192:195], v[88:91]
ds_read_b64_tr_b16 v[246:247], v251 offset:33032
v_mfma_f32_16x16x32_bf16 v[88:91], a[248:251], a[196:199], v[88:91]
v_mfma_f32_16x16x32_bf16 v[84:87], a[244:247], a[184:187], v[84:87]
v_mfma_f32_16x16x32_bf16 v[84:87], a[248:251], a[188:191], v[84:87]
v_mfma_f32_16x16x32_bf16 v[80:83], a[244:247], a[176:179], v[80:83]
v_mfma_f32_16x16x32_bf16 v[80:83], a[248:251], a[180:183], v[80:83]
v_mfma_f32_16x16x32_bf16 v[76:79], a[244:247], a[168:171], v[76:79]
v_mfma_f32_16x16x32_bf16 v[76:79], a[248:251], a[172:175], v[76:79]
s_waitcnt lgkmcnt(2)
buffer_store_dwordx4 v[240:243], v254, s[8:11], s41 offen offset:0 sc1
v_mfma_f32_16x16x32_bf16 v[72:75], a[244:247], a[160:163], v[72:75]
v_mfma_f32_16x16x32_bf16 v[72:75], a[248:251], a[164:167], v[72:75]
v_mfma_f32_16x16x32_bf16 v[68:71], a[244:247], a[152:155], v[68:71]
v_mfma_f32_16x16x32_bf16 v[68:71], a[248:251], a[156:159], v[68:71]
v_mfma_f32_16x16x32_bf16 v[64:67], a[244:247], a[144:147], v[64:67]
buffer_load_dwordx4 a[244:247], v254, s[8:11], s20 offen offset:2048
v_mfma_f32_16x16x32_bf16 v[64:67], a[248:251], a[148:151], v[64:67]
s_waitcnt vmcnt(8)
v_mfma_f32_16x16x32_bf16 v[96:99], a[208:211], a[144:147], v[96:99]
buffer_load_dwordx4 a[248:251], v254, s[8:11], s20 offen offset:3072
v_mfma_f32_16x16x32_bf16 v[96:99], a[212:215], a[148:151], v[96:99]
s_add_u32 s20, s20, 4096
v_mfma_f32_16x16x32_bf16 v[100:103], a[208:211], a[152:155], v[100:103]
v_mfma_f32_16x16x32_bf16 v[100:103], a[212:215], a[156:159], v[100:103]
v_mfma_f32_16x16x32_bf16 v[104:107], a[208:211], a[160:163], v[104:107]
v_mfma_f32_16x16x32_bf16 v[104:107], a[212:215], a[164:167], v[104:107]
v_mfma_f32_16x16x32_bf16 v[108:111], a[208:211], a[168:171], v[108:111]
v_mfma_f32_16x16x32_bf16 v[108:111], a[212:215], a[172:175], v[108:111]
v_mfma_f32_16x16x32_bf16 v[112:115], a[208:211], a[176:179], v[112:115]
v_mfma_f32_16x16x32_bf16 v[112:115], a[212:215], a[180:183], v[112:115]
v_mfma_f32_16x16x32_bf16 v[116:119], a[208:211], a[184:187], v[116:119]
v_mfma_f32_16x16x32_bf16 v[116:119], a[212:215], a[188:191], v[116:119]
v_mfma_f32_16x16x32_bf16 v[120:123], a[208:211], a[192:195], v[120:123]
v_mfma_f32_16x16x32_bf16 v[120:123], a[212:215], a[196:199], v[120:123]
v_mfma_f32_16x16x32_bf16 v[124:127], a[208:211], a[200:203], v[124:127]
buffer_load_dwordx4 a[208:211], v254, s[8:11], s20 offen offset:0
v_mfma_f32_16x16x32_bf16 v[124:127], a[212:215], a[204:207], v[124:127]
s_waitcnt vmcnt(8)
v_mfma_f32_16x16x32_bf16 v[156:159], a[220:223], a[200:203], v[156:159]
buffer_load_dwordx4 a[212:215], v254, s[8:11], s20 offen offset:1024
v_mfma_f32_16x16x32_bf16 v[156:159], a[224:227], a[204:207], v[156:159]
v_mfma_f32_16x16x32_bf16 v[152:155], a[220:223], a[192:195], v[152:155]
buffer_load_dwordx4 a[216:219], v254, s[8:11], s20 offen offset:2048
v_mfma_f32_16x16x32_bf16 v[152:155], a[224:227], a[196:199], v[152:155]
v_mfma_f32_16x16x32_bf16 v[148:151], a[220:223], a[184:187], v[148:151]
v_mfma_f32_16x16x32_bf16 v[148:151], a[224:227], a[188:191], v[148:151]
v_mfma_f32_16x16x32_bf16 v[144:147], a[220:223], a[176:179], v[144:147]
s_waitcnt lgkmcnt(0)
buffer_store_dwordx4 v[244:247], v254, s[8:11], s41 offen offset:2048 sc1
v_mfma_f32_16x16x32_bf16 v[144:147], a[224:227], a[180:183], v[144:147]
s_add_u32 s41, s41, 262144
v_mfma_f32_16x16x32_bf16 v[140:143], a[220:223], a[168:171], v[140:143]
v_mfma_f32_16x16x32_bf16 v[140:143], a[224:227], a[172:175], v[140:143]
v_mfma_f32_16x16x32_bf16 v[136:139], a[220:223], a[160:163], v[136:139]
v_mfma_f32_16x16x32_bf16 v[136:139], a[224:227], a[164:167], v[136:139]
v_mfma_f32_16x16x32_bf16 v[132:135], a[220:223], a[152:155], v[132:135]
v_mfma_f32_16x16x32_bf16 v[132:135], a[224:227], a[156:159], v[132:135]
v_mfma_f32_16x16x32_bf16 v[128:131], a[220:223], a[144:147], v[128:131]
buffer_load_dwordx4 a[220:223], v254, s[8:11], s20 offen offset:3072
v_mfma_f32_16x16x32_bf16 v[128:131], a[224:227], a[148:151], v[128:131]
s_waitcnt vmcnt(10)
s_add_u32 s20, s20, 4096
v_mfma_f32_16x16x32_bf16 v[160:163], a[228:231], a[144:147], v[160:163]
buffer_load_dwordx4 a[224:227], v254, s[8:11], s20 offen offset:0
v_mfma_f32_16x16x32_bf16 v[160:163], a[232:235], a[148:151], v[160:163]
v_mfma_f32_16x16x32_bf16 v[164:167], a[228:231], a[152:155], v[164:167]
v_mfma_f32_16x16x32_bf16 v[164:167], a[232:235], a[156:159], v[164:167]
v_mfma_f32_16x16x32_bf16 v[168:171], a[228:231], a[160:163], v[168:171]
v_mfma_f32_16x16x32_bf16 v[168:171], a[232:235], a[164:167], v[168:171]
v_mfma_f32_16x16x32_bf16 v[172:175], a[228:231], a[168:171], v[172:175]
v_mfma_f32_16x16x32_bf16 v[172:175], a[232:235], a[172:175], v[172:175]
v_add_u32 v252, 0x0, v253
v_mfma_f32_16x16x32_bf16 v[176:179], a[228:231], a[176:179], v[176:179]
v_mfma_f32_16x16x32_bf16 v[176:179], a[232:235], a[180:183], v[176:179]
v_mfma_f32_16x16x32_bf16 v[180:183], a[228:231], a[184:187], v[180:183]
v_mfma_f32_16x16x32_bf16 v[180:183], a[232:235], a[188:191], v[180:183]
v_mfma_f32_16x16x32_bf16 v[184:187], a[228:231], a[192:195], v[184:187]
v_mfma_f32_16x16x32_bf16 v[184:187], a[232:235], a[196:199], v[184:187]
v_mfma_f32_16x16x32_bf16 v[188:191], a[228:231], a[200:203], v[188:191]
buffer_load_dwordx4 a[228:231], v254, s[8:11], s20 offen offset:1024
v_mfma_f32_16x16x32_bf16 v[188:191], a[232:235], a[204:207], v[188:191]
s_waitcnt vmcnt(10)
v_mfma_f32_16x16x32_bf16 v[220:223], a[236:239], a[200:203], v[220:223]
buffer_load_dwordx4 a[232:235], v254, s[8:11], s20 offen offset:2048
v_mfma_f32_16x16x32_bf16 v[220:223], a[240:243], a[204:207], v[220:223]
v_mfma_f32_16x16x32_bf16 v[216:219], a[236:239], a[192:195], v[216:219]
v_mfma_f32_16x16x32_bf16 v[216:219], a[240:243], a[196:199], v[216:219]
v_mfma_f32_16x16x32_bf16 v[212:215], a[236:239], a[184:187], v[212:215]
v_mfma_f32_16x16x32_bf16 v[212:215], a[240:243], a[188:191], v[212:215]
v_mfma_f32_16x16x32_bf16 v[208:211], a[236:239], a[176:179], v[208:211]
v_mfma_f32_16x16x32_bf16 v[208:211], a[240:243], a[180:183], v[208:211]
v_mfma_f32_16x16x32_bf16 v[204:207], a[236:239], a[168:171], v[204:207]
v_mfma_f32_16x16x32_bf16 v[204:207], a[240:243], a[172:175], v[204:207]
v_mfma_f32_16x16x32_bf16 v[200:203], a[236:239], a[160:163], v[200:203]
v_mfma_f32_16x16x32_bf16 v[200:203], a[240:243], a[164:167], v[200:203]
v_mfma_f32_16x16x32_bf16 v[196:199], a[236:239], a[152:155], v[196:199]
s_barrier
v_mfma_f32_16x16x32_bf16 v[196:199], a[240:243], a[156:159], v[196:199]
v_mfma_f32_16x16x32_bf16 v[192:195], a[236:239], a[144:147], v[192:195]
buffer_load_dwordx4 a[236:239], v254, s[8:11], s20 offen offset:3072
v_mfma_f32_16x16x32_bf16 v[192:195], a[240:243], a[148:151], v[192:195]
s_waitcnt vmcnt(9)
s_add_u32 s20, s20, 4096
buffer_load_dwordx4 a[240:243], v254, s[8:11], s20 offen offset:0
v_mfma_f32_16x16x32_bf16 v[224:227], a[244:247], a[144:147], v[224:227]
ds_read_b128 a[144:147], v252 offset:16384
v_mfma_f32_16x16x32_bf16 v[224:227], a[248:251], a[148:151], v[224:227]
ds_read_b128 a[148:151], v252 offset:16896
v_mfma_f32_16x16x32_bf16 v[228:231], a[244:247], a[152:155], v[228:231]
ds_read_b128 a[152:155], v252 offset:18432
v_mfma_f32_16x16x32_bf16 v[228:231], a[248:251], a[156:159], v[228:231]
ds_read_b128 a[156:159], v252 offset:18944
v_mfma_f32_16x16x32_bf16 v[232:235], a[244:247], a[160:163], v[232:235]
ds_read_b128 a[160:163], v252 offset:20480
v_mfma_f32_16x16x32_bf16 v[232:235], a[248:251], a[164:167], v[232:235]
ds_read_b128 a[164:167], v252 offset:20992
v_mfma_f32_16x16x32_bf16 v[236:239], a[244:247], a[168:171], v[236:239]
ds_read_b128 a[168:171], v252 offset:22528
v_mfma_f32_16x16x32_bf16 v[236:239], a[248:251], a[172:175], v[236:239]
ds_read_b128 a[172:175], v252 offset:23040
v_mfma_f32_16x16x32_bf16 a[0:3], a[244:247], a[176:179], a[0:3]
ds_read_b128 a[176:179], v252 offset:24576
v_mfma_f32_16x16x32_bf16 a[0:3], a[248:251], a[180:183], a[0:3]
ds_read_b128 a[180:183], v252 offset:25088
v_mfma_f32_16x16x32_bf16 a[4:7], a[244:247], a[184:187], a[4:7]
ds_read_b128 a[184:187], v252 offset:26624
v_mfma_f32_16x16x32_bf16 a[4:7], a[248:251], a[188:191], a[4:7]
ds_read_b128 a[188:191], v252 offset:27136
v_mfma_f32_16x16x32_bf16 a[8:11], a[244:247], a[192:195], a[8:11]
ds_read_b128 a[192:195], v252 offset:28672
v_mfma_f32_16x16x32_bf16 a[8:11], a[248:251], a[196:199], a[8:11]
ds_read_b128 a[196:199], v252 offset:29184
v_mfma_f32_16x16x32_bf16 a[12:15], a[244:247], a[200:203], a[12:15]
ds_read_b128 a[200:203], v252 offset:30720
v_mfma_f32_16x16x32_bf16 a[12:15], a[248:251], a[204:207], a[12:15]
s_waitcnt vmcnt(8) lgkmcnt(11)
ds_read_b128 a[204:207], v252 offset:31232
v_mfma_f32_16x16x32_bf16 v[0:3], a[208:211], a[144:147], v[0:3]
buffer_load_dwordx4 a[244:247], v254, s[8:11], s20 offen offset:1024
v_mfma_f32_16x16x32_bf16 v[0:3], a[212:215], a[148:151], v[0:3]
v_mfma_f32_16x16x32_bf16 v[4:7], a[208:211], a[152:155], v[4:7]
buffer_load_dwordx4 a[248:251], v254, s[8:11], s20 offen offset:2048
v_mfma_f32_16x16x32_bf16 v[4:7], a[212:215], a[156:159], v[4:7]
s_waitcnt lgkmcnt(8)
v_mfma_f32_16x16x32_bf16 v[8:11], a[208:211], a[160:163], v[8:11]
v_mfma_f32_16x16x32_bf16 v[8:11], a[212:215], a[164:167], v[8:11]
v_mfma_f32_16x16x32_bf16 v[12:15], a[208:211], a[168:171], v[12:15]
v_mfma_f32_16x16x32_bf16 v[12:15], a[212:215], a[172:175], v[12:15]
s_waitcnt lgkmcnt(4)
v_mfma_f32_16x16x32_bf16 v[16:19], a[208:211], a[176:179], v[16:19]
v_mfma_f32_16x16x32_bf16 v[16:19], a[212:215], a[180:183], v[16:19]
v_mfma_f32_16x16x32_bf16 v[20:23], a[208:211], a[184:187], v[20:23]
v_mfma_f32_16x16x32_bf16 v[20:23], a[212:215], a[188:191], v[20:23]
s_waitcnt lgkmcnt(0)
v_mfma_f32_16x16x32_bf16 v[24:27], a[208:211], a[192:195], v[24:27]
v_mfma_f32_16x16x32_bf16 v[24:27], a[212:215], a[196:199], v[24:27]
v_mfma_f32_16x16x32_bf16 v[28:31], a[208:211], a[200:203], v[28:31]
buffer_load_dwordx4 a[208:211], v254, s[8:11], s20 offen offset:3072
v_mfma_f32_16x16x32_bf16 v[28:31], a[212:215], a[204:207], v[28:31]
s_waitcnt vmcnt(8)
s_add_u32 s20, s20, 4096
v_mfma_f32_16x16x32_bf16 v[60:63], a[216:219], a[200:203], v[60:63]
buffer_load_dwordx4 a[212:215], v254, s[8:11], s20 offen offset:0
v_mfma_f32_16x16x32_bf16 v[60:63], a[220:223], a[204:207], v[60:63]
v_mfma_f32_16x16x32_bf16 v[56:59], a[216:219], a[192:195], v[56:59]
v_mfma_f32_16x16x32_bf16 v[56:59], a[220:223], a[196:199], v[56:59]
v_mfma_f32_16x16x32_bf16 v[52:55], a[216:219], a[184:187], v[52:55]
v_mfma_f32_16x16x32_bf16 v[52:55], a[220:223], a[188:191], v[52:55]
v_mfma_f32_16x16x32_bf16 v[48:51], a[216:219], a[176:179], v[48:51]
v_mfma_f32_16x16x32_bf16 v[48:51], a[220:223], a[180:183], v[48:51]
v_mfma_f32_16x16x32_bf16 v[44:47], a[216:219], a[168:171], v[44:47]
v_mfma_f32_16x16x32_bf16 v[44:47], a[220:223], a[172:175], v[44:47]
v_mfma_f32_16x16x32_bf16 v[40:43], a[216:219], a[160:163], v[40:43]
v_mfma_f32_16x16x32_bf16 v[40:43], a[220:223], a[164:167], v[40:43]
v_mfma_f32_16x16x32_bf16 v[36:39], a[216:219], a[152:155], v[36:39]
v_mfma_f32_16x16x32_bf16 v[36:39], a[220:223], a[156:159], v[36:39]
v_mfma_f32_16x16x32_bf16 v[32:35], a[216:219], a[144:147], v[32:35]
buffer_load_dwordx4 a[216:219], v254, s[8:11], s20 offen offset:1024
v_mfma_f32_16x16x32_bf16 v[32:35], a[220:223], a[148:151], v[32:35]
s_waitcnt vmcnt(8)
v_mfma_f32_16x16x32_bf16 v[64:67], a[224:227], a[144:147], v[64:67]
buffer_load_dwordx4 a[220:223], v254, s[8:11], s20 offen offset:2048
v_mfma_f32_16x16x32_bf16 v[64:67], a[228:231], a[148:151], v[64:67]
v_mfma_f32_16x16x32_bf16 v[68:71], a[224:227], a[152:155], v[68:71]
v_mov_b32 v248, s29
v_mfma_f32_16x16x32_bf16 v[68:71], a[228:231], a[156:159], v[68:71]
buffer_store_dword v248, off, s[8:11], s50 sc1
v_mfma_f32_16x16x32_bf16 v[72:75], a[224:227], a[160:163], v[72:75]
v_mfma_f32_16x16x32_bf16 v[72:75], a[228:231], a[164:167], v[72:75]
v_mfma_f32_16x16x32_bf16 v[76:79], a[224:227], a[168:171], v[76:79]
v_mfma_f32_16x16x32_bf16 v[76:79], a[228:231], a[172:175], v[76:79]
v_mfma_f32_16x16x32_bf16 v[80:83], a[224:227], a[176:179], v[80:83]
v_mfma_f32_16x16x32_bf16 v[80:83], a[228:231], a[180:183], v[80:83]
v_mfma_f32_16x16x32_bf16 v[84:87], a[224:227], a[184:187], v[84:87]
v_mfma_f32_16x16x32_bf16 v[84:87], a[228:231], a[188:191], v[84:87]
v_mfma_f32_16x16x32_bf16 v[88:91], a[224:227], a[192:195], v[88:91]
v_mfma_f32_16x16x32_bf16 v[88:91], a[228:231], a[196:199], v[88:91]
v_mfma_f32_16x16x32_bf16 v[92:95], a[224:227], a[200:203], v[92:95]
buffer_load_dwordx4 a[224:227], v254, s[8:11], s20 offen offset:3072
v_mfma_f32_16x16x32_bf16 v[92:95], a[228:231], a[204:207], v[92:95]
s_waitcnt vmcnt(9)
s_add_u32 s20, s20, 4096
v_mfma_f32_16x16x32_bf16 v[124:127], a[232:235], a[200:203], v[124:127]
buffer_load_dwordx4 a[228:231], v254, s[8:11], s20 offen offset:0
v_mfma_f32_16x16x32_bf16 v[124:127], a[236:239], a[204:207], v[124:127]
v_mfma_f32_16x16x32_bf16 v[120:123], a[232:235], a[192:195], v[120:123]
v_mfma_f32_16x16x32_bf16 v[120:123], a[236:239], a[196:199], v[120:123]
v_mfma_f32_16x16x32_bf16 v[116:119], a[232:235], a[184:187], v[116:119]
v_mfma_f32_16x16x32_bf16 v[116:119], a[236:239], a[188:191], v[116:119]
v_mfma_f32_16x16x32_bf16 v[112:115], a[232:235], a[176:179], v[112:115]
v_mfma_f32_16x16x32_bf16 v[112:115], a[236:239], a[180:183], v[112:115]
v_mfma_f32_16x16x32_bf16 v[108:111], a[232:235], a[168:171], v[108:111]
v_mfma_f32_16x16x32_bf16 v[108:111], a[236:239], a[172:175], v[108:111]
v_mfma_f32_16x16x32_bf16 v[104:107], a[232:235], a[160:163], v[104:107]
v_mfma_f32_16x16x32_bf16 v[104:107], a[236:239], a[164:167], v[104:107]
v_mfma_f32_16x16x32_bf16 v[100:103], a[232:235], a[152:155], v[100:103]
v_mfma_f32_16x16x32_bf16 v[100:103], a[236:239], a[156:159], v[100:103]
v_mfma_f32_16x16x32_bf16 v[96:99], a[232:235], a[144:147], v[96:99]
buffer_load_dwordx4 a[232:235], v254, s[8:11], s20 offen offset:1024
v_mfma_f32_16x16x32_bf16 v[96:99], a[236:239], a[148:151], v[96:99]
s_waitcnt vmcnt(9)
s_and_b32 s42, s22, 1
v_mfma_f32_16x16x32_bf16 v[128:131], a[240:243], a[144:147], v[128:131]
s_add_u32 s42, s42, 1
buffer_load_dwordx4 a[236:239], v254, s[8:11], s20 offen offset:2048
v_mfma_f32_16x16x32_bf16 v[128:131], a[244:247], a[148:151], v[128:131]
s_mul_i32 s43, s42, 41943040
v_mfma_f32_16x16x32_bf16 v[132:135], a[240:243], a[152:155], v[132:135]
s_add_u32 s12, s44, s43
s_addc_u32 s13, s45, 0
v_mfma_f32_16x16x32_bf16 v[132:135], a[244:247], a[156:159], v[132:135]
s_mov_b32 s16, s12
v_mfma_f32_16x16x32_bf16 v[136:139], a[240:243], a[160:163], v[136:139]
s_mov_b32 s17, s13
v_mfma_f32_16x16x32_bf16 v[136:139], a[244:247], a[164:167], v[136:139]
s_mov_b32 s14, 33685504
v_mfma_f32_16x16x32_bf16 v[140:143], a[240:243], a[168:171], v[140:143]
s_mov_b32 s32, s33
v_mfma_f32_16x16x32_bf16 v[140:143], a[244:247], a[172:175], v[140:143]
s_mov_b32 s30, s31
v_mfma_f32_16x16x32_bf16 v[144:147], a[240:243], a[176:179], v[144:147]
v_mfma_f32_16x16x32_bf16 v[144:147], a[244:247], a[180:183], v[144:147]
v_mfma_f32_16x16x32_bf16 v[148:151], a[240:243], a[184:187], v[148:151]
v_mfma_f32_16x16x32_bf16 v[148:151], a[244:247], a[188:191], v[148:151]
v_mfma_f32_16x16x32_bf16 v[152:155], a[240:243], a[192:195], v[152:155]
v_mfma_f32_16x16x32_bf16 v[152:155], a[244:247], a[196:199], v[152:155]
v_mfma_f32_16x16x32_bf16 v[156:159], a[240:243], a[200:203], v[156:159]
buffer_load_dwordx4 a[240:243], v254, s[8:11], s20 offen offset:3072
v_mfma_f32_16x16x32_bf16 v[156:159], a[244:247], a[204:207], v[156:159]
s_waitcnt vmcnt(9)
s_add_u32 s20, s20, 4096
v_mfma_f32_16x16x32_bf16 v[188:191], a[248:251], a[200:203], v[188:191]
buffer_load_dwordx4 a[244:247], v254, s[8:11], s20 offen offset:0
v_mfma_f32_16x16x32_bf16 v[188:191], a[208:211], a[204:207], v[188:191]
v_mfma_f32_16x16x32_bf16 v[184:187], a[248:251], a[192:195], v[184:187]
v_mfma_f32_16x16x32_bf16 v[184:187], a[208:211], a[196:199], v[184:187]
v_mfma_f32_16x16x32_bf16 v[180:183], a[248:251], a[184:187], v[180:183]
v_mfma_f32_16x16x32_bf16 v[180:183], a[208:211], a[188:191], v[180:183]
v_mfma_f32_16x16x32_bf16 v[176:179], a[248:251], a[176:179], v[176:179]
v_mfma_f32_16x16x32_bf16 v[176:179], a[208:211], a[180:183], v[176:179]
v_mfma_f32_16x16x32_bf16 v[172:175], a[248:251], a[168:171], v[172:175]
v_mfma_f32_16x16x32_bf16 v[172:175], a[208:211], a[172:175], v[172:175]
v_mfma_f32_16x16x32_bf16 v[168:171], a[248:251], a[160:163], v[168:171]
v_mfma_f32_16x16x32_bf16 v[168:171], a[208:211], a[164:167], v[168:171]
v_mfma_f32_16x16x32_bf16 v[164:167], a[248:251], a[152:155], v[164:167]
v_mfma_f32_16x16x32_bf16 v[164:167], a[208:211], a[156:159], v[164:167]
v_mfma_f32_16x16x32_bf16 v[160:163], a[248:251], a[144:147], v[160:163]
buffer_load_dwordx4 a[248:251], v254, s[8:11], s20 offen offset:1024
v_mfma_f32_16x16x32_bf16 v[160:163], a[208:211], a[148:151], v[160:163]
s_waitcnt vmcnt(9)
v_mfma_f32_16x16x32_bf16 v[192:195], a[212:215], a[144:147], v[192:195]
buffer_load_dwordx4 a[208:211], v254, s[8:11], s20 offen offset:2048
v_mfma_f32_16x16x32_bf16 v[192:195], a[216:219], a[148:151], v[192:195]
v_mfma_f32_16x16x32_bf16 v[196:199], a[212:215], a[152:155], v[196:199]
v_mfma_f32_16x16x32_bf16 v[196:199], a[216:219], a[156:159], v[196:199]
v_mfma_f32_16x16x32_bf16 v[200:203], a[212:215], a[160:163], v[200:203]
v_mfma_f32_16x16x32_bf16 v[200:203], a[216:219], a[164:167], v[200:203]
v_mfma_f32_16x16x32_bf16 v[204:207], a[212:215], a[168:171], v[204:207]
v_mfma_f32_16x16x32_bf16 v[204:207], a[216:219], a[172:175], v[204:207]
v_mfma_f32_16x16x32_bf16 v[208:211], a[212:215], a[176:179], v[208:211]
v_mfma_f32_16x16x32_bf16 v[208:211], a[216:219], a[180:183], v[208:211]
v_mfma_f32_16x16x32_bf16 v[212:215], a[212:215], a[184:187], v[212:215]
v_mfma_f32_16x16x32_bf16 v[212:215], a[216:219], a[188:191], v[212:215]
v_mfma_f32_16x16x32_bf16 v[216:219], a[212:215], a[192:195], v[216:219]
v_mfma_f32_16x16x32_bf16 v[216:219], a[216:219], a[196:199], v[216:219]
v_mfma_f32_16x16x32_bf16 v[220:223], a[212:215], a[200:203], v[220:223]
buffer_load_dwordx4 a[212:215], v254, s[8:11], s20 offen offset:3072
v_mfma_f32_16x16x32_bf16 v[220:223], a[216:219], a[204:207], v[220:223]
s_waitcnt vmcnt(8)
s_add_u32 s20, s20, 4096
v_mfma_f32_16x16x32_bf16 a[12:15], a[220:223], a[200:203], a[12:15]
ds_read_b128 a[200:203], v252 offset:63488
v_mfma_f32_16x16x32_bf16 a[12:15], a[224:227], a[204:207], a[12:15]
ds_read_b128 a[204:207], v252 offset:64000
v_mfma_f32_16x16x32_bf16 a[8:11], a[220:223], a[192:195], a[8:11]
ds_read_b128 a[192:195], v252 offset:61440
v_mfma_f32_16x16x32_bf16 a[8:11], a[224:227], a[196:199], a[8:11]
ds_read_b128 a[196:199], v252 offset:61952
v_mfma_f32_16x16x32_bf16 a[4:7], a[220:223], a[184:187], a[4:7]
ds_read_b128 a[184:187], v252 offset:59392
v_mfma_f32_16x16x32_bf16 a[4:7], a[224:227], a[188:191], a[4:7]
ds_read_b128 a[188:191], v252 offset:59904
v_mfma_f32_16x16x32_bf16 a[0:3], a[220:223], a[176:179], a[0:3]
ds_read_b128 a[176:179], v252 offset:57344
v_mfma_f32_16x16x32_bf16 a[0:3], a[224:227], a[180:183], a[0:3]
ds_read_b128 a[180:183], v252 offset:57856
v_mfma_f32_16x16x32_bf16 v[236:239], a[220:223], a[168:171], v[236:239]
ds_read_b128 a[168:171], v252 offset:55296
v_mfma_f32_16x16x32_bf16 v[236:239], a[224:227], a[172:175], v[236:239]
ds_read_b128 a[172:175], v252 offset:55808
v_mfma_f32_16x16x32_bf16 v[232:235], a[220:223], a[160:163], v[232:235]
ds_read_b128 a[160:163], v252 offset:53248
v_mfma_f32_16x16x32_bf16 v[232:235], a[224:227], a[164:167], v[232:235]
ds_read_b128 a[164:167], v252 offset:53760
v_mfma_f32_16x16x32_bf16 v[228:231], a[220:223], a[152:155], v[228:231]
ds_read_b128 a[152:155], v252 offset:51200
v_mfma_f32_16x16x32_bf16 v[228:231], a[224:227], a[156:159], v[228:231]
ds_read_b128 a[156:159], v252 offset:51712
v_mfma_f32_16x16x32_bf16 v[224:227], a[220:223], a[144:147], v[224:227]
ds_read_b128 a[144:147], v252 offset:49152
v_mfma_f32_16x16x32_bf16 v[224:227], a[224:227], a[148:151], v[224:227]
s_waitcnt vmcnt(6) lgkmcnt(11)
ds_read_b128 a[148:151], v252 offset:49664
v_mfma_f32_16x16x32_bf16 v[28:31], a[228:231], a[200:203], v[28:31]
buffer_load_dwordx4 a[220:223], v254, s[8:11], s20 offen offset:0
v_mfma_f32_16x16x32_bf16 v[28:31], a[232:235], a[204:207], v[28:31]
v_mfma_f32_16x16x32_bf16 v[24:27], a[228:231], a[192:195], v[24:27]
buffer_load_dwordx4 a[224:227], v254, s[8:11], s20 offen offset:1024
v_mfma_f32_16x16x32_bf16 v[24:27], a[232:235], a[196:199], v[24:27]
s_waitcnt lgkmcnt(8)
v_mfma_f32_16x16x32_bf16 v[20:23], a[228:231], a[184:187], v[20:23]
v_mfma_f32_16x16x32_bf16 v[20:23], a[232:235], a[188:191], v[20:23]
v_add_u32 v252, s25, v253
v_mfma_f32_16x16x32_bf16 v[16:19], a[228:231], a[176:179], v[16:19]
v_mfma_f32_16x16x32_bf16 v[16:19], a[232:235], a[180:183], v[16:19]
s_waitcnt lgkmcnt(4)
v_mfma_f32_16x16x32_bf16 v[12:15], a[228:231], a[168:171], v[12:15]
v_mfma_f32_16x16x32_bf16 v[12:15], a[232:235], a[172:175], v[12:15]
v_mfma_f32_16x16x32_bf16 v[8:11], a[228:231], a[160:163], v[8:11]
v_mfma_f32_16x16x32_bf16 v[8:11], a[232:235], a[164:167], v[8:11]
s_waitcnt lgkmcnt(0)
v_mfma_f32_16x16x32_bf16 v[4:7], a[228:231], a[152:155], v[4:7]
v_mfma_f32_16x16x32_bf16 v[4:7], a[232:235], a[156:159], v[4:7]
v_mfma_f32_4x4x4_16b_bf16 v[240:243], a[252:253], a[16:17], 0
v_mfma_f32_16x16x32_bf16 v[0:3], a[228:231], a[144:147], v[0:3]
buffer_load_dwordx4 a[228:231], v254, s[8:11], s20 offen offset:2048
v_mfma_f32_16x16x32_bf16 v[0:3], a[232:235], a[148:151], v[0:3]
s_waitcnt vmcnt(7)
v_mfma_f32_4x4x4_16b_bf16 v[244:247], a[252:253], a[18:19], 0
v_mfma_f32_16x16x32_bf16 v[32:35], a[236:239], a[144:147], v[32:35]
buffer_load_dwordx4 a[232:235], v254, s[8:11], s20 offen offset:3072
v_mfma_f32_16x16x32_bf16 v[32:35], a[240:243], a[148:151], v[32:35]
s_add_u32 s20, s20, 4096
s_barrier
v_mfma_f32_16x16x32_bf16 v[36:39], a[236:239], a[152:155], v[36:39]
v_mfma_f32_16x16x32_bf16 v[36:39], a[240:243], a[156:159], v[36:39]
v_mfma_f32_16x16x32_bf16 v[40:43], a[236:239], a[160:163], v[40:43]
v_mul_f32 v240, v240, v0
v_mul_f32 v241, v241, v1
v_mfma_f32_16x16x32_bf16 v[40:43], a[240:243], a[164:167], v[40:43]
v_mul_f32 v242, v242, v2
v_mul_f32 v243, v243, v3
v_mfma_f32_16x16x32_bf16 v[44:47], a[236:239], a[168:171], v[44:47]
v_cvt_pk_bf16_f32 v248, v240, v241
v_cvt_pk_bf16_f32 v249, v242, v243
v_mfma_f32_4x4x4_16b_bf16 v[240:243], a[252:253], a[20:21], 0
v_mul_f32 v244, v244, v32
v_mul_f32 v245, v245, v33
v_mfma_f32_16x16x32_bf16 v[44:47], a[240:243], a[172:175], v[44:47]
v_mul_f32 v246, v246, v34
v_mul_f32 v247, v247, v35
v_mfma_f32_16x16x32_bf16 v[48:51], a[236:239], a[176:179], v[48:51]
v_cvt_pk_bf16_f32 v250, v244, v245
v_cvt_pk_bf16_f32 v251, v246, v247
v_mfma_f32_4x4x4_16b_bf16 v[244:247], a[252:253], a[22:23], 0
ds_write_b128 v252, v[248:251] offset:0
v_mfma_f32_16x16x32_bf16 v[48:51], a[240:243], a[180:183], v[48:51]
v_mul_f32 v240, v240, v4
v_mul_f32 v241, v241, v5
v_mfma_f32_16x16x32_bf16 v[52:55], a[236:239], a[184:187], v[52:55]
v_mul_f32 v242, v242, v6
v_mul_f32 v243, v243, v7
v_mfma_f32_16x16x32_bf16 v[52:55], a[240:243], a[188:191], v[52:55]
v_cvt_pk_bf16_f32 v248, v240, v241
v_cvt_pk_bf16_f32 v249, v242, v243
v_mfma_f32_4x4x4_16b_bf16 v[240:243], a[252:253], a[24:25], 0
v_mul_f32 v244, v244, v36
v_mul_f32 v245, v245, v37
v_mfma_f32_16x16x32_bf16 v[56:59], a[236:239], a[192:195], v[56:59]
v_mul_f32 v246, v246, v38
v_mul_f32 v247, v247, v39
v_mfma_f32_16x16x32_bf16 v[56:59], a[240:243], a[196:199], v[56:59]
v_cvt_pk_bf16_f32 v250, v244, v245
v_cvt_pk_bf16_f32 v251, v246, v247
v_mfma_f32_4x4x4_16b_bf16 v[244:247], a[252:253], a[26:27], 0
ds_write_b128 v252, v[248:251] offset:2048
v_mfma_f32_16x16x32_bf16 v[60:63], a[236:239], a[200:203], v[60:63]
buffer_load_dwordx4 a[236:239], v254, s[8:11], s20 offen offset:0
v_mul_f32 v240, v240, v8
v_mfma_f32_16x16x32_bf16 v[60:63], a[240:243], a[204:207], v[60:63]
s_waitcnt vmcnt(7)
v_mul_f32 v241, v241, v9
v_mul_f32 v242, v242, v10
v_mfma_f32_16x16x32_bf16 v[92:95], a[244:247], a[200:203], v[92:95]
buffer_load_dwordx4 a[240:243], v254, s[8:11], s20 offen offset:1024
v_mul_f32 v243, v243, v11
v_mfma_f32_16x16x32_bf16 v[92:95], a[248:251], a[204:207], v[92:95]
v_cvt_pk_bf16_f32 v248, v240, v241
v_cvt_pk_bf16_f32 v249, v242, v243
v_mfma_f32_4x4x4_16b_bf16 v[240:243], a[252:253], a[28:29], 0
v_mul_f32 v244, v244, v40
v_mul_f32 v245, v245, v41
v_mfma_f32_16x16x32_bf16 v[88:91], a[244:247], a[192:195], v[88:91]
v_mul_f32 v246, v246, v42
v_mul_f32 v247, v247, v43
v_mfma_f32_16x16x32_bf16 v[88:91], a[248:251], a[196:199], v[88:91]
v_cvt_pk_bf16_f32 v250, v244, v245
v_cvt_pk_bf16_f32 v251, v246, v247
v_mfma_f32_4x4x4_16b_bf16 v[244:247], a[252:253], a[30:31], 0
ds_write_b128 v252, v[248:251] offset:4096
v_mfma_f32_16x16x32_bf16 v[84:87], a[244:247], a[184:187], v[84:87]
v_mul_f32 v240, v240, v12
v_mul_f32 v241, v241, v13
v_mfma_f32_16x16x32_bf16 v[84:87], a[248:251], a[188:191], v[84:87]
v_mul_f32 v242, v242, v14
v_mul_f32 v243, v243, v15
v_mfma_f32_16x16x32_bf16 v[80:83], a[244:247], a[176:179], v[80:83]
v_cvt_pk_bf16_f32 v248, v240, v241
v_cvt_pk_bf16_f32 v249, v242, v243
v_mfma_f32_4x4x4_16b_bf16 v[240:243], a[252:253], a[32:33], 0
v_mul_f32 v244, v244, v44
v_mul_f32 v245, v245, v45
v_mfma_f32_16x16x32_bf16 v[80:83], a[248:251], a[180:183], v[80:83]
v_mul_f32 v246, v246, v46
v_mul_f32 v247, v247, v47
v_mfma_f32_16x16x32_bf16 v[76:79], a[244:247], a[168:171], v[76:79]
v_cvt_pk_bf16_f32 v250, v244, v245
v_cvt_pk_bf16_f32 v251, v246, v247
v_mfma_f32_4x4x4_16b_bf16 v[244:247], a[252:253], a[34:35], 0
ds_write_b128 v252, v[248:251] offset:6144
v_mfma_f32_16x16x32_bf16 v[76:79], a[248:251], a[172:175], v[76:79]
v_mul_f32 v240, v240, v16
v_mul_f32 v241, v241, v17
v_mfma_f32_16x16x32_bf16 v[72:75], a[244:247], a[160:163], v[72:75]
v_mul_f32 v242, v242, v18
v_mul_f32 v243, v243, v19
v_mfma_f32_16x16x32_bf16 v[72:75], a[248:251], a[164:167], v[72:75]
v_cvt_pk_bf16_f32 v248, v240, v241
v_cvt_pk_bf16_f32 v249, v242, v243
v_mfma_f32_4x4x4_16b_bf16 v[240:243], a[252:253], a[36:37], 0
v_mul_f32 v244, v244, v48
v_mul_f32 v245, v245, v49
v_mfma_f32_16x16x32_bf16 v[68:71], a[244:247], a[152:155], v[68:71]
v_mul_f32 v246, v246, v50
v_mul_f32 v247, v247, v51
v_mfma_f32_16x16x32_bf16 v[68:71], a[248:251], a[156:159], v[68:71]
v_cvt_pk_bf16_f32 v250, v244, v245
v_cvt_pk_bf16_f32 v251, v246, v247
v_mfma_f32_4x4x4_16b_bf16 v[244:247], a[252:253], a[38:39], 0
ds_write_b128 v252, v[248:251] offset:8192
v_mfma_f32_16x16x32_bf16 v[64:67], a[244:247], a[144:147], v[64:67]
buffer_load_dwordx4 a[244:247], v254, s[8:11], s20 offen offset:2048
v_mul_f32 v240, v240, v20
v_mfma_f32_16x16x32_bf16 v[64:67], a[248:251], a[148:151], v[64:67]
s_waitcnt vmcnt(7)
v_mul_f32 v241, v241, v21
v_mul_f32 v242, v242, v22
v_mfma_f32_16x16x32_bf16 v[96:99], a[208:211], a[144:147], v[96:99]
buffer_load_dwordx4 a[248:251], v254, s[8:11], s20 offen offset:3072
v_mul_f32 v243, v243, v23
v_mfma_f32_16x16x32_bf16 v[96:99], a[212:215], a[148:151], v[96:99]
s_add_u32 s20, s20, 4096
v_cvt_pk_bf16_f32 v248, v240, v241
v_cvt_pk_bf16_f32 v249, v242, v243
v_mfma_f32_4x4x4_16b_bf16 v[240:243], a[252:253], a[40:41], 0
v_mul_f32 v244, v244, v52
v_mul_f32 v245, v245, v53
v_mfma_f32_16x16x32_bf16 v[100:103], a[208:211], a[152:155], v[100:103]
v_mul_f32 v246, v246, v54
v_mul_f32 v247, v247, v55
v_mfma_f32_16x16x32_bf16 v[100:103], a[212:215], a[156:159], v[100:103]
v_cvt_pk_bf16_f32 v250, v244, v245
v_cvt_pk_bf16_f32 v251, v246, v247
v_mfma_f32_4x4x4_16b_bf16 v[244:247], a[252:253], a[42:43], 0
ds_write_b128 v252, v[248:251] offset:10240
v_mfma_f32_16x16x32_bf16 v[104:107], a[208:211], a[160:163], v[104:107]
v_mul_f32 v240, v240, v24
v_mul_f32 v241, v241, v25
v_mfma_f32_16x16x32_bf16 v[104:107], a[212:215], a[164:167], v[104:107]
v_mul_f32 v242, v242, v26
v_mul_f32 v243, v243, v27
v_mfma_f32_16x16x32_bf16 v[108:111], a[208:211], a[168:171], v[108:111]
v_cvt_pk_bf16_f32 v248, v240, v241
v_cvt_pk_bf16_f32 v249, v242, v243
v_mfma_f32_4x4x4_16b_bf16 v[240:243], a[252:253], a[44:45], 0
v_mul_f32 v244, v244, v56
v_mul_f32 v245, v245, v57
v_mfma_f32_16x16x32_bf16 v[108:111], a[212:215], a[172:175], v[108:111]
v_mul_f32 v246, v246, v58
v_mul_f32 v247, v247, v59
v_mfma_f32_16x16x32_bf16 v[112:115], a[208:211], a[176:179], v[112:115]
v_cvt_pk_bf16_f32 v250, v244, v245
v_cvt_pk_bf16_f32 v251, v246, v247
v_mfma_f32_4x4x4_16b_bf16 v[244:247], a[252:253], a[46:47], 0
ds_write_b128 v252, v[248:251] offset:12288
v_mfma_f32_16x16x32_bf16 v[112:115], a[212:215], a[180:183], v[112:115]
v_mul_f32 v240, v240, v28
v_mul_f32 v241, v241, v29
v_mfma_f32_16x16x32_bf16 v[116:119], a[208:211], a[184:187], v[116:119]
v_mul_f32 v242, v242, v30
v_mul_f32 v243, v243, v31
v_mfma_f32_16x16x32_bf16 v[116:119], a[212:215], a[188:191], v[116:119]
v_cvt_pk_bf16_f32 v248, v240, v241
v_cvt_pk_bf16_f32 v249, v242, v243
v_mfma_f32_4x4x4_16b_bf16 v[240:243], a[252:253], a[48:49], 0
v_mul_f32 v244, v244, v60
v_mul_f32 v245, v245, v61
v_mfma_f32_16x16x32_bf16 v[120:123], a[208:211], a[192:195], v[120:123]
v_mul_f32 v246, v246, v62
v_mul_f32 v247, v247, v63
v_mfma_f32_16x16x32_bf16 v[120:123], a[212:215], a[196:199], v[120:123]
v_cvt_pk_bf16_f32 v250, v244, v245
v_cvt_pk_bf16_f32 v251, v246, v247
v_mfma_f32_4x4x4_16b_bf16 v[244:247], a[252:253], a[50:51], 0
ds_write_b128 v252, v[248:251] offset:14336
v_mfma_f32_16x16x32_bf16 v[124:127], a[208:211], a[200:203], v[124:127]
buffer_load_dwordx4 a[208:211], v254, s[8:11], s20 offen offset:0
v_mul_f32 v240, v240, v64
v_mfma_f32_16x16x32_bf16 v[124:127], a[212:215], a[204:207], v[124:127]
s_waitcnt vmcnt(7)
v_mul_f32 v241, v241, v65
v_mul_f32 v242, v242, v66
v_mfma_f32_16x16x32_bf16 v[156:159], a[220:223], a[200:203], v[156:159]
buffer_load_dwordx4 a[212:215], v254, s[8:11], s20 offen offset:1024
v_mul_f32 v243, v243, v67
v_mfma_f32_16x16x32_bf16 v[156:159], a[224:227], a[204:207], v[156:159]
v_cvt_pk_bf16_f32 v248, v240, v241
v_cvt_pk_bf16_f32 v249, v242, v243
v_mfma_f32_4x4x4_16b_bf16 v[240:243], a[252:253], a[52:53], 0
v_mul_f32 v244, v244, v96
v_mul_f32 v245, v245, v97
v_mfma_f32_16x16x32_bf16 v[152:155], a[220:223], a[192:195], v[152:155]
buffer_load_dwordx4 a[216:219], v254, s[8:11], s20 offen offset:2048
v_mul_f32 v246, v246, v98
v_mfma_f32_16x16x32_bf16 v[152:155], a[224:227], a[196:199], v[152:155]
v_mul_f32 v247, v247, v99
v_cvt_pk_bf16_f32 v250, v244, v245
v_mfma_f32_16x16x32_bf16 v[148:151], a[220:223], a[184:187], v[148:151]
v_cvt_pk_bf16_f32 v251, v246, v247
v_mfma_f32_4x4x4_16b_bf16 v[244:247], a[252:253], a[54:55], 0
ds_write_b128 v252, v[248:251] offset:512
v_mfma_f32_16x16x32_bf16 v[148:151], a[224:227], a[188:191], v[148:151]
v_mul_f32 v240, v240, v68
v_mul_f32 v241, v241, v69
v_mfma_f32_16x16x32_bf16 v[144:147], a[220:223], a[176:179], v[144:147]
v_mul_f32 v242, v242, v70
v_mul_f32 v243, v243, v71
v_mfma_f32_16x16x32_bf16 v[144:147], a[224:227], a[180:183], v[144:147]
v_cvt_pk_bf16_f32 v248, v240, v241
v_cvt_pk_bf16_f32 v249, v242, v243
v_mfma_f32_4x4x4_16b_bf16 v[240:243], a[252:253], a[56:57], 0
v_mul_f32 v244, v244, v100
v_mul_f32 v245, v245, v101
v_mfma_f32_16x16x32_bf16 v[140:143], a[220:223], a[168:171], v[140:143]
v_mul_f32 v246, v246, v102
v_mul_f32 v247, v247, v103
v_mfma_f32_16x16x32_bf16 v[140:143], a[224:227], a[172:175], v[140:143]
v_cvt_pk_bf16_f32 v250, v244, v245
v_cvt_pk_bf16_f32 v251, v246, v247
v_mfma_f32_4x4x4_16b_bf16 v[244:247], a[252:253], a[58:59], 0
ds_write_b128 v252, v[248:251] offset:2560
v_mfma_f32_16x16x32_bf16 v[136:139], a[220:223], a[160:163], v[136:139]
v_mul_f32 v240, v240, v72
v_mul_f32 v241, v241, v73
v_mfma_f32_16x16x32_bf16 v[136:139], a[224:227], a[164:167], v[136:139]
v_mul_f32 v242, v242, v74
v_mul_f32 v243, v243, v75
v_mfma_f32_16x16x32_bf16 v[132:135], a[220:223], a[152:155], v[132:135]
v_cvt_pk_bf16_f32 v248, v240, v241
v_cvt_pk_bf16_f32 v249, v242, v243
v_mfma_f32_4x4x4_16b_bf16 v[240:243], a[252:253], a[60:61], 0
v_mul_f32 v244, v244, v104
v_mul_f32 v245, v245, v105
v_mfma_f32_16x16x32_bf16 v[132:135], a[224:227], a[156:159], v[132:135]
v_mul_f32 v246, v246, v106
v_mul_f32 v247, v247, v107
v_mfma_f32_16x16x32_bf16 v[128:131], a[220:223], a[144:147], v[128:131]
buffer_load_dwordx4 a[220:223], v254, s[8:11], s20 offen offset:3072
v_cvt_pk_bf16_f32 v250, v244, v245
v_mfma_f32_16x16x32_bf16 v[128:131], a[224:227], a[148:151], v[128:131]
s_waitcnt vmcnt(8)
s_add_u32 s20, s20, 4096
v_cvt_pk_bf16_f32 v251, v246, v247
v_mfma_f32_4x4x4_16b_bf16 v[244:247], a[252:253], a[62:63], 0
ds_write_b128 v252, v[248:251] offset:4608
v_mfma_f32_16x16x32_bf16 v[160:163], a[228:231], a[144:147], v[160:163]
buffer_load_dwordx4 a[224:227], v254, s[8:11], s20 offen offset:0
v_mul_f32 v240, v240, v76
v_mfma_f32_16x16x32_bf16 v[160:163], a[232:235], a[148:151], v[160:163]
v_mul_f32 v241, v241, v77
v_mul_f32 v242, v242, v78
v_mfma_f32_16x16x32_bf16 v[164:167], a[228:231], a[152:155], v[164:167]
v_mul_f32 v243, v243, v79
v_cvt_pk_bf16_f32 v248, v240, v241
v_mfma_f32_16x16x32_bf16 v[164:167], a[232:235], a[156:159], v[164:167]
v_cvt_pk_bf16_f32 v249, v242, v243
v_mfma_f32_4x4x4_16b_bf16 v[240:243], a[252:253], a[64:65], 0
v_mul_f32 v244, v244, v108
v_mul_f32 v245, v245, v109
v_mfma_f32_16x16x32_bf16 v[168:171], a[228:231], a[160:163], v[168:171]
v_mul_f32 v246, v246, v110
v_mul_f32 v247, v247, v111
v_mfma_f32_16x16x32_bf16 v[168:171], a[232:235], a[164:167], v[168:171]
v_cvt_pk_bf16_f32 v250, v244, v245
v_cvt_pk_bf16_f32 v251, v246, v247
v_mfma_f32_4x4x4_16b_bf16 v[244:247], a[252:253], a[66:67], 0
ds_write_b128 v252, v[248:251] offset:6656
v_mfma_f32_16x16x32_bf16 v[172:175], a[228:231], a[168:171], v[172:175]
v_mul_f32 v240, v240, v80
v_mul_f32 v241, v241, v81
v_mfma_f32_16x16x32_bf16 v[172:175], a[232:235], a[172:175], v[172:175]
v_mul_f32 v242, v242, v82
v_mul_f32 v243, v243, v83
v_mfma_f32_16x16x32_bf16 v[176:179], a[228:231], a[176:179], v[176:179]
v_cvt_pk_bf16_f32 v248, v240, v241
v_cvt_pk_bf16_f32 v249, v242, v243
v_mfma_f32_4x4x4_16b_bf16 v[240:243], a[252:253], a[68:69], 0
v_mul_f32 v244, v244, v112
v_mul_f32 v245, v245, v113
v_mfma_f32_16x16x32_bf16 v[176:179], a[232:235], a[180:183], v[176:179]
v_mul_f32 v246, v246, v114
v_mul_f32 v247, v247, v115
v_mfma_f32_16x16x32_bf16 v[180:183], a[228:231], a[184:187], v[180:183]
v_cvt_pk_bf16_f32 v250, v244, v245
v_cvt_pk_bf16_f32 v251, v246, v247
v_mfma_f32_4x4x4_16b_bf16 v[244:247], a[252:253], a[70:71], 0
ds_write_b128 v252, v[248:251] offset:8704
v_mfma_f32_16x16x32_bf16 v[180:183], a[232:235], a[188:191], v[180:183]
v_mul_f32 v240, v240, v84
v_mul_f32 v241, v241, v85
v_mfma_f32_16x16x32_bf16 v[184:187], a[228:231], a[192:195], v[184:187]
v_mul_f32 v242, v242, v86
v_mul_f32 v243, v243, v87
v_mfma_f32_16x16x32_bf16 v[184:187], a[232:235], a[196:199], v[184:187]
v_cvt_pk_bf16_f32 v248, v240, v241
v_cvt_pk_bf16_f32 v249, v242, v243
v_mfma_f32_4x4x4_16b_bf16 v[240:243], a[252:253], a[72:73], 0
v_mul_f32 v244, v244, v116
v_mul_f32 v245, v245, v117
v_mfma_f32_16x16x32_bf16 v[188:191], a[228:231], a[200:203], v[188:191]
buffer_load_dwordx4 a[228:231], v254, s[8:11], s20 offen offset:1024
v_mul_f32 v246, v246, v118
v_mfma_f32_16x16x32_bf16 v[188:191], a[232:235], a[204:207], v[188:191]
s_waitcnt vmcnt(8)
v_mul_f32 v247, v247, v119
v_cvt_pk_bf16_f32 v250, v244, v245
v_mfma_f32_16x16x32_bf16 v[220:223], a[236:239], a[200:203], v[220:223]
buffer_load_dwordx4 a[232:235], v254, s[8:11], s20 offen offset:2048
v_cvt_pk_bf16_f32 v251, v246, v247
v_mfma_f32_4x4x4_16b_bf16 v[244:247], a[252:253], a[74:75], 0
ds_write_b128 v252, v[248:251] offset:10752
v_mfma_f32_16x16x32_bf16 v[220:223], a[240:243], a[204:207], v[220:223]
v_mul_f32 v240, v240, v88
v_mul_f32 v241, v241, v89
v_mfma_f32_16x16x32_bf16 v[216:219], a[236:239], a[192:195], v[216:219]
v_mul_f32 v242, v242, v90
v_mul_f32 v243, v243, v91
v_mfma_f32_16x16x32_bf16 v[216:219], a[240:243], a[196:199], v[216:219]
v_cvt_pk_bf16_f32 v248, v240, v241
v_cvt_pk_bf16_f32 v249, v242, v243
v_mfma_f32_4x4x4_16b_bf16 v[240:243], a[252:253], a[76:77], 0
v_mul_f32 v244, v244, v120
v_mul_f32 v245, v245, v121
v_mfma_f32_16x16x32_bf16 v[212:215], a[236:239], a[184:187], v[212:215]
v_mul_f32 v246, v246, v122
v_mul_f32 v247, v247, v123
v_mfma_f32_16x16x32_bf16 v[212:215], a[240:243], a[188:191], v[212:215]
v_cvt_pk_bf16_f32 v250, v244, v245
v_cvt_pk_bf16_f32 v251, v246, v247
v_mfma_f32_4x4x4_16b_bf16 v[244:247], a[252:253], a[78:79], 0
ds_write_b128 v252, v[248:251] offset:12800
v_mfma_f32_16x16x32_bf16 v[208:211], a[236:239], a[176:179], v[208:211]
v_mul_f32 v240, v240, v92
v_mul_f32 v241, v241, v93
v_mfma_f32_16x16x32_bf16 v[208:211], a[240:243], a[180:183], v[208:211]
v_mul_f32 v242, v242, v94
v_mul_f32 v243, v243, v95
v_mfma_f32_16x16x32_bf16 v[204:207], a[236:239], a[168:171], v[204:207]
v_cvt_pk_bf16_f32 v248, v240, v241
v_cvt_pk_bf16_f32 v249, v242, v243
v_mfma_f32_4x4x4_16b_bf16 v[240:243], a[252:253], a[80:81], 0
v_mul_f32 v244, v244, v124
v_mul_f32 v245, v245, v125
v_mfma_f32_16x16x32_bf16 v[204:207], a[240:243], a[172:175], v[204:207]
v_mul_f32 v246, v246, v126
v_mul_f32 v247, v247, v127
v_mfma_f32_16x16x32_bf16 v[200:203], a[236:239], a[160:163], v[200:203]
v_cvt_pk_bf16_f32 v250, v244, v245
v_cvt_pk_bf16_f32 v251, v246, v247
v_mfma_f32_4x4x4_16b_bf16 v[244:247], a[252:253], a[82:83], 0
ds_write_b128 v252, v[248:251] offset:14848
v_mfma_f32_16x16x32_bf16 v[200:203], a[240:243], a[164:167], v[200:203]
v_mul_f32 v240, v240, v128
v_mul_f32 v241, v241, v129
v_mfma_f32_16x16x32_bf16 v[196:199], a[236:239], a[152:155], v[196:199]
v_mul_f32 v242, v242, v130
v_mul_f32 v243, v243, v131
v_mfma_f32_16x16x32_bf16 v[196:199], a[240:243], a[156:159], v[196:199]
v_cvt_pk_bf16_f32 v248, v240, v241
v_cvt_pk_bf16_f32 v249, v242, v243
v_mfma_f32_4x4x4_16b_bf16 v[240:243], a[252:253], a[84:85], 0
v_mul_f32 v244, v244, v160
v_mul_f32 v245, v245, v161
v_mfma_f32_16x16x32_bf16 v[192:195], a[236:239], a[144:147], v[192:195]
buffer_load_dwordx4 a[236:239], v254, s[8:11], s20 offen offset:3072
v_mul_f32 v246, v246, v162
v_mfma_f32_16x16x32_bf16 v[192:195], a[240:243], a[148:151], v[192:195]
s_waitcnt vmcnt(8)
s_add_u32 s20, s20, 4096
buffer_load_dwordx4 a[240:243], v254, s[8:11], s20 offen offset:0
v_mul_f32 v247, v247, v163
v_mfma_f32_16x16x32_bf16 v[224:227], a[244:247], a[144:147], v[224:227]
ds_read_b128 a[144:147], v252 offset:0
v_cvt_pk_bf16_f32 v250, v244, v245
v_mfma_f32_16x16x32_bf16 v[224:227], a[248:251], a[148:151], v[224:227]
ds_read_b128 a[148:151], v252 offset:512
v_cvt_pk_bf16_f32 v251, v246, v247
v_mfma_f32_4x4x4_16b_bf16 v[244:247], a[252:253], a[86:87], 0
ds_write_b128 v252, v[248:251] offset:16384
v_mfma_f32_16x16x32_bf16 v[228:231], a[244:247], a[152:155], v[228:231]
ds_read_b128 a[152:155], v252 offset:2048
v_mul_f32 v240, v240, v132
v_mfma_f32_16x16x32_bf16 v[228:231], a[248:251], a[156:159], v[228:231]
ds_read_b128 a[156:159], v252 offset:2560
v_mul_f32 v241, v241, v133
v_mfma_f32_16x16x32_bf16 v[232:235], a[244:247], a[160:163], v[232:235]
ds_read_b128 a[160:163], v252 offset:4096
v_mul_f32 v242, v242, v134
v_mfma_f32_16x16x32_bf16 v[232:235], a[248:251], a[164:167], v[232:235]
ds_read_b128 a[164:167], v252 offset:4608
v_mul_f32 v243, v243, v135
v_mfma_f32_16x16x32_bf16 v[236:239], a[244:247], a[168:171], v[236:239]
ds_read_b128 a[168:171], v252 offset:6144
v_cvt_pk_bf16_f32 v248, v240, v241
v_mfma_f32_16x16x32_bf16 v[236:239], a[248:251], a[172:175], v[236:239]
ds_read_b128 a[172:175], v252 offset:6656
v_cvt_pk_bf16_f32 v249, v242, v243
v_mfma_f32_4x4x4_16b_bf16 v[240:243], a[252:253], a[88:89], 0
v_mul_f32 v244, v244, v164
v_mul_f32 v245, v245, v165
v_mfma_f32_16x16x32_bf16 a[0:3], a[244:247], a[176:179], a[0:3]
ds_read_b128 a[176:179], v252 offset:8192
v_mul_f32 v246, v246, v166
v_mfma_f32_16x16x32_bf16 a[0:3], a[248:251], a[180:183], a[0:3]
ds_read_b128 a[180:183], v252 offset:8704
v_mul_f32 v247, v247, v167
v_mfma_f32_16x16x32_bf16 a[4:7], a[244:247], a[184:187], a[4:7]
ds_read_b128 a[184:187], v252 offset:10240
v_cvt_pk_bf16_f32 v250, v244, v245
v_mfma_f32_16x16x32_bf16 a[4:7], a[248:251], a[188:191], a[4:7]
ds_read_b128 a[188:191], v252 offset:10752
v_cvt_pk_bf16_f32 v251, v246, v247
v_mfma_f32_4x4x4_16b_bf16 v[244:247], a[252:253], a[90:91], 0
ds_write_b128 v252, v[248:251] offset:18432
v_mfma_f32_16x16x32_bf16 a[8:11], a[244:247], a[192:195], a[8:11]
ds_read_b128 a[192:195], v252 offset:12288
v_mul_f32 v240, v240, v136
v_mfma_f32_16x16x32_bf16 a[8:11], a[248:251], a[196:199], a[8:11]
ds_read_b128 a[196:199], v252 offset:12800
v_mul_f32 v241, v241, v137
v_mfma_f32_16x16x32_bf16 a[12:15], a[244:247], a[200:203], a[12:15]
ds_read_b128 a[200:203], v252 offset:14336
v_mul_f32 v242, v242, v138
v_mfma_f32_16x16x32_bf16 a[12:15], a[248:251], a[204:207], a[12:15]
ds_read_b128 a[204:207], v252 offset:14848
s_add_u32 s22, s22, 1
s_branch L_loop
L_lz:
v_mfma_f32_16x16x32_bf16 v[0:3], a[208:211], a[144:147], v[0:3]
s_add_u32 s43, s20, 8192
buffer_load_dwordx4 a[244:247], v254, s[8:11], s43 offen offset:0
v_mfma_f32_16x16x32_bf16 v[0:3], a[212:215], a[148:151], v[0:3]
s_add_u32 s43, s20, 8192
v_mfma_f32_16x16x32_bf16 v[4:7], a[208:211], a[152:155], v[4:7]
buffer_load_dwordx4 a[248:251], v254, s[8:11], s43 offen offset:1024
v_mfma_f32_16x16x32_bf16 v[4:7], a[212:215], a[156:159], v[4:7]
s_waitcnt lgkmcnt(8)
v_mfma_f32_16x16x32_bf16 v[8:11], a[208:211], a[160:163], v[8:11]
v_mfma_f32_16x16x32_bf16 v[8:11], a[212:215], a[164:167], v[8:11]
s_mov_b32 s16, s46
v_mfma_f32_16x16x32_bf16 v[12:15], a[208:211], a[168:171], v[12:15]
s_mov_b32 s17, s47
v_mfma_f32_16x16x32_bf16 v[12:15], a[212:215], a[172:175], v[12:15]
s_waitcnt lgkmcnt(4)
s_mov_b32 s18, 0x2000000
v_mfma_f32_16x16x32_bf16 v[16:19], a[208:211], a[176:179], v[16:19]
s_lshl_b32 s42, s48, 14
v_mfma_f32_16x16x32_bf16 v[16:19], a[212:215], a[180:183], v[16:19]
s_add_u32 s42, s42, 98304
v_mfma_f32_16x16x32_bf16 v[20:23], a[208:211], a[184:187], v[20:23]
s_cmp_lt_u32 s48, 2
s_cselect_b32 s42, s25, s42
v_mfma_f32_16x16x32_bf16 v[20:23], a[212:215], a[188:191], v[20:23]
s_waitcnt lgkmcnt(0)
v_bfe_u32 v248, v254, 6, 3
v_mfma_f32_16x16x32_bf16 v[24:27], a[208:211], a[192:195], v[24:27]
v_lshlrev_b32 v255, 3, v248
v_mfma_f32_16x16x32_bf16 v[24:27], a[212:215], a[196:199], v[24:27]
v_xor_b32 v255, v255, v254
v_mfma_f32_16x16x32_bf16 v[28:31], a[208:211], a[200:203], v[28:31]
v_and_b32 v255, 0x30, v255
v_mfma_f32_16x16x32_bf16 v[28:31], a[212:215], a[204:207], v[28:31]
s_waitcnt vmcnt(10)
v_lshl_add_u32 v255, v248, 11, v255
s_add_u32 s43, s20, 8192
v_mfma_f32_16x16x32_bf16 v[60:63], a[216:219], a[200:203], v[60:63]
buffer_load_dwordx4 a[208:211], v254, s[8:11], s43 offen offset:2048
v_lshrrev_b32 v248, 9, v254
v_mfma_f32_16x16x32_bf16 v[60:63], a[220:223], a[204:207], v[60:63]
v_lshl_add_u32 v255, v248, 6, v255
s_add_u32 s43, s20, 8192
v_mfma_f32_16x16x32_bf16 v[56:59], a[216:219], a[192:195], v[56:59]
buffer_load_dwordx4 a[212:215], v254, s[8:11], s43 offen offset:3072
v_add_u32 v253, s42, v253
v_mfma_f32_16x16x32_bf16 v[56:59], a[220:223], a[196:199], v[56:59]
v_mfma_f32_16x16x32_bf16 v[52:55], a[216:219], a[184:187], v[52:55]
v_mfma_f32_16x16x32_bf16 v[52:55], a[220:223], a[188:191], v[52:55]
v_mfma_f32_16x16x32_bf16 v[48:51], a[216:219], a[176:179], v[48:51]
v_mfma_f32_16x16x32_bf16 v[48:51], a[220:223], a[180:183], v[48:51]
v_mfma_f32_16x16x32_bf16 v[44:47], a[216:219], a[168:171], v[44:47]
v_mfma_f32_16x16x32_bf16 v[44:47], a[220:223], a[172:175], v[44:47]
v_mfma_f32_16x16x32_bf16 v[40:43], a[216:219], a[160:163], v[40:43]
v_mfma_f32_16x16x32_bf16 v[40:43], a[220:223], a[164:167], v[40:43]
v_mfma_f32_16x16x32_bf16 v[36:39], a[216:219], a[152:155], v[36:39]
v_mfma_f32_16x16x32_bf16 v[36:39], a[220:223], a[156:159], v[36:39]
v_mfma_f32_16x16x32_bf16 v[32:35], a[216:219], a[144:147], v[32:35]
v_mfma_f32_16x16x32_bf16 v[32:35], a[220:223], a[148:151], v[32:35]
s_waitcnt vmcnt(9)
s_add_u32 s43, s20, 12288
v_mfma_f32_16x16x32_bf16 v[64:67], a[224:227], a[144:147], v[64:67]
buffer_load_dwordx4 a[216:219], v254, s[8:11], s43 offen offset:0
v_mfma_f32_16x16x32_bf16 v[64:67], a[228:231], a[148:151], v[64:67]
s_add_u32 s43, s20, 12288
v_mfma_f32_16x16x32_bf16 v[68:71], a[224:227], a[152:155], v[68:71]
buffer_load_dwordx4 a[220:223], v254, s[8:11], s43 offen offset:1024
v_mfma_f32_16x16x32_bf16 v[68:71], a[228:231], a[156:159], v[68:71]
v_mfma_f32_16x16x32_bf16 v[72:75], a[224:227], a[160:163], v[72:75]
v_mfma_f32_16x16x32_bf16 v[72:75], a[228:231], a[164:167], v[72:75]
v_mfma_f32_16x16x32_bf16 v[76:79], a[224:227], a[168:171], v[76:79]
v_mfma_f32_16x16x32_bf16 v[76:79], a[228:231], a[172:175], v[76:79]
v_mfma_f32_16x16x32_bf16 v[80:83], a[224:227], a[176:179], v[80:83]
v_mfma_f32_16x16x32_bf16 v[80:83], a[228:231], a[180:183], v[80:83]
v_mfma_f32_16x16x32_bf16 v[84:87], a[224:227], a[184:187], v[84:87]
v_mfma_f32_16x16x32_bf16 v[84:87], a[228:231], a[188:191], v[84:87]
v_mfma_f32_16x16x32_bf16 v[88:91], a[224:227], a[192:195], v[88:91]
v_mfma_f32_16x16x32_bf16 v[88:91], a[228:231], a[196:199], v[88:91]
v_mfma_f32_16x16x32_bf16 v[92:95], a[224:227], a[200:203], v[92:95]
v_mfma_f32_16x16x32_bf16 v[92:95], a[228:231], a[204:207], v[92:95]
s_waitcnt vmcnt(8)
s_add_u32 s43, s20, 12288
v_mfma_f32_16x16x32_bf16 v[124:127], a[232:235], a[200:203], v[124:127]
buffer_load_dwordx4 a[224:227], v254, s[8:11], s43 offen offset:2048
ds_read_b128 a[200:203], v252 offset:47104
v_mfma_f32_16x16x32_bf16 v[124:127], a[236:239], a[204:207], v[124:127]
ds_read_b128 a[204:207], v252 offset:47616
s_add_u32 s43, s20, 12288
v_mfma_f32_16x16x32_bf16 v[120:123], a[232:235], a[192:195], v[120:123]
buffer_load_dwordx4 a[228:231], v254, s[8:11], s43 offen offset:3072
ds_read_b128 a[192:195], v252 offset:45056
v_mfma_f32_16x16x32_bf16 v[120:123], a[236:239], a[196:199], v[120:123]
ds_read_b128 a[196:199], v252 offset:45568
v_mfma_f32_16x16x32_bf16 v[116:119], a[232:235], a[184:187], v[116:119]
ds_read_b128 a[184:187], v252 offset:43008
v_mfma_f32_16x16x32_bf16 v[116:119], a[236:239], a[188:191], v[116:119]
ds_read_b128 a[188:191], v252 offset:43520
v_mfma_f32_16x16x32_bf16 v[112:115], a[232:235], a[176:179], v[112:115]
ds_read_b128 a[176:179], v252 offset:40960
v_mfma_f32_16x16x32_bf16 v[112:115], a[236:239], a[180:183], v[112:115]
ds_read_b128 a[180:183], v252 offset:41472
v_mfma_f32_16x16x32_bf16 v[108:111], a[232:235], a[168:171], v[108:111]
ds_read_b128 a[168:171], v252 offset:38912
v_mfma_f32_16x16x32_bf16 v[108:111], a[236:239], a[172:175], v[108:111]
ds_read_b128 a[172:175], v252 offset:39424
v_mfma_f32_16x16x32_bf16 v[104:107], a[232:235], a[160:163], v[104:107]
ds_read_b128 a[160:163], v252 offset:36864
v_mfma_f32_16x16x32_bf16 v[104:107], a[236:239], a[164:167], v[104:107]
ds_read_b128 a[164:167], v252 offset:37376
v_mfma_f32_16x16x32_bf16 v[100:103], a[232:235], a[152:155], v[100:103]
ds_read_b128 a[152:155], v252 offset:34816
v_mfma_f32_16x16x32_bf16 v[100:103], a[236:239], a[156:159], v[100:103]
ds_read_b128 a[156:159], v252 offset:35328
v_mfma_f32_16x16x32_bf16 v[96:99], a[232:235], a[144:147], v[96:99]
ds_read_b128 a[144:147], v252 offset:32768
v_mfma_f32_16x16x32_bf16 v[96:99], a[236:239], a[148:151], v[96:99]
s_waitcnt vmcnt(6) lgkmcnt(11)
ds_read_b128 a[148:151], v252 offset:33280
s_add_u32 s43, s20, 24576
v_mfma_f32_16x16x32_bf16 v[28:31], a[244:247], a[200:203], v[28:31]
buffer_load_dwordx4 a[232:235], v254, s[8:11], s43 offen offset:0
v_mfma_f32_16x16x32_bf16 v[28:31], a[248:251], a[204:207], v[28:31]
s_add_u32 s43, s20, 24576
v_mfma_f32_16x16x32_bf16 v[24:27], a[244:247], a[192:195], v[24:27]
buffer_load_dwordx4 a[236:239], v254, s[8:11], s43 offen offset:1024
v_mfma_f32_16x16x32_bf16 v[24:27], a[248:251], a[196:199], v[24:27]
s_waitcnt lgkmcnt(8)
v_mfma_f32_16x16x32_bf16 v[20:23], a[244:247], a[184:187], v[20:23]
v_mfma_f32_16x16x32_bf16 v[20:23], a[248:251], a[188:191], v[20:23]
v_mfma_f32_16x16x32_bf16 v[16:19], a[244:247], a[176:179], v[16:19]
v_mfma_f32_16x16x32_bf16 v[16:19], a[248:251], a[180:183], v[16:19]
s_waitcnt lgkmcnt(4)
v_mfma_f32_16x16x32_bf16 v[12:15], a[244:247], a[168:171], v[12:15]
v_mfma_f32_16x16x32_bf16 v[12:15], a[248:251], a[172:175], v[12:15]
v_mfma_f32_16x16x32_bf16 v[8:11], a[244:247], a[160:163], v[8:11]
v_mfma_f32_16x16x32_bf16 v[8:11], a[248:251], a[164:167], v[8:11]
s_waitcnt lgkmcnt(0)
v_mfma_f32_16x16x32_bf16 v[4:7], a[244:247], a[152:155], v[4:7]
v_mfma_f32_16x16x32_bf16 v[4:7], a[248:251], a[156:159], v[4:7]
v_mfma_f32_16x16x32_bf16 v[0:3], a[244:247], a[144:147], v[0:3]
v_mfma_f32_16x16x32_bf16 v[0:3], a[248:251], a[148:151], v[0:3]
s_waitcnt vmcnt(6)
s_add_u32 s43, s20, 24576
v_mfma_f32_16x16x32_bf16 v[32:35], a[208:211], a[144:147], v[32:35]
buffer_load_dwordx4 a[244:247], v254, s[8:11], s43 offen offset:2048
v_mfma_f32_16x16x32_bf16 v[32:35], a[212:215], a[148:151], v[32:35]
s_add_u32 s43, s20, 24576
v_mfma_f32_16x16x32_bf16 v[36:39], a[208:211], a[152:155], v[36:39]
buffer_load_dwordx4 a[248:251], v254, s[8:11], s43 offen offset:3072
v_mfma_f32_16x16x32_bf16 v[36:39], a[212:215], a[156:159], v[36:39]
v_mfma_f32_16x16x32_bf16 v[40:43], a[208:211], a[160:163], v[40:43]
v_mfma_f32_16x16x32_bf16 v[40:43], a[212:215], a[164:167], v[40:43]
v_mfma_f32_16x16x32_bf16 v[44:47], a[208:211], a[168:171], v[44:47]
v_mfma_f32_16x16x32_bf16 v[44:47], a[212:215], a[172:175], v[44:47]
v_mfma_f32_16x16x32_bf16 v[48:51], a[208:211], a[176:179], v[48:51]
v_mfma_f32_16x16x32_bf16 v[48:51], a[212:215], a[180:183], v[48:51]
v_mfma_f32_16x16x32_bf16 v[52:55], a[208:211], a[184:187], v[52:55]
v_mfma_f32_16x16x32_bf16 v[52:55], a[212:215], a[188:191], v[52:55]
v_mfma_f32_16x16x32_bf16 v[56:59], a[208:211], a[192:195], v[56:59]
v_mfma_f32_16x16x32_bf16 v[56:59], a[212:215], a[196:199], v[56:59]
v_mfma_f32_16x16x32_bf16 v[60:63], a[208:211], a[200:203], v[60:63]
v_mfma_f32_16x16x32_bf16 v[60:63], a[212:215], a[204:207], v[60:63]
s_waitcnt vmcnt(6)
s_add_u32 s43, s20, 28672
v_mfma_f32_16x16x32_bf16 v[92:95], a[216:219], a[200:203], v[92:95]
buffer_load_dwordx4 a[208:211], v254, s[8:11], s43 offen offset:0
v_mfma_f32_16x16x32_bf16 v[92:95], a[220:223], a[204:207], v[92:95]
s_add_u32 s43, s20, 28672
v_mfma_f32_16x16x32_bf16 v[88:91], a[216:219], a[192:195], v[88:91]
buffer_load_dwordx4 a[212:215], v254, s[8:11], s43 offen offset:1024
v_mfma_f32_16x16x32_bf16 v[88:91], a[220:223], a[196:199], v[88:91]
v_mfma_f32_16x16x32_bf16 v[84:87], a[216:219], a[184:187], v[84:87]
v_mfma_f32_16x16x32_bf16 v[84:87], a[220:223], a[188:191], v[84:87]
v_mfma_f32_16x16x32_bf16 v[80:83], a[216:219], a[176:179], v[80:83]
v_mfma_f32_16x16x32_bf16 v[80:83], a[220:223], a[180:183], v[80:83]
v_xor_b32 v252, 0x10000, v252
v_mfma_f32_16x16x32_bf16 v[76:79], a[216:219], a[168:171], v[76:79]
v_mfma_f32_16x16x32_bf16 v[76:79], a[220:223], a[172:175], v[76:79]
s_barrier
v_mfma_f32_16x16x32_bf16 v[72:75], a[216:219], a[160:163], v[72:75]
v_mfma_f32_16x16x32_bf16 v[72:75], a[220:223], a[164:167], v[72:75]
v_mfma_f32_16x16x32_bf16 v[68:71], a[216:219], a[152:155], v[68:71]
v_mfma_f32_16x16x32_bf16 v[68:71], a[220:223], a[156:159], v[68:71]
v_mfma_f32_16x16x32_bf16 v[64:67], a[216:219], a[144:147], v[64:67]
v_mfma_f32_16x16x32_bf16 v[64:67], a[220:223], a[148:151], v[64:67]
s_waitcnt vmcnt(6)
s_add_u32 s43, s20, 28672
v_mfma_f32_16x16x32_bf16 v[96:99], a[224:227], a[144:147], v[96:99]
buffer_load_dwordx4 a[216:219], v254, s[8:11], s43 offen offset:2048
ds_read_b128 a[144:147], v252 offset:16384
v_mfma_f32_16x16x32_bf16 v[96:99], a[228:231], a[148:151], v[96:99]
ds_read_b128 a[148:151], v252 offset:16896
s_add_u32 s43, s20, 28672
v_mfma_f32_16x16x32_bf16 v[100:103], a[224:227], a[152:155], v[100:103]
buffer_load_dwordx4 a[220:223], v254, s[8:11], s43 offen offset:3072
ds_read_b128 a[152:155], v252 offset:18432
v_mfma_f32_16x16x32_bf16 v[100:103], a[228:231], a[156:159], v[100:103]
ds_read_b128 a[156:159], v252 offset:18944
v_mfma_f32_16x16x32_bf16 v[104:107], a[224:227], a[160:163], v[104:107]
ds_read_b128 a[160:163], v252 offset:20480
v_mfma_f32_16x16x32_bf16 v[104:107], a[228:231], a[164:167], v[104:107]
ds_read_b128 a[164:167], v252 offset:20992
v_mfma_f32_16x16x32_bf16 v[108:111], a[224:227], a[168:171], v[108:111]
ds_read_b128 a[168:171], v252 offset:22528
v_mfma_f32_16x16x32_bf16 v[108:111], a[228:231], a[172:175], v[108:111]
ds_read_b128 a[172:175], v252 offset:23040
v_mfma_f32_16x16x32_bf16 v[112:115], a[224:227], a[176:179], v[112:115]
ds_read_b128 a[176:179], v252 offset:24576
v_mfma_f32_16x16x32_bf16 v[112:115], a[228:231], a[180:183], v[112:115]
ds_read_b128 a[180:183], v252 offset:25088
v_mfma_f32_16x16x32_bf16 v[116:119], a[224:227], a[184:187], v[116:119]
ds_read_b128 a[184:187], v252 offset:26624
v_mfma_f32_16x16x32_bf16 v[116:119], a[228:231], a[188:191], v[116:119]
ds_read_b128 a[188:191], v252 offset:27136
v_mfma_f32_16x16x32_bf16 v[120:123], a[224:227], a[192:195], v[120:123]
ds_read_b128 a[192:195], v252 offset:28672
v_mfma_f32_16x16x32_bf16 v[120:123], a[228:231], a[196:199], v[120:123]
ds_read_b128 a[196:199], v252 offset:29184
v_mfma_f32_16x16x32_bf16 v[124:127], a[224:227], a[200:203], v[124:127]
ds_read_b128 a[200:203], v252 offset:30720
v_mfma_f32_16x16x32_bf16 v[124:127], a[228:231], a[204:207], v[124:127]
s_waitcnt vmcnt(6) lgkmcnt(11)
ds_read_b128 a[204:207], v252 offset:31232
s_add_u32 s43, s20, 40960
v_mfma_f32_16x16x32_bf16 v[0:3], a[232:235], a[144:147], v[0:3]
buffer_load_dwordx4 a[224:227], v254, s[8:11], s43 offen offset:0
v_mfma_f32_16x16x32_bf16 v[0:3], a[236:239], a[148:151], v[0:3]
s_add_u32 s43, s20, 40960
v_mfma_f32_16x16x32_bf16 v[4:7], a[232:235], a[152:155], v[4:7]
buffer_load_dwordx4 a[228:231], v254, s[8:11], s43 offen offset:1024
v_mfma_f32_16x16x32_bf16 v[4:7], a[236:239], a[156:159], v[4:7]
s_waitcnt lgkmcnt(8)
v_mfma_f32_16x16x32_bf16 v[8:11], a[232:235], a[160:163], v[8:11]
v_mfma_f32_16x16x32_bf16 v[8:11], a[236:239], a[164:167], v[8:11]
v_mfma_f32_16x16x32_bf16 v[12:15], a[232:235], a[168:171], v[12:15]
v_mfma_f32_16x16x32_bf16 v[12:15], a[236:239], a[172:175], v[12:15]
s_waitcnt lgkmcnt(4)
v_mfma_f32_16x16x32_bf16 v[16:19], a[232:235], a[176:179], v[16:19]
v_mfma_f32_16x16x32_bf16 v[16:19], a[236:239], a[180:183], v[16:19]
v_mfma_f32_16x16x32_bf16 v[20:23], a[232:235], a[184:187], v[20:23]
v_mfma_f32_16x16x32_bf16 v[20:23], a[236:239], a[188:191], v[20:23]
s_waitcnt lgkmcnt(0)
v_mfma_f32_16x16x32_bf16 v[24:27], a[232:235], a[192:195], v[24:27]
v_mfma_f32_16x16x32_bf16 v[24:27], a[236:239], a[196:199], v[24:27]
v_mfma_f32_16x16x32_bf16 v[28:31], a[232:235], a[200:203], v[28:31]
v_mfma_f32_16x16x32_bf16 v[28:31], a[236:239], a[204:207], v[28:31]
s_waitcnt vmcnt(6)
s_add_u32 s43, s20, 40960
v_mfma_f32_16x16x32_bf16 v[60:63], a[244:247], a[200:203], v[60:63]
buffer_load_dwordx4 a[232:235], v254, s[8:11], s43 offen offset:2048
v_mfma_f32_16x16x32_bf16 v[60:63], a[248:251], a[204:207], v[60:63]
s_add_u32 s43, s20, 40960
v_mfma_f32_16x16x32_bf16 v[56:59], a[244:247], a[192:195], v[56:59]
buffer_load_dwordx4 a[236:239], v254, s[8:11], s43 offen offset:3072
v_mfma_f32_16x16x32_bf16 v[56:59], a[248:251], a[196:199], v[56:59]
v_mfma_f32_16x16x32_bf16 v[52:55], a[244:247], a[184:187], v[52:55]
v_mfma_f32_16x16x32_bf16 v[52:55], a[248:251], a[188:191], v[52:55]
v_mfma_f32_16x16x32_bf16 v[48:51], a[244:247], a[176:179], v[48:51]
v_mfma_f32_16x16x32_bf16 v[48:51], a[248:251], a[180:183], v[48:51]
v_mfma_f32_16x16x32_bf16 v[44:47], a[244:247], a[168:171], v[44:47]
v_mfma_f32_16x16x32_bf16 v[44:47], a[248:251], a[172:175], v[44:47]
v_mfma_f32_16x16x32_bf16 v[40:43], a[244:247], a[160:163], v[40:43]
v_mfma_f32_16x16x32_bf16 v[40:43], a[248:251], a[164:167], v[40:43]
v_mfma_f32_16x16x32_bf16 v[36:39], a[244:247], a[152:155], v[36:39]
v_mfma_f32_16x16x32_bf16 v[36:39], a[248:251], a[156:159], v[36:39]
v_mfma_f32_16x16x32_bf16 v[32:35], a[244:247], a[144:147], v[32:35]
v_mfma_f32_16x16x32_bf16 v[32:35], a[248:251], a[148:151], v[32:35]
s_waitcnt vmcnt(6)
s_add_u32 s43, s20, 45056
v_mfma_f32_16x16x32_bf16 v[64:67], a[208:211], a[144:147], v[64:67]
buffer_load_dwordx4 a[244:247], v254, s[8:11], s43 offen offset:0
v_mfma_f32_16x16x32_bf16 v[64:67], a[212:215], a[148:151], v[64:67]
s_add_u32 s43, s20, 45056
v_mfma_f32_16x16x32_bf16 v[68:71], a[208:211], a[152:155], v[68:71]
buffer_load_dwordx4 a[248:251], v254, s[8:11], s43 offen offset:1024
v_mfma_f32_16x16x32_bf16 v[68:71], a[212:215], a[156:159], v[68:71]
v_mfma_f32_16x16x32_bf16 v[72:75], a[208:211], a[160:163], v[72:75]
v_mfma_f32_16x16x32_bf16 v[72:75], a[212:215], a[164:167], v[72:75]
v_mfma_f32_16x16x32_bf16 v[76:79], a[208:211], a[168:171], v[76:79]
v_mfma_f32_16x16x32_bf16 v[76:79], a[212:215], a[172:175], v[76:79]
v_mfma_f32_16x16x32_bf16 v[80:83], a[208:211], a[176:179], v[80:83]
v_mfma_f32_16x16x32_bf16 v[80:83], a[212:215], a[180:183], v[80:83]
v_mfma_f32_16x16x32_bf16 v[84:87], a[208:211], a[184:187], v[84:87]
v_mfma_f32_16x16x32_bf16 v[84:87], a[212:215], a[188:191], v[84:87]
v_mfma_f32_16x16x32_bf16 v[88:91], a[208:211], a[192:195], v[88:91]
v_mfma_f32_16x16x32_bf16 v[88:91], a[212:215], a[196:199], v[88:91]
v_mfma_f32_16x16x32_bf16 v[92:95], a[208:211], a[200:203], v[92:95]
v_mfma_f32_16x16x32_bf16 v[92:95], a[212:215], a[204:207], v[92:95]
s_waitcnt vmcnt(6)
s_add_u32 s43, s20, 45056
v_mfma_f32_16x16x32_bf16 v[124:127], a[216:219], a[200:203], v[124:127]
buffer_load_dwordx4 a[208:211], v254, s[8:11], s43 offen offset:2048
ds_read_b128 a[200:203], v252 offset:63488
v_mfma_f32_16x16x32_bf16 v[124:127], a[220:223], a[204:207], v[124:127]
ds_read_b128 a[204:207], v252 offset:64000
s_add_u32 s43, s20, 45056
v_mfma_f32_16x16x32_bf16 v[120:123], a[216:219], a[192:195], v[120:123]
buffer_load_dwordx4 a[212:215], v254, s[8:11], s43 offen offset:3072
ds_read_b128 a[192:195], v252 offset:61440
v_mfma_f32_16x16x32_bf16 v[120:123], a[220:223], a[196:199], v[120:123]
ds_read_b128 a[196:199], v252 offset:61952
v_mfma_f32_16x16x32_bf16 v[116:119], a[216:219], a[184:187], v[116:119]
ds_read_b128 a[184:187], v252 offset:59392
v_mfma_f32_16x16x32_bf16 v[116:119], a[220:223], a[188:191], v[116:119]
ds_read_b128 a[188:191], v252 offset:59904
v_mfma_f32_16x16x32_bf16 v[112:115], a[216:219], a[176:179], v[112:115]
ds_read_b128 a[176:179], v252 offset:57344
v_mfma_f32_16x16x32_bf16 v[112:115], a[220:223], a[180:183], v[112:115]
ds_read_b128 a[180:183], v252 offset:57856
v_mfma_f32_16x16x32_bf16 v[108:111], a[216:219], a[168:171], v[108:111]
ds_read_b128 a[168:171], v252 offset:55296
v_mfma_f32_16x16x32_bf16 v[108:111], a[220:223], a[172:175], v[108:111]
ds_read_b128 a[172:175], v252 offset:55808
v_mfma_f32_16x16x32_bf16 v[104:107], a[216:219], a[160:163], v[104:107]
ds_read_b128 a[160:163], v252 offset:53248
v_mfma_f32_16x16x32_bf16 v[104:107], a[220:223], a[164:167], v[104:107]
ds_read_b128 a[164:167], v252 offset:53760
v_mfma_f32_16x16x32_bf16 v[100:103], a[216:219], a[152:155], v[100:103]
ds_read_b128 a[152:155], v252 offset:51200
v_mfma_f32_16x16x32_bf16 v[100:103], a[220:223], a[156:159], v[100:103]
ds_read_b128 a[156:159], v252 offset:51712
v_mfma_f32_16x16x32_bf16 v[96:99], a[216:219], a[144:147], v[96:99]
ds_read_b128 a[144:147], v252 offset:49152
v_mfma_f32_16x16x32_bf16 v[96:99], a[220:223], a[148:151], v[96:99]
s_waitcnt vmcnt(6) lgkmcnt(11)
ds_read_b128 a[148:151], v252 offset:49664
s_add_u32 s43, s20, 0
v_mfma_f32_16x16x32_bf16 v[28:31], a[224:227], a[200:203], v[28:31]
buffer_load_dwordx4 a[216:219], v254, s[8:11], s43 offen offset:1024
v_mfma_f32_16x16x32_bf16 v[28:31], a[228:231], a[204:207], v[28:31]
s_add_u32 s43, s20, 0
v_mfma_f32_16x16x32_bf16 v[24:27], a[224:227], a[192:195], v[24:27]
buffer_load_dwordx4 a[220:223], v254, s[8:11], s43 offen offset:2048
v_mfma_f32_16x16x32_bf16 v[24:27], a[228:231], a[196:199], v[24:27]
s_waitcnt lgkmcnt(8)
v_mfma_f32_16x16x32_bf16 v[20:23], a[224:227], a[184:187], v[20:23]
v_mfma_f32_16x16x32_bf16 v[20:23], a[228:231], a[188:191], v[20:23]
v_mfma_f32_16x16x32_bf16 v[16:19], a[224:227], a[176:179], v[16:19]
v_mfma_f32_16x16x32_bf16 v[16:19], a[228:231], a[180:183], v[16:19]
s_waitcnt lgkmcnt(4)
v_mfma_f32_16x16x32_bf16 v[12:15], a[224:227], a[168:171], v[12:15]
v_mfma_f32_16x16x32_bf16 v[12:15], a[228:231], a[172:175], v[12:15]
v_mfma_f32_16x16x32_bf16 v[8:11], a[224:227], a[160:163], v[8:11]
v_mfma_f32_16x16x32_bf16 v[8:11], a[228:231], a[164:167], v[8:11]
s_waitcnt lgkmcnt(0)
v_mfma_f32_16x16x32_bf16 v[4:7], a[224:227], a[152:155], v[4:7]
v_mfma_f32_4x4x4_16b_bf16 v[240:243], a[252:253], a[16:17], 0
v_mfma_f32_4x4x4_16b_bf16 v[244:247], a[252:253], a[18:19], 0
v_mfma_f32_16x16x32_bf16 v[4:7], a[228:231], a[156:159], v[4:7]
v_mfma_f32_16x16x32_bf16 v[0:3], a[224:227], a[144:147], v[0:3]
v_mfma_f32_16x16x32_bf16 v[0:3], a[228:231], a[148:151], v[0:3]
s_waitcnt vmcnt(6)
s_add_u32 s43, s20, 0
v_mfma_f32_16x16x32_bf16 v[32:35], a[232:235], a[144:147], v[32:35]
buffer_load_dwordx4 a[224:227], v254, s[8:11], s43 offen offset:3072
v_mfma_f32_16x16x32_bf16 v[32:35], a[236:239], a[148:151], v[32:35]
s_add_u32 s43, s20, 4096
v_mfma_f32_16x16x32_bf16 v[36:39], a[232:235], a[152:155], v[36:39]
buffer_load_dwordx4 a[228:231], v254, s[8:11], s43 offen offset:0
v_mfma_f32_16x16x32_bf16 v[36:39], a[236:239], a[156:159], v[36:39]
v_mfma_f32_16x16x32_bf16 v[40:43], a[232:235], a[160:163], v[40:43]
v_mul_f32 v240, v240, v0
v_mul_f32 v241, v241, v1
v_mfma_f32_16x16x32_bf16 v[40:43], a[236:239], a[164:167], v[40:43]
v_mul_f32 v242, v242, v2
v_mul_f32 v243, v243, v3
v_mfma_f32_16x16x32_bf16 v[44:47], a[232:235], a[168:171], v[44:47]
v_cvt_pk_bf16_f32 v248, v240, v241
v_cvt_pk_bf16_f32 v249, v242, v243
v_mfma_f32_4x4x4_16b_bf16 v[240:243], a[252:253], a[20:21], 0
v_mul_f32 v244, v244, v32
v_mul_f32 v245, v245, v33
v_mfma_f32_16x16x32_bf16 v[44:47], a[236:239], a[172:175], v[44:47]
v_mul_f32 v246, v246, v34
v_mul_f32 v247, v247, v35
v_mfma_f32_16x16x32_bf16 v[48:51], a[232:235], a[176:179], v[48:51]
v_cvt_pk_bf16_f32 v250, v244, v245
v_cvt_pk_bf16_f32 v251, v246, v247
v_mfma_f32_4x4x4_16b_bf16 v[244:247], a[252:253], a[22:23], 0
ds_write_b128 v253, v[248:251] offset:0
v_mfma_f32_16x16x32_bf16 v[48:51], a[236:239], a[180:183], v[48:51]
v_mul_f32 v240, v240, v4
v_mul_f32 v241, v241, v5
v_mfma_f32_16x16x32_bf16 v[52:55], a[232:235], a[184:187], v[52:55]
v_mul_f32 v242, v242, v6
v_mul_f32 v243, v243, v7
v_mfma_f32_16x16x32_bf16 v[52:55], a[236:239], a[188:191], v[52:55]
v_cvt_pk_bf16_f32 v248, v240, v241
v_cvt_pk_bf16_f32 v249, v242, v243
v_mfma_f32_4x4x4_16b_bf16 v[240:243], a[252:253], a[24:25], 0
v_mul_f32 v244, v244, v36
v_mul_f32 v245, v245, v37
v_mfma_f32_16x16x32_bf16 v[56:59], a[232:235], a[192:195], v[56:59]
v_mul_f32 v246, v246, v38
v_mul_f32 v247, v247, v39
v_mfma_f32_16x16x32_bf16 v[56:59], a[236:239], a[196:199], v[56:59]
v_cvt_pk_bf16_f32 v250, v244, v245
v_cvt_pk_bf16_f32 v251, v246, v247
v_mfma_f32_4x4x4_16b_bf16 v[244:247], a[252:253], a[26:27], 0
ds_write_b128 v253, v[248:251] offset:2048
v_mfma_f32_16x16x32_bf16 v[60:63], a[232:235], a[200:203], v[60:63]
v_mul_f32 v240, v240, v8
v_mul_f32 v241, v241, v9
v_mfma_f32_16x16x32_bf16 v[60:63], a[236:239], a[204:207], v[60:63]
s_waitcnt vmcnt(6)
v_mul_f32 v242, v242, v10
s_add_u32 s43, s20, 4096
v_mfma_f32_16x16x32_bf16 v[92:95], a[244:247], a[200:203], v[92:95]
buffer_load_dwordx4 a[232:235], v254, s[8:11], s43 offen offset:1024
v_mul_f32 v243, v243, v11
v_mfma_f32_16x16x32_bf16 v[92:95], a[248:251], a[204:207], v[92:95]
v_cvt_pk_bf16_f32 v248, v240, v241
s_add_u32 s43, s20, 4096
v_mfma_f32_16x16x32_bf16 v[88:91], a[244:247], a[192:195], v[88:91]
buffer_load_dwordx4 a[236:239], v254, s[8:11], s43 offen offset:2048
v_cvt_pk_bf16_f32 v249, v242, v243
v_mfma_f32_4x4x4_16b_bf16 v[240:243], a[252:253], a[28:29], 0
v_mul_f32 v244, v244, v40
v_mul_f32 v245, v245, v41
v_mfma_f32_16x16x32_bf16 v[88:91], a[248:251], a[196:199], v[88:91]
v_mul_f32 v246, v246, v42
v_mul_f32 v247, v247, v43
v_mfma_f32_16x16x32_bf16 v[84:87], a[244:247], a[184:187], v[84:87]
v_cvt_pk_bf16_f32 v250, v244, v245
v_cvt_pk_bf16_f32 v251, v246, v247
v_mfma_f32_4x4x4_16b_bf16 v[244:247], a[252:253], a[30:31], 0
ds_write_b128 v253, v[248:251] offset:4096
v_mfma_f32_16x16x32_bf16 v[84:87], a[248:251], a[188:191], v[84:87]
v_mul_f32 v240, v240, v12
v_mul_f32 v241, v241, v13
v_mfma_f32_16x16x32_bf16 v[80:83], a[244:247], a[176:179], v[80:83]
v_mul_f32 v242, v242, v14
v_mul_f32 v243, v243, v15
v_mfma_f32_16x16x32_bf16 v[80:83], a[248:251], a[180:183], v[80:83]
v_xor_b32 v252, 0x10000, v252
v_cvt_pk_bf16_f32 v248, v240, v241
v_mfma_f32_16x16x32_bf16 v[76:79], a[244:247], a[168:171], v[76:79]
v_cvt_pk_bf16_f32 v249, v242, v243
v_mfma_f32_4x4x4_16b_bf16 v[240:243], a[252:253], a[32:33], 0
v_mul_f32 v244, v244, v44
v_mul_f32 v245, v245, v45
v_mfma_f32_16x16x32_bf16 v[76:79], a[248:251], a[172:175], v[76:79]
v_mul_f32 v246, v246, v46
v_mul_f32 v247, v247, v47
v_mfma_f32_16x16x32_bf16 v[72:75], a[244:247], a[160:163], v[72:75]
v_cvt_pk_bf16_f32 v250, v244, v245
v_cvt_pk_bf16_f32 v251, v246, v247
v_mfma_f32_4x4x4_16b_bf16 v[244:247], a[252:253], a[34:35], 0
ds_write_b128 v253, v[248:251] offset:6144
v_mfma_f32_16x16x32_bf16 v[72:75], a[248:251], a[164:167], v[72:75]
v_mul_f32 v240, v240, v16
v_mul_f32 v241, v241, v17
v_mfma_f32_16x16x32_bf16 v[68:71], a[244:247], a[152:155], v[68:71]
v_mul_f32 v242, v242, v18
v_mul_f32 v243, v243, v19
v_mfma_f32_16x16x32_bf16 v[68:71], a[248:251], a[156:159], v[68:71]
v_cvt_pk_bf16_f32 v248, v240, v241
v_cvt_pk_bf16_f32 v249, v242, v243
v_mfma_f32_4x4x4_16b_bf16 v[240:243], a[252:253], a[36:37], 0
v_mul_f32 v244, v244, v48
v_mul_f32 v245, v245, v49
v_mfma_f32_16x16x32_bf16 v[64:67], a[244:247], a[144:147], v[64:67]
v_mul_f32 v246, v246, v50
v_mul_f32 v247, v247, v51
v_mfma_f32_16x16x32_bf16 v[64:67], a[248:251], a[148:151], v[64:67]
s_waitcnt vmcnt(6)
v_cvt_pk_bf16_f32 v250, v244, v245
s_add_u32 s43, s20, 4096
v_mfma_f32_16x16x32_bf16 v[96:99], a[208:211], a[144:147], v[96:99]
buffer_load_dwordx4 a[244:247], v254, s[8:11], s43 offen offset:3072
ds_read_b128 a[144:147], v252 offset:0
v_cvt_pk_bf16_f32 v251, v246, v247
v_mfma_f32_4x4x4_16b_bf16 v[244:247], a[252:253], a[38:39], 0
ds_write_b128 v253, v[248:251] offset:8192
v_mfma_f32_16x16x32_bf16 v[96:99], a[212:215], a[148:151], v[96:99]
ds_read_b128 a[148:151], v252 offset:512
s_add_u32 s43, s20, 16384
v_mfma_f32_16x16x32_bf16 v[100:103], a[208:211], a[152:155], v[100:103]
buffer_load_dwordx4 a[248:251], v254, s[8:11], s43 offen offset:0
ds_read_b128 a[152:155], v252 offset:2048
v_mul_f32 v240, v240, v20
v_mfma_f32_16x16x32_bf16 v[100:103], a[212:215], a[156:159], v[100:103]
ds_read_b128 a[156:159], v252 offset:2560
v_mul_f32 v241, v241, v21
v_mfma_f32_16x16x32_bf16 v[104:107], a[208:211], a[160:163], v[104:107]
ds_read_b128 a[160:163], v252 offset:4096
v_mul_f32 v242, v242, v22
v_mfma_f32_16x16x32_bf16 v[104:107], a[212:215], a[164:167], v[104:107]
ds_read_b128 a[164:167], v252 offset:4608
v_mul_f32 v243, v243, v23
v_mfma_f32_16x16x32_bf16 v[108:111], a[208:211], a[168:171], v[108:111]
ds_read_b128 a[168:171], v252 offset:6144
v_cvt_pk_bf16_f32 v248, v240, v241
v_mfma_f32_16x16x32_bf16 v[108:111], a[212:215], a[172:175], v[108:111]
ds_read_b128 a[172:175], v252 offset:6656
v_cvt_pk_bf16_f32 v249, v242, v243
v_mfma_f32_4x4x4_16b_bf16 v[240:243], a[252:253], a[40:41], 0
v_mul_f32 v244, v244, v52
v_mul_f32 v245, v245, v53
v_mfma_f32_16x16x32_bf16 v[112:115], a[208:211], a[176:179], v[112:115]
ds_read_b128 a[176:179], v252 offset:8192
v_mul_f32 v246, v246, v54
v_mfma_f32_16x16x32_bf16 v[112:115], a[212:215], a[180:183], v[112:115]
ds_read_b128 a[180:183], v252 offset:8704
v_mul_f32 v247, v247, v55
v_mfma_f32_16x16x32_bf16 v[116:119], a[208:211], a[184:187], v[116:119]
ds_read_b128 a[184:187], v252 offset:10240
v_cvt_pk_bf16_f32 v250, v244, v245
v_mfma_f32_16x16x32_bf16 v[116:119], a[212:215], a[188:191], v[116:119]
ds_read_b128 a[188:191], v252 offset:10752
v_cvt_pk_bf16_f32 v251, v246, v247
v_mfma_f32_4x4x4_16b_bf16 v[244:247], a[252:253], a[42:43], 0
ds_write_b128 v253, v[248:251] offset:10240
v_mfma_f32_16x16x32_bf16 v[120:123], a[208:211], a[192:195], v[120:123]
ds_read_b128 a[192:195], v252 offset:12288
v_mul_f32 v240, v240, v24
v_mfma_f32_16x16x32_bf16 v[120:123], a[212:215], a[196:199], v[120:123]
ds_read_b128 a[196:199], v252 offset:12800
v_mul_f32 v241, v241, v25
v_mfma_f32_16x16x32_bf16 v[124:127], a[208:211], a[200:203], v[124:127]
ds_read_b128 a[200:203], v252 offset:14336
v_mul_f32 v242, v242, v26
v_mfma_f32_16x16x32_bf16 v[124:127], a[212:215], a[204:207], v[124:127]
s_waitcnt vmcnt(7) lgkmcnt(12)
ds_read_b128 a[204:207], v252 offset:14848
s_add_u32 s43, s20, 16384
v_mfma_f32_16x16x32_bf16 v[128:131], a[240:243], a[144:147], v[128:131]
buffer_load_dwordx4 a[208:211], v254, s[8:11], s43 offen offset:1024
v_mul_f32 v243, v243, v27
v_mfma_f32_16x16x32_bf16 v[128:131], a[216:219], a[148:151], v[128:131]
v_cvt_pk_bf16_f32 v248, v240, v241
s_add_u32 s43, s20, 16384
v_mfma_f32_16x16x32_bf16 v[132:135], a[240:243], a[152:155], v[132:135]
buffer_load_dwordx4 a[212:215], v254, s[8:11], s43 offen offset:2048
v_cvt_pk_bf16_f32 v249, v242, v243
v_mfma_f32_4x4x4_16b_bf16 v[240:243], a[252:253], a[44:45], 0
v_mul_f32 v244, v244, v56
v_mul_f32 v245, v245, v57
v_mfma_f32_16x16x32_bf16 v[132:135], a[216:219], a[156:159], v[132:135]
s_waitcnt lgkmcnt(9)
v_mul_f32 v246, v246, v58
v_mul_f32 v247, v247, v59
v_mfma_f32_16x16x32_bf16 v[136:139], a[240:243], a[160:163], v[136:139]
v_cvt_pk_bf16_f32 v250, v244, v245
v_cvt_pk_bf16_f32 v251, v246, v247
v_mfma_f32_4x4x4_16b_bf16 v[244:247], a[252:253], a[46:47], 0
ds_write_b128 v253, v[248:251] offset:12288
v_mfma_f32_16x16x32_bf16 v[136:139], a[216:219], a[164:167], v[136:139]
v_mul_f32 v240, v240, v28
v_mul_f32 v241, v241, v29
v_mfma_f32_16x16x32_bf16 v[140:143], a[240:243], a[168:171], v[140:143]
v_mul_f32 v242, v242, v30
v_mul_f32 v243, v243, v31
v_mfma_f32_16x16x32_bf16 v[140:143], a[216:219], a[172:175], v[140:143]
s_waitcnt lgkmcnt(6)
v_cvt_pk_bf16_f32 v248, v240, v241
v_cvt_pk_bf16_f32 v249, v242, v243
v_mfma_f32_4x4x4_16b_bf16 v[240:243], a[252:253], a[48:49], 0
v_mul_f32 v244, v244, v60
v_mul_f32 v245, v245, v61
v_mfma_f32_16x16x32_bf16 v[144:147], a[240:243], a[176:179], v[144:147]
v_mul_f32 v246, v246, v62
v_mul_f32 v247, v247, v63
v_mfma_f32_16x16x32_bf16 v[144:147], a[216:219], a[180:183], v[144:147]
v_cvt_pk_bf16_f32 v250, v244, v245
v_cvt_pk_bf16_f32 v251, v246, v247
v_mfma_f32_4x4x4_16b_bf16 v[244:247], a[252:253], a[50:51], 0
ds_write_b128 v253, v[248:251] offset:14336
v_mfma_f32_16x16x32_bf16 v[148:151], a[240:243], a[184:187], v[148:151]
v_add_u32 v0, s42, v254
v_mul_f32 v240, v240, v64
v_mfma_f32_16x16x32_bf16 v[148:151], a[216:219], a[188:191], v[148:151]
s_waitcnt lgkmcnt(2)
v_mul_f32 v241, v241, v65
v_mul_f32 v242, v242, v66
v_mfma_f32_16x16x32_bf16 v[152:155], a[240:243], a[192:195], v[152:155]
v_mul_f32 v243, v243, v67
v_cvt_pk_bf16_f32 v248, v240, v241
v_mfma_f32_16x16x32_bf16 v[152:155], a[216:219], a[196:199], v[152:155]
v_cvt_pk_bf16_f32 v249, v242, v243
v_mfma_f32_4x4x4_16b_bf16 v[240:243], a[252:253], a[52:53], 0
v_mul_f32 v244, v244, v96
v_mul_f32 v245, v245, v97
v_mfma_f32_16x16x32_bf16 v[156:159], a[240:243], a[200:203], v[156:159]
v_mul_f32 v246, v246, v98
v_mul_f32 v247, v247, v99
v_mfma_f32_16x16x32_bf16 v[156:159], a[216:219], a[204:207], v[156:159]
s_waitcnt vmcnt(7)
v_cvt_pk_bf16_f32 v250, v244, v245
s_add_u32 s43, s20, 16384
v_mfma_f32_16x16x32_bf16 v[188:191], a[220:223], a[200:203], v[188:191]
buffer_load_dwordx4 a[216:219], v254, s[8:11], s43 offen offset:3072
v_cvt_pk_bf16_f32 v251, v246, v247
v_mfma_f32_4x4x4_16b_bf16 v[244:247], a[252:253], a[54:55], 0
ds_write_b128 v253, v[248:251] offset:512
v_mfma_f32_16x16x32_bf16 v[188:191], a[224:227], a[204:207], v[188:191]
ds_read_b128 v[4:7], v0 offset:0
v_mul_f32 v240, v240, v68
s_add_u32 s43, s20, 20480
v_mfma_f32_16x16x32_bf16 v[184:187], a[220:223], a[192:195], v[184:187]
buffer_load_dwordx4 a[240:243], v254, s[8:11], s43 offen offset:0
v_mul_f32 v241, v241, v69
v_mfma_f32_16x16x32_bf16 v[184:187], a[224:227], a[196:199], v[184:187]
v_mul_f32 v242, v242, v70
v_mul_f32 v243, v243, v71
v_mfma_f32_16x16x32_bf16 v[180:183], a[220:223], a[184:187], v[180:183]
v_cvt_pk_bf16_f32 v248, v240, v241
v_cvt_pk_bf16_f32 v249, v242, v243
v_mfma_f32_4x4x4_16b_bf16 v[240:243], a[252:253], a[56:57], 0
v_mul_f32 v244, v244, v100
v_mul_f32 v245, v245, v101
v_mfma_f32_16x16x32_bf16 v[180:183], a[224:227], a[188:191], v[180:183]
v_mul_f32 v246, v246, v102
v_mul_f32 v247, v247, v103
v_mfma_f32_16x16x32_bf16 v[176:179], a[220:223], a[176:179], v[176:179]
v_cvt_pk_bf16_f32 v250, v244, v245
v_cvt_pk_bf16_f32 v251, v246, v247
v_mfma_f32_4x4x4_16b_bf16 v[244:247], a[252:253], a[58:59], 0
ds_write_b128 v253, v[248:251] offset:2560
v_mfma_f32_16x16x32_bf16 v[176:179], a[224:227], a[180:183], v[176:179]
s_waitcnt lgkmcnt(1)
buffer_store_dwordx4 v[4:7], v255, s[16:19], s37 offen offset:0 nt
v_mul_f32 v240, v240, v72
v_mul_f32 v241, v241, v73
v_mfma_f32_16x16x32_bf16 v[172:175], a[220:223], a[168:171], v[172:175]
s_add_u32 s37, s37, 16384
v_mul_f32 v242, v242, v74
v_mul_f32 v243, v243, v75
v_mfma_f32_16x16x32_bf16 v[172:175], a[224:227], a[172:175], v[172:175]
v_cvt_pk_bf16_f32 v248, v240, v241
v_cvt_pk_bf16_f32 v249, v242, v243
v_mfma_f32_4x4x4_16b_bf16 v[240:243], a[252:253], a[60:61], 0
v_mul_f32 v244, v244, v104
v_mul_f32 v245, v245, v105
v_mfma_f32_16x16x32_bf16 v[168:171], a[220:223], a[160:163], v[168:171]
ds_read_b128 v[8:11], v0 offset:1024
v_mul_f32 v246, v246, v106
v_mul_f32 v247, v247, v107
v_mfma_f32_16x16x32_bf16 v[168:171], a[224:227], a[164:167], v[168:171]
v_cvt_pk_bf16_f32 v250, v244, v245
v_cvt_pk_bf16_f32 v251, v246, v247
v_mfma_f32_4x4x4_16b_bf16 v[244:247], a[252:253], a[62:63], 0
ds_write_b128 v253, v[248:251] offset:4608
v_mfma_f32_16x16x32_bf16 v[164:167], a[220:223], a[152:155], v[164:167]
v_mul_f32 v240, v240, v76
v_mul_f32 v241, v241, v77
v_mfma_f32_16x16x32_bf16 v[164:167], a[224:227], a[156:159], v[164:167]
v_mul_f32 v242, v242, v78
v_mul_f32 v243, v243, v79
v_mfma_f32_16x16x32_bf16 v[160:163], a[220:223], a[144:147], v[160:163]
v_cvt_pk_bf16_f32 v248, v240, v241
v_cvt_pk_bf16_f32 v249, v242, v243
v_mfma_f32_4x4x4_16b_bf16 v[240:243], a[252:253], a[64:65], 0
v_mul_f32 v244, v244, v108
v_mul_f32 v245, v245, v109
v_mfma_f32_16x16x32_bf16 v[160:163], a[224:227], a[148:151], v[160:163]
s_waitcnt vmcnt(8)
v_mul_f32 v246, v246, v110
s_add_u32 s43, s20, 20480
v_mfma_f32_16x16x32_bf16 v[192:195], a[228:231], a[144:147], v[192:195]
buffer_load_dwordx4 a[220:223], v254, s[8:11], s43 offen offset:1024
v_mul_f32 v247, v247, v111
v_mfma_f32_16x16x32_bf16 v[192:195], a[232:235], a[148:151], v[192:195]
s_waitcnt lgkmcnt(1)
buffer_store_dwordx4 v[8:11], v255, s[16:19], s37 offen offset:0 nt
v_cvt_pk_bf16_f32 v250, v244, v245
s_add_u32 s43, s20, 20480
v_mfma_f32_16x16x32_bf16 v[196:199], a[228:231], a[152:155], v[196:199]
s_add_u32 s37, s37, 16384
buffer_load_dwordx4 a[224:227], v254, s[8:11], s43 offen offset:2048
v_cvt_pk_bf16_f32 v251, v246, v247
v_mfma_f32_4x4x4_16b_bf16 v[244:247], a[252:253], a[66:67], 0
ds_write_b128 v253, v[248:251] offset:6656
v_mfma_f32_16x16x32_bf16 v[196:199], a[232:235], a[156:159], v[196:199]
ds_read_b128 v[12:15], v0 offset:2048
v_mul_f32 v240, v240, v80
v_mul_f32 v241, v241, v81
v_mfma_f32_16x16x32_bf16 v[200:203], a[228:231], a[160:163], v[200:203]
v_mul_f32 v242, v242, v82
v_mul_f32 v243, v243, v83
v_mfma_f32_16x16x32_bf16 v[200:203], a[232:235], a[164:167], v[200:203]
v_cvt_pk_bf16_f32 v248, v240, v241
v_cvt_pk_bf16_f32 v249, v242, v243
v_mfma_f32_4x4x4_16b_bf16 v[240:243], a[252:253], a[68:69], 0
v_mul_f32 v244, v244, v112
v_mul_f32 v245, v245, v113
v_mfma_f32_16x16x32_bf16 v[204:207], a[228:231], a[168:171], v[204:207]
v_mul_f32 v246, v246, v114
v_mul_f32 v247, v247, v115
v_mfma_f32_16x16x32_bf16 v[204:207], a[232:235], a[172:175], v[204:207]
v_cvt_pk_bf16_f32 v250, v244, v245
v_cvt_pk_bf16_f32 v251, v246, v247
v_mfma_f32_4x4x4_16b_bf16 v[244:247], a[252:253], a[70:71], 0
ds_write_b128 v253, v[248:251] offset:8704
v_mfma_f32_16x16x32_bf16 v[208:211], a[228:231], a[176:179], v[208:211]
v_mul_f32 v240, v240, v84
v_mul_f32 v241, v241, v85
v_mfma_f32_16x16x32_bf16 v[208:211], a[232:235], a[180:183], v[208:211]
s_waitcnt lgkmcnt(1)
buffer_store_dwordx4 v[12:15], v255, s[16:19], s37 offen offset:0 nt
v_mul_f32 v242, v242, v86
v_mul_f32 v243, v243, v87
v_mfma_f32_16x16x32_bf16 v[212:215], a[228:231], a[184:187], v[212:215]
s_add_u32 s37, s37, 16384
v_cvt_pk_bf16_f32 v248, v240, v241
v_cvt_pk_bf16_f32 v249, v242, v243
v_mfma_f32_4x4x4_16b_bf16 v[240:243], a[252:253], a[72:73], 0
v_mul_f32 v244, v244, v116
v_mul_f32 v245, v245, v117
v_mfma_f32_16x16x32_bf16 v[212:215], a[232:235], a[188:191], v[212:215]
v_mul_f32 v246, v246, v118
v_mul_f32 v247, v247, v119
v_mfma_f32_16x16x32_bf16 v[216:219], a[228:231], a[192:195], v[216:219]
ds_read_b128 v[16:19], v0 offset:3072
v_cvt_pk_bf16_f32 v250, v244, v245
v_cvt_pk_bf16_f32 v251, v246, v247
v_mfma_f32_4x4x4_16b_bf16 v[244:247], a[252:253], a[74:75], 0
ds_write_b128 v253, v[248:251] offset:10752
v_mfma_f32_16x16x32_bf16 v[216:219], a[232:235], a[196:199], v[216:219]
v_mul_f32 v240, v240, v88
v_mul_f32 v241, v241, v89
v_mfma_f32_16x16x32_bf16 v[220:223], a[228:231], a[200:203], v[220:223]
v_mul_f32 v242, v242, v90
v_mul_f32 v243, v243, v91
v_mfma_f32_16x16x32_bf16 v[220:223], a[232:235], a[204:207], v[220:223]
s_waitcnt vmcnt(10)
v_cvt_pk_bf16_f32 v248, v240, v241
s_add_u32 s43, s20, 20480
v_mfma_f32_16x16x32_bf16 a[12:15], a[236:239], a[200:203], a[12:15]
buffer_load_dwordx4 a[228:231], v254, s[8:11], s43 offen offset:3072
ds_read_b128 a[200:203], v252 offset:47104
v_cvt_pk_bf16_f32 v249, v242, v243
v_mfma_f32_4x4x4_16b_bf16 v[240:243], a[252:253], a[76:77], 0
v_mul_f32 v244, v244, v120
v_mul_f32 v245, v245, v121
v_mfma_f32_16x16x32_bf16 a[12:15], a[244:247], a[204:207], a[12:15]
ds_read_b128 a[204:207], v252 offset:47616
s_add_u32 s43, s20, 32768
v_mfma_f32_16x16x32_bf16 a[8:11], a[236:239], a[192:195], a[8:11]
s_waitcnt lgkmcnt(3)
buffer_load_dwordx4 a[232:235], v254, s[8:11], s43 offen offset:0
ds_read_b128 a[192:195], v252 offset:45056
buffer_store_dwordx4 v[16:19], v255, s[16:19], s37 offen offset:0 nt
v_mul_f32 v246, v246, v122
v_mfma_f32_16x16x32_bf16 a[8:11], a[244:247], a[196:199], a[8:11]
s_add_u32 s37, s37, 16384
ds_read_b128 a[196:199], v252 offset:45568
v_mul_f32 v247, v247, v123
v_mfma_f32_16x16x32_bf16 a[4:7], a[236:239], a[184:187], a[4:7]
ds_read_b128 a[184:187], v252 offset:43008
v_cvt_pk_bf16_f32 v250, v244, v245
v_mfma_f32_16x16x32_bf16 a[4:7], a[244:247], a[188:191], a[4:7]
ds_read_b128 a[188:191], v252 offset:43520
ds_read_b128 v[20:23], v0 offset:4096
v_cvt_pk_bf16_f32 v251, v246, v247
v_mfma_f32_4x4x4_16b_bf16 v[244:247], a[252:253], a[78:79], 0
ds_write_b128 v253, v[248:251] offset:12800
v_mfma_f32_16x16x32_bf16 a[0:3], a[236:239], a[176:179], a[0:3]
ds_read_b128 a[176:179], v252 offset:40960
v_mul_f32 v240, v240, v92
v_mfma_f32_16x16x32_bf16 a[0:3], a[244:247], a[180:183], a[0:3]
ds_read_b128 a[180:183], v252 offset:41472
v_mul_f32 v241, v241, v93
v_mfma_f32_16x16x32_bf16 v[236:239], a[236:239], a[168:171], v[236:239]
ds_read_b128 a[168:171], v252 offset:38912
v_mul_f32 v242, v242, v94
v_mfma_f32_16x16x32_bf16 v[236:239], a[244:247], a[172:175], v[236:239]
ds_read_b128 a[172:175], v252 offset:39424
v_mul_f32 v243, v243, v95
v_mfma_f32_16x16x32_bf16 v[232:235], a[236:239], a[160:163], v[232:235]
ds_read_b128 a[160:163], v252 offset:36864
v_cvt_pk_bf16_f32 v248, v240, v241
v_mfma_f32_16x16x32_bf16 v[232:235], a[244:247], a[164:167], v[232:235]
ds_read_b128 a[164:167], v252 offset:37376
v_cvt_pk_bf16_f32 v249, v242, v243
v_mfma_f32_4x4x4_16b_bf16 v[240:243], a[252:253], a[80:81], 0
v_mul_f32 v244, v244, v124
v_mul_f32 v245, v245, v125
v_mfma_f32_16x16x32_bf16 v[228:231], a[236:239], a[152:155], v[228:231]
ds_read_b128 a[152:155], v252 offset:34816
v_mul_f32 v246, v246, v126
v_mfma_f32_16x16x32_bf16 v[228:231], a[244:247], a[156:159], v[228:231]
ds_read_b128 a[156:159], v252 offset:35328
v_mul_f32 v247, v247, v127
v_mfma_f32_16x16x32_bf16 v[224:227], a[236:239], a[144:147], v[224:227]
ds_read_b128 a[144:147], v252 offset:32768
v_cvt_pk_bf16_f32 v250, v244, v245
v_mfma_f32_16x16x32_bf16 v[224:227], a[244:247], a[148:151], v[224:227]
s_waitcnt vmcnt(11) lgkmcnt(13)
ds_read_b128 a[148:151], v252 offset:33280
s_add_u32 s43, s20, 32768
v_mfma_f32_16x16x32_bf16 v[156:159], a[248:251], a[200:203], v[156:159]
buffer_load_dwordx4 a[236:239], v254, s[8:11], s43 offen offset:1024
v_cvt_pk_bf16_f32 v251, v246, v247
v_mfma_f32_4x4x4_16b_bf16 v[244:247], a[252:253], a[82:83], 0
ds_write_b128 v253, v[248:251] offset:14848
v_mfma_f32_16x16x32_bf16 v[156:159], a[208:211], a[204:207], v[156:159]
s_waitcnt lgkmcnt(12)
buffer_store_dwordx4 v[20:23], v255, s[16:19], s37 offen offset:0 nt
s_add_u32 s43, s20, 32768
v_mfma_f32_16x16x32_bf16 v[152:155], a[248:251], a[192:195], v[152:155]
s_add_u32 s37, s37, 16384
buffer_load_dwordx4 a[244:247], v254, s[8:11], s43 offen offset:2048
v_mfma_f32_16x16x32_bf16 v[152:155], a[208:211], a[196:199], v[152:155]
s_waitcnt lgkmcnt(9)
ds_read_b128 v[24:27], v0 offset:5120
v_mfma_f32_16x16x32_bf16 v[148:151], a[248:251], a[184:187], v[148:151]
v_mfma_f32_16x16x32_bf16 v[148:151], a[208:211], a[188:191], v[148:151]
v_mfma_f32_16x16x32_bf16 v[144:147], a[248:251], a[176:179], v[144:147]
v_mfma_f32_16x16x32_bf16 v[144:147], a[208:211], a[180:183], v[144:147]
s_waitcnt lgkmcnt(6)
ds_read_b128 v[4:7], v0 offset:6144
v_mfma_f32_16x16x32_bf16 v[140:143], a[248:251], a[168:171], v[140:143]
v_mfma_f32_16x16x32_bf16 v[140:143], a[208:211], a[172:175], v[140:143]
s_waitcnt lgkmcnt(1)
buffer_store_dwordx4 v[24:27], v255, s[16:19], s37 offen offset:0 nt
v_mfma_f32_16x16x32_bf16 v[136:139], a[248:251], a[160:163], v[136:139]
s_add_u32 s37, s37, 16384
v_mfma_f32_16x16x32_bf16 v[136:139], a[208:211], a[164:167], v[136:139]
v_mfma_f32_16x16x32_bf16 v[132:135], a[248:251], a[152:155], v[132:135]
v_mfma_f32_16x16x32_bf16 v[132:135], a[208:211], a[156:159], v[132:135]
s_waitcnt lgkmcnt(0)
buffer_store_dwordx4 v[4:7], v255, s[16:19], s37 offen offset:0 nt
v_mfma_f32_16x16x32_bf16 v[128:131], a[248:251], a[144:147], v[128:131]
s_add_u32 s37, s37, 16384
v_mfma_f32_16x16x32_bf16 v[128:131], a[208:211], a[148:151], v[128:131]
s_waitcnt vmcnt(14)
s_add_u32 s43, s20, 32768
v_mfma_f32_16x16x32_bf16 v[160:163], a[212:215], a[144:147], v[160:163]
buffer_load_dwordx4 a[208:211], v254, s[8:11], s43 offen offset:3072
v_mfma_f32_16x16x32_bf16 v[160:163], a[216:219], a[148:151], v[160:163]
ds_read_b128 v[8:11], v0 offset:7168
s_add_u32 s43, s20, 36864
v_mfma_f32_16x16x32_bf16 v[164:167], a[212:215], a[152:155], v[164:167]
buffer_load_dwordx4 a[248:251], v254, s[8:11], s43 offen offset:0
v_mfma_f32_16x16x32_bf16 v[164:167], a[216:219], a[156:159], v[164:167]
v_mfma_f32_16x16x32_bf16 v[168:171], a[212:215], a[160:163], v[168:171]
v_mfma_f32_16x16x32_bf16 v[168:171], a[216:219], a[164:167], v[168:171]
v_mfma_f32_16x16x32_bf16 v[172:175], a[212:215], a[168:171], v[172:175]
v_mfma_f32_16x16x32_bf16 v[172:175], a[216:219], a[172:175], v[172:175]
s_waitcnt lgkmcnt(0)
buffer_store_dwordx4 v[8:11], v255, s[16:19], s37 offen offset:0 nt
v_mfma_f32_16x16x32_bf16 v[176:179], a[212:215], a[176:179], v[176:179]
s_add_u32 s37, s37, 16384
v_mfma_f32_16x16x32_bf16 v[176:179], a[216:219], a[180:183], v[176:179]
ds_read_b128 v[12:15], v0 offset:8192
v_mfma_f32_16x16x32_bf16 v[180:183], a[212:215], a[184:187], v[180:183]
v_mfma_f32_16x16x32_bf16 v[180:183], a[216:219], a[188:191], v[180:183]
v_mfma_f32_16x16x32_bf16 v[184:187], a[212:215], a[192:195], v[184:187]
v_mfma_f32_16x16x32_bf16 v[184:187], a[216:219], a[196:199], v[184:187]
v_mfma_f32_16x16x32_bf16 v[188:191], a[212:215], a[200:203], v[188:191]
v_mfma_f32_16x16x32_bf16 v[188:191], a[216:219], a[204:207], v[188:191]
s_waitcnt vmcnt(14)
s_add_u32 s43, s20, 36864
v_mfma_f32_16x16x32_bf16 v[220:223], a[240:243], a[200:203], v[220:223]
buffer_load_dwordx4 a[212:215], v254, s[8:11], s43 offen offset:1024
v_mfma_f32_16x16x32_bf16 v[220:223], a[220:223], a[204:207], v[220:223]
s_waitcnt lgkmcnt(0)
buffer_store_dwordx4 v[12:15], v255, s[16:19], s37 offen offset:0 nt
s_add_u32 s43, s20, 36864
v_mfma_f32_16x16x32_bf16 v[216:219], a[240:243], a[192:195], v[216:219]
s_add_u32 s37, s37, 16384
buffer_load_dwordx4 a[216:219], v254, s[8:11], s43 offen offset:2048
v_mfma_f32_16x16x32_bf16 v[216:219], a[220:223], a[196:199], v[216:219]
ds_read_b128 v[16:19], v0 offset:9216
v_mfma_f32_16x16x32_bf16 v[212:215], a[240:243], a[184:187], v[212:215]
v_mfma_f32_16x16x32_bf16 v[212:215], a[220:223], a[188:191], v[212:215]
v_mfma_f32_16x16x32_bf16 v[208:211], a[240:243], a[176:179], v[208:211]
v_mfma_f32_16x16x32_bf16 v[208:211], a[220:223], a[180:183], v[208:211]
v_xor_b32 v252, 0x10000, v252
v_mfma_f32_16x16x32_bf16 v[204:207], a[240:243], a[168:171], v[204:207]
v_mfma_f32_16x16x32_bf16 v[204:207], a[220:223], a[172:175], v[204:207]
s_waitcnt lgkmcnt(0)
buffer_store_dwordx4 v[16:19], v255, s[16:19], s37 offen offset:0 nt
v_mfma_f32_16x16x32_bf16 v[200:203], a[240:243], a[160:163], v[200:203]
s_add_u32 s37, s37, 16384
v_mfma_f32_16x16x32_bf16 v[200:203], a[220:223], a[164:167], v[200:203]
ds_read_b128 v[20:23], v0 offset:10240
v_mfma_f32_16x16x32_bf16 v[196:199], a[240:243], a[152:155], v[196:199]
v_mfma_f32_16x16x32_bf16 v[196:199], a[220:223], a[156:159], v[196:199]
v_mfma_f32_16x16x32_bf16 v[192:195], a[240:243], a[144:147], v[192:195]
v_mfma_f32_16x16x32_bf16 v[192:195], a[220:223], a[148:151], v[192:195]
s_waitcnt vmcnt(14)
s_add_u32 s43, s20, 36864
v_mfma_f32_16x16x32_bf16 v[224:227], a[224:227], a[144:147], v[224:227]
buffer_load_dwordx4 a[220:223], v254, s[8:11], s43 offen offset:3072
ds_read_b128 a[144:147], v252 offset:16384
v_mfma_f32_16x16x32_bf16 v[224:227], a[228:231], a[148:151], v[224:227]
s_waitcnt lgkmcnt(1)
ds_read_b128 a[148:151], v252 offset:16896
buffer_store_dwordx4 v[20:23], v255, s[16:19], s37 offen offset:0 nt
s_add_u32 s43, s20, 49152
v_mfma_f32_16x16x32_bf16 v[228:231], a[224:227], a[152:155], v[228:231]
s_add_u32 s37, s37, 16384
buffer_load_dwordx4 a[240:243], v254, s[8:11], s43 offen offset:0
ds_read_b128 a[152:155], v252 offset:18432
v_mfma_f32_16x16x32_bf16 v[228:231], a[228:231], a[156:159], v[228:231]
ds_read_b128 a[156:159], v252 offset:18944
v_mfma_f32_16x16x32_bf16 v[232:235], a[224:227], a[160:163], v[232:235]
ds_read_b128 a[160:163], v252 offset:20480
ds_read_b128 v[24:27], v0 offset:11264
v_mfma_f32_16x16x32_bf16 v[232:235], a[228:231], a[164:167], v[232:235]
ds_read_b128 a[164:167], v252 offset:20992
v_mfma_f32_16x16x32_bf16 v[236:239], a[224:227], a[168:171], v[236:239]
ds_read_b128 a[168:171], v252 offset:22528
v_mfma_f32_16x16x32_bf16 v[236:239], a[228:231], a[172:175], v[236:239]
ds_read_b128 a[172:175], v252 offset:23040
v_mfma_f32_16x16x32_bf16 a[0:3], a[224:227], a[176:179], a[0:3]
ds_read_b128 a[176:179], v252 offset:24576
v_mfma_f32_16x16x32_bf16 a[0:3], a[228:231], a[180:183], a[0:3]
ds_read_b128 a[180:183], v252 offset:25088
v_mfma_f32_16x16x32_bf16 a[4:7], a[224:227], a[184:187], a[4:7]
ds_read_b128 a[184:187], v252 offset:26624
v_mfma_f32_16x16x32_bf16 a[4:7], a[228:231], a[188:191], a[4:7]
ds_read_b128 a[188:191], v252 offset:27136
v_mfma_f32_16x16x32_bf16 a[8:11], a[224:227], a[192:195], a[8:11]
ds_read_b128 a[192:195], v252 offset:28672
v_mfma_f32_16x16x32_bf16 a[8:11], a[228:231], a[196:199], a[8:11]
ds_read_b128 a[196:199], v252 offset:29184
v_mfma_f32_16x16x32_bf16 a[12:15], a[224:227], a[200:203], a[12:15]
ds_read_b128 a[200:203], v252 offset:30720
v_mfma_f32_16x16x32_bf16 a[12:15], a[228:231], a[204:207], a[12:15]
s_waitcnt vmcnt(14) lgkmcnt(12)
ds_read_b128 a[204:207], v252 offset:31232
s_add_u32 s43, s20, 49152
v_mfma_f32_16x16x32_bf16 v[128:131], a[232:235], a[144:147], v[128:131]
buffer_load_dwordx4 a[224:227], v254, s[8:11], s43 offen offset:1024
v_mfma_f32_16x16x32_bf16 v[128:131], a[236:239], a[148:151], v[128:131]
s_waitcnt lgkmcnt(11)
buffer_store_dwordx4 v[24:27], v255, s[16:19], s37 offen offset:0 nt
s_add_u32 s43, s20, 49152
v_mfma_f32_16x16x32_bf16 v[132:135], a[232:235], a[152:155], v[132:135]
s_add_u32 s37, s37, 16384
buffer_load_dwordx4 a[228:231], v254, s[8:11], s43 offen offset:2048
v_mfma_f32_16x16x32_bf16 v[132:135], a[236:239], a[156:159], v[132:135]
s_waitcnt lgkmcnt(8)
ds_read_b128 v[4:7], v0 offset:12288
v_mfma_f32_16x16x32_bf16 v[136:139], a[232:235], a[160:163], v[136:139]
v_mfma_f32_16x16x32_bf16 v[136:139], a[236:239], a[164:167], v[136:139]
v_mfma_f32_16x16x32_bf16 v[140:143], a[232:235], a[168:171], v[140:143]
ds_read_b128 v[8:11], v0 offset:13312
v_mfma_f32_16x16x32_bf16 v[140:143], a[236:239], a[172:175], v[140:143]
s_waitcnt lgkmcnt(6)
v_mfma_f32_16x16x32_bf16 v[144:147], a[232:235], a[176:179], v[144:147]
v_mfma_f32_16x16x32_bf16 v[144:147], a[236:239], a[180:183], v[144:147]
s_waitcnt lgkmcnt(1)
buffer_store_dwordx4 v[4:7], v255, s[16:19], s37 offen offset:0 nt
v_mfma_f32_16x16x32_bf16 v[148:151], a[232:235], a[184:187], v[148:151]
s_add_u32 s37, s37, 16384
v_mfma_f32_16x16x32_bf16 v[148:151], a[236:239], a[188:191], v[148:151]
v_mfma_f32_16x16x32_bf16 v[152:155], a[232:235], a[192:195], v[152:155]
s_waitcnt lgkmcnt(0)
buffer_store_dwordx4 v[8:11], v255, s[16:19], s37 offen offset:0 nt
v_mfma_f32_16x16x32_bf16 v[152:155], a[236:239], a[196:199], v[152:155]
s_add_u32 s37, s37, 16384
v_mfma_f32_16x16x32_bf16 v[156:159], a[232:235], a[200:203], v[156:159]
v_mfma_f32_16x16x32_bf16 v[156:159], a[236:239], a[204:207], v[156:159]
s_waitcnt vmcnt(14)
ds_read_b128 v[12:15], v0 offset:14336
s_add_u32 s43, s20, 49152
v_mfma_f32_16x16x32_bf16 v[188:191], a[244:247], a[200:203], v[188:191]
buffer_load_dwordx4 a[232:235], v254, s[8:11], s43 offen offset:3072
v_mfma_f32_16x16x32_bf16 v[188:191], a[208:211], a[204:207], v[188:191]
s_add_u32 s43, s20, 53248
v_mfma_f32_16x16x32_bf16 v[184:187], a[244:247], a[192:195], v[184:187]
buffer_load_dwordx4 a[236:239], v254, s[8:11], s43 offen offset:0
v_mfma_f32_16x16x32_bf16 v[184:187], a[208:211], a[196:199], v[184:187]
v_mfma_f32_16x16x32_bf16 v[180:183], a[244:247], a[184:187], v[180:183]
v_mfma_f32_16x16x32_bf16 v[180:183], a[208:211], a[188:191], v[180:183]
s_waitcnt lgkmcnt(0)
buffer_store_dwordx4 v[12:15], v255, s[16:19], s37 offen offset:0 nt
v_mfma_f32_16x16x32_bf16 v[176:179], a[244:247], a[176:179], v[176:179]
s_add_u32 s37, s37, 16384
v_mfma_f32_16x16x32_bf16 v[176:179], a[208:211], a[180:183], v[176:179]
v_mfma_f32_16x16x32_bf16 v[172:175], a[244:247], a[168:171], v[172:175]
ds_read_b128 v[16:19], v0 offset:15360
v_mfma_f32_16x16x32_bf16 v[172:175], a[208:211], a[172:175], v[172:175]
v_mfma_f32_16x16x32_bf16 v[168:171], a[244:247], a[160:163], v[168:171]
v_mfma_f32_16x16x32_bf16 v[168:171], a[208:211], a[164:167], v[168:171]
v_mfma_f32_16x16x32_bf16 v[164:167], a[244:247], a[152:155], v[164:167]
v_mfma_f32_16x16x32_bf16 v[164:167], a[208:211], a[156:159], v[164:167]
v_mfma_f32_16x16x32_bf16 v[160:163], a[244:247], a[144:147], v[160:163]
s_waitcnt lgkmcnt(0)
buffer_store_dwordx4 v[16:19], v255, s[16:19], s37 offen offset:0 nt
v_mfma_f32_16x16x32_bf16 v[160:163], a[208:211], a[148:151], v[160:163]
s_waitcnt vmcnt(15)
s_add_u32 s37, s37, 4294721536
s_add_u32 s43, s20, 53248
v_mfma_f32_16x16x32_bf16 v[192:195], a[248:251], a[144:147], v[192:195]
buffer_load_dwordx4 a[208:211], v254, s[8:11], s43 offen offset:1024
v_mfma_f32_16x16x32_bf16 v[192:195], a[212:215], a[148:151], v[192:195]
s_add_u32 s43, s20, 53248
v_mfma_f32_16x16x32_bf16 v[196:199], a[248:251], a[152:155], v[196:199]
buffer_load_dwordx4 a[244:247], v254, s[8:11], s43 offen offset:2048
v_mfma_f32_16x16x32_bf16 v[196:199], a[212:215], a[156:159], v[196:199]
v_mfma_f32_16x16x32_bf16 v[200:203], a[248:251], a[160:163], v[200:203]
v_mfma_f32_16x16x32_bf16 v[200:203], a[212:215], a[164:167], v[200:203]
v_mfma_f32_16x16x32_bf16 v[204:207], a[248:251], a[168:171], v[204:207]
v_mfma_f32_16x16x32_bf16 v[204:207], a[212:215], a[172:175], v[204:207]
v_mfma_f32_16x16x32_bf16 v[208:211], a[248:251], a[176:179], v[208:211]
v_mfma_f32_16x16x32_bf16 v[208:211], a[212:215], a[180:183], v[208:211]
v_mfma_f32_16x16x32_bf16 v[212:215], a[248:251], a[184:187], v[212:215]
v_mfma_f32_16x16x32_bf16 v[212:215], a[212:215], a[188:191], v[212:215]
v_mfma_f32_16x16x32_bf16 v[216:219], a[248:251], a[192:195], v[216:219]
v_mfma_f32_16x16x32_bf16 v[216:219], a[212:215], a[196:199], v[216:219]
v_mfma_f32_16x16x32_bf16 v[220:223], a[248:251], a[200:203], v[220:223]
v_mfma_f32_16x16x32_bf16 v[220:223], a[212:215], a[204:207], v[220:223]
s_waitcnt vmcnt(13)
s_add_u32 s43, s20, 53248
v_mfma_f32_16x16x32_bf16 a[12:15], a[216:219], a[200:203], a[12:15]
buffer_load_dwordx4 a[212:215], v254, s[8:11], s43 offen offset:3072
ds_read_b128 a[200:203], v252 offset:63488
v_mfma_f32_16x16x32_bf16 a[12:15], a[220:223], a[204:207], a[12:15]
ds_read_b128 a[204:207], v252 offset:64000
v_mfma_f32_16x16x32_bf16 a[8:11], a[216:219], a[192:195], a[8:11]
ds_read_b128 a[192:195], v252 offset:61440
v_mfma_f32_16x16x32_bf16 a[8:11], a[220:223], a[196:199], a[8:11]
ds_read_b128 a[196:199], v252 offset:61952
v_mfma_f32_16x16x32_bf16 a[4:7], a[216:219], a[184:187], a[4:7]
ds_read_b128 a[184:187], v252 offset:59392
v_mfma_f32_16x16x32_bf16 a[4:7], a[220:223], a[188:191], a[4:7]
ds_read_b128 a[188:191], v252 offset:59904
v_mfma_f32_16x16x32_bf16 a[0:3], a[216:219], a[176:179], a[0:3]
ds_read_b128 a[176:179], v252 offset:57344
v_mfma_f32_16x16x32_bf16 a[0:3], a[220:223], a[180:183], a[0:3]
ds_read_b128 a[180:183], v252 offset:57856
v_mfma_f32_16x16x32_bf16 v[236:239], a[216:219], a[168:171], v[236:239]
ds_read_b128 a[168:171], v252 offset:55296
v_mfma_f32_16x16x32_bf16 v[236:239], a[220:223], a[172:175], v[236:239]
ds_read_b128 a[172:175], v252 offset:55808
v_mfma_f32_16x16x32_bf16 v[232:235], a[216:219], a[160:163], v[232:235]
ds_read_b128 a[160:163], v252 offset:53248
v_mfma_f32_16x16x32_bf16 v[232:235], a[220:223], a[164:167], v[232:235]
ds_read_b128 a[164:167], v252 offset:53760
v_mfma_f32_16x16x32_bf16 v[228:231], a[216:219], a[152:155], v[228:231]
ds_read_b128 a[152:155], v252 offset:51200
v_mfma_f32_16x16x32_bf16 v[228:231], a[220:223], a[156:159], v[228:231]
ds_read_b128 a[156:159], v252 offset:51712
v_mfma_f32_16x16x32_bf16 v[224:227], a[216:219], a[144:147], v[224:227]
ds_read_b128 a[144:147], v252 offset:49152
v_mfma_f32_16x16x32_bf16 v[224:227], a[220:223], a[148:151], v[224:227]
s_waitcnt vmcnt(11) lgkmcnt(11)
ds_read_b128 a[148:151], v252 offset:49664
v_mfma_f32_16x16x32_bf16 v[156:159], a[240:243], a[200:203], v[156:159]
v_mfma_f32_16x16x32_bf16 v[156:159], a[224:227], a[204:207], v[156:159]
v_mfma_f32_16x16x32_bf16 v[152:155], a[240:243], a[192:195], v[152:155]
v_mfma_f32_16x16x32_bf16 v[152:155], a[224:227], a[196:199], v[152:155]
s_waitcnt lgkmcnt(8)
v_mfma_f32_16x16x32_bf16 v[148:151], a[240:243], a[184:187], v[148:151]
v_mfma_f32_16x16x32_bf16 v[148:151], a[224:227], a[188:191], v[148:151]
v_mfma_f32_16x16x32_bf16 v[144:147], a[240:243], a[176:179], v[144:147]
v_mfma_f32_16x16x32_bf16 v[144:147], a[224:227], a[180:183], v[144:147]
s_waitcnt lgkmcnt(4)
v_mfma_f32_16x16x32_bf16 v[140:143], a[240:243], a[168:171], v[140:143]
v_mfma_f32_16x16x32_bf16 v[140:143], a[224:227], a[172:175], v[140:143]
v_mfma_f32_16x16x32_bf16 v[136:139], a[240:243], a[160:163], v[136:139]
v_mfma_f32_16x16x32_bf16 v[136:139], a[224:227], a[164:167], v[136:139]
s_waitcnt lgkmcnt(0)
v_mfma_f32_16x16x32_bf16 v[132:135], a[240:243], a[152:155], v[132:135]
v_mfma_f32_16x16x32_bf16 v[132:135], a[224:227], a[156:159], v[132:135]
v_mfma_f32_16x16x32_bf16 v[128:131], a[240:243], a[144:147], v[128:131]
v_mfma_f32_16x16x32_bf16 v[128:131], a[224:227], a[148:151], v[128:131]
s_waitcnt vmcnt(6)
v_mfma_f32_16x16x32_bf16 v[160:163], a[228:231], a[144:147], v[160:163]
v_mfma_f32_16x16x32_bf16 v[160:163], a[232:235], a[148:151], v[160:163]
v_mfma_f32_16x16x32_bf16 v[164:167], a[228:231], a[152:155], v[164:167]
v_mfma_f32_16x16x32_bf16 v[164:167], a[232:235], a[156:159], v[164:167]
v_mfma_f32_16x16x32_bf16 v[168:171], a[228:231], a[160:163], v[168:171]
s_nop 1
v_mul_f32 v240, v240, v128
v_mul_f32 v241, v241, v129
v_mfma_f32_16x16x32_bf16 v[168:171], a[232:235], a[164:167], v[168:171]
v_mul_f32 v242, v242, v130
v_mul_f32 v243, v243, v131
v_mfma_f32_16x16x32_bf16 v[172:175], a[228:231], a[168:171], v[172:175]
v_cvt_pk_bf16_f32 v248, v240, v241
v_cvt_pk_bf16_f32 v249, v242, v243
v_mfma_f32_4x4x4_16b_bf16 v[240:243], a[252:253], a[84:85], 0
v_mul_f32 v244, v244, v160
v_mul_f32 v245, v245, v161
v_mfma_f32_16x16x32_bf16 v[172:175], a[232:235], a[172:175], v[172:175]
v_mul_f32 v246, v246, v162
v_mul_f32 v247, v247, v163
v_mfma_f32_16x16x32_bf16 v[176:179], a[228:231], a[176:179], v[176:179]
v_cvt_pk_bf16_f32 v250, v244, v245
v_cvt_pk_bf16_f32 v251, v246, v247
v_mfma_f32_4x4x4_16b_bf16 v[244:247], a[252:253], a[86:87], 0
ds_write_b128 v253, v[248:251] offset:0
v_mfma_f32_16x16x32_bf16 v[176:179], a[232:235], a[180:183], v[176:179]
v_mul_f32 v240, v240, v132
v_mul_f32 v241, v241, v133
v_mfma_f32_16x16x32_bf16 v[180:183], a[228:231], a[184:187], v[180:183]
v_mul_f32 v242, v242, v134
v_mul_f32 v243, v243, v135
v_mfma_f32_16x16x32_bf16 v[180:183], a[232:235], a[188:191], v[180:183]
v_cvt_pk_bf16_f32 v248, v240, v241
v_cvt_pk_bf16_f32 v249, v242, v243
v_mfma_f32_4x4x4_16b_bf16 v[240:243], a[252:253], a[88:89], 0
v_mul_f32 v244, v244, v164
v_mul_f32 v245, v245, v165
v_mfma_f32_16x16x32_bf16 v[184:187], a[228:231], a[192:195], v[184:187]
v_mul_f32 v246, v246, v166
v_mul_f32 v247, v247, v167
v_mfma_f32_16x16x32_bf16 v[184:187], a[232:235], a[196:199], v[184:187]
v_cvt_pk_bf16_f32 v250, v244, v245
v_cvt_pk_bf16_f32 v251, v246, v247
v_mfma_f32_4x4x4_16b_bf16 v[244:247], a[252:253], a[90:91], 0
ds_write_b128 v253, v[248:251] offset:2048
v_mfma_f32_16x16x32_bf16 v[188:191], a[228:231], a[200:203], v[188:191]
v_mul_f32 v240, v240, v136
v_mul_f32 v241, v241, v137
v_mfma_f32_16x16x32_bf16 v[188:191], a[232:235], a[204:207], v[188:191]
s_waitcnt vmcnt(2)
v_mul_f32 v242, v242, v138
v_mul_f32 v243, v243, v139
v_mfma_f32_16x16x32_bf16 v[220:223], a[236:239], a[200:203], v[220:223]
v_cvt_pk_bf16_f32 v248, v240, v241
v_cvt_pk_bf16_f32 v249, v242, v243
v_mfma_f32_4x4x4_16b_bf16 v[240:243], a[252:253], a[92:93], 0
v_mul_f32 v244, v244, v168
v_mul_f32 v245, v245, v169
v_mfma_f32_16x16x32_bf16 v[220:223], a[208:211], a[204:207], v[220:223]
v_mul_f32 v246, v246, v170
v_mul_f32 v247, v247, v171
v_mfma_f32_16x16x32_bf16 v[216:219], a[236:239], a[192:195], v[216:219]
v_cvt_pk_bf16_f32 v250, v244, v245
v_cvt_pk_bf16_f32 v251, v246, v247
v_mfma_f32_4x4x4_16b_bf16 v[244:247], a[252:253], a[94:95], 0
ds_write_b128 v253, v[248:251] offset:4096
v_mfma_f32_16x16x32_bf16 v[216:219], a[208:211], a[196:199], v[216:219]
v_mul_f32 v240, v240, v140
v_mul_f32 v241, v241, v141
v_mfma_f32_16x16x32_bf16 v[212:215], a[236:239], a[184:187], v[212:215]
v_mul_f32 v242, v242, v142
v_mul_f32 v243, v243, v143
v_mfma_f32_16x16x32_bf16 v[212:215], a[208:211], a[188:191], v[212:215]
v_cvt_pk_bf16_f32 v248, v240, v241
v_cvt_pk_bf16_f32 v249, v242, v243
v_mfma_f32_4x4x4_16b_bf16 v[240:243], a[252:253], a[96:97], 0
v_mul_f32 v244, v244, v172
v_mul_f32 v245, v245, v173
v_mfma_f32_16x16x32_bf16 v[208:211], a[236:239], a[176:179], v[208:211]
v_mul_f32 v246, v246, v174
v_mul_f32 v247, v247, v175
v_mfma_f32_16x16x32_bf16 v[208:211], a[208:211], a[180:183], v[208:211]
v_cvt_pk_bf16_f32 v250, v244, v245
v_cvt_pk_bf16_f32 v251, v246, v247
v_mfma_f32_4x4x4_16b_bf16 v[244:247], a[252:253], a[98:99], 0
ds_write_b128 v253, v[248:251] offset:6144
v_mfma_f32_16x16x32_bf16 v[204:207], a[236:239], a[168:171], v[204:207]
v_mul_f32 v240, v240, v144
v_mul_f32 v241, v241, v145
v_mfma_f32_16x16x32_bf16 v[204:207], a[208:211], a[172:175], v[204:207]
v_mul_f32 v242, v242, v146
v_mul_f32 v243, v243, v147
v_mfma_f32_16x16x32_bf16 v[200:203], a[236:239], a[160:163], v[200:203]
v_cvt_pk_bf16_f32 v248, v240, v241
v_cvt_pk_bf16_f32 v249, v242, v243
v_mfma_f32_4x4x4_16b_bf16 v[240:243], a[252:253], a[100:101], 0
v_mul_f32 v244, v244, v176
v_mul_f32 v245, v245, v177
v_mfma_f32_16x16x32_bf16 v[200:203], a[208:211], a[164:167], v[200:203]
v_mul_f32 v246, v246, v178
v_mul_f32 v247, v247, v179
v_mfma_f32_16x16x32_bf16 v[196:199], a[236:239], a[152:155], v[196:199]
v_cvt_pk_bf16_f32 v250, v244, v245
v_cvt_pk_bf16_f32 v251, v246, v247
v_mfma_f32_4x4x4_16b_bf16 v[244:247], a[252:253], a[102:103], 0
ds_write_b128 v253, v[248:251] offset:8192
v_mfma_f32_16x16x32_bf16 v[196:199], a[208:211], a[156:159], v[196:199]
v_mul_f32 v240, v240, v148
v_mul_f32 v241, v241, v149
v_mfma_f32_16x16x32_bf16 v[192:195], a[236:239], a[144:147], v[192:195]
v_mul_f32 v242, v242, v150
v_mul_f32 v243, v243, v151
v_mfma_f32_16x16x32_bf16 v[192:195], a[208:211], a[148:151], v[192:195]
s_waitcnt vmcnt(0)
v_cvt_pk_bf16_f32 v248, v240, v241
v_cvt_pk_bf16_f32 v249, v242, v243
v_mfma_f32_4x4x4_16b_bf16 v[240:243], a[252:253], a[104:105], 0
v_mul_f32 v244, v244, v180
v_mul_f32 v245, v245, v181
v_mfma_f32_16x16x32_bf16 v[224:227], a[244:247], a[144:147], v[224:227]
v_mul_f32 v246, v246, v182
v_mul_f32 v247, v247, v183
v_mfma_f32_16x16x32_bf16 v[224:227], a[212:215], a[148:151], v[224:227]
v_cvt_pk_bf16_f32 v250, v244, v245
v_cvt_pk_bf16_f32 v251, v246, v247
v_mfma_f32_4x4x4_16b_bf16 v[244:247], a[252:253], a[106:107], 0
ds_write_b128 v253, v[248:251] offset:10240
v_mfma_f32_16x16x32_bf16 v[228:231], a[244:247], a[152:155], v[228:231]
v_mul_f32 v240, v240, v152
v_mul_f32 v241, v241, v153
v_mfma_f32_16x16x32_bf16 v[228:231], a[212:215], a[156:159], v[228:231]
v_mul_f32 v242, v242, v154
v_mul_f32 v243, v243, v155
v_mfma_f32_16x16x32_bf16 v[232:235], a[244:247], a[160:163], v[232:235]
v_cvt_pk_bf16_f32 v248, v240, v241
v_cvt_pk_bf16_f32 v249, v242, v243
v_mfma_f32_4x4x4_16b_bf16 v[240:243], a[252:253], a[108:109], 0
v_mul_f32 v244, v244, v184
v_mul_f32 v245, v245, v185
v_mfma_f32_16x16x32_bf16 v[232:235], a[212:215], a[164:167], v[232:235]
v_mul_f32 v246, v246, v186
v_mul_f32 v247, v247, v187
v_mfma_f32_16x16x32_bf16 v[236:239], a[244:247], a[168:171], v[236:239]
v_cvt_pk_bf16_f32 v250, v244, v245
v_cvt_pk_bf16_f32 v251, v246, v247
v_mfma_f32_4x4x4_16b_bf16 v[244:247], a[252:253], a[110:111], 0
ds_write_b128 v253, v[248:251] offset:12288
v_mfma_f32_16x16x32_bf16 v[236:239], a[212:215], a[172:175], v[236:239]
v_mul_f32 v240, v240, v156
v_mul_f32 v241, v241, v157
v_mfma_f32_16x16x32_bf16 a[0:3], a[244:247], a[176:179], a[0:3]
v_mul_f32 v242, v242, v158
v_mul_f32 v243, v243, v159
v_mfma_f32_16x16x32_bf16 a[0:3], a[212:215], a[180:183], a[0:3]
v_cvt_pk_bf16_f32 v248, v240, v241
v_cvt_pk_bf16_f32 v249, v242, v243
v_mfma_f32_4x4x4_16b_bf16 v[240:243], a[252:253], a[112:113], 0
v_mul_f32 v244, v244, v188
v_mul_f32 v245, v245, v189
v_mfma_f32_16x16x32_bf16 a[4:7], a[244:247], a[184:187], a[4:7]
v_mul_f32 v246, v246, v190
v_mul_f32 v247, v247, v191
v_mfma_f32_16x16x32_bf16 a[4:7], a[212:215], a[188:191], a[4:7]
v_cvt_pk_bf16_f32 v250, v244, v245
v_cvt_pk_bf16_f32 v251, v246, v247
v_mfma_f32_4x4x4_16b_bf16 v[244:247], a[252:253], a[114:115], 0
ds_write_b128 v253, v[248:251] offset:14336
v_mfma_f32_16x16x32_bf16 a[8:11], a[244:247], a[192:195], a[8:11]
v_mul_f32 v240, v240, v192
v_mul_f32 v241, v241, v193
v_mfma_f32_16x16x32_bf16 a[8:11], a[212:215], a[196:199], a[8:11]
v_mul_f32 v242, v242, v194
v_mul_f32 v243, v243, v195
v_mfma_f32_16x16x32_bf16 a[12:15], a[244:247], a[200:203], a[12:15]
v_cvt_pk_bf16_f32 v248, v240, v241
v_cvt_pk_bf16_f32 v249, v242, v243
v_mfma_f32_4x4x4_16b_bf16 v[240:243], a[252:253], a[116:117], 0
v_mul_f32 v244, v244, v224
v_mul_f32 v245, v245, v225
v_mfma_f32_16x16x32_bf16 a[12:15], a[212:215], a[204:207], a[12:15]
v_mul_f32 v246, v246, v226
v_mul_f32 v247, v247, v227
v_cvt_pk_bf16_f32 v250, v244, v245
v_cvt_pk_bf16_f32 v251, v246, v247
v_mfma_f32_4x4x4_16b_bf16 v[244:247], a[252:253], a[118:119], 0
ds_write_b128 v253, v[248:251] offset:512
ds_read_b128 v[20:23], v0 offset:0
ds_read_b128 v[24:27], v0 offset:1024
v_mul_f32 v240, v240, v196
v_mul_f32 v241, v241, v197
v_mul_f32 v242, v242, v198
v_mul_f32 v243, v243, v199
v_cvt_pk_bf16_f32 v248, v240, v241
v_cvt_pk_bf16_f32 v249, v242, v243
v_mfma_f32_4x4x4_16b_bf16 v[240:243], a[252:253], a[120:121], 0
v_mul_f32 v244, v244, v228
v_mul_f32 v245, v245, v229
v_mul_f32 v246, v246, v230
v_mul_f32 v247, v247, v231
v_cvt_pk_bf16_f32 v250, v244, v245
v_cvt_pk_bf16_f32 v251, v246, v247
v_mfma_f32_4x4x4_16b_bf16 v[244:247], a[252:253], a[122:123], 0
ds_write_b128 v253, v[248:251] offset:2560
s_waitcnt lgkmcnt(2)
buffer_store_dwordx4 v[20:23], v255, s[16:19], s37 offen offset:128 nt
s_add_u32 s37, s37, 16384
s_waitcnt lgkmcnt(1)
buffer_store_dwordx4 v[24:27], v255, s[16:19], s37 offen offset:128 nt
s_add_u32 s37, s37, 16384
ds_read_b128 v[4:7], v0 offset:2048
ds_read_b128 v[8:11], v0 offset:3072
v_mul_f32 v240, v240, v200
v_mul_f32 v241, v241, v201
v_mul_f32 v242, v242, v202
v_mul_f32 v243, v243, v203
v_cvt_pk_bf16_f32 v248, v240, v241
v_cvt_pk_bf16_f32 v249, v242, v243
v_mfma_f32_4x4x4_16b_bf16 v[240:243], a[252:253], a[124:125], 0
v_mul_f32 v244, v244, v232
v_mul_f32 v245, v245, v233
v_mul_f32 v246, v246, v234
v_mul_f32 v247, v247, v235
v_cvt_pk_bf16_f32 v250, v244, v245
v_cvt_pk_bf16_f32 v251, v246, v247
v_mfma_f32_4x4x4_16b_bf16 v[244:247], a[252:253], a[126:127], 0
ds_write_b128 v253, v[248:251] offset:4608
s_waitcnt lgkmcnt(2)
buffer_store_dwordx4 v[4:7], v255, s[16:19], s37 offen offset:128 nt
s_add_u32 s37, s37, 16384
s_waitcnt lgkmcnt(1)
buffer_store_dwordx4 v[8:11], v255, s[16:19], s37 offen offset:128 nt
s_add_u32 s37, s37, 16384
ds_read_b128 v[12:15], v0 offset:4096
ds_read_b128 v[16:19], v0 offset:5120
v_mul_f32 v240, v240, v204
v_mul_f32 v241, v241, v205
v_mul_f32 v242, v242, v206
v_mul_f32 v243, v243, v207
v_cvt_pk_bf16_f32 v248, v240, v241
v_cvt_pk_bf16_f32 v249, v242, v243
v_mfma_f32_4x4x4_16b_bf16 v[240:243], a[252:253], a[128:129], 0
v_mul_f32 v244, v244, v236
v_mul_f32 v245, v245, v237
v_mul_f32 v246, v246, v238
v_mul_f32 v247, v247, v239
v_cvt_pk_bf16_f32 v250, v244, v245
v_cvt_pk_bf16_f32 v251, v246, v247
v_mfma_f32_4x4x4_16b_bf16 v[244:247], a[252:253], a[130:131], 0
ds_write_b128 v253, v[248:251] offset:6656
s_waitcnt lgkmcnt(2)
buffer_store_dwordx4 v[12:15], v255, s[16:19], s37 offen offset:128 nt
s_add_u32 s37, s37, 16384
s_waitcnt lgkmcnt(1)
buffer_store_dwordx4 v[16:19], v255, s[16:19], s37 offen offset:128 nt
s_add_u32 s37, s37, 16384
ds_read_b128 v[20:23], v0 offset:6144
ds_read_b128 v[24:27], v0 offset:7168
v_mul_f32 v240, v240, v208
v_mul_f32 v241, v241, v209
v_mul_f32 v242, v242, v210
v_mul_f32 v243, v243, v211
v_cvt_pk_bf16_f32 v248, v240, v241
v_cvt_pk_bf16_f32 v249, v242, v243
v_mfma_f32_4x4x4_16b_bf16 v[240:243], a[252:253], a[132:133], 0
v_accvgpr_read_b32 v250, a0
v_mul_f32 v244, v244, v250
v_accvgpr_read_b32 v251, a1
v_mul_f32 v245, v245, v251
v_accvgpr_read_b32 v250, a2
v_mul_f32 v246, v246, v250
v_accvgpr_read_b32 v251, a3
v_mul_f32 v247, v247, v251
v_cvt_pk_bf16_f32 v250, v244, v245
v_cvt_pk_bf16_f32 v251, v246, v247
v_mfma_f32_4x4x4_16b_bf16 v[244:247], a[252:253], a[134:135], 0
ds_write_b128 v253, v[248:251] offset:8704
s_waitcnt lgkmcnt(2)
buffer_store_dwordx4 v[20:23], v255, s[16:19], s37 offen offset:128 nt
s_add_u32 s37, s37, 16384
s_waitcnt lgkmcnt(1)
buffer_store_dwordx4 v[24:27], v255, s[16:19], s37 offen offset:128 nt
s_add_u32 s37, s37, 16384
ds_read_b128 v[4:7], v0 offset:8192
ds_read_b128 v[8:11], v0 offset:9216
v_mul_f32 v240, v240, v212
v_mul_f32 v241, v241, v213
v_mul_f32 v242, v242, v214
v_mul_f32 v243, v243, v215
v_cvt_pk_bf16_f32 v248, v240, v241
v_cvt_pk_bf16_f32 v249, v242, v243
v_mfma_f32_4x4x4_16b_bf16 v[240:243], a[252:253], a[136:137], 0
v_accvgpr_read_b32 v250, a4
v_mul_f32 v244, v244, v250
v_accvgpr_read_b32 v251, a5
v_mul_f32 v245, v245, v251
v_accvgpr_read_b32 v250, a6
v_mul_f32 v246, v246, v250
v_accvgpr_read_b32 v251, a7
v_mul_f32 v247, v247, v251
v_cvt_pk_bf16_f32 v250, v244, v245
v_cvt_pk_bf16_f32 v251, v246, v247
v_mfma_f32_4x4x4_16b_bf16 v[244:247], a[252:253], a[138:139], 0
ds_write_b128 v253, v[248:251] offset:10752
s_waitcnt lgkmcnt(2)
buffer_store_dwordx4 v[4:7], v255, s[16:19], s37 offen offset:128 nt
s_add_u32 s37, s37, 16384
s_waitcnt lgkmcnt(1)
buffer_store_dwordx4 v[8:11], v255, s[16:19], s37 offen offset:128 nt
s_add_u32 s37, s37, 16384
ds_read_b128 v[12:15], v0 offset:10240
ds_read_b128 v[16:19], v0 offset:11264
v_mul_f32 v240, v240, v216
v_mul_f32 v241, v241, v217
v_mul_f32 v242, v242, v218
v_mul_f32 v243, v243, v219
v_cvt_pk_bf16_f32 v248, v240, v241
v_cvt_pk_bf16_f32 v249, v242, v243
v_mfma_f32_4x4x4_16b_bf16 v[240:243], a[252:253], a[140:141], 0
v_accvgpr_read_b32 v250, a8
v_mul_f32 v244, v244, v250
v_accvgpr_read_b32 v251, a9
v_mul_f32 v245, v245, v251
v_accvgpr_read_b32 v250, a10
v_mul_f32 v246, v246, v250
v_accvgpr_read_b32 v251, a11
v_mul_f32 v247, v247, v251
v_cvt_pk_bf16_f32 v250, v244, v245
v_cvt_pk_bf16_f32 v251, v246, v247
v_mfma_f32_4x4x4_16b_bf16 v[244:247], a[252:253], a[142:143], 0
ds_write_b128 v253, v[248:251] offset:12800
s_waitcnt lgkmcnt(2)
buffer_store_dwordx4 v[12:15], v255, s[16:19], s37 offen offset:128 nt
s_add_u32 s37, s37, 16384
s_waitcnt lgkmcnt(1)
buffer_store_dwordx4 v[16:19], v255, s[16:19], s37 offen offset:128 nt
s_add_u32 s37, s37, 16384
ds_read_b128 v[20:23], v0 offset:12288
ds_read_b128 v[24:27], v0 offset:13312
v_mul_f32 v240, v240, v220
v_mul_f32 v241, v241, v221
v_mul_f32 v242, v242, v222
v_mul_f32 v243, v243, v223
v_cvt_pk_bf16_f32 v248, v240, v241
v_cvt_pk_bf16_f32 v249, v242, v243
v_accvgpr_read_b32 v250, a12
v_mul_f32 v244, v244, v250
v_accvgpr_read_b32 v251, a13
v_mul_f32 v245, v245, v251
v_accvgpr_read_b32 v250, a14
v_mul_f32 v246, v246, v250
v_accvgpr_read_b32 v251, a15
v_mul_f32 v247, v247, v251
v_cvt_pk_bf16_f32 v250, v244, v245
v_cvt_pk_bf16_f32 v251, v246, v247
ds_write_b128 v253, v[248:251] offset:14848
s_waitcnt lgkmcnt(2)
buffer_store_dwordx4 v[20:23], v255, s[16:19], s37 offen offset:128 nt
s_add_u32 s37, s37, 16384
s_waitcnt lgkmcnt(1)
buffer_store_dwordx4 v[24:27], v255, s[16:19], s37 offen offset:128 nt
s_add_u32 s37, s37, 16384
ds_read_b128 v[4:7], v0 offset:14336
ds_read_b128 v[8:11], v0 offset:15360
s_waitcnt lgkmcnt(1)
buffer_store_dwordx4 v[4:7], v255, s[16:19], s37 offen offset:128 nt
s_add_u32 s37, s37, 16384
s_waitcnt lgkmcnt(0)
buffer_store_dwordx4 v[8:11], v255, s[16:19], s37 offen offset:128 nt
s_add_u32 s37, s37, 4294721536
L_done:
s_endpgm
L_spinAdbg:
s_sleep 16
buffer_load_dword v244, off, s[60:63], s3 offset:0 sc1
s_waitcnt vmcnt(0)
s_add_u32 s49, s49, 1
v_cmp_le_u32 vcc, 4, v244
s_nop 4
s_cmp_eq_u64 vcc, -1
s_cbranch_scc1 L_retAdbg
s_cmp_lt_u32 s49, 0x40000
s_cbranch_scc1 L_spinAdbg
s_branch L_retAdbg
L_spinAdbgB:
s_sleep 16
buffer_load_dword v244, off, s[60:63], s3 offset:128 sc1
s_waitcnt vmcnt(0)
s_add_u32 s49, s49, 1
v_cmp_le_u32 vcc, 28, v244
s_nop 4
s_cmp_eq_u64 vcc, -1
s_cbranch_scc1 L_retAdbgB
s_cmp_lt_u32 s49, 0x40000
s_cbranch_scc1 L_spinAdbgB
s_branch L_retAdbgB
L_spinAdbg2:
s_sleep 16
buffer_load_dword v244, off, s[60:63], s67 offset:128 sc1
s_waitcnt vmcnt(0)
s_add_u32 s49, s49, 1
v_cmp_le_u32 vcc, 28, v244
s_nop 4
s_cmp_eq_u64 vcc, -1
s_cbranch_scc1 L_retAdbg2
s_cmp_lt_u32 s49, 0x40000
s_cbranch_scc1 L_spinAdbg2
s_branch L_retAdbg2
L_spinAdbg3:
s_sleep 16
buffer_load_dword v244, off, s[60:63], s67 offset:0 sc1
s_waitcnt vmcnt(0)
s_add_u32 s49, s49, 1
v_cmp_le_u32 vcc, 4, v244
s_nop 4
s_cmp_eq_u64 vcc, -1
s_cbranch_scc1 L_retAdbg3
s_cmp_lt_u32 s49, 0x40000
s_cbranch_scc1 L_spinAdbg3
s_branch L_retAdbg3
L_spinAwf:
s_sleep 4
buffer_load_dwordx4 v[244:247], v248, s[8:11], s51 offen sc1
s_waitcnt vmcnt(0)
s_add_u32 s49, s49, 1
v_min_u32 v244, v244, v245
s_nop 4
v_min3_u32 v244, v244, v246, v247
s_nop 4
v_cmp_lt_u32 vcc, s22, v244
s_nop 4
s_cmp_eq_u64 vcc, -1
s_cbranch_scc1 L_retAwf
s_cmp_lt_u32 s49, 0x40000
s_cbranch_scc1 L_spinAwf
s_branch L_retAwf
L_spinBx0:
s_sleep 4
buffer_load_dword a255, v254, s[60:63], 0 offen sc1
s_waitcnt vmcnt(0)
s_add_u32 s49, s49, 1
v_accvgpr_read_b32 v249, a255
s_nop 4
v_cmp_le_u32 vcc, s35, v249
s_nop 4
s_and_b32 s42, vcc_lo, 15
s_cmp_eq_u32 s42, 15
s_cbranch_scc1 L_retBx0
s_cmp_lt_u32 s49, 0x40000
s_cbranch_scc1 L_spinBx0
s_branch L_retBx0
L_spinBx1:
s_sleep 4
buffer_load_dword a255, v254, s[60:63], 0 offen sc1
s_waitcnt vmcnt(0)
s_add_u32 s49, s49, 1
v_accvgpr_read_b32 v249, a255
s_nop 4
v_cmp_le_u32 vcc, s35, v249
s_nop 4
s_and_b32 s42, vcc_lo, 15
s_cmp_eq_u32 s42, 15
s_cbranch_scc1 L_retBx1
s_cmp_lt_u32 s49, 0x40000
s_cbranch_scc1 L_spinBx1
s_branch L_retBx1
L_spinBx2:
s_sleep 4
buffer_load_dword a255, v254, s[60:63], 0 offen sc1
s_waitcnt vmcnt(0)
s_add_u32 s49, s49, 1
v_accvgpr_read_b32 v249, a255
s_nop 4
v_cmp_le_u32 vcc, s35, v249
s_nop 4
s_and_b32 s42, vcc_lo, 15
s_cmp_eq_u32 s42, 15
s_cbranch_scc1 L_retBx2
s_cmp_lt_u32 s49, 0x40000
s_cbranch_scc1 L_spinBx2
s_branch L_retBx2
L_spinBx3:
s_sleep 4
buffer_load_dword a255, v254, s[60:63], 0 offen sc1
s_waitcnt vmcnt(0)
s_add_u32 s49, s49, 1
v_accvgpr_read_b32 v249, a255
s_nop 4
v_cmp_le_u32 vcc, s35, v249
s_nop 4
s_and_b32 s42, vcc_lo, 15
s_cmp_eq_u32 s42, 15
s_cbranch_scc1 L_retBx3
s_cmp_lt_u32 s49, 0x40000
s_cbranch_scc1 L_spinBx3
s_branch L_retBx3
L_spinBwf:
s_sleep 4
buffer_load_dwordx4 v[244:247], v248, s[8:11], s51 offen sc1
s_waitcnt vmcnt(0)
s_add_u32 s49, s49, 1
v_min_u32 v244, v244, v245
s_nop 4
v_min3_u32 v244, v244, v246, v247
s_nop 4
v_cmp_lt_u32 vcc, s22, v244
s_nop 4
s_cmp_eq_u64 vcc, -1
s_cbranch_scc1 L_retBwf
s_cmp_lt_u32 s49, 0x40000
s_cbranch_scc1 L_spinBwf
s_branch L_retBwf
L_codeend:
.section .rodata,"a"
.p2align 6
.amdhsa_kernel standalone__cross_network_dcn__recsys_kernel
  .amdhsa_next_free_vgpr 512
  .amdhsa_next_free_sgpr 102
  .amdhsa_accum_offset 256
  .amdhsa_group_segment_fixed_size 0
  .amdhsa_kernarg_size 48
  .amdhsa_user_sgpr_count 2
  .amdhsa_user_sgpr_kernarg_segment_ptr 1
  .amdhsa_system_sgpr_workgroup_id_x 1
  .amdhsa_float_denorm_mode_32 3
.end_amdhsa_kernel
```
